```python
import torch

def _softmax(x, axis=-1):
    return torch.softmax(x, dim=axis)
def _gelu(x):
    return torch.nn.functional.gelu(x, approximate="tanh")
def _silu(x):
    return torch.nn.functional.silu(x)
def _sigmoid(x):
    return torch.sigmoid(x)
def _layernorm(x, axis=-1, eps=1e-5):
    m = x.mean(dim=axis, keepdim=True)
    v = x.var(dim=axis, keepdim=True, unbiased=False)
    return (x - m) / torch.sqrt(v + eps)
def _scatter_add(tgt, idx, src, axis=0):
    return tgt.clone().index_add_(axis, idx, src)
def _segment_sum(src, seg, n):
    out = torch.zeros((n,) + src.shape[1:], dtype=src.dtype)
    return out.index_add_(0, seg, src)
def _pad(x, pw):
    flat = tuple(v for pair in reversed(pw) for v in pair)
    return torch.nn.functional.pad(x, flat)

kernel_name = 'standalone__gqa_softmax__near_ridge'

def setup_inputs():

    _w = (lambda a: (lambda t: t.to(torch.bfloat16) if t.is_floating_point() else t)(torch.as_tensor(a)))
    B, Hq, Hkv, Sq, Sk, D = 32, 32, 8, 192, 512, 128
    return {
        "q": _w((lambda *s: torch.randn(*s, dtype=torch.bfloat16) * 0.8)(B, Hq, Sq, D)),
        "k": _w((lambda *s: torch.randn(*s, dtype=torch.bfloat16) * 0.8)(B, Hkv, Sk, D)),
        "v": _w((lambda *s: torch.randn(*s, dtype=torch.bfloat16) * 0.05)(B, Hkv, Sk, D)),
    }

def reference(q, k, v):
    B, Hq, Sq, D = q.shape
    Hkv = k.shape[1]
    rep = Hq // Hkv
    k = (lambda x, n, axis: torch.repeat_interleave(x, n, dim=axis))(k, rep, axis=1)
    v = (lambda x, n, axis: torch.repeat_interleave(x, n, dim=axis))(v, rep, axis=1)
    scale = D ** -0.5
    scores = torch.einsum("bhqd,bhkd->bhqk", q, k) * scale
    p = _softmax(scores, axis=-1)
    return torch.einsum("bhqk,bhkd->bhqd", p, v)
```

```asm
; @launch grid=(256,1,1) block=(256,1,1) lds=163840
.amdgcn_target "amdgcn-amd-amdhsa--gfx950"
.text
.globl standalone__gqa_softmax__near_ridge_kernel
.p2align 8
.type standalone__gqa_softmax__near_ridge_kernel,@function
standalone__gqa_softmax__near_ridge_kernel:

    s_cmp_ge_u32 s2, 256
    s_cbranch_scc1 L_end
    s_load_dwordx4 s[64:67], s[0:1], 0
    s_load_dwordx4 s[68:71], s[0:1], 16
    v_lshrrev_b32 v1, 6, v0
    s_lshr_b32 s73, s2, 3
    s_getpc_b64 s[86:87]
L_pc:
    v_and_b32 v2, 7, v0
    v_lshl_add_u32 v2, v2, 2, v1
    v_lshlrev_b32 v2, 12, v2
    s_lshl_b32 s88, s73, 7
    v_add_u32 v2, s88, v2
    v_min_u32 v2, L_end-L_main+4096, v2
    s_and_b32 s86, s86, 0xfffff000
    v_readfirstlane_b32 s32, v1
    v_and_b32 v0, 63, v0
    global_load_dword v4, v2, s[86:87]
    s_and_b32 s72, s2, 7
    s_lshr_b32 s74, s73, 1
    s_and_b32 s75, s73, 1
    s_lshl_b32 s72, s72, 4
    s_add_u32 s72, s72, s74
    s_lshl_b32 s76, s72, 18
    s_mul_i32 s77, s72, 393216
    s_mul_i32 s78, s75, 98304
    s_add_u32 s77, s77, s78
    s_and_b32 s79, s32, 1
    s_lshr_b32 s80, s32, 1
    s_lshl_b32 s81, s79, 10
    s_lshl_b32 s82, s80, 12
    s_add_u32 s26, s81, s82
    s_lshl_b32 s81, s79, 7
    s_add_u32 s81, s81, s82
    s_mul_i32 s83, s32, 24576
    s_sub_u32 s27, s83, s81
    s_lshl_b32 s28, s32, 13
    v_lshrrev_b32 v1, 3, v0
    v_and_b32 v2, 6, v1
    v_and_b32 v3, 7, v0
    v_xor_b32 v2, v2, v3
    v_lshlrev_b32 v2, 4, v2
    v_lshl_add_u32 v2, v1, 8, v2
    v_add_u32 v54, s81, v2
    s_mov_b32 s10, 294912
    s_mov_b32 s11, 0x20000
    s_mov_b32 s14, 0x40000
    s_mov_b32 s15, 0x20000
    s_mov_b32 s18, 0x40000
    s_mov_b32 s19, 0x20000
    s_mov_b32 s22, 294912
    s_mov_b32 s23, 0x20000
    s_getreg_b32 s33, hwreg(HW_REG_XCC_ID, 0, 1)
    s_waitcnt lgkmcnt(0)
    s_add_u32 s8, s64, s77
    s_addc_u32 s9, s65, 0
    s_add_u32 s12, s66, s76
    s_addc_u32 s13, s67, 0
 s_add_u32 m0, s28, 131072
 s_add_u32 s30, s27, 0
 buffer_load_dwordx4 v54, s[8:11], s30 offen offset:0 nt lds
 buffer_load_dwordx4 v54, s[8:11], s30 offen offset:2048 nt lds
 s_addk_i32 m0, 896
 s_nop 0
 buffer_load_dwordx4 v54, s[8:11], s30 offen offset:128 nt lds
 buffer_load_dwordx4 v54, s[8:11], s30 offen offset:2176 nt lds
 s_add_u32 m0, s26, 0
 s_mov_b32 s29, 0
 buffer_load_dwordx4 v54, s[12:15], s29 offen offset:0 nt lds
 buffer_load_dwordx4 v54, s[12:15], s29 offen offset:2048 nt lds
    s_cmp_eq_u32 s33, 0
    s_cbranch_scc1 L_thr0
 s_add_u32 m0, s28, 135168
 s_add_u32 s30, s27, 4096
 buffer_load_dwordx4 v54, s[8:11], s30 offen offset:0 nt lds
 buffer_load_dwordx4 v54, s[8:11], s30 offen offset:2048 nt lds
 s_addk_i32 m0, 896
 s_nop 0
 buffer_load_dwordx4 v54, s[8:11], s30 offen offset:128 nt lds
 buffer_load_dwordx4 v54, s[8:11], s30 offen offset:2176 nt lds
 s_add_u32 m0, s26, 8192
 s_mov_b32 s29, 8192
 buffer_load_dwordx4 v54, s[12:15], s29 offen offset:0 nt lds
 buffer_load_dwordx4 v54, s[12:15], s29 offen offset:2048 nt lds
L_thr0:

    s_add_u32 s16, s68, s76
    s_addc_u32 s17, s69, 0
    s_add_u32 s20, s70, s77
    s_addc_u32 s21, s71, 0
    s_mov_b32 s24, 0x3e0293ee
    s_mov_b32 s25, 0x5f800000
    s_mov_b32 s7, 0xffff0000
    s_add_u32 s84, s28, 131072
    v_xor_b32 v2, v1, v3
    v_lshlrev_b32 v2, 4, v2
    v_lshl_add_u32 v2, v1, 8, v2
    v_add_u32 v58, s83, v2
    v_lshl_add_u32 v59, v0, 4, s84
    v_and_b32 v1, 15, v0
    v_lshrrev_b32 v2, 4, v0
    v_lshlrev_b32 v40, 2, v1
    v_and_b32 v5, 7, v1
    v_lshlrev_b32 v6, 7, v5
    v_lshrrev_b32 v7, 3, v1
    v_lshl_add_u32 v6, v7, 11, v6
    v_and_b32 v3, 6, v1
    v_xor_b32 v3, v3, v2
    v_lshl_add_u32 v46, v3, 4, v6
    v_xor_b32 v47, 64, v46
    v_add_u32 v52, s84, v46
    v_add_u32 v53, s84, v47
    v_lshrrev_b32 v3, 1, v2
    v_xor_b32 v3, v3, v5
    v_lshl_add_u32 v3, v3, 4, v6
    v_and_b32 v2, 1, v2
    v_xor_b32 v2, v2, v7
    v_lshl_add_u32 v3, v2, 3, v3
    v_add_u32 v56, s84, v3
    v_xor_b32 v57, 32, v56
    v_lshrrev_b32 v1, 2, v0
    v_and_b32 v2, 6, v1
    v_bfe_u32 v3, v0, 1, 1
    v_xor_b32 v2, v2, v3
    v_lshlrev_b32 v2, 4, v2
    v_and_b32 v3, 1, v0
    v_lshl_add_u32 v2, v3, 3, v2
    v_and_b32 v3, 7, v1
    v_lshl_add_u32 v2, v3, 7, v2
    v_lshrrev_b32 v3, 3, v1
    v_lshl_add_u32 v2, v3, 11, v2
    v_add_u32 v48, 65536, v2
    v_xor_b32 v49, 32, v48
    v_xor_b32 v50, 64, v48
    v_xor_b32 v51, 0x60, v48
    v_mov_b32 v1, 0x3f803f80
    v_bfe_u32 v2, v0, 1, 1
    v_lshrrev_b32 v3, 5, v0
    v_cmp_eq_u32 vcc, v2, v3
    v_and_b32 v5, 3, v0
    v_mov_b32 v6, 0x4444
    v_cndmask_b32 v2, 0, v1, vcc
    v_cmp_eq_u32 vcc, 0, v5
    v_accvgpr_write_b32 a236, v2
    v_accvgpr_write_b32 a237, v2
    v_cndmask_b32 v3, 0, v1, vcc
    v_cmp_eq_u32 vcc, 2, v5
    v_accvgpr_write_b32 a238, v2
    v_accvgpr_write_b32 a239, v2
    v_cndmask_b32 v2, 0, v1, vcc
    v_and_b32 v5, 1, v0
    v_mul_u32_u24 v5, 0xaaaa, v5
    v_add_u32 v55, v5, v6
    v_accvgpr_write_b32 a240, v3
    v_accvgpr_write_b32 a241, v3
    v_accvgpr_write_b32 a242, v3
    v_accvgpr_write_b32 a243, v3
    v_accvgpr_write_b32 a244, v2
    v_accvgpr_write_b32 a245, v2
    v_accvgpr_write_b32 a246, v2
    v_accvgpr_write_b32 a247, v2
    v_accvgpr_write_b32 a248, v56
    v_accvgpr_write_b32 a249, v57
    v_accvgpr_write_b32 a250, v58
    v_accvgpr_write_b32 a251, v59
    s_waitcnt vmcnt(12)
    s_cmp_eq_u32 s33, 0
    s_cbranch_scc0 L_thr1
    s_waitcnt vmcnt(6)
L_thr1:
 s_mov_b64 vcc, -1
 s_cmp_eq_u32 s32, 0
 s_cbranch_scc1 L_stub0
 s_cmp_eq_u32 s32, 1
 s_cbranch_scc1 L_stub1
 s_cmp_eq_u32 s32, 2
 s_cbranch_scc1 L_stub2
 s_cmp_eq_u32 s32, 3
 s_cbranch_scc1 L_stub3
L_back0:
 s_mov_b64 vcc, 0
    s_cmp_eq_u32 s33, 0
    s_cbranch_scc0 L_pre
 s_add_u32 m0, s28, 135168
 s_add_u32 s30, s27, 4096
 s_waitcnt vmcnt(4)
 buffer_load_dwordx4 v54, s[8:11], s30 offen offset:0 nt lds
 buffer_load_dwordx4 v54, s[8:11], s30 offen offset:2048 nt lds
 s_addk_i32 m0, 896
 s_nop 0
 s_waitcnt vmcnt(4)
 buffer_load_dwordx4 v54, s[8:11], s30 offen offset:128 nt lds
 buffer_load_dwordx4 v54, s[8:11], s30 offen offset:2176 nt lds
 s_add_u32 m0, s26, 8192
 s_mov_b32 s29, 8192
 s_waitcnt vmcnt(4)
 buffer_load_dwordx4 v54, s[12:15], s29 offen offset:0 nt lds
 buffer_load_dwordx4 v54, s[12:15], s29 offen offset:2048 nt lds
L_pre:
 s_waitcnt vmcnt(8)
 ds_read_b128 v[224:227], v52 offset:0
 ds_read_b128 v[228:231], v53 offset:0
 ds_read_b128 v[232:235], v52 offset:1024
 ds_read_b128 v[236:239], v53 offset:1024
 s_add_u32 m0, s26, 65536
 s_mov_b32 s29, 0
 buffer_load_dwordx4 v54, s[16:19], s29 offen offset:0 nt lds
 buffer_load_dwordx4 v54, s[16:19], s29 offen offset:2048 nt lds
 s_add_u32 m0, s26, 73728
 s_mov_b32 s29, 8192
 buffer_load_dwordx4 v54, s[16:19], s29 offen offset:0 nt lds
 buffer_load_dwordx4 v54, s[16:19], s29 offen offset:2048 nt lds
 s_waitcnt lgkmcnt(3)
 v_lshlrev_b32 v192, 16, v224
 v_and_b32 v193, s7, v224
 v_lshlrev_b32 v194, 16, v225
 v_and_b32 v195, s7, v225
 v_lshlrev_b32 v196, 16, v226
 v_and_b32 v197, s7, v226
 v_lshlrev_b32 v198, 16, v227
 v_and_b32 v199, s7, v227
 s_waitcnt lgkmcnt(2)
 v_lshlrev_b32 v200, 16, v228
 v_and_b32 v201, s7, v228
 v_lshlrev_b32 v202, 16, v229
 v_and_b32 v203, s7, v229
 v_lshlrev_b32 v204, 16, v230
 v_and_b32 v205, s7, v230
 v_lshlrev_b32 v206, 16, v231
 v_and_b32 v207, s7, v231
 s_waitcnt lgkmcnt(1)
 v_lshlrev_b32 v208, 16, v232
 v_and_b32 v209, s7, v232
 v_lshlrev_b32 v210, 16, v233
 v_and_b32 v211, s7, v233
 v_lshlrev_b32 v212, 16, v234
 v_and_b32 v213, s7, v234
 v_lshlrev_b32 v214, 16, v235
 v_and_b32 v215, s7, v235
 s_waitcnt lgkmcnt(0)
 v_lshlrev_b32 v216, 16, v236
 v_and_b32 v217, s7, v236
 v_lshlrev_b32 v218, 16, v237
 v_and_b32 v219, s7, v237
 v_lshlrev_b32 v220, 16, v238
 v_and_b32 v221, s7, v238
 v_lshlrev_b32 v222, 16, v239
 v_and_b32 v223, s7, v239
 v_pk_mul_f32 v[192:193], v[192:193], s[24:25] op_sel_hi:[1,0]
 v_cvt_pk_bf16_f32 v224, v192, v193
 v_accvgpr_write_b32 a0, v224
 v_pk_mul_f32 v[194:195], v[194:195], s[24:25] op_sel_hi:[1,0]
 v_cvt_pk_bf16_f32 v225, v194, v195
 v_accvgpr_write_b32 a1, v225
 v_pk_mul_f32 v[196:197], v[196:197], s[24:25] op_sel_hi:[1,0]
 v_cvt_pk_bf16_f32 v226, v196, v197
 v_accvgpr_write_b32 a2, v226
 v_pk_mul_f32 v[198:199], v[198:199], s[24:25] op_sel_hi:[1,0]
 v_cvt_pk_bf16_f32 v227, v198, v199
 v_accvgpr_write_b32 a3, v227
 v_pk_mul_f32 v[200:201], v[200:201], s[24:25] op_sel_hi:[1,0]
 v_cvt_pk_bf16_f32 v228, v200, v201
 v_accvgpr_write_b32 a4, v228
 v_pk_mul_f32 v[202:203], v[202:203], s[24:25] op_sel_hi:[1,0]
 v_cvt_pk_bf16_f32 v229, v202, v203
 v_accvgpr_write_b32 a5, v229
 v_pk_mul_f32 v[204:205], v[204:205], s[24:25] op_sel_hi:[1,0]
 v_cvt_pk_bf16_f32 v230, v204, v205
 v_accvgpr_write_b32 a6, v230
 v_pk_mul_f32 v[206:207], v[206:207], s[24:25] op_sel_hi:[1,0]
 v_cvt_pk_bf16_f32 v231, v206, v207
 v_accvgpr_write_b32 a7, v231
 v_pk_mul_f32 v[208:209], v[208:209], s[24:25] op_sel_hi:[1,0]
 v_cvt_pk_bf16_f32 v232, v208, v209
 v_accvgpr_write_b32 a8, v232
 v_pk_mul_f32 v[210:211], v[210:211], s[24:25] op_sel_hi:[1,0]
 v_cvt_pk_bf16_f32 v233, v210, v211
 v_accvgpr_write_b32 a9, v233
 v_pk_mul_f32 v[212:213], v[212:213], s[24:25] op_sel_hi:[1,0]
 v_cvt_pk_bf16_f32 v234, v212, v213
 v_accvgpr_write_b32 a10, v234
 v_pk_mul_f32 v[214:215], v[214:215], s[24:25] op_sel_hi:[1,0]
 v_cvt_pk_bf16_f32 v235, v214, v215
 v_accvgpr_write_b32 a11, v235
 v_pk_mul_f32 v[216:217], v[216:217], s[24:25] op_sel_hi:[1,0]
 v_cvt_pk_bf16_f32 v236, v216, v217
 v_accvgpr_write_b32 a12, v236
 v_pk_mul_f32 v[218:219], v[218:219], s[24:25] op_sel_hi:[1,0]
 v_cvt_pk_bf16_f32 v237, v218, v219
 v_accvgpr_write_b32 a13, v237
 v_pk_mul_f32 v[220:221], v[220:221], s[24:25] op_sel_hi:[1,0]
 v_cvt_pk_bf16_f32 v238, v220, v221
 v_accvgpr_write_b32 a14, v238
 v_pk_mul_f32 v[222:223], v[222:223], s[24:25] op_sel_hi:[1,0]
 v_cvt_pk_bf16_f32 v239, v222, v223
 v_accvgpr_write_b32 a15, v239
 s_waitcnt vmcnt(10)
 s_barrier
 ds_read_b128 a[160:163], v46 offset:0
 ds_read_b128 a[164:167], v47 offset:0
 ds_read_b128 a[168:171], v46 offset:1024
 ds_read_b128 a[172:175], v47 offset:1024
 ds_read_b128 a[188:191], v47 offset:5120
 ds_read_b128 a[184:187], v46 offset:5120
 ds_read_b128 a[180:183], v47 offset:4096
 ds_read_b128 a[176:179], v46 offset:4096
 s_waitcnt vmcnt(6)
 ds_read_b128 v[240:243], v52 offset:4096
 ds_read_b128 v[244:247], v53 offset:4096
 ds_read_b128 v[248:251], v52 offset:5120
 ds_read_b128 v[252:255], v53 offset:5120
 s_add_u32 m0, s26, 16384
 s_mov_b32 s29, 16384
 buffer_load_dwordx4 v54, s[12:15], s29 offen offset:0 nt lds
 buffer_load_dwordx4 v54, s[12:15], s29 offen offset:2048 nt lds
 s_add_u32 m0, s26, 81920
 s_nop 0
 buffer_load_dwordx4 v54, s[16:19], s29 offen offset:0 nt lds
 buffer_load_dwordx4 v54, s[16:19], s29 offen offset:2048 nt lds
 s_waitcnt lgkmcnt(3)
 v_lshlrev_b32 v192, 16, v240
 v_and_b32 v193, s7, v240
 v_lshlrev_b32 v194, 16, v241
 v_and_b32 v195, s7, v241
 v_lshlrev_b32 v196, 16, v242
 v_and_b32 v197, s7, v242
 v_lshlrev_b32 v198, 16, v243
 v_and_b32 v199, s7, v243
 s_waitcnt lgkmcnt(2)
 v_lshlrev_b32 v200, 16, v244
 v_and_b32 v201, s7, v244
 v_lshlrev_b32 v202, 16, v245
 v_and_b32 v203, s7, v245
 v_lshlrev_b32 v204, 16, v246
 v_and_b32 v205, s7, v246
 v_lshlrev_b32 v206, 16, v247
 v_and_b32 v207, s7, v247
 s_waitcnt lgkmcnt(1)
 v_lshlrev_b32 v208, 16, v248
 v_and_b32 v209, s7, v248
 v_lshlrev_b32 v210, 16, v249
 v_and_b32 v211, s7, v249
 v_lshlrev_b32 v212, 16, v250
 v_and_b32 v213, s7, v250
 v_lshlrev_b32 v214, 16, v251
 v_and_b32 v215, s7, v251
 s_waitcnt lgkmcnt(0)
 v_lshlrev_b32 v216, 16, v252
 v_and_b32 v217, s7, v252
 v_lshlrev_b32 v218, 16, v253
 v_and_b32 v219, s7, v253
 v_lshlrev_b32 v220, 16, v254
 v_and_b32 v221, s7, v254
 v_lshlrev_b32 v222, 16, v255
 v_and_b32 v223, s7, v255
 v_pk_mul_f32 v[192:193], v[192:193], s[24:25] op_sel_hi:[1,0]
 v_cvt_pk_bf16_f32 v240, v192, v193
 v_accvgpr_write_b32 a16, v240
 v_pk_mul_f32 v[194:195], v[194:195], s[24:25] op_sel_hi:[1,0]
 v_cvt_pk_bf16_f32 v241, v194, v195
 v_accvgpr_write_b32 a17, v241
 v_pk_mul_f32 v[196:197], v[196:197], s[24:25] op_sel_hi:[1,0]
 v_cvt_pk_bf16_f32 v242, v196, v197
 v_accvgpr_write_b32 a18, v242
 v_pk_mul_f32 v[198:199], v[198:199], s[24:25] op_sel_hi:[1,0]
 v_cvt_pk_bf16_f32 v243, v198, v199
 v_accvgpr_write_b32 a19, v243
 v_pk_mul_f32 v[200:201], v[200:201], s[24:25] op_sel_hi:[1,0]
 v_cvt_pk_bf16_f32 v244, v200, v201
 v_accvgpr_write_b32 a20, v244
 v_pk_mul_f32 v[202:203], v[202:203], s[24:25] op_sel_hi:[1,0]
 v_cvt_pk_bf16_f32 v245, v202, v203
 v_accvgpr_write_b32 a21, v245
 v_pk_mul_f32 v[204:205], v[204:205], s[24:25] op_sel_hi:[1,0]
 v_cvt_pk_bf16_f32 v246, v204, v205
 v_accvgpr_write_b32 a22, v246
 v_pk_mul_f32 v[206:207], v[206:207], s[24:25] op_sel_hi:[1,0]
 v_cvt_pk_bf16_f32 v247, v206, v207
 v_accvgpr_write_b32 a23, v247
 v_pk_mul_f32 v[208:209], v[208:209], s[24:25] op_sel_hi:[1,0]
 v_cvt_pk_bf16_f32 v248, v208, v209
 v_accvgpr_write_b32 a24, v248
 v_pk_mul_f32 v[210:211], v[210:211], s[24:25] op_sel_hi:[1,0]
 v_cvt_pk_bf16_f32 v249, v210, v211
 v_accvgpr_write_b32 a25, v249
 v_pk_mul_f32 v[212:213], v[212:213], s[24:25] op_sel_hi:[1,0]
 v_cvt_pk_bf16_f32 v250, v212, v213
 v_accvgpr_write_b32 a26, v250
 v_pk_mul_f32 v[214:215], v[214:215], s[24:25] op_sel_hi:[1,0]
 v_cvt_pk_bf16_f32 v251, v214, v215
 v_accvgpr_write_b32 a27, v251
 v_pk_mul_f32 v[216:217], v[216:217], s[24:25] op_sel_hi:[1,0]
 v_cvt_pk_bf16_f32 v252, v216, v217
 v_accvgpr_write_b32 a28, v252
 v_pk_mul_f32 v[218:219], v[218:219], s[24:25] op_sel_hi:[1,0]
 v_cvt_pk_bf16_f32 v253, v218, v219
 v_accvgpr_write_b32 a29, v253
 v_pk_mul_f32 v[220:221], v[220:221], s[24:25] op_sel_hi:[1,0]
 v_cvt_pk_bf16_f32 v254, v220, v221
 v_accvgpr_write_b32 a30, v254
 v_pk_mul_f32 v[222:223], v[222:223], s[24:25] op_sel_hi:[1,0]
 v_cvt_pk_bf16_f32 v255, v222, v223
 v_accvgpr_write_b32 a31, v255
 v_mfma_f32_16x16x32_bf16 v[0:3], a[160:163], a[0:3], 0
 s_add_u32 m0, s28, 131072
 v_accvgpr_write_b32 a224, 0
 v_accvgpr_write_b32 a225, 0
 v_mfma_f32_16x16x32_bf16 v[0:3], a[164:167], a[4:7], v[0:3]
 s_add_u32 s30, s27, 8192
 v_accvgpr_write_b32 a226, 0
 v_accvgpr_write_b32 a227, 0
 v_mfma_f32_16x16x32_bf16 v[0:3], a[168:171], a[8:11], v[0:3]
 s_addk_i32 s29, 8192
 v_accvgpr_write_b32 a228, 0
 v_accvgpr_write_b32 a229, 0
 v_mfma_f32_16x16x32_bf16 v[0:3], a[172:175], a[12:15], v[0:3]
 s_mov_b32 s31, 0
 v_accvgpr_write_b32 a230, 0
 v_accvgpr_write_b32 a231, 0
 v_mfma_f32_16x16x32_bf16 v[4:7], a[188:191], a[12:15], 0
 v_accvgpr_write_b32 a232, 0
 v_accvgpr_write_b32 a233, 0
 v_mfma_f32_16x16x32_bf16 v[4:7], a[184:187], a[8:11], v[4:7]
 v_accvgpr_write_b32 a234, 0
 v_max3_f32 v56, v0, v1, v2
 v_max_f32 v56, v56, v3
 v_mfma_f32_16x16x32_bf16 v[4:7], a[180:183], a[4:7], v[4:7]
 s_waitcnt vmcnt(6)
 ds_bpermute_b32 v56, v40, v56
 v_accvgpr_write_b32 a235, 0
 v_mfma_f32_16x16x32_bf16 v[4:7], a[176:179], a[0:3], v[4:7]
 s_barrier
 buffer_load_dwordx4 v54, s[8:11], s30 offen offset:0 nt lds
 v_mfma_f32_16x16x32_bf16 v[8:11], a[160:163], a[16:19], 0
 ds_read_b128 a[160:163], v46 offset:8192
 v_mfma_f32_16x16x32_bf16 v[8:11], a[164:167], a[20:23], v[8:11]
 buffer_load_dwordx4 v54, s[8:11], s30 offen offset:2048 nt lds
 s_addk_i32 m0, 896
 v_mfma_f32_16x16x32_bf16 v[8:11], a[168:171], a[24:27], v[8:11]
 ds_read_b128 a[164:167], v47 offset:8192
 ds_read_b128 a[168:171], v46 offset:9216
 v_mfma_f32_16x16x32_bf16 v[8:11], a[172:175], a[28:31], v[8:11]
 s_waitcnt lgkmcnt(3)
 buffer_load_dwordx4 v54, s[8:11], s30 offen offset:128 nt lds
 v_xor_b32 v56, 0x80000000, v56
 v_add_f32 v0, v0, v56
 v_add_f32 v1, v1, v56
 v_exp_f32 v0, v0
 v_mfma_f32_16x16x32_bf16 v[12:15], a[188:191], a[28:31], 0
 buffer_load_dwordx4 v54, s[8:11], s30 offen offset:2176 nt lds
 v_exp_f32 v1, v1
 v_mfma_f32_16x16x32_bf16 v[12:15], a[184:187], a[24:27], v[12:15]
 s_add_u32 m0, s28, 135168
 ds_read_b128 a[172:175], v47 offset:9216
 ds_read_b128 a[188:191], v47 offset:13312
 ds_read_b128 a[184:187], v46 offset:13312
 v_cvt_pk_bf16_f32 v24, v0, v1
 v_add_f32 v2, v2, v56
 v_mfma_f32_16x16x32_bf16 v[12:15], a[180:183], a[20:23], v[12:15]
 s_addk_i32 s30, 4096
 ds_read_b128 a[180:183], v47 offset:12288
 v_mov_b32 v57, v56
 v_mov_b32 v58, v56
 v_mov_b32 v59, v56
 v_add_f32 v3, v3, v56
 v_exp_f32 v2, v2
 v_mfma_f32_16x16x32_bf16 v[12:15], a[176:179], a[16:19], v[12:15]
 s_waitcnt lgkmcnt(6)
 ds_read_b128 a[176:179], v46 offset:12288
 ds_read_b64_tr_b16 a[192:193], v48 offset:0
 ds_read_b64_tr_b16 a[194:195], v48 offset:4096
 v_exp_f32 v3, v3
 v_mfma_f32_16x16x32_bf16 v[16:19], a[160:163], a[0:3], v[56:59]
 s_waitcnt lgkmcnt(8)
 buffer_load_dwordx4 v54, s[8:11], s30 offen offset:0 nt lds
 v_cvt_pk_bf16_f32 v25, v2, v3
 v_add_f32 v4, v4, v56
 v_mfma_f32_16x16x32_bf16 v[16:19], a[164:167], a[4:7], v[16:19]
 s_waitcnt lgkmcnt(7)
 ds_read_b64_tr_b16 a[196:197], v49 offset:0
 ds_read_b64_tr_b16 a[198:199], v49 offset:4096
 ds_read_b64_tr_b16 a[200:201], v50 offset:0
 v_add_f32 v5, v5, v56
 v_exp_f32 v4, v4
 v_max3_f32 v60, v8, v9, v10
    s_branch L_main
.p2align 12
L_main:
L_stub0:
 s_cbranch_vccnz L_stub4
.if ((L_stub0-L_main)>>6) != 0
.error "stub misplaced"
.endif
 v_mfma_f32_16x16x32_bf16 v[16:19], a[168:171], a[8:11], v[16:19]
 s_waitcnt lgkmcnt(9)
 buffer_load_dwordx4 v54, s[8:11], s30 offen offset:2048 nt lds
 v_exp_f32 v5, v5
 v_max_f32 v60, v60, v11
 s_addk_i32 m0, 896
 v_mfma_f32_16x16x32_bf16 v[16:19], a[172:175], a[12:15], v[16:19]
 s_waitcnt lgkmcnt(8)
 ds_read_b64_tr_b16 a[202:203], v50 offset:4096
 ds_read_b64_tr_b16 a[204:205], v51 offset:0
 ds_read_b64_tr_b16 a[206:207], v51 offset:4096
 v_cvt_pk_bf16_f32 v26, v4, v5
 v_add_f32 v6, v6, v56
 v_mfma_f32_16x16x32_bf16 v[20:23], a[188:191], a[12:15], v[56:59]
 s_waitcnt lgkmcnt(10)
 buffer_load_dwordx4 v54, s[8:11], s30 offen offset:128 nt lds
 v_add_f32 v7, v7, v56
 v_exp_f32 v6, v6
 v_mfma_f32_16x16x32_bf16 v[20:23], a[184:187], a[8:11], v[20:23]
 s_waitcnt lgkmcnt(6)
 buffer_load_dwordx4 v54, s[8:11], s30 offen offset:2176 nt lds
 v_exp_f32 v7, v7
 v_mfma_f32_16x16x32_bf16 v[20:23], a[180:183], a[4:7], v[20:23]
 s_add_u32 m0, s26, 24576
 ds_bpermute_b32 v60, v40, v60
 ds_read_b64_tr_b16 a[208:209], v48 offset:1024
 ds_read_b64_tr_b16 a[210:211], v48 offset:5120
 v_cvt_pk_bf16_f32 v27, v6, v7
 v_mfma_f32_16x16x32_bf16 v[20:23], a[176:179], a[0:3], v[20:23]
 s_addk_i32 s30, 4096
 ds_read_b64_tr_b16 a[212:213], v49 offset:1024
 ds_read_b64_tr_b16 a[214:215], v49 offset:5120
 ds_read_b64_tr_b16 a[216:217], v50 offset:1024
 v_mfma_f32_16x16x32_bf16 v[64:67], a[192:195], v[24:27], 0
 s_waitcnt lgkmcnt(9)
 ds_read_b64_tr_b16 a[218:219], v50 offset:5120
 ds_read_b64_tr_b16 a[220:221], v51 offset:1024
 ds_read_b64_tr_b16 a[222:223], v51 offset:5120
 v_mfma_f32_16x16x32_bf16 v[68:71], a[196:199], v[24:27], 0
 s_waitcnt lgkmcnt(11)
 v_exp_f32 v16, v16
 v_mfma_f32_16x16x32_bf16 v[72:75], a[200:203], v[24:27], 0
 s_waitcnt lgkmcnt(9)
 v_exp_f32 v17, v17
 v_mfma_f32_16x16x32_bf16 v[76:79], a[204:207], v[24:27], 0
 s_waitcnt lgkmcnt(6)
 v_xor_b32 v60, 0x80000000, v60
 v_add_f32 v8, v8, v60
 v_add_f32 v9, v9, v60
 v_exp_f32 v8, v8
 v_mfma_f32_16x16x32_bf16 v[80:83], a[208:211], v[24:27], 0
 s_waitcnt lgkmcnt(4)
 v_exp_f32 v9, v9
 v_mfma_f32_16x16x32_bf16 v[84:87], a[212:215], v[24:27], 0
 s_waitcnt lgkmcnt(2)
 v_cvt_pk_bf16_f32 v28, v8, v9
 v_add_f32 v10, v10, v60
 v_mfma_f32_16x16x32_bf16 v[88:91], a[216:219], v[24:27], 0
 s_waitcnt vmcnt(8) lgkmcnt(0)
 v_mov_b32 v61, v60
 v_mov_b32 v62, v60
 v_mov_b32 v63, v60
 v_add_f32 v11, v11, v60
 v_exp_f32 v10, v10
 v_mfma_f32_16x16x32_bf16 v[92:95], a[220:223], v[24:27], 0
 s_barrier
 v_exp_f32 v11, v11
 v_mfma_f32_16x16x32_bf16 v[0:3], a[160:163], a[16:19], v[60:63]
 v_cvt_pk_bf16_f32 v29, v10, v11
 v_add_f32 v12, v12, v60
 v_mfma_f32_16x16x32_bf16 v[0:3], a[164:167], a[20:23], v[0:3]
 v_add_f32 v13, v13, v60
 v_exp_f32 v12, v12
 v_mfma_f32_16x16x32_bf16 v[0:3], a[168:171], a[24:27], v[0:3]
 v_exp_f32 v13, v13
 v_mfma_f32_16x16x32_bf16 v[0:3], a[172:175], a[28:31], v[0:3]
 v_cvt_pk_bf16_f32 v30, v12, v13
 v_add_f32 v14, v14, v60
 v_mfma_f32_16x16x32_bf16 v[4:7], a[188:191], a[28:31], v[60:63]
 v_add_f32 v15, v15, v60
 v_exp_f32 v14, v14
 v_mfma_f32_16x16x32_bf16 v[4:7], a[184:187], a[24:27], v[4:7]
 v_exp_f32 v15, v15
 v_mfma_f32_16x16x32_bf16 v[4:7], a[180:183], a[20:23], v[4:7]
 v_cvt_pk_bf16_f32 v31, v14, v15
 v_cvt_pk_bf16_f32 v32, v16, v17
 v_mfma_f32_16x16x32_bf16 v[4:7], a[176:179], a[16:19], v[4:7]
 v_exp_f32 v18, v18
 v_smfmac_f32_16x16x64_bf16 a[224:227], a[236:239], v[24:31], v55
 ds_read_b128 a[160:163], v46 offset:16384
 v_mfma_f32_16x16x32_bf16 v[96:99], a[192:195], v[28:31], 0
 ds_read_b128 a[164:167], v47 offset:16384
 v_mfma_f32_16x16x32_bf16 v[100:103], a[196:199], v[28:31], 0
 ds_read_b128 a[168:171], v46 offset:17408
 v_mfma_f32_16x16x32_bf16 v[104:107], a[200:203], v[28:31], 0
 ds_read_b128 a[172:175], v47 offset:17408
 v_mfma_f32_16x16x32_bf16 v[108:111], a[204:207], v[28:31], 0
 ds_read_b128 a[188:191], v47 offset:21504
 v_mfma_f32_16x16x32_bf16 v[112:115], a[208:211], v[28:31], 0
 ds_read_b128 a[184:187], v46 offset:21504
 v_mfma_f32_16x16x32_bf16 v[116:119], a[212:215], v[28:31], 0
 ds_read_b128 a[180:183], v47 offset:20480
 v_mfma_f32_16x16x32_bf16 v[120:123], a[216:219], v[28:31], 0
 ds_read_b128 a[176:179], v46 offset:20480
 v_mfma_f32_16x16x32_bf16 v[124:127], a[220:223], v[28:31], 0
 s_waitcnt lgkmcnt(6)
 ds_read_b64_tr_b16 a[192:193], v48 offset:8192
 ds_read_b64_tr_b16 a[194:195], v48 offset:12288
 v_exp_f32 v19, v19
 v_mfma_f32_16x16x32_bf16 v[8:11], a[160:163], a[0:3], v[56:59]
 ds_read_b64_tr_b16 a[196:197], v49 offset:8192
 ds_read_b64_tr_b16 a[198:199], v49 offset:12288
 v_cvt_pk_bf16_f32 v33, v18, v19
 v_mfma_f32_16x16x32_bf16 v[8:11], a[164:167], a[4:7], v[8:11]
 s_waitcnt lgkmcnt(8)
 ds_read_b64_tr_b16 a[200:201], v50 offset:8192
 ds_read_b64_tr_b16 a[202:203], v50 offset:12288
 v_exp_f32 v20, v20
 v_mfma_f32_16x16x32_bf16 v[8:11], a[168:171], a[8:11], v[8:11]
 ds_read_b64_tr_b16 a[204:205], v51 offset:8192
 ds_read_b64_tr_b16 a[206:207], v51 offset:12288
 v_exp_f32 v21, v21
 v_mfma_f32_16x16x32_bf16 v[8:11], a[172:175], a[12:15], v[8:11]
 s_waitcnt lgkmcnt(10)
 ds_read_b64_tr_b16 a[208:209], v48 offset:9216
 ds_read_b64_tr_b16 a[210:211], v48 offset:13312
 v_cvt_pk_bf16_f32 v34, v20, v21
 v_mfma_f32_16x16x32_bf16 v[12:15], a[188:191], a[12:15], v[56:59]
 ds_read_b64_tr_b16 a[212:213], v49 offset:9216
 ds_read_b64_tr_b16 a[214:215], v49 offset:13312
 v_exp_f32 v22, v22
 v_mfma_f32_16x16x32_bf16 v[12:15], a[184:187], a[8:11], v[12:15]
 s_waitcnt lgkmcnt(12)
 ds_read_b64_tr_b16 a[216:217], v50 offset:9216
 ds_read_b64_tr_b16 a[218:219], v50 offset:13312
 v_exp_f32 v23, v23
 v_mfma_f32_16x16x32_bf16 v[12:15], a[180:183], a[4:7], v[12:15]
 ds_read_b64_tr_b16 a[220:221], v51 offset:9216
 ds_read_b64_tr_b16 a[222:223], v51 offset:13312
 v_cvt_pk_bf16_f32 v35, v22, v23
 v_mfma_f32_16x16x32_bf16 v[12:15], a[176:179], a[0:3], v[12:15]
 s_waitcnt lgkmcnt(12)
 v_exp_f32 v0, v0
 v_mfma_f32_16x16x32_bf16 v[64:67], a[192:195], v[32:35], v[64:67]
 v_exp_f32 v1, v1
 v_mfma_f32_16x16x32_bf16 v[68:71], a[196:199], v[32:35], v[68:71]
 s_waitcnt lgkmcnt(8)
 v_exp_f32 v2, v2
 v_mfma_f32_16x16x32_bf16 v[72:75], a[200:203], v[32:35], v[72:75]
 v_exp_f32 v3, v3
 v_mfma_f32_16x16x32_bf16 v[76:79], a[204:207], v[32:35], v[76:79]
 s_waitcnt lgkmcnt(4)
 v_cvt_pk_bf16_f32 v36, v0, v1
 v_cvt_pk_bf16_f32 v37, v2, v3
 v_mfma_f32_16x16x32_bf16 v[80:83], a[208:211], v[32:35], v[80:83]
 v_exp_f32 v4, v4
 v_mfma_f32_16x16x32_bf16 v[84:87], a[212:215], v[32:35], v[84:87]
 s_waitcnt lgkmcnt(0)
 v_exp_f32 v5, v5
 v_mfma_f32_16x16x32_bf16 v[88:91], a[216:219], v[32:35], v[88:91]
 v_exp_f32 v6, v6
 v_mfma_f32_16x16x32_bf16 v[92:95], a[220:223], v[32:35], v[92:95]
 v_exp_f32 v7, v7
 v_mfma_f32_16x16x32_bf16 v[16:19], a[160:163], a[16:19], v[60:63]
 v_cvt_pk_bf16_f32 v38, v4, v5
 v_cvt_pk_bf16_f32 v39, v6, v7
 v_mfma_f32_16x16x32_bf16 v[16:19], a[164:167], a[20:23], v[16:19]
 v_exp_f32 v8, v8
 v_mfma_f32_16x16x32_bf16 v[16:19], a[168:171], a[24:27], v[16:19]
 v_exp_f32 v9, v9
 v_mfma_f32_16x16x32_bf16 v[16:19], a[172:175], a[28:31], v[16:19]
 v_exp_f32 v10, v10
 v_mfma_f32_16x16x32_bf16 v[20:23], a[188:191], a[28:31], v[60:63]
 v_exp_f32 v11, v11
 v_mfma_f32_16x16x32_bf16 v[20:23], a[184:187], a[24:27], v[20:23]
 v_cvt_pk_bf16_f32 v24, v8, v9
 v_cvt_pk_bf16_f32 v25, v10, v11
 v_mfma_f32_16x16x32_bf16 v[20:23], a[180:183], a[20:23], v[20:23]
 v_exp_f32 v12, v12
 v_mfma_f32_16x16x32_bf16 v[20:23], a[176:179], a[16:19], v[20:23]
 v_exp_f32 v13, v13
 v_smfmac_f32_16x16x64_bf16 a[224:227], a[236:239], v[32:39], v55
 s_waitcnt vmcnt(4)
 ds_read_b128 a[32:35], v52 offset:0
 v_mfma_f32_16x16x32_bf16 v[96:99], a[192:195], v[36:39], v[96:99]
 ds_read_b128 a[36:39], v53 offset:0
 v_cvt_pk_bf16_f32 v26, v12, v13
 v_mfma_f32_16x16x32_bf16 v[100:103], a[196:199], v[36:39], v[100:103]
 ds_read_b128 a[40:43], v52 offset:1024
 v_mfma_f32_16x16x32_bf16 v[104:107], a[200:203], v[36:39], v[104:107]
 ds_read_b128 a[44:47], v53 offset:1024
 v_mfma_f32_16x16x32_bf16 v[108:111], a[204:207], v[36:39], v[108:111]
 v_exp_f32 v14, v14
 v_mfma_f32_16x16x32_bf16 v[112:115], a[208:211], v[36:39], v[112:115]
 v_exp_f32 v15, v15
 v_mfma_f32_16x16x32_bf16 v[116:119], a[212:215], v[36:39], v[116:119]
 v_exp_f32 v16, v16
 v_mfma_f32_16x16x32_bf16 v[120:123], a[216:219], v[36:39], v[120:123]
 v_exp_f32 v17, v17
 v_mfma_f32_16x16x32_bf16 v[124:127], a[220:223], v[36:39], v[124:127]
 s_waitcnt lgkmcnt(2)
 ds_read_b64_tr_b16 a[192:193], v48 offset:16384
 ds_read_b64_tr_b16 a[194:195], v48 offset:20480
 v_mfma_f32_16x16x32_bf16 v[0:3], a[160:163], a[32:35], 0
 ds_read_b64_tr_b16 a[196:197], v49 offset:16384
 ds_read_b64_tr_b16 a[198:199], v49 offset:20480
 v_mfma_f32_16x16x32_bf16 v[0:3], a[164:167], a[36:39], v[0:3]
 s_waitcnt lgkmcnt(4)
 ds_read_b64_tr_b16 a[200:201], v50 offset:16384
 ds_read_b64_tr_b16 a[202:203], v50 offset:20480
 v_mfma_f32_16x16x32_bf16 v[0:3], a[168:171], a[40:43], v[0:3]
 ds_read_b64_tr_b16 a[204:205], v51 offset:16384
 ds_read_b64_tr_b16 a[206:207], v51 offset:20480
 v_mfma_f32_16x16x32_bf16 v[0:3], a[172:175], a[44:47], v[0:3]
 ds_read_b64_tr_b16 a[208:209], v48 offset:17408
 ds_read_b64_tr_b16 a[210:211], v48 offset:21504
 v_mfma_f32_16x16x32_bf16 v[4:7], a[188:191], a[44:47], 0
 ds_read_b64_tr_b16 a[212:213], v49 offset:17408
 ds_read_b64_tr_b16 a[214:215], v49 offset:21504
 v_mfma_f32_16x16x32_bf16 v[4:7], a[184:187], a[40:43], v[4:7]
 ds_read_b64_tr_b16 a[216:217], v50 offset:17408
 ds_read_b64_tr_b16 a[218:219], v50 offset:21504
 v_mfma_f32_16x16x32_bf16 v[4:7], a[180:183], a[36:39], v[4:7]
 ds_read_b64_tr_b16 a[220:221], v51 offset:17408
 ds_read_b64_tr_b16 a[222:223], v51 offset:21504
 v_cvt_pk_bf16_f32 v27, v14, v15
 v_mfma_f32_16x16x32_bf16 v[4:7], a[176:179], a[32:35], v[4:7]
 s_waitcnt vmcnt(0) lgkmcnt(12)
 ds_read_b128 a[48:51], v52 offset:4096
 v_cvt_pk_bf16_f32 v28, v16, v17
 v_mfma_f32_16x16x32_bf16 v[64:67], a[192:195], v[24:27], v[64:67]
 ds_read_b128 a[52:55], v53 offset:4096
 v_max3_f32 v42, v0, v1, v2
 v_mfma_f32_16x16x32_bf16 v[68:71], a[196:199], v[24:27], v[68:71]
 s_waitcnt lgkmcnt(10)
 ds_read_b128 a[56:59], v52 offset:5120
 v_max_f32 v42, v42, v3
 v_mfma_f32_16x16x32_bf16 v[72:75], a[200:203], v[24:27], v[72:75]
 ds_read_b128 a[60:63], v53 offset:5120
 ds_bpermute_b32 v42, v40, v42
 v_mfma_f32_16x16x32_bf16 v[76:79], a[204:207], v[24:27], v[76:79]
 s_waitcnt lgkmcnt(9)
 v_exp_f32 v18, v18
 v_mfma_f32_16x16x32_bf16 v[80:83], a[208:211], v[24:27], v[80:83]
 buffer_load_dwordx4 v54, s[12:15], s29 offen offset:0 nt lds
 v_mfma_f32_16x16x32_bf16 v[84:87], a[212:215], v[24:27], v[84:87]
 s_waitcnt lgkmcnt(5)
 v_exp_f32 v19, v19
 v_mfma_f32_16x16x32_bf16 v[88:91], a[216:219], v[24:27], v[88:91]
 v_exp_f32 v20, v20
 v_mfma_f32_16x16x32_bf16 v[92:95], a[220:223], v[24:27], v[92:95]
 s_waitcnt lgkmcnt(0)
 v_cvt_pk_bf16_f32 v29, v18, v19
 v_mul_f32 v42, 0xbe0293ee, v42
 v_mfma_f32_16x16x32_bf16 v[8:11], a[160:163], a[48:51], 0
 v_exp_f32 v21, v21
 v_mfma_f32_16x16x32_bf16 v[8:11], a[164:167], a[52:55], v[8:11]
 buffer_load_dwordx4 v54, s[12:15], s29 offen offset:2048 nt lds
 v_mfma_f32_16x16x32_bf16 v[8:11], a[168:171], a[56:59], v[8:11]
 s_add_u32 m0, s26, 90112
 v_cvt_pk_bf16_f32 v30, v20, v21
 v_fma_f32 v0, v0, s24, v42
 v_mfma_f32_16x16x32_bf16 v[8:11], a[172:175], a[60:63], v[8:11]
 v_exp_f32 v22, v22
 v_mfma_f32_16x16x32_bf16 v[12:15], a[188:191], a[60:63], 0
 v_exp_f32 v23, v23
 v_mfma_f32_16x16x32_bf16 v[12:15], a[184:187], a[56:59], v[12:15]
 v_cvt_pk_bf16_f32 v31, v22, v23
 v_fma_f32 v1, v1, s24, v42
 v_mfma_f32_16x16x32_bf16 v[12:15], a[180:183], a[52:55], v[12:15]
 v_exp_f32 v0, v0
 v_mfma_f32_16x16x32_bf16 v[12:15], a[176:179], a[48:51], v[12:15]
 buffer_load_dwordx4 v54, s[16:19], s29 offen offset:0 nt lds
 v_smfmac_f32_16x16x64_bf16 a[224:227], a[236:239], v[24:31], v55
 ds_read_b128 a[160:163], v46 offset:8192
 v_mfma_f32_16x16x32_bf16 v[96:99], a[192:195], v[28:31], v[96:99]
 ds_read_b128 a[164:167], v47 offset:8192
 v_fma_f32 v2, v2, s24, v42
 v_mfma_f32_16x16x32_bf16 v[100:103], a[196:199], v[28:31], v[100:103]
 ds_read_b128 a[168:171], v46 offset:9216
 v_fma_f32 v3, v3, s24, v42
 v_mfma_f32_16x16x32_bf16 v[104:107], a[200:203], v[28:31], v[104:107]
 ds_read_b128 a[172:175], v47 offset:9216
 v_fma_f32 v4, v4, s24, v42
 v_mfma_f32_16x16x32_bf16 v[108:111], a[204:207], v[28:31], v[108:111]
 ds_read_b128 a[188:191], v47 offset:13312
 v_fma_f32 v5, v5, s24, v42
 v_mfma_f32_16x16x32_bf16 v[112:115], a[208:211], v[28:31], v[112:115]
 ds_read_b128 a[184:187], v46 offset:13312
 v_exp_f32 v1, v1
 v_mfma_f32_16x16x32_bf16 v[116:119], a[212:215], v[28:31], v[116:119]
 ds_read_b128 a[180:183], v47 offset:12288
 v_cvt_pk_bf16_f32 v32, v0, v1
 v_mfma_f32_16x16x32_bf16 v[120:123], a[216:219], v[28:31], v[120:123]
 ds_read_b128 a[176:179], v46 offset:12288
 v_exp_f32 v2, v2
 v_mfma_f32_16x16x32_bf16 v[124:127], a[220:223], v[28:31], v[124:127]
 s_waitcnt lgkmcnt(6)
 v_exp_f32 v3, v3
 v_mfma_f32_16x16x32_bf16 v[16:19], a[160:163], a[32:35], 0
 s_waitcnt lgkmcnt(4)
 buffer_load_dwordx4 v54, s[16:19], s29 offen offset:2048 nt lds
 v_cvt_pk_bf16_f32 v33, v2, v3
 v_mfma_f32_16x16x32_bf16 v[16:19], a[164:167], a[36:39], v[16:19]
 s_add_u32 m0, s26, 32768
 v_exp_f32 v4, v4
 v_max3_f32 v43, v8, v9, v10
 v_mfma_f32_16x16x32_bf16 v[16:19], a[168:171], a[40:43], v[16:19]
 s_addk_i32 s29, 8192
 v_exp_f32 v5, v5
 v_max_f32 v43, v43, v11
 v_mfma_f32_16x16x32_bf16 v[16:19], a[172:175], a[44:47], v[16:19]
 s_waitcnt lgkmcnt(2)
 ds_bpermute_b32 v43, v40, v43
 v_cvt_pk_bf16_f32 v34, v4, v5
 v_fma_f32 v6, v6, s24, v42
 v_mfma_f32_16x16x32_bf16 v[20:23], a[188:191], a[44:47], 0
 v_exp_f32 v6, v6
 v_fma_f32 v7, v7, s24, v42
 v_mfma_f32_16x16x32_bf16 v[20:23], a[184:187], a[40:43], v[20:23]
 s_waitcnt lgkmcnt(1)
 v_exp_f32 v7, v7
 v_mfma_f32_16x16x32_bf16 v[20:23], a[180:183], a[36:39], v[20:23]
 v_cvt_pk_bf16_f32 v35, v6, v7
 v_fma_f32 v16, v16, s24, v42
 v_mfma_f32_16x16x32_bf16 v[20:23], a[176:179], a[32:35], v[20:23]
 v_fma_f32 v17, v17, s24, v42
 v_fma_f32 v18, v18, s24, v42
 v_mfma_f32_16x16x32_bf16 v[128:131], a[192:195], v[32:35], 0
 s_waitcnt lgkmcnt(0)
 v_mul_f32 v43, 0xbe0293ee, v43
 v_fma_f32 v8, v8, s24, v43
 v_mfma_f32_16x16x32_bf16 v[132:135], a[196:199], v[32:35], 0
 v_fma_f32 v9, v9, s24, v43
 v_fma_f32 v10, v10, s24, v43
 v_mfma_f32_16x16x32_bf16 v[136:139], a[200:203], v[32:35], 0
 v_exp_f32 v8, v8
 v_mfma_f32_16x16x32_bf16 v[140:143], a[204:207], v[32:35], 0
 buffer_load_dwordx4 v54, s[12:15], s29 offen offset:0 nt lds
 v_mfma_f32_16x16x32_bf16 v[144:147], a[208:211], v[32:35], 0
 v_exp_f32 v9, v9
 v_mfma_f32_16x16x32_bf16 v[148:151], a[212:215], v[32:35], 0
 v_cvt_pk_bf16_f32 v36, v8, v9
 v_fma_f32 v11, v11, s24, v43
 v_mfma_f32_16x16x32_bf16 v[152:155], a[216:219], v[32:35], 0
 v_exp_f32 v10, v10
 v_mfma_f32_16x16x32_bf16 v[156:159], a[220:223], v[32:35], 0
 v_exp_f32 v11, v11
 v_mfma_f32_16x16x32_bf16 v[0:3], a[160:163], a[48:51], 0
 ds_read_b128 a[160:163], v46 offset:0
 v_cvt_pk_bf16_f32 v37, v10, v11
 v_fma_f32 v12, v12, s24, v43
 v_mfma_f32_16x16x32_bf16 v[0:3], a[164:167], a[52:55], v[0:3]
 v_fma_f32 v13, v13, s24, v43
 v_exp_f32 v12, v12
 v_mfma_f32_16x16x32_bf16 v[0:3], a[168:171], a[56:59], v[0:3]
 buffer_load_dwordx4 v54, s[12:15], s29 offen offset:2048 nt lds
 v_exp_f32 v13, v13
 v_mfma_f32_16x16x32_bf16 v[0:3], a[172:175], a[60:63], v[0:3]
 s_add_u32 m0, s26, 98304
 ds_read_b128 a[164:167], v47 offset:0
 v_cvt_pk_bf16_f32 v38, v12, v13
 v_fma_f32 v14, v14, s24, v43
 v_mfma_f32_16x16x32_bf16 v[4:7], a[188:191], a[60:63], 0
 v_fma_f32 v15, v15, s24, v43
 v_exp_f32 v14, v14
 v_mfma_f32_16x16x32_bf16 v[4:7], a[184:187], a[56:59], v[4:7]
 ds_read_b128 a[168:171], v46 offset:1024
 v_exp_f32 v15, v15
 v_mfma_f32_16x16x32_bf16 v[4:7], a[180:183], a[52:55], v[4:7]
 v_cvt_pk_bf16_f32 v39, v14, v15
 v_fma_f32 v19, v19, s24, v42
 v_mfma_f32_16x16x32_bf16 v[4:7], a[176:179], a[48:51], v[4:7]
 buffer_load_dwordx4 v54, s[16:19], s29 offen offset:0 nt lds
 v_smfmac_f32_16x16x64_bf16 a[228:231], a[236:239], v[32:39], v55
 ds_read_b128 a[172:175], v47 offset:1024
 v_mfma_f32_16x16x32_bf16 v[160:163], a[192:195], v[36:39], 0
 v_exp_f32 v16, v16
 v_mfma_f32_16x16x32_bf16 v[164:167], a[196:199], v[36:39], 0
 ds_read_b128 a[188:191], v47 offset:5120
 v_fma_f32 v20, v20, s24, v42
 v_mfma_f32_16x16x32_bf16 v[168:171], a[200:203], v[36:39], 0
 v_exp_f32 v17, v17
 v_mfma_f32_16x16x32_bf16 v[172:175], a[204:207], v[36:39], 0
 ds_read_b128 a[184:187], v46 offset:5120
 v_cvt_pk_bf16_f32 v24, v16, v17
 v_mfma_f32_16x16x32_bf16 v[176:179], a[208:211], v[36:39], 0
 v_exp_f32 v18, v18
 v_mfma_f32_16x16x32_bf16 v[180:183], a[212:215], v[36:39], 0
 s_waitcnt lgkmcnt(2)
 buffer_load_dwordx4 v54, s[16:19], s29 offen offset:2048 nt lds
 v_mfma_f32_16x16x32_bf16 v[184:187], a[216:219], v[36:39], 0
 s_add_u32 m0, s28, 131072
 ds_read_b128 a[180:183], v47 offset:4096
 ds_read_b128 a[176:179], v46 offset:4096
 v_mfma_f32_16x16x32_bf16 v[188:191], a[220:223], v[36:39], 0
 s_addk_i32 s29, 8192
 ds_read_b64_tr_b16 a[192:193], v48 offset:8192
 ds_read_b64_tr_b16 a[194:195], v48 offset:12288
 v_exp_f32 v19, v19
 v_mfma_f32_16x16x32_bf16 v[8:11], a[160:163], a[32:35], 0
 ds_read_b64_tr_b16 a[196:197], v49 offset:8192
 ds_read_b64_tr_b16 a[198:199], v49 offset:12288
 v_cvt_pk_bf16_f32 v25, v18, v19
 v_mfma_f32_16x16x32_bf16 v[8:11], a[164:167], a[36:39], v[8:11]
 ds_read_b64_tr_b16 a[200:201], v50 offset:8192
 ds_read_b64_tr_b16 a[202:203], v50 offset:12288
 v_fma_f32 v21, v21, s24, v42
 v_exp_f32 v20, v20
 v_mfma_f32_16x16x32_bf16 v[8:11], a[168:171], a[40:43], v[8:11]
 ds_read_b64_tr_b16 a[204:205], v51 offset:8192
 ds_read_b64_tr_b16 a[206:207], v51 offset:12288
 v_exp_f32_e64 v21, v21
 v_mfma_f32_16x16x32_bf16 v[8:11], a[172:175], a[44:47], v[8:11]
 s_waitcnt lgkmcnt(10)
 ds_read_b64_tr_b16 a[208:209], v48 offset:9216
 ds_read_b64_tr_b16 a[210:211], v48 offset:13312
 v_cvt_pk_bf16_f32 v26, v20, v21
 v_fma_f32 v22, v22, s24, v42
 v_mfma_f32_16x16x32_bf16 v[12:15], a[188:191], a[44:47], 0
 ds_read_b64_tr_b16 a[212:213], v49 offset:9216
 ds_read_b64_tr_b16 a[214:215], v49 offset:13312
 v_fma_f32 v23, v23, s24, v42
 v_exp_f32 v22, v22
 v_mfma_f32_16x16x32_bf16 v[12:15], a[184:187], a[40:43], v[12:15]
 s_waitcnt lgkmcnt(12)
 ds_read_b64_tr_b16 a[216:217], v50 offset:9216
 ds_read_b64_tr_b16 a[218:219], v50 offset:13312
 v_exp_f32 v23, v23
 v_mfma_f32_16x16x32_bf16 v[12:15], a[180:183], a[36:39], v[12:15]
 ds_read_b64_tr_b16 a[220:221], v51 offset:9216
 ds_read_b64_tr_b16 a[222:223], v51 offset:13312
 v_cvt_pk_bf16_f32 v27, v22, v23
 v_mfma_f32_16x16x32_bf16 v[12:15], a[176:179], a[32:35], v[12:15]
 s_waitcnt lgkmcnt(12)
 v_fma_f32 v0, v0, s24, v43
 v_fma_f32 v1, v1, s24, v43
 v_mfma_f32_16x16x32_bf16 v[128:131], a[192:195], v[24:27], v[128:131]
 v_exp_f32 v0, v0
 v_mfma_f32_16x16x32_bf16 v[132:135], a[196:199], v[24:27], v[132:135]
 s_waitcnt lgkmcnt(8)
 v_exp_f32 v1, v1
 v_mfma_f32_16x16x32_bf16 v[136:139], a[200:203], v[24:27], v[136:139]
 v_cvt_pk_bf16_f32 v28, v0, v1
 v_fma_f32 v2, v2, s24, v43
 v_mfma_f32_16x16x32_bf16 v[140:143], a[204:207], v[24:27], v[140:143]
 s_waitcnt lgkmcnt(4)
 buffer_load_dwordx4 v54, s[8:11], s30 offen offset:0 nt lds
 v_mfma_f32_16x16x32_bf16 v[144:147], a[208:211], v[24:27], v[144:147]
 v_fma_f32 v3, v3, s24, v43
 v_fma_f32 v4, v4, s24, v43
 v_mfma_f32_16x16x32_bf16 v[148:151], a[212:215], v[24:27], v[148:151]
 s_waitcnt lgkmcnt(0)
 v_exp_f32 v2, v2
 v_mfma_f32_16x16x32_bf16 v[152:155], a[216:219], v[24:27], v[152:155]
 s_waitcnt vmcnt(5)
 v_exp_f32 v3, v3
 v_mfma_f32_16x16x32_bf16 v[156:159], a[220:223], v[24:27], v[156:159]
 s_barrier
 v_cvt_pk_bf16_f32 v29, v2, v3
 v_fma_f32 v5, v5, s24, v43
 v_mfma_f32_16x16x32_bf16 v[16:19], a[160:163], a[48:51], 0
 v_exp_f32 v4, v4
 v_mfma_f32_16x16x32_bf16 v[16:19], a[164:167], a[52:55], v[16:19]
 v_exp_f32 v5, v5
 v_mfma_f32_16x16x32_bf16 v[16:19], a[168:171], a[56:59], v[16:19]
 ds_read_b128 a[160:163], v46 offset:24576
 v_cvt_pk_bf16_f32 v30, v4, v5
 v_mfma_f32_16x16x32_bf16 v[16:19], a[172:175], a[60:63], v[16:19]
 v_fma_f32 v6, v6, s24, v43
 v_fma_f32 v7, v7, s24, v43
 v_mfma_f32_16x16x32_bf16 v[20:23], a[188:191], a[60:63], 0
 buffer_load_dwordx4 v54, s[8:11], s30 offen offset:2048 nt lds
 v_exp_f32 v6, v6
 v_mfma_f32_16x16x32_bf16 v[20:23], a[184:187], a[56:59], v[20:23]
 s_addk_i32 m0, 896
 ds_read_b128 a[164:167], v47 offset:24576
 v_exp_f32 v7, v7
 v_mfma_f32_16x16x32_bf16 v[20:23], a[180:183], a[52:55], v[20:23]
 v_cvt_pk_bf16_f32 v31, v6, v7
 v_fma_f32 v8, v8, s24, v42
 v_mfma_f32_16x16x32_bf16 v[20:23], a[176:179], a[48:51], v[20:23]
 ds_read_b128 a[168:171], v46 offset:25600
 v_fma_f32 v9, v9, s24, v42
 v_smfmac_f32_16x16x64_bf16 a[228:231], a[236:239], v[24:31], v55
 v_fma_f32 v10, v10, s24, v42
 v_mfma_f32_16x16x32_bf16 v[160:163], a[192:195], v[28:31], v[160:163]
 ds_read_b128 a[172:175], v47 offset:25600
 v_fma_f32 v11, v11, s24, v42
 v_mfma_f32_16x16x32_bf16 v[164:167], a[196:199], v[28:31], v[164:167]
 v_exp_f32 v8, v8
 v_mfma_f32_16x16x32_bf16 v[168:171], a[200:203], v[28:31], v[168:171]
 buffer_load_dwordx4 v54, s[8:11], s30 offen offset:128 nt lds
 v_mfma_f32_16x16x32_bf16 v[172:175], a[204:207], v[28:31], v[172:175]
 ds_read_b128 a[188:191], v47 offset:29696
 v_fma_f32 v12, v12, s24, v42
 v_mfma_f32_16x16x32_bf16 v[176:179], a[208:211], v[28:31], v[176:179]
 ds_read_b128 a[184:187], v46 offset:29696
 v_exp_f32 v9, v9
 v_mfma_f32_16x16x32_bf16 v[180:183], a[212:215], v[28:31], v[180:183]
 ds_read_b128 a[180:183], v47 offset:28672
 v_cvt_pk_bf16_f32 v32, v8, v9
 v_mfma_f32_16x16x32_bf16 v[184:187], a[216:219], v[28:31], v[184:187]
 ds_read_b128 a[176:179], v46 offset:28672
 v_exp_f32 v10, v10
 v_mfma_f32_16x16x32_bf16 v[188:191], a[220:223], v[28:31], v[188:191]
 s_waitcnt lgkmcnt(4)
 ds_read_b64_tr_b16 a[192:193], v48 offset:0
 ds_read_b64_tr_b16 a[194:195], v48 offset:4096
 v_exp_f32_e64 v11, v11
 v_mfma_f32_16x16x32_bf16 v[0:3], a[160:163], a[0:3], v[56:59]
 ds_read_b64_tr_b16 a[196:197], v49 offset:0
 ds_read_b64_tr_b16 a[198:199], v49 offset:4096
 v_cvt_pk_bf16_f32 v33, v10, v11
 v_mfma_f32_16x16x32_bf16 v[0:3], a[164:167], a[4:7], v[0:3]
 ds_read_b64_tr_b16 a[200:201], v50 offset:0
 ds_read_b64_tr_b16 a[202:203], v50 offset:4096
 v_fma_f32 v13, v13, s24, v42
 v_exp_f32 v12, v12
 v_mfma_f32_16x16x32_bf16 v[0:3], a[168:171], a[8:11], v[0:3]
 ds_read_b64_tr_b16 a[204:205], v51 offset:0
 ds_read_b64_tr_b16 a[206:207], v51 offset:4096
 v_exp_f32_e64 v13, v13
 v_mfma_f32_16x16x32_bf16 v[0:3], a[172:175], a[12:15], v[0:3]
 s_waitcnt lgkmcnt(10)
 ds_read_b64_tr_b16 a[208:209], v48 offset:1024
 ds_read_b64_tr_b16 a[210:211], v48 offset:5120
 v_cvt_pk_bf16_f32 v34, v12, v13
 v_fma_f32 v14, v14, s24, v42
 v_mfma_f32_16x16x32_bf16 v[4:7], a[188:191], a[12:15], v[56:59]
 ds_read_b64_tr_b16 a[212:213], v49 offset:1024
 ds_read_b64_tr_b16 a[214:215], v49 offset:5120
 v_fma_f32 v15, v15, s24, v42
 v_exp_f32 v14, v14
 v_mfma_f32_16x16x32_bf16 v[4:7], a[184:187], a[8:11], v[4:7]
 s_waitcnt lgkmcnt(12)
 ds_read_b64_tr_b16 a[216:217], v50 offset:1024
 ds_read_b64_tr_b16 a[218:219], v50 offset:5120
 v_exp_f32 v15, v15
 v_mfma_f32_16x16x32_bf16 v[4:7], a[180:183], a[4:7], v[4:7]
 s_waitcnt lgkmcnt(10)
 buffer_load_dwordx4 v54, s[8:11], s30 offen offset:2176 nt lds
 v_cvt_pk_bf16_f32 v35, v14, v15
 v_mfma_f32_16x16x32_bf16 v[4:7], a[176:179], a[0:3], v[4:7]
 s_add_u32 m0, s28, 135168
 ds_read_b64_tr_b16 a[220:221], v51 offset:1024
 ds_read_b64_tr_b16 a[222:223], v51 offset:5120
 v_mfma_f32_16x16x32_bf16 v[128:131], a[192:195], v[32:35], v[128:131]
 s_addk_i32 s30, 4096
 v_fma_f32 v16, v16, s24, v43
 v_fma_f32 v17, v17, s24, v43
 v_mfma_f32_16x16x32_bf16 v[132:135], a[196:199], v[32:35], v[132:135]
 s_waitcnt lgkmcnt(8)
 v_exp_f32 v16, v16
 v_mfma_f32_16x16x32_bf16 v[136:139], a[200:203], v[32:35], v[136:139]
 v_exp_f32 v17, v17
 v_mfma_f32_16x16x32_bf16 v[140:143], a[204:207], v[32:35], v[140:143]
 s_waitcnt lgkmcnt(4)
 v_cvt_pk_bf16_f32 v36, v16, v17
 v_fma_f32 v18, v18, s24, v43
 v_mfma_f32_16x16x32_bf16 v[144:147], a[208:211], v[32:35], v[144:147]
 v_fma_f32 v19, v19, s24, v43
 v_fma_f32 v20, v20, s24, v43
 v_mfma_f32_16x16x32_bf16 v[148:151], a[212:215], v[32:35], v[148:151]
 s_waitcnt lgkmcnt(2)
 v_exp_f32 v18, v18
 v_mfma_f32_16x16x32_bf16 v[152:155], a[216:219], v[32:35], v[152:155]
 s_waitcnt lgkmcnt(0)
 v_exp_f32 v19, v19
 v_mfma_f32_16x16x32_bf16 v[156:159], a[220:223], v[32:35], v[156:159]
 v_cvt_pk_bf16_f32 v37, v18, v19
 v_fma_f32 v21, v21, s24, v43
 v_mfma_f32_16x16x32_bf16 v[8:11], a[160:163], a[16:19], v[60:63]
 v_exp_f32 v20, v20
 v_mfma_f32_16x16x32_bf16 v[8:11], a[164:167], a[20:23], v[8:11]
 v_exp_f32 v21, v21
 v_mfma_f32_16x16x32_bf16 v[8:11], a[168:171], a[24:27], v[8:11]
 v_cvt_pk_bf16_f32 v38, v20, v21
 v_fma_f32 v22, v22, s24, v43
 v_mfma_f32_16x16x32_bf16 v[8:11], a[172:175], a[28:31], v[8:11]
 v_exp_f32 v22, v22
 v_mfma_f32_16x16x32_bf16 v[12:15], a[188:191], a[28:31], v[60:63]
 v_exp_f32 v0, v0
 v_fma_f32 v23, v23, s24, v43
 v_mfma_f32_16x16x32_bf16 v[12:15], a[184:187], a[24:27], v[12:15]
 v_exp_f32 v23, v23
 v_mfma_f32_16x16x32_bf16 v[12:15], a[180:183], a[20:23], v[12:15]
 v_exp_f32 v1, v1
 v_cvt_pk_bf16_f32 v39, v22, v23
 v_mfma_f32_16x16x32_bf16 v[12:15], a[176:179], a[16:19], v[12:15]
 v_exp_f32 v2, v2
 v_smfmac_f32_16x16x64_bf16 a[228:231], a[236:239], v[32:39], v55
 v_cvt_pk_bf16_f32 v24, v0, v1
 v_mfma_f32_16x16x32_bf16 v[160:163], a[192:195], v[36:39], v[160:163]
L_stub1:
 s_cbranch_vccnz L_stub5
.if ((L_stub1-L_main)>>6) != 64
.error "stub misplaced"
.endif
 ds_read_b64_tr_b16 a[192:193], v48 offset:24576
 ds_read_b64_tr_b16 a[194:195], v48 offset:28672
 v_mfma_f32_16x16x32_bf16 v[164:167], a[196:199], v[36:39], v[164:167]
 v_exp_f32 v3, v3
 v_mfma_f32_16x16x32_bf16 v[168:171], a[200:203], v[36:39], v[168:171]
 buffer_load_dwordx4 v54, s[8:11], s30 offen offset:0 nt lds
 v_mfma_f32_16x16x32_bf16 v[172:175], a[204:207], v[36:39], v[172:175]
 ds_read_b64_tr_b16 a[196:197], v49 offset:24576
 ds_read_b64_tr_b16 a[198:199], v49 offset:28672
 v_mfma_f32_16x16x32_bf16 v[176:179], a[208:211], v[36:39], v[176:179]
 v_exp_f32 v4, v4
 v_mfma_f32_16x16x32_bf16 v[180:183], a[212:215], v[36:39], v[180:183]
 ds_read_b64_tr_b16 a[200:201], v50 offset:24576
 ds_read_b64_tr_b16 a[202:203], v50 offset:28672
 v_mfma_f32_16x16x32_bf16 v[184:187], a[216:219], v[36:39], v[184:187]
 v_exp_f32 v5, v5
 v_mfma_f32_16x16x32_bf16 v[188:191], a[220:223], v[36:39], v[188:191]
 ds_read_b64_tr_b16 a[204:205], v51 offset:24576
 ds_read_b64_tr_b16 a[206:207], v51 offset:28672
 v_mfma_f32_16x16x32_bf16 v[16:19], a[160:163], a[32:35], 0
 v_cvt_pk_bf16_f32 v25, v2, v3
 v_cvt_pk_bf16_f32 v26, v4, v5
 v_mfma_f32_16x16x32_bf16 v[16:19], a[164:167], a[36:39], v[16:19]
 ds_read_b64_tr_b16 a[208:209], v48 offset:25600
 ds_read_b64_tr_b16 a[210:211], v48 offset:29696
 v_mfma_f32_16x16x32_bf16 v[16:19], a[168:171], a[40:43], v[16:19]
 v_exp_f32 v6, v6
 v_mfma_f32_16x16x32_bf16 v[16:19], a[172:175], a[44:47], v[16:19]
 buffer_load_dwordx4 v54, s[8:11], s30 offen offset:2048 nt lds
 v_mfma_f32_16x16x32_bf16 v[20:23], a[188:191], a[44:47], 0
 s_addk_i32 m0, 896
 ds_read_b64_tr_b16 a[212:213], v49 offset:25600
 ds_read_b64_tr_b16 a[214:215], v49 offset:29696
 v_mfma_f32_16x16x32_bf16 v[20:23], a[184:187], a[40:43], v[20:23]
 ds_read_b64_tr_b16 a[216:217], v50 offset:25600
 ds_read_b64_tr_b16 a[218:219], v50 offset:29696
 v_exp_f32 v7, v7
 v_mfma_f32_16x16x32_bf16 v[20:23], a[180:183], a[36:39], v[20:23]
 ds_read_b64_tr_b16 a[220:221], v51 offset:25600
 ds_read_b64_tr_b16 a[222:223], v51 offset:29696
 v_cvt_pk_bf16_f32 v27, v6, v7
 v_mfma_f32_16x16x32_bf16 v[20:23], a[176:179], a[32:35], v[20:23]
 s_waitcnt lgkmcnt(8)
 v_exp_f32 v8, v8
 v_mfma_f32_16x16x32_bf16 v[64:67], a[192:195], v[24:27], v[64:67]
 v_exp_f32 v9, v9
 v_mfma_f32_16x16x32_bf16 v[68:71], a[196:199], v[24:27], v[68:71]
 v_cvt_pk_bf16_f32 v28, v8, v9
 v_fma_f32 v16, v16, s24, v42
 v_mfma_f32_16x16x32_bf16 v[72:75], a[200:203], v[24:27], v[72:75]
 buffer_load_dwordx4 v54, s[8:11], s30 offen offset:128 nt lds
 v_mfma_f32_16x16x32_bf16 v[76:79], a[204:207], v[24:27], v[76:79]
 s_waitcnt lgkmcnt(4)
 v_exp_f32 v10, v10
 v_mfma_f32_16x16x32_bf16 v[80:83], a[208:211], v[24:27], v[80:83]
 v_exp_f32 v11, v11
 v_mfma_f32_16x16x32_bf16 v[84:87], a[212:215], v[24:27], v[84:87]
 s_waitcnt lgkmcnt(0)
 v_cvt_pk_bf16_f32 v29, v10, v11
 v_fma_f32 v17, v17, s24, v42
 v_mfma_f32_16x16x32_bf16 v[88:91], a[216:219], v[24:27], v[88:91]
 s_waitcnt vmcnt(7)
 v_exp_f32 v12, v12
 v_mfma_f32_16x16x32_bf16 v[92:95], a[220:223], v[24:27], v[92:95]
 s_barrier
 v_exp_f32 v13, v13
 v_mfma_f32_16x16x32_bf16 v[0:3], a[160:163], a[48:51], 0
 ds_read_b128 a[160:163], v46 offset:32768
 v_cvt_pk_bf16_f32 v30, v12, v13
 v_mfma_f32_16x16x32_bf16 v[0:3], a[164:167], a[52:55], v[0:3]
 v_exp_f32 v14, v14
 v_mfma_f32_16x16x32_bf16 v[0:3], a[168:171], a[56:59], v[0:3]
 buffer_load_dwordx4 v54, s[8:11], s30 offen offset:2176 nt lds
 v_mfma_f32_16x16x32_bf16 v[0:3], a[172:175], a[60:63], v[0:3]
 s_add_u32 m0, s26, 40960
 ds_read_b128 a[164:167], v47 offset:32768
 v_fma_f32 v18, v18, s24, v42
 v_mfma_f32_16x16x32_bf16 v[4:7], a[188:191], a[60:63], 0
 s_add_u32 s30, s27, 196608
 v_exp_f32 v15, v15
 v_mfma_f32_16x16x32_bf16 v[4:7], a[184:187], a[56:59], v[4:7]
 ds_read_b128 a[168:171], v46 offset:33792
 v_cvt_pk_bf16_f32 v31, v14, v15
 v_mfma_f32_16x16x32_bf16 v[4:7], a[180:183], a[52:55], v[4:7]
 v_exp_f32 v16, v16
 v_mfma_f32_16x16x32_bf16 v[4:7], a[176:179], a[48:51], v[4:7]
 ds_read_b128 a[172:175], v47 offset:33792
 v_fma_f32 v19, v19, s24, v42
 v_smfmac_f32_16x16x64_bf16 a[224:227], a[236:239], v[24:31], v55
 v_fma_f32 v20, v20, s24, v42
 v_mfma_f32_16x16x32_bf16 v[96:99], a[192:195], v[28:31], v[96:99]
 ds_read_b128 a[188:191], v47 offset:37888
 v_fma_f32 v21, v21, s24, v42
 v_mfma_f32_16x16x32_bf16 v[100:103], a[196:199], v[28:31], v[100:103]
 v_exp_f32 v17, v17
 v_mfma_f32_16x16x32_bf16 v[104:107], a[200:203], v[28:31], v[104:107]
 ds_read_b128 a[184:187], v46 offset:37888
 v_cvt_pk_bf16_f32 v32, v16, v17
 v_mfma_f32_16x16x32_bf16 v[108:111], a[204:207], v[28:31], v[108:111]
 v_exp_f32 v18, v18
 v_mfma_f32_16x16x32_bf16 v[112:115], a[208:211], v[28:31], v[112:115]
 ds_read_b128 a[180:183], v47 offset:36864
 v_fma_f32 v22, v22, s24, v42
 v_mfma_f32_16x16x32_bf16 v[116:119], a[212:215], v[28:31], v[116:119]
 v_exp_f32 v19, v19
 v_mfma_f32_16x16x32_bf16 v[120:123], a[216:219], v[28:31], v[120:123]
 ds_read_b128 a[176:179], v46 offset:36864
 v_cvt_pk_bf16_f32 v33, v18, v19
 v_mfma_f32_16x16x32_bf16 v[124:127], a[220:223], v[28:31], v[124:127]
 s_waitcnt lgkmcnt(3)
 v_exp_f32 v20, v20
 v_mfma_f32_16x16x32_bf16 v[8:11], a[160:163], a[0:3], v[56:59]
 v_exp_f32 v21, v21
 v_mfma_f32_16x16x32_bf16 v[8:11], a[164:167], a[4:7], v[8:11]
 v_cvt_pk_bf16_f32 v34, v20, v21
 v_fma_f32 v23, v23, s24, v42
 v_mfma_f32_16x16x32_bf16 v[8:11], a[168:171], a[8:11], v[8:11]
 v_exp_f32 v22, v22
 v_mfma_f32_16x16x32_bf16 v[8:11], a[172:175], a[12:15], v[8:11]
 v_exp_f32 v23, v23
 v_mfma_f32_16x16x32_bf16 v[12:15], a[188:191], a[12:15], v[56:59]
 s_waitcnt lgkmcnt(1)
 v_cvt_pk_bf16_f32 v35, v22, v23
 v_fma_f32 v0, v0, s24, v43
 v_mfma_f32_16x16x32_bf16 v[12:15], a[184:187], a[8:11], v[12:15]
 v_fma_f32 v1, v1, s24, v43
 v_fma_f32 v2, v2, s24, v43
 v_mfma_f32_16x16x32_bf16 v[12:15], a[180:183], a[4:7], v[12:15]
 s_waitcnt lgkmcnt(0)
 v_exp_f32 v0, v0
 v_mfma_f32_16x16x32_bf16 v[12:15], a[176:179], a[0:3], v[12:15]
 v_exp_f32 v1, v1
 v_mfma_f32_16x16x32_bf16 v[128:131], a[192:195], v[32:35], v[128:131]
 v_cvt_pk_bf16_f32 v36, v0, v1
 v_fma_f32 v3, v3, s24, v43
 v_mfma_f32_16x16x32_bf16 v[132:135], a[196:199], v[32:35], v[132:135]
 v_exp_f32 v2, v2
 v_mfma_f32_16x16x32_bf16 v[136:139], a[200:203], v[32:35], v[136:139]
 v_exp_f32 v3, v3
 v_mfma_f32_16x16x32_bf16 v[140:143], a[204:207], v[32:35], v[140:143]
 v_cvt_pk_bf16_f32 v37, v2, v3
 v_fma_f32 v4, v4, s24, v43
 v_mfma_f32_16x16x32_bf16 v[144:147], a[208:211], v[32:35], v[144:147]
 v_fma_f32 v5, v5, s24, v43
 v_fma_f32 v6, v6, s24, v43
 v_mfma_f32_16x16x32_bf16 v[148:151], a[212:215], v[32:35], v[148:151]
 v_exp_f32 v4, v4
 v_mfma_f32_16x16x32_bf16 v[152:155], a[216:219], v[32:35], v[152:155]
 v_exp_f32 v5, v5
 v_mfma_f32_16x16x32_bf16 v[156:159], a[220:223], v[32:35], v[156:159]
 v_cvt_pk_bf16_f32 v38, v4, v5
 v_fma_f32 v7, v7, s24, v43
 v_mfma_f32_16x16x32_bf16 v[16:19], a[160:163], a[16:19], v[60:63]
 v_exp_f32 v6, v6
 v_mfma_f32_16x16x32_bf16 v[16:19], a[164:167], a[20:23], v[16:19]
 v_exp_f32 v7, v7
 v_mfma_f32_16x16x32_bf16 v[16:19], a[168:171], a[24:27], v[16:19]
 v_exp_f32 v8, v8
 v_mfma_f32_16x16x32_bf16 v[16:19], a[172:175], a[28:31], v[16:19]
 v_exp_f32 v9, v9
 v_mfma_f32_16x16x32_bf16 v[20:23], a[188:191], a[28:31], v[60:63]
 v_cvt_pk_bf16_f32 v39, v6, v7
 v_cvt_pk_bf16_f32 v24, v8, v9
 v_mfma_f32_16x16x32_bf16 v[20:23], a[184:187], a[24:27], v[20:23]
 v_exp_f32 v10, v10
 v_mfma_f32_16x16x32_bf16 v[20:23], a[180:183], a[20:23], v[20:23]
 v_exp_f32 v11, v11
 v_mfma_f32_16x16x32_bf16 v[20:23], a[176:179], a[16:19], v[20:23]
 v_exp_f32 v12, v12
 v_smfmac_f32_16x16x64_bf16 a[228:231], a[236:239], v[32:39], v55
 v_cvt_pk_bf16_f32 v25, v10, v11
 v_mfma_f32_16x16x32_bf16 v[160:163], a[192:195], v[36:39], v[160:163]
 ds_read_b64_tr_b16 a[192:193], v48 offset:32768
 ds_read_b64_tr_b16 a[194:195], v48 offset:36864
 v_mfma_f32_16x16x32_bf16 v[164:167], a[196:199], v[36:39], v[164:167]
 v_exp_f32 v13, v13
 v_mfma_f32_16x16x32_bf16 v[168:171], a[200:203], v[36:39], v[168:171]
 ds_read_b64_tr_b16 a[196:197], v49 offset:32768
 ds_read_b64_tr_b16 a[198:199], v49 offset:36864
 v_mfma_f32_16x16x32_bf16 v[172:175], a[204:207], v[36:39], v[172:175]
 v_exp_f32 v14, v14
 v_mfma_f32_16x16x32_bf16 v[176:179], a[208:211], v[36:39], v[176:179]
 ds_read_b64_tr_b16 a[200:201], v50 offset:32768
 ds_read_b64_tr_b16 a[202:203], v50 offset:36864
 v_mfma_f32_16x16x32_bf16 v[180:183], a[212:215], v[36:39], v[180:183]
 v_exp_f32 v15, v15
 v_mfma_f32_16x16x32_bf16 v[184:187], a[216:219], v[36:39], v[184:187]
 ds_read_b64_tr_b16 a[204:205], v51 offset:32768
 ds_read_b64_tr_b16 a[206:207], v51 offset:36864
 v_mfma_f32_16x16x32_bf16 v[188:191], a[220:223], v[36:39], v[188:191]
 v_cvt_pk_bf16_f32 v26, v12, v13
 v_cvt_pk_bf16_f32 v27, v14, v15
 v_mfma_f32_16x16x32_bf16 v[0:3], a[160:163], a[32:35], 0
 ds_read_b64_tr_b16 a[208:209], v48 offset:33792
 ds_read_b64_tr_b16 a[210:211], v48 offset:37888
 v_mfma_f32_16x16x32_bf16 v[0:3], a[164:167], a[36:39], v[0:3]
 v_exp_f32 v16, v16
 v_mfma_f32_16x16x32_bf16 v[0:3], a[168:171], a[40:43], v[0:3]
 ds_read_b64_tr_b16 a[212:213], v49 offset:33792
 ds_read_b64_tr_b16 a[214:215], v49 offset:37888
 v_mfma_f32_16x16x32_bf16 v[0:3], a[172:175], a[44:47], v[0:3]
 v_exp_f32 v17, v17
 v_mfma_f32_16x16x32_bf16 v[4:7], a[188:191], a[44:47], 0
 ds_read_b64_tr_b16 a[216:217], v50 offset:33792
 ds_read_b64_tr_b16 a[218:219], v50 offset:37888
 v_mfma_f32_16x16x32_bf16 v[4:7], a[184:187], a[40:43], v[4:7]
 v_exp_f32 v18, v18
 v_mfma_f32_16x16x32_bf16 v[4:7], a[180:183], a[36:39], v[4:7]
 ds_read_b64_tr_b16 a[220:221], v51 offset:33792
 ds_read_b64_tr_b16 a[222:223], v51 offset:37888
 v_mfma_f32_16x16x32_bf16 v[4:7], a[176:179], a[32:35], v[4:7]
 s_waitcnt lgkmcnt(6)
 v_cvt_pk_bf16_f32 v28, v16, v17
 v_fma_f32 v0, v0, s24, v42
 v_mfma_f32_16x16x32_bf16 v[64:67], a[192:195], v[24:27], v[64:67]
 v_exp_f32 v19, v19
 v_mfma_f32_16x16x32_bf16 v[68:71], a[196:199], v[24:27], v[68:71]
 v_cvt_pk_bf16_f32 v29, v18, v19
 v_fma_f32 v1, v1, s24, v42
 v_mfma_f32_16x16x32_bf16 v[72:75], a[200:203], v[24:27], v[72:75]
 v_exp_f32 v20, v20
 v_mfma_f32_16x16x32_bf16 v[76:79], a[204:207], v[24:27], v[76:79]
 v_exp_f32 v21, v21
 v_mfma_f32_16x16x32_bf16 v[80:83], a[208:211], v[24:27], v[80:83]
 s_waitcnt lgkmcnt(2)
 v_cvt_pk_bf16_f32 v30, v20, v21
 v_fma_f32 v2, v2, s24, v42
 v_mfma_f32_16x16x32_bf16 v[84:87], a[212:215], v[24:27], v[84:87]
 v_exp_f32 v22, v22
 v_mfma_f32_16x16x32_bf16 v[88:91], a[216:219], v[24:27], v[88:91]
 s_waitcnt lgkmcnt(0)
 v_exp_f32 v23, v23
 v_mfma_f32_16x16x32_bf16 v[92:95], a[220:223], v[24:27], v[92:95]
 v_cvt_pk_bf16_f32 v31, v22, v23
 v_fma_f32 v3, v3, s24, v42
 v_mfma_f32_16x16x32_bf16 v[8:11], a[160:163], a[48:51], 0
 v_exp_f32 v0, v0
 v_mfma_f32_16x16x32_bf16 v[8:11], a[164:167], a[52:55], v[8:11]
 v_exp_f32 v1, v1
 v_mfma_f32_16x16x32_bf16 v[8:11], a[168:171], a[56:59], v[8:11]
 v_cvt_pk_bf16_f32 v32, v0, v1
 v_fma_f32 v4, v4, s24, v42
 v_mfma_f32_16x16x32_bf16 v[8:11], a[172:175], a[60:63], v[8:11]
 v_exp_f32 v2, v2
 v_mfma_f32_16x16x32_bf16 v[12:15], a[188:191], a[60:63], 0
 v_exp_f32 v3, v3
 v_mfma_f32_16x16x32_bf16 v[12:15], a[184:187], a[56:59], v[12:15]
 v_cvt_pk_bf16_f32 v33, v2, v3
 v_fma_f32 v5, v5, s24, v42
 v_mfma_f32_16x16x32_bf16 v[12:15], a[180:183], a[52:55], v[12:15]
 v_exp_f32 v4, v4
 v_mfma_f32_16x16x32_bf16 v[12:15], a[176:179], a[48:51], v[12:15]
 v_exp_f32 v5, v5
 v_smfmac_f32_16x16x64_bf16 a[224:227], a[236:239], v[24:31], v55
 s_waitcnt vmcnt(4)
 ds_read_b128 a[64:67], v52 offset:0
 v_mfma_f32_16x16x32_bf16 v[96:99], a[192:195], v[28:31], v[96:99]
 ds_read_b128 a[68:71], v53 offset:0
 v_cvt_pk_bf16_f32 v34, v4, v5
 v_mfma_f32_16x16x32_bf16 v[100:103], a[196:199], v[28:31], v[100:103]
 ds_read_b128 a[72:75], v52 offset:1024
 v_fma_f32 v6, v6, s24, v42
 v_mfma_f32_16x16x32_bf16 v[104:107], a[200:203], v[28:31], v[104:107]
 ds_read_b128 a[76:79], v53 offset:1024
 v_fma_f32 v7, v7, s24, v42
 v_mfma_f32_16x16x32_bf16 v[108:111], a[204:207], v[28:31], v[108:111]
 v_exp_f32 v6, v6
 v_mfma_f32_16x16x32_bf16 v[112:115], a[208:211], v[28:31], v[112:115]
 v_exp_f32 v7, v7
 v_mfma_f32_16x16x32_bf16 v[116:119], a[212:215], v[28:31], v[116:119]
 v_cvt_pk_bf16_f32 v35, v6, v7
 v_fma_f32 v8, v8, s24, v43
 v_mfma_f32_16x16x32_bf16 v[120:123], a[216:219], v[28:31], v[120:123]
 v_fma_f32 v9, v9, s24, v43
 v_fma_f32 v10, v10, s24, v43
 v_mfma_f32_16x16x32_bf16 v[124:127], a[220:223], v[28:31], v[124:127]
 s_waitcnt lgkmcnt(2)
 v_exp_f32 v8, v8
 v_mfma_f32_16x16x32_bf16 v[16:19], a[160:163], a[64:67], 0
 v_exp_f32 v9, v9
 v_mfma_f32_16x16x32_bf16 v[16:19], a[164:167], a[68:71], v[16:19]
 s_waitcnt lgkmcnt(0)
 v_cvt_pk_bf16_f32 v36, v8, v9
 v_fma_f32 v11, v11, s24, v43
 v_mfma_f32_16x16x32_bf16 v[16:19], a[168:171], a[72:75], v[16:19]
 v_exp_f32 v10, v10
 v_mfma_f32_16x16x32_bf16 v[16:19], a[172:175], a[76:79], v[16:19]
 v_exp_f32 v11, v11
 v_mfma_f32_16x16x32_bf16 v[20:23], a[188:191], a[76:79], 0
 v_cvt_pk_bf16_f32 v37, v10, v11
 v_fma_f32 v12, v12, s24, v43
 v_mfma_f32_16x16x32_bf16 v[20:23], a[184:187], a[72:75], v[20:23]
 v_fma_f32 v13, v13, s24, v43
 v_fma_f32 v14, v14, s24, v43
 v_mfma_f32_16x16x32_bf16 v[20:23], a[180:183], a[68:71], v[20:23]
 v_exp_f32 v12, v12
 v_mfma_f32_16x16x32_bf16 v[20:23], a[176:179], a[64:67], v[20:23]
 s_waitcnt vmcnt(0)
 ds_read_b128 a[80:83], v52 offset:4096
 v_max3_f32 v44, v16, v17, v18
 v_mfma_f32_16x16x32_bf16 v[128:131], a[192:195], v[32:35], v[128:131]
 ds_read_b128 a[84:87], v53 offset:4096
 v_max_f32 v44, v44, v19
 v_mfma_f32_16x16x32_bf16 v[132:135], a[196:199], v[32:35], v[132:135]
 ds_read_b128 a[88:91], v52 offset:5120
 ds_bpermute_b32 v44, v40, v44
 v_mfma_f32_16x16x32_bf16 v[136:139], a[200:203], v[32:35], v[136:139]
 ds_read_b128 a[92:95], v53 offset:5120
 v_fma_f32 v15, v15, s24, v43
 v_mfma_f32_16x16x32_bf16 v[140:143], a[204:207], v[32:35], v[140:143]
 v_exp_f32 v13, v13
 v_mfma_f32_16x16x32_bf16 v[144:147], a[208:211], v[32:35], v[144:147]
 v_exp_f32 v14, v14
 v_mfma_f32_16x16x32_bf16 v[148:151], a[212:215], v[32:35], v[148:151]
 v_exp_f32 v15, v15
 v_mfma_f32_16x16x32_bf16 v[152:155], a[216:219], v[32:35], v[152:155]
 v_cvt_pk_bf16_f32 v38, v12, v13
 v_cvt_pk_bf16_f32 v39, v14, v15
 v_mfma_f32_16x16x32_bf16 v[156:159], a[220:223], v[32:35], v[156:159]
 s_waitcnt lgkmcnt(1)
 v_mul_f32 v44, 0xbe0293ee, v44
 v_fma_f32 v16, v16, s24, v44
 v_mfma_f32_16x16x32_bf16 v[0:3], a[160:163], a[80:83], 0
 ds_read_b128 a[160:163], v46 offset:0
 v_fma_f32 v17, v17, s24, v44
 v_mfma_f32_16x16x32_bf16 v[0:3], a[164:167], a[84:87], v[0:3]
 v_exp_f32 v16, v16
 v_mfma_f32_16x16x32_bf16 v[0:3], a[168:171], a[88:91], v[0:3]
 s_waitcnt lgkmcnt(1)
 ds_read_b128 a[164:167], v47 offset:0
 v_fma_f32 v18, v18, s24, v44
 v_mfma_f32_16x16x32_bf16 v[0:3], a[172:175], a[92:95], v[0:3]
 v_exp_f32 v17, v17
 v_mfma_f32_16x16x32_bf16 v[4:7], a[188:191], a[92:95], 0
 ds_read_b128 a[168:171], v46 offset:1024
 v_cvt_pk_bf16_f32 v24, v16, v17
 v_mfma_f32_16x16x32_bf16 v[4:7], a[184:187], a[88:91], v[4:7]
 v_fma_f32 v19, v19, s24, v44
 v_fma_f32 v20, v20, s24, v44
 v_mfma_f32_16x16x32_bf16 v[4:7], a[180:183], a[84:87], v[4:7]
 ds_read_b128 a[172:175], v47 offset:1024
 v_fma_f32 v21, v21, s24, v44
 v_mfma_f32_16x16x32_bf16 v[4:7], a[176:179], a[80:83], v[4:7]
 v_exp_f32 v18, v18
 v_smfmac_f32_16x16x64_bf16 a[228:231], a[236:239], v[32:39], v55
 ds_read_b128 a[188:191], v47 offset:5120
 v_mfma_f32_16x16x32_bf16 v[160:163], a[192:195], v[36:39], v[160:163]
 v_exp_f32 v19, v19
 v_mfma_f32_16x16x32_bf16 v[164:167], a[196:199], v[36:39], v[164:167]
 ds_read_b128 a[184:187], v46 offset:5120
 v_cvt_pk_bf16_f32 v25, v18, v19
 v_mfma_f32_16x16x32_bf16 v[168:171], a[200:203], v[36:39], v[168:171]
 v_exp_f32 v20, v20
 v_mfma_f32_16x16x32_bf16 v[172:175], a[204:207], v[36:39], v[172:175]
 buffer_load_dwordx4 v54, s[12:15], s29 offen offset:0 nt lds
 v_mfma_f32_16x16x32_bf16 v[176:179], a[208:211], v[36:39], v[176:179]
 ds_read_b128 a[180:183], v47 offset:4096
 v_max3_f32 v45, v0, v1, v2
 v_mfma_f32_16x16x32_bf16 v[180:183], a[212:215], v[36:39], v[180:183]
 v_exp_f32 v21, v21
 v_mfma_f32_16x16x32_bf16 v[184:187], a[216:219], v[36:39], v[184:187]
 ds_read_b128 a[176:179], v46 offset:4096
 v_max_f32 v45, v45, v3
 v_mfma_f32_16x16x32_bf16 v[188:191], a[220:223], v[36:39], v[188:191]
 s_waitcnt lgkmcnt(3)
 ds_bpermute_b32 v45, v40, v45
 v_cvt_pk_bf16_f32 v26, v20, v21
 v_mfma_f32_16x16x32_bf16 v[8:11], a[160:163], a[64:67], 0
 v_fma_f32 v22, v22, s24, v44
 v_fma_f32 v23, v23, s24, v44
 v_mfma_f32_16x16x32_bf16 v[8:11], a[164:167], a[68:71], v[8:11]
 v_exp_f32 v22, v22
 v_mfma_f32_16x16x32_bf16 v[8:11], a[168:171], a[72:75], v[8:11]
 v_exp_f32 v23, v23
 v_mfma_f32_16x16x32_bf16 v[8:11], a[172:175], a[76:79], v[8:11]
 v_cvt_pk_bf16_f32 v27, v22, v23
 v_mfma_f32_16x16x32_bf16 v[12:15], a[188:191], a[76:79], 0
 s_waitcnt lgkmcnt(0)
 v_mul_f32 v45, 0xbe0293ee, v45
 v_fma_f32 v0, v0, s24, v45
 v_mfma_f32_16x16x32_bf16 v[12:15], a[184:187], a[72:75], v[12:15]
 v_fma_f32 v1, v1, s24, v45
 v_fma_f32 v2, v2, s24, v45
 v_mfma_f32_16x16x32_bf16 v[12:15], a[180:183], a[68:71], v[12:15]
 buffer_load_dwordx4 v54, s[12:15], s29 offen offset:2048 nt lds
 v_mfma_f32_16x16x32_bf16 v[12:15], a[176:179], a[64:67], v[12:15]
 s_add_u32 m0, s26, 106496
 v_exp_f32 v0, v0
 v_mfma_f32_16x16x32_bf16 v[192:195], a[192:195], v[24:27], 0
 v_exp_f32 v1, v1
 v_mfma_f32_16x16x32_bf16 v[196:199], a[196:199], v[24:27], 0
 v_cvt_pk_bf16_f32 v28, v0, v1
 v_fma_f32 v3, v3, s24, v45
 v_mfma_f32_16x16x32_bf16 v[200:203], a[200:203], v[24:27], 0
 v_exp_f32 v2, v2
 v_mfma_f32_16x16x32_bf16 v[204:207], a[204:207], v[24:27], 0
 v_exp_f32 v3, v3
 v_mfma_f32_16x16x32_bf16 v[208:211], a[208:211], v[24:27], 0
 v_cvt_pk_bf16_f32 v29, v2, v3
 v_fma_f32 v4, v4, s24, v45
 v_mfma_f32_16x16x32_bf16 v[212:215], a[212:215], v[24:27], 0
 v_fma_f32 v5, v5, s24, v45
 v_fma_f32 v6, v6, s24, v45
 v_mfma_f32_16x16x32_bf16 v[216:219], a[216:219], v[24:27], 0
 v_exp_f32 v4, v4
 v_mfma_f32_16x16x32_bf16 v[220:223], a[220:223], v[24:27], 0
 v_exp_f32 v5, v5
 v_mfma_f32_16x16x32_bf16 v[16:19], a[160:163], a[80:83], 0
 ds_read_b128 a[160:163], v46 offset:8192
 v_cvt_pk_bf16_f32 v30, v4, v5
 v_mfma_f32_16x16x32_bf16 v[16:19], a[164:167], a[84:87], v[16:19]
 v_fma_f32 v7, v7, s24, v45
 v_fma_f32 v8, v8, s24, v44
 v_mfma_f32_16x16x32_bf16 v[16:19], a[168:171], a[88:91], v[16:19]
 buffer_load_dwordx4 v54, s[16:19], s29 offen offset:0 nt lds
 v_mfma_f32_16x16x32_bf16 v[16:19], a[172:175], a[92:95], v[16:19]
 ds_read_b128 a[164:167], v47 offset:8192
 v_fma_f32 v9, v9, s24, v44
 v_mfma_f32_16x16x32_bf16 v[20:23], a[188:191], a[92:95], 0
 v_exp_f32 v6, v6
 v_mfma_f32_16x16x32_bf16 v[20:23], a[184:187], a[88:91], v[20:23]
 ds_read_b128 a[168:171], v46 offset:9216
 v_exp_f32 v7, v7
 v_mfma_f32_16x16x32_bf16 v[20:23], a[180:183], a[84:87], v[20:23]
 v_cvt_pk_bf16_f32 v31, v6, v7
 v_fma_f32 v10, v10, s24, v44
 v_mfma_f32_16x16x32_bf16 v[20:23], a[176:179], a[80:83], v[20:23]
 ds_read_b128 a[172:175], v47 offset:9216
 v_fma_f32 v11, v11, s24, v44
 v_smfmac_f32_16x16x64_bf16 a[232:235], a[236:239], v[24:31], v55
 v_fma_f32 v12, v12, s24, v44
 v_mfma_f32_16x16x32_bf16 v[224:227], a[192:195], v[28:31], 0
 ds_read_b128 a[188:191], v47 offset:13312
 v_fma_f32 v13, v13, s24, v44
 v_mfma_f32_16x16x32_bf16 v[228:231], a[196:199], v[28:31], 0
 v_exp_f32 v8, v8
 v_mfma_f32_16x16x32_bf16 v[232:235], a[200:203], v[28:31], 0
 ds_read_b128 a[184:187], v46 offset:13312
 v_fma_f32 v14, v14, s24, v44
 v_mfma_f32_16x16x32_bf16 v[236:239], a[204:207], v[28:31], 0
 v_exp_f32 v9, v9
 v_mfma_f32_16x16x32_bf16 v[240:243], a[208:211], v[28:31], 0
 ds_read_b128 a[180:183], v47 offset:12288
 v_cvt_pk_bf16_f32 v32, v8, v9
 v_mfma_f32_16x16x32_bf16 v[244:247], a[212:215], v[28:31], 0
 v_exp_f32 v10, v10
 v_mfma_f32_16x16x32_bf16 v[248:251], a[216:219], v[28:31], 0
 s_waitcnt lgkmcnt(2)
 buffer_load_dwordx4 v54, s[16:19], s29 offen offset:2048 nt lds
 v_mfma_f32_16x16x32_bf16 v[252:255], a[220:223], v[28:31], 0
 s_add_u32 m0, s26, 49152
 ds_read_b128 a[176:179], v46 offset:12288
 ds_read_b64_tr_b16 a[192:193], v48 offset:0
 ds_read_b64_tr_b16 a[194:195], v48 offset:4096
 v_exp_f32 v11, v11
 v_mfma_f32_16x16x32_bf16 v[0:3], a[160:163], a[64:67], 0
 s_addk_i32 s29, 8192
 ds_read_b64_tr_b16 a[196:197], v49 offset:0
 ds_read_b64_tr_b16 a[198:199], v49 offset:4096
 v_cvt_pk_bf16_f32 v33, v10, v11
 v_mfma_f32_16x16x32_bf16 v[0:3], a[164:167], a[68:71], v[0:3]
 ds_read_b64_tr_b16 a[200:201], v50 offset:0
 ds_read_b64_tr_b16 a[202:203], v50 offset:4096
 v_exp_f32 v12, v12
 v_mfma_f32_16x16x32_bf16 v[0:3], a[168:171], a[72:75], v[0:3]
 ds_read_b64_tr_b16 a[204:205], v51 offset:0
 ds_read_b64_tr_b16 a[206:207], v51 offset:4096
 v_exp_f32 v13, v13
 v_mfma_f32_16x16x32_bf16 v[0:3], a[172:175], a[76:79], v[0:3]
 ds_read_b64_tr_b16 a[208:209], v48 offset:1024
 ds_read_b64_tr_b16 a[210:211], v48 offset:5120
 v_cvt_pk_bf16_f32 v34, v12, v13
 v_mfma_f32_16x16x32_bf16 v[4:7], a[188:191], a[76:79], 0
 s_waitcnt lgkmcnt(11)
 ds_read_b64_tr_b16 a[212:213], v49 offset:1024
 ds_read_b64_tr_b16 a[214:215], v49 offset:5120
 v_fma_f32 v15, v15, s24, v44
 v_exp_f32 v14, v14
 v_mfma_f32_16x16x32_bf16 v[4:7], a[184:187], a[72:75], v[4:7]
 ds_read_b64_tr_b16 a[216:217], v50 offset:1024
 ds_read_b64_tr_b16 a[218:219], v50 offset:5120
 v_exp_f32 v15, v15
 v_mfma_f32_16x16x32_bf16 v[4:7], a[180:183], a[68:71], v[4:7]
 s_waitcnt lgkmcnt(12)
 ds_read_b64_tr_b16 a[220:221], v51 offset:1024
 ds_read_b64_tr_b16 a[222:223], v51 offset:5120
 v_cvt_pk_bf16_f32 v35, v14, v15
 v_mfma_f32_16x16x32_bf16 v[4:7], a[176:179], a[64:67], v[4:7]
 v_fma_f32 v16, v16, s24, v45
 v_fma_f32 v17, v17, s24, v45
 v_mfma_f32_16x16x32_bf16 v[192:195], a[192:195], v[32:35], v[192:195]
 s_waitcnt lgkmcnt(10)
 v_exp_f32 v16, v16
 v_mfma_f32_16x16x32_bf16 v[196:199], a[196:199], v[32:35], v[196:199]
 v_exp_f32 v17, v17
 v_mfma_f32_16x16x32_bf16 v[200:203], a[200:203], v[32:35], v[200:203]
 s_waitcnt lgkmcnt(6)
 v_cvt_pk_bf16_f32 v36, v16, v17
 v_fma_f32 v18, v18, s24, v45
 v_mfma_f32_16x16x32_bf16 v[204:207], a[204:207], v[32:35], v[204:207]
 buffer_load_dwordx4 v54, s[12:15], s29 offen offset:0 nt lds
 v_mfma_f32_16x16x32_bf16 v[208:211], a[208:211], v[32:35], v[208:211]
 s_waitcnt lgkmcnt(2)
 v_fma_f32 v19, v19, s24, v45
 v_fma_f32 v20, v20, s24, v45
 v_mfma_f32_16x16x32_bf16 v[212:215], a[212:215], v[32:35], v[212:215]
 v_exp_f32 v18, v18
 v_mfma_f32_16x16x32_bf16 v[216:219], a[216:219], v[32:35], v[216:219]
 s_waitcnt lgkmcnt(0)
 v_exp_f32 v19, v19
 v_mfma_f32_16x16x32_bf16 v[220:223], a[220:223], v[32:35], v[220:223]
 v_cvt_pk_bf16_f32 v37, v18, v19
 v_fma_f32 v21, v21, s24, v45
 v_mfma_f32_16x16x32_bf16 v[8:11], a[160:163], a[80:83], 0
 v_exp_f32 v20, v20
 v_mfma_f32_16x16x32_bf16 v[8:11], a[164:167], a[84:87], v[8:11]
 ds_read_b128 a[160:163], v46 offset:16384
 v_fma_f32 v22, v22, s24, v45
 v_mfma_f32_16x16x32_bf16 v[8:11], a[168:171], a[88:91], v[8:11]
 v_exp_f32 v21, v21
 v_mfma_f32_16x16x32_bf16 v[8:11], a[172:175], a[92:95], v[8:11]
 ds_read_b128 a[164:167], v47 offset:16384
 v_cvt_pk_bf16_f32 v38, v20, v21
 v_mfma_f32_16x16x32_bf16 v[12:15], a[188:191], a[92:95], 0
 v_fma_f32 v23, v23, s24, v45
 v_exp_f32 v22, v22
 v_mfma_f32_16x16x32_bf16 v[12:15], a[184:187], a[88:91], v[12:15]
 ds_read_b128 a[168:171], v46 offset:17408
 v_exp_f32 v23, v23
 v_mfma_f32_16x16x32_bf16 v[12:15], a[180:183], a[84:87], v[12:15]
 v_cvt_pk_bf16_f32 v39, v22, v23
 v_fma_f32 v0, v0, s24, v44
 v_mfma_f32_16x16x32_bf16 v[12:15], a[176:179], a[80:83], v[12:15]
 buffer_load_dwordx4 v54, s[12:15], s29 offen offset:2048 nt lds
 v_smfmac_f32_16x16x64_bf16 a[232:235], a[236:239], v[32:39], v55
 s_add_u32 m0, s26, 114688
 ds_read_b128 a[172:175], v47 offset:17408
 v_mfma_f32_16x16x32_bf16 v[224:227], a[192:195], v[36:39], v[224:227]
 v_fma_f32 v1, v1, s24, v44
 v_fma_f32 v2, v2, s24, v44
 v_mfma_f32_16x16x32_bf16 v[228:231], a[196:199], v[36:39], v[228:231]
 ds_read_b128 a[188:191], v47 offset:21504
 v_fma_f32 v3, v3, s24, v44
 v_mfma_f32_16x16x32_bf16 v[232:235], a[200:203], v[36:39], v[232:235]
 v_exp_f32 v0, v0
 v_mfma_f32_16x16x32_bf16 v[236:239], a[204:207], v[36:39], v[236:239]
 ds_read_b128 a[184:187], v46 offset:21504
 v_fma_f32 v4, v4, s24, v44
 v_mfma_f32_16x16x32_bf16 v[240:243], a[208:211], v[36:39], v[240:243]
 v_exp_f32 v1, v1
 v_mfma_f32_16x16x32_bf16 v[244:247], a[212:215], v[36:39], v[244:247]
 ds_read_b128 a[180:183], v47 offset:20480
 v_cvt_pk_bf16_f32 v24, v0, v1
 v_mfma_f32_16x16x32_bf16 v[248:251], a[216:219], v[36:39], v[248:251]
 ds_read_b128 a[176:179], v46 offset:20480
 v_exp_f32 v2, v2
 v_mfma_f32_16x16x32_bf16 v[252:255], a[220:223], v[36:39], v[252:255]
 s_waitcnt lgkmcnt(4)
 ds_read_b64_tr_b16 a[192:193], v48 offset:8192
 ds_read_b64_tr_b16 a[194:195], v48 offset:12288
 v_exp_f32_e64 v3, v3
 v_mfma_f32_16x16x32_bf16 v[16:19], a[160:163], a[64:67], 0
 ds_read_b64_tr_b16 a[196:197], v49 offset:8192
 ds_read_b64_tr_b16 a[198:199], v49 offset:12288
 v_cvt_pk_bf16_f32 v25, v2, v3
 v_mfma_f32_16x16x32_bf16 v[16:19], a[164:167], a[68:71], v[16:19]
 ds_read_b64_tr_b16 a[200:201], v50 offset:8192
 ds_read_b64_tr_b16 a[202:203], v50 offset:12288
 v_fma_f32 v5, v5, s24, v44
 v_exp_f32 v4, v4
 v_mfma_f32_16x16x32_bf16 v[16:19], a[168:171], a[72:75], v[16:19]
 ds_read_b64_tr_b16 a[204:205], v51 offset:8192
 ds_read_b64_tr_b16 a[206:207], v51 offset:12288
 v_exp_f32_e64 v5, v5
 v_mfma_f32_16x16x32_bf16 v[16:19], a[172:175], a[76:79], v[16:19]
 s_waitcnt lgkmcnt(10)
 ds_read_b64_tr_b16 a[208:209], v48 offset:9216
 ds_read_b64_tr_b16 a[210:211], v48 offset:13312
 v_cvt_pk_bf16_f32 v26, v4, v5
 v_fma_f32 v6, v6, s24, v44
 v_mfma_f32_16x16x32_bf16 v[20:23], a[188:191], a[76:79], 0
L_stub2:
 s_cbranch_vccnz L_stub6
.if ((L_stub2-L_main)>>6) != 128
.error "stub misplaced"
.endif
 ds_read_b64_tr_b16 a[212:213], v49 offset:9216
 ds_read_b64_tr_b16 a[214:215], v49 offset:13312
 v_fma_f32 v7, v7, s24, v44
 v_exp_f32 v6, v6
 v_mfma_f32_16x16x32_bf16 v[20:23], a[184:187], a[72:75], v[20:23]
 s_waitcnt lgkmcnt(12)
 ds_read_b64_tr_b16 a[216:217], v50 offset:9216
 ds_read_b64_tr_b16 a[218:219], v50 offset:13312
 v_exp_f32 v7, v7
 v_mfma_f32_16x16x32_bf16 v[20:23], a[180:183], a[68:71], v[20:23]
 buffer_load_dwordx4 v54, s[16:19], s29 offen offset:0 nt lds
 v_cvt_pk_bf16_f32 v27, v6, v7
 v_mfma_f32_16x16x32_bf16 v[20:23], a[176:179], a[64:67], v[20:23]
 s_waitcnt lgkmcnt(10)
 ds_read_b64_tr_b16 a[220:221], v51 offset:9216
 ds_read_b64_tr_b16 a[222:223], v51 offset:13312
 v_mfma_f32_16x16x32_bf16 v[192:195], a[192:195], v[24:27], v[192:195]
 v_fma_f32 v8, v8, s24, v45
 v_fma_f32 v9, v9, s24, v45
 v_mfma_f32_16x16x32_bf16 v[196:199], a[196:199], v[24:27], v[196:199]
 s_waitcnt lgkmcnt(8)
 v_exp_f32 v8, v8
 v_mfma_f32_16x16x32_bf16 v[200:203], a[200:203], v[24:27], v[200:203]
 v_exp_f32 v9, v9
 v_mfma_f32_16x16x32_bf16 v[204:207], a[204:207], v[24:27], v[204:207]
 s_waitcnt lgkmcnt(4)
 v_cvt_pk_bf16_f32 v28, v8, v9
 v_fma_f32 v10, v10, s24, v45
 v_mfma_f32_16x16x32_bf16 v[208:211], a[208:211], v[24:27], v[208:211]
 v_fma_f32 v11, v11, s24, v45
 v_fma_f32 v12, v12, s24, v45
 v_mfma_f32_16x16x32_bf16 v[212:215], a[212:215], v[24:27], v[212:215]
 s_waitcnt lgkmcnt(2)
 v_exp_f32 v10, v10
 v_mfma_f32_16x16x32_bf16 v[216:219], a[216:219], v[24:27], v[216:219]
 s_waitcnt lgkmcnt(0)
 buffer_load_dwordx4 v54, s[16:19], s29 offen offset:2048 nt lds
 v_mfma_f32_16x16x32_bf16 v[220:223], a[220:223], v[24:27], v[220:223]
 s_add_u32 m0, s26, 57344
 v_exp_f32 v11, v11
 v_mfma_f32_16x16x32_bf16 v[0:3], a[160:163], a[80:83], 0
 s_addk_i32 s29, 8192
 v_cvt_pk_bf16_f32 v29, v10, v11
 v_fma_f32 v13, v13, s24, v45
 v_mfma_f32_16x16x32_bf16 v[0:3], a[164:167], a[84:87], v[0:3]
 ds_read_b128 a[160:163], v46 offset:24576
 v_exp_f32 v12, v12
 v_mfma_f32_16x16x32_bf16 v[0:3], a[168:171], a[88:91], v[0:3]
 v_exp_f32 v13, v13
 v_mfma_f32_16x16x32_bf16 v[0:3], a[172:175], a[92:95], v[0:3]
 ds_read_b128 a[164:167], v47 offset:24576
 v_cvt_pk_bf16_f32 v30, v12, v13
 v_fma_f32 v14, v14, s24, v45
 v_mfma_f32_16x16x32_bf16 v[4:7], a[188:191], a[92:95], 0
 v_fma_f32 v15, v15, s24, v45
 v_exp_f32 v14, v14
 v_mfma_f32_16x16x32_bf16 v[4:7], a[184:187], a[88:91], v[4:7]
 ds_read_b128 a[168:171], v46 offset:25600
 v_exp_f32 v15, v15
 v_mfma_f32_16x16x32_bf16 v[4:7], a[180:183], a[84:87], v[4:7]
 v_cvt_pk_bf16_f32 v31, v14, v15
 v_fma_f32 v16, v16, s24, v44
 v_mfma_f32_16x16x32_bf16 v[4:7], a[176:179], a[80:83], v[4:7]
 ds_read_b128 a[172:175], v47 offset:25600
 v_fma_f32 v17, v17, s24, v44
 v_smfmac_f32_16x16x64_bf16 a[232:235], a[236:239], v[24:31], v55
 v_fma_f32 v18, v18, s24, v44
 v_mfma_f32_16x16x32_bf16 v[224:227], a[192:195], v[28:31], v[224:227]
 ds_read_b128 a[188:191], v47 offset:29696
 v_fma_f32 v19, v19, s24, v44
 v_mfma_f32_16x16x32_bf16 v[228:231], a[196:199], v[28:31], v[228:231]
 v_exp_f32 v16, v16
 v_mfma_f32_16x16x32_bf16 v[232:235], a[200:203], v[28:31], v[232:235]
 buffer_load_dwordx4 v54, s[12:15], s29 offen offset:0 nt lds
 v_mfma_f32_16x16x32_bf16 v[236:239], a[204:207], v[28:31], v[236:239]
 ds_read_b128 a[184:187], v46 offset:29696
 v_fma_f32 v20, v20, s24, v44
 v_mfma_f32_16x16x32_bf16 v[240:243], a[208:211], v[28:31], v[240:243]
 v_exp_f32 v17, v17
 v_mfma_f32_16x16x32_bf16 v[244:247], a[212:215], v[28:31], v[244:247]
 ds_read_b128 a[180:183], v47 offset:28672
 v_cvt_pk_bf16_f32 v32, v16, v17
 v_mfma_f32_16x16x32_bf16 v[248:251], a[216:219], v[28:31], v[248:251]
 ds_read_b128 a[176:179], v46 offset:28672
 v_exp_f32 v18, v18
 v_mfma_f32_16x16x32_bf16 v[252:255], a[220:223], v[28:31], v[252:255]
 s_waitcnt lgkmcnt(3)
 ds_read_b64_tr_b16 a[192:193], v48 offset:16384
 ds_read_b64_tr_b16 a[194:195], v48 offset:20480
 v_exp_f32_e64 v19, v19
 v_mfma_f32_16x16x32_bf16 v[8:11], a[160:163], a[64:67], 0
 ds_read_b64_tr_b16 a[196:197], v49 offset:16384
 ds_read_b64_tr_b16 a[198:199], v49 offset:20480
 v_cvt_pk_bf16_f32 v33, v18, v19
 v_mfma_f32_16x16x32_bf16 v[8:11], a[164:167], a[68:71], v[8:11]
 ds_read_b64_tr_b16 a[200:201], v50 offset:16384
 ds_read_b64_tr_b16 a[202:203], v50 offset:20480
 v_fma_f32 v21, v21, s24, v44
 v_exp_f32 v20, v20
 v_mfma_f32_16x16x32_bf16 v[8:11], a[168:171], a[72:75], v[8:11]
 ds_read_b64_tr_b16 a[204:205], v51 offset:16384
 ds_read_b64_tr_b16 a[206:207], v51 offset:20480
 v_exp_f32 v21, v21
 v_mfma_f32_16x16x32_bf16 v[8:11], a[172:175], a[76:79], v[8:11]
 ds_read_b64_tr_b16 a[208:209], v48 offset:17408
 ds_read_b64_tr_b16 a[210:211], v48 offset:21504
 v_cvt_pk_bf16_f32 v34, v20, v21
 v_fma_f32 v22, v22, s24, v44
 v_mfma_f32_16x16x32_bf16 v[12:15], a[188:191], a[76:79], 0
 s_waitcnt lgkmcnt(11)
 ds_read_b64_tr_b16 a[212:213], v49 offset:17408
 ds_read_b64_tr_b16 a[214:215], v49 offset:21504
 v_fma_f32 v23, v23, s24, v44
 v_exp_f32 v22, v22
 v_mfma_f32_16x16x32_bf16 v[12:15], a[184:187], a[72:75], v[12:15]
 ds_read_b64_tr_b16 a[216:217], v50 offset:17408
 ds_read_b64_tr_b16 a[218:219], v50 offset:21504
 v_exp_f32 v23, v23
 v_mfma_f32_16x16x32_bf16 v[12:15], a[180:183], a[68:71], v[12:15]
 s_waitcnt lgkmcnt(12)
 ds_read_b64_tr_b16 a[220:221], v51 offset:17408
 ds_read_b64_tr_b16 a[222:223], v51 offset:21504
 v_cvt_pk_bf16_f32 v35, v22, v23
 v_mfma_f32_16x16x32_bf16 v[12:15], a[176:179], a[64:67], v[12:15]
 v_fma_f32 v0, v0, s24, v45
 v_fma_f32 v1, v1, s24, v45
 v_mfma_f32_16x16x32_bf16 v[192:195], a[192:195], v[32:35], v[192:195]
 s_waitcnt lgkmcnt(10)
 buffer_load_dwordx4 v54, s[12:15], s29 offen offset:2048 nt lds
 v_mfma_f32_16x16x32_bf16 v[196:199], a[196:199], v[32:35], v[196:199]
 s_add_u32 m0, s26, 122880
 v_exp_f32 v0, v0
 v_mfma_f32_16x16x32_bf16 v[200:203], a[200:203], v[32:35], v[200:203]
 s_waitcnt lgkmcnt(6)
 v_exp_f32 v1, v1
 v_mfma_f32_16x16x32_bf16 v[204:207], a[204:207], v[32:35], v[204:207]
 v_cvt_pk_bf16_f32 v36, v0, v1
 v_fma_f32 v2, v2, s24, v45
 v_mfma_f32_16x16x32_bf16 v[208:211], a[208:211], v[32:35], v[208:211]
 s_waitcnt lgkmcnt(2)
 v_fma_f32 v3, v3, s24, v45
 v_fma_f32 v4, v4, s24, v45
 v_mfma_f32_16x16x32_bf16 v[212:215], a[212:215], v[32:35], v[212:215]
 v_exp_f32 v2, v2
 v_mfma_f32_16x16x32_bf16 v[216:219], a[216:219], v[32:35], v[216:219]
 s_waitcnt vmcnt(6) lgkmcnt(0)
 v_exp_f32 v3, v3
 v_mfma_f32_16x16x32_bf16 v[220:223], a[220:223], v[32:35], v[220:223]
 s_barrier
 v_cvt_pk_bf16_f32 v37, v2, v3
 v_fma_f32 v5, v5, s24, v45
 v_mfma_f32_16x16x32_bf16 v[16:19], a[160:163], a[80:83], 0
 v_exp_f32 v4, v4
 v_mfma_f32_16x16x32_bf16 v[16:19], a[164:167], a[84:87], v[16:19]
 ds_read_b128 a[160:163], v46 offset:40960
 v_fma_f32 v6, v6, s24, v45
 v_mfma_f32_16x16x32_bf16 v[16:19], a[168:171], a[88:91], v[16:19]
 v_exp_f32 v5, v5
 v_mfma_f32_16x16x32_bf16 v[16:19], a[172:175], a[92:95], v[16:19]
 buffer_load_dwordx4 v54, s[16:19], s29 offen offset:0 nt lds
 v_cvt_pk_bf16_f32 v38, v4, v5
 v_mfma_f32_16x16x32_bf16 v[20:23], a[188:191], a[92:95], 0
 ds_read_b128 a[164:167], v47 offset:40960
 v_fma_f32 v7, v7, s24, v45
 v_exp_f32 v6, v6
 v_mfma_f32_16x16x32_bf16 v[20:23], a[184:187], a[88:91], v[20:23]
 v_exp_f32 v7, v7
 v_mfma_f32_16x16x32_bf16 v[20:23], a[180:183], a[84:87], v[20:23]
 ds_read_b128 a[168:171], v46 offset:41984
 v_cvt_pk_bf16_f32 v39, v6, v7
 v_mfma_f32_16x16x32_bf16 v[20:23], a[176:179], a[80:83], v[20:23]
 v_fma_f32 v8, v8, s24, v44
 v_fma_f32 v9, v9, s24, v44
 v_smfmac_f32_16x16x64_bf16 a[232:235], a[236:239], v[32:39], v55
 ds_read_b128 a[172:175], v47 offset:41984
 v_mfma_f32_16x16x32_bf16 v[224:227], a[192:195], v[36:39], v[224:227]
 v_exp_f32 v8, v8
 v_mfma_f32_16x16x32_bf16 v[228:231], a[196:199], v[36:39], v[228:231]
 ds_read_b128 a[188:191], v47 offset:46080
 v_fma_f32 v10, v10, s24, v44
 v_mfma_f32_16x16x32_bf16 v[232:235], a[200:203], v[36:39], v[232:235]
 v_exp_f32 v9, v9
 v_mfma_f32_16x16x32_bf16 v[236:239], a[204:207], v[36:39], v[236:239]
 ds_read_b128 a[184:187], v46 offset:46080
 v_cvt_pk_bf16_f32 v24, v8, v9
 v_mfma_f32_16x16x32_bf16 v[240:243], a[208:211], v[36:39], v[240:243]
 v_fma_f32 v11, v11, s24, v44
 v_fma_f32 v12, v12, s24, v44
 v_mfma_f32_16x16x32_bf16 v[244:247], a[212:215], v[36:39], v[244:247]
 s_waitcnt lgkmcnt(2)
 buffer_load_dwordx4 v54, s[16:19], s29 offen offset:2048 nt lds
 v_mfma_f32_16x16x32_bf16 v[248:251], a[216:219], v[36:39], v[248:251]
 s_add_u32 m0, s26, 32768
 ds_read_b128 a[180:183], v47 offset:45056
 ds_read_b128 a[176:179], v46 offset:45056
 v_exp_f32 v10, v10
 v_mfma_f32_16x16x32_bf16 v[252:255], a[220:223], v[36:39], v[252:255]
 s_addk_i32 s29, 8192
 ds_read_b64_tr_b16 a[192:193], v48 offset:24576
 ds_read_b64_tr_b16 a[194:195], v48 offset:28672
 v_exp_f32_e64 v11, v11
 v_mfma_f32_16x16x32_bf16 v[0:3], a[160:163], a[0:3], v[56:59]
 ds_read_b64_tr_b16 a[196:197], v49 offset:24576
 ds_read_b64_tr_b16 a[198:199], v49 offset:28672
 v_cvt_pk_bf16_f32 v25, v10, v11
 v_mfma_f32_16x16x32_bf16 v[0:3], a[164:167], a[4:7], v[0:3]
 ds_read_b64_tr_b16 a[200:201], v50 offset:24576
 ds_read_b64_tr_b16 a[202:203], v50 offset:28672
 v_fma_f32 v13, v13, s24, v44
 v_exp_f32 v12, v12
 v_mfma_f32_16x16x32_bf16 v[0:3], a[168:171], a[8:11], v[0:3]
 ds_read_b64_tr_b16 a[204:205], v51 offset:24576
 ds_read_b64_tr_b16 a[206:207], v51 offset:28672
 v_exp_f32_e64 v13, v13
 v_mfma_f32_16x16x32_bf16 v[0:3], a[172:175], a[12:15], v[0:3]
 s_waitcnt lgkmcnt(10)
 ds_read_b64_tr_b16 a[208:209], v48 offset:25600
 ds_read_b64_tr_b16 a[210:211], v48 offset:29696
 v_cvt_pk_bf16_f32 v26, v12, v13
 v_fma_f32 v14, v14, s24, v44
 v_mfma_f32_16x16x32_bf16 v[4:7], a[188:191], a[12:15], v[56:59]
 ds_read_b64_tr_b16 a[212:213], v49 offset:25600
 ds_read_b64_tr_b16 a[214:215], v49 offset:29696
 v_fma_f32 v15, v15, s24, v44
 v_exp_f32 v14, v14
 v_mfma_f32_16x16x32_bf16 v[4:7], a[184:187], a[8:11], v[4:7]
 s_waitcnt lgkmcnt(12)
 ds_read_b64_tr_b16 a[216:217], v50 offset:25600
 ds_read_b64_tr_b16 a[218:219], v50 offset:29696
 v_exp_f32 v15, v15
 v_mfma_f32_16x16x32_bf16 v[4:7], a[180:183], a[4:7], v[4:7]
 ds_read_b64_tr_b16 a[220:221], v51 offset:25600
 ds_read_b64_tr_b16 a[222:223], v51 offset:29696
 v_cvt_pk_bf16_f32 v27, v14, v15
 v_mfma_f32_16x16x32_bf16 v[4:7], a[176:179], a[0:3], v[4:7]
 s_waitcnt lgkmcnt(12)
 v_fma_f32 v16, v16, s24, v45
 v_fma_f32 v17, v17, s24, v45
 v_mfma_f32_16x16x32_bf16 v[192:195], a[192:195], v[24:27], v[192:195]
 v_exp_f32 v16, v16
 v_mfma_f32_16x16x32_bf16 v[196:199], a[196:199], v[24:27], v[196:199]
 s_waitcnt lgkmcnt(8)
 v_exp_f32 v17, v17
 v_mfma_f32_16x16x32_bf16 v[200:203], a[200:203], v[24:27], v[200:203]
 v_cvt_pk_bf16_f32 v28, v16, v17
 v_fma_f32 v18, v18, s24, v45
 v_mfma_f32_16x16x32_bf16 v[204:207], a[204:207], v[24:27], v[204:207]
 s_waitcnt lgkmcnt(4)
 buffer_load_dwordx4 v54, s[12:15], s29 offen offset:0 nt lds
 v_mfma_f32_16x16x32_bf16 v[208:211], a[208:211], v[24:27], v[208:211]
 v_fma_f32 v19, v19, s24, v45
 v_fma_f32 v20, v20, s24, v45
 v_mfma_f32_16x16x32_bf16 v[212:215], a[212:215], v[24:27], v[212:215]
 s_waitcnt lgkmcnt(0)
 v_exp_f32 v18, v18
 v_mfma_f32_16x16x32_bf16 v[216:219], a[216:219], v[24:27], v[216:219]
 v_exp_f32 v19, v19
 v_mfma_f32_16x16x32_bf16 v[220:223], a[220:223], v[24:27], v[220:223]
 v_cvt_pk_bf16_f32 v29, v18, v19
 v_fma_f32 v21, v21, s24, v45
 v_mfma_f32_16x16x32_bf16 v[8:11], a[160:163], a[16:19], v[60:63]
 v_exp_f32 v20, v20
 v_mfma_f32_16x16x32_bf16 v[8:11], a[164:167], a[20:23], v[8:11]
 v_exp_f32 v21, v21
 v_mfma_f32_16x16x32_bf16 v[8:11], a[168:171], a[24:27], v[8:11]
 v_cvt_pk_bf16_f32 v30, v20, v21
 v_fma_f32 v22, v22, s24, v45
 v_mfma_f32_16x16x32_bf16 v[8:11], a[172:175], a[28:31], v[8:11]
 v_exp_f32 v22, v22
 v_mfma_f32_16x16x32_bf16 v[12:15], a[188:191], a[28:31], v[60:63]
 v_exp_f32 v0, v0
 v_fma_f32 v23, v23, s24, v45
 v_mfma_f32_16x16x32_bf16 v[12:15], a[184:187], a[24:27], v[12:15]
 v_exp_f32 v23, v23
 v_mfma_f32_16x16x32_bf16 v[12:15], a[180:183], a[20:23], v[12:15]
 v_exp_f32 v1, v1
 v_cvt_pk_bf16_f32 v31, v22, v23
 v_mfma_f32_16x16x32_bf16 v[12:15], a[176:179], a[16:19], v[12:15]
 buffer_load_dwordx4 v54, s[12:15], s29 offen offset:2048 nt lds
 v_smfmac_f32_16x16x64_bf16 a[232:235], a[236:239], v[24:31], v55
 s_add_u32 m0, s26, 98304
 v_cvt_pk_bf16_f32 v32, v0, v1
 v_mfma_f32_16x16x32_bf16 v[224:227], a[192:195], v[28:31], v[224:227]
 ds_read_b64_tr_b16 a[192:193], v48 offset:40960
 ds_read_b64_tr_b16 a[194:195], v48 offset:45056
 v_mfma_f32_16x16x32_bf16 v[228:231], a[196:199], v[28:31], v[228:231]
 v_exp_f32 v2, v2
 v_mfma_f32_16x16x32_bf16 v[232:235], a[200:203], v[28:31], v[232:235]
 ds_read_b64_tr_b16 a[196:197], v49 offset:40960
 ds_read_b64_tr_b16 a[198:199], v49 offset:45056
 v_mfma_f32_16x16x32_bf16 v[236:239], a[204:207], v[28:31], v[236:239]
 v_exp_f32 v3, v3
 v_mfma_f32_16x16x32_bf16 v[240:243], a[208:211], v[28:31], v[240:243]
 ds_read_b64_tr_b16 a[200:201], v50 offset:40960
 ds_read_b64_tr_b16 a[202:203], v50 offset:45056
 v_mfma_f32_16x16x32_bf16 v[244:247], a[212:215], v[28:31], v[244:247]
 v_exp_f32 v4, v4
 v_mfma_f32_16x16x32_bf16 v[248:251], a[216:219], v[28:31], v[248:251]
 ds_read_b64_tr_b16 a[204:205], v51 offset:40960
 ds_read_b64_tr_b16 a[206:207], v51 offset:45056
 v_mfma_f32_16x16x32_bf16 v[252:255], a[220:223], v[28:31], v[252:255]
 v_exp_f32 v5, v5
 v_mfma_f32_16x16x32_bf16 v[16:19], a[160:163], a[32:35], 0
 ds_read_b64_tr_b16 a[208:209], v48 offset:41984
 ds_read_b64_tr_b16 a[210:211], v48 offset:46080
 v_cvt_pk_bf16_f32 v33, v2, v3
 v_mfma_f32_16x16x32_bf16 v[16:19], a[164:167], a[36:39], v[16:19]
 v_exp_f32 v6, v6
 v_mfma_f32_16x16x32_bf16 v[16:19], a[168:171], a[40:43], v[16:19]
 buffer_load_dwordx4 v54, s[16:19], s29 offen offset:0 nt lds
 v_mfma_f32_16x16x32_bf16 v[16:19], a[172:175], a[44:47], v[16:19]
 ds_read_b64_tr_b16 a[212:213], v49 offset:41984
 ds_read_b64_tr_b16 a[214:215], v49 offset:46080
 v_cvt_pk_bf16_f32 v34, v4, v5
 v_mfma_f32_16x16x32_bf16 v[20:23], a[188:191], a[44:47], 0
 v_exp_f32 v7, v7
 v_mfma_f32_16x16x32_bf16 v[20:23], a[184:187], a[40:43], v[20:23]
 ds_read_b64_tr_b16 a[216:217], v50 offset:41984
 ds_read_b64_tr_b16 a[218:219], v50 offset:46080
 v_mfma_f32_16x16x32_bf16 v[20:23], a[180:183], a[36:39], v[20:23]
 ds_read_b64_tr_b16 a[220:221], v51 offset:41984
 ds_read_b64_tr_b16 a[222:223], v51 offset:46080
 v_cvt_pk_bf16_f32 v35, v6, v7
 v_mfma_f32_16x16x32_bf16 v[20:23], a[176:179], a[32:35], v[20:23]
 s_waitcnt lgkmcnt(6)
 v_exp_f32 v8, v8
 v_mfma_f32_16x16x32_bf16 v[64:67], a[192:195], v[32:35], v[64:67]
 v_exp_f32 v9, v9
 v_mfma_f32_16x16x32_bf16 v[68:71], a[196:199], v[32:35], v[68:71]
 v_cvt_pk_bf16_f32 v36, v8, v9
 v_fma_f32 v16, v16, s24, v42
 v_mfma_f32_16x16x32_bf16 v[72:75], a[200:203], v[32:35], v[72:75]
 v_exp_f32 v10, v10
 v_mfma_f32_16x16x32_bf16 v[76:79], a[204:207], v[32:35], v[76:79]
 v_exp_f32 v11, v11
 v_mfma_f32_16x16x32_bf16 v[80:83], a[208:211], v[32:35], v[80:83]
 s_waitcnt lgkmcnt(2)
 v_cvt_pk_bf16_f32 v37, v10, v11
 v_fma_f32 v17, v17, s24, v42
 v_mfma_f32_16x16x32_bf16 v[84:87], a[212:215], v[32:35], v[84:87]
 v_exp_f32 v12, v12
 v_mfma_f32_16x16x32_bf16 v[88:91], a[216:219], v[32:35], v[88:91]
 s_waitcnt lgkmcnt(0)
 buffer_load_dwordx4 v54, s[16:19], s29 offen offset:2048 nt lds
 v_mfma_f32_16x16x32_bf16 v[92:95], a[220:223], v[32:35], v[92:95]
 s_add_u32 m0, s28, 131072
 v_exp_f32 v13, v13
 v_mfma_f32_16x16x32_bf16 v[0:3], a[160:163], a[48:51], 0
 s_addk_i32 s29, 8192
 v_cvt_pk_bf16_f32 v38, v12, v13
 v_fma_f32 v18, v18, s24, v42
 v_mfma_f32_16x16x32_bf16 v[0:3], a[164:167], a[52:55], v[0:3]
 v_exp_f32 v14, v14
 v_mfma_f32_16x16x32_bf16 v[0:3], a[168:171], a[56:59], v[0:3]
 v_exp_f32 v15, v15
 v_mfma_f32_16x16x32_bf16 v[0:3], a[172:175], a[60:63], v[0:3]
 v_cvt_pk_bf16_f32 v39, v14, v15
 v_fma_f32 v19, v19, s24, v42
 v_mfma_f32_16x16x32_bf16 v[4:7], a[188:191], a[60:63], 0
 v_exp_f32 v16, v16
 v_mfma_f32_16x16x32_bf16 v[4:7], a[184:187], a[56:59], v[4:7]
 v_exp_f32 v17, v17
 v_mfma_f32_16x16x32_bf16 v[4:7], a[180:183], a[52:55], v[4:7]
 v_cvt_pk_bf16_f32 v24, v16, v17
 v_fma_f32 v20, v20, s24, v42
 v_mfma_f32_16x16x32_bf16 v[4:7], a[176:179], a[48:51], v[4:7]
 v_exp_f32 v18, v18
 v_smfmac_f32_16x16x64_bf16 a[224:227], a[236:239], v[32:39], v55
 v_fma_f32 v21, v21, s24, v42
 v_mfma_f32_16x16x32_bf16 v[96:99], a[192:195], v[36:39], v[96:99]
 v_exp_f32 v19, v19
 v_mfma_f32_16x16x32_bf16 v[100:103], a[196:199], v[36:39], v[100:103]
 v_cvt_pk_bf16_f32 v25, v18, v19
 v_fma_f32 v22, v22, s24, v42
 v_mfma_f32_16x16x32_bf16 v[104:107], a[200:203], v[36:39], v[104:107]
 buffer_load_dwordx4 v54, s[8:11], s30 offen offset:0 nt lds
 v_mfma_f32_16x16x32_bf16 v[108:111], a[204:207], v[36:39], v[108:111]
 v_exp_f32 v20, v20
 v_mfma_f32_16x16x32_bf16 v[112:115], a[208:211], v[36:39], v[112:115]
 v_exp_f32 v21, v21
 v_mfma_f32_16x16x32_bf16 v[116:119], a[212:215], v[36:39], v[116:119]
 v_cvt_pk_bf16_f32 v26, v20, v21
 v_fma_f32 v23, v23, s24, v42
 v_mfma_f32_16x16x32_bf16 v[120:123], a[216:219], v[36:39], v[120:123]
 v_exp_f32 v22, v22
 v_mfma_f32_16x16x32_bf16 v[124:127], a[220:223], v[36:39], v[124:127]
 v_exp_f32 v23, v23
 v_mfma_f32_16x16x32_bf16 v[8:11], a[160:163], a[64:67], 0
 v_cvt_pk_bf16_f32 v27, v22, v23
 v_fma_f32 v0, v0, s24, v43
 v_mfma_f32_16x16x32_bf16 v[8:11], a[164:167], a[68:71], v[8:11]
 v_fma_f32 v1, v1, s24, v43
 v_fma_f32 v2, v2, s24, v43
 v_mfma_f32_16x16x32_bf16 v[8:11], a[168:171], a[72:75], v[8:11]
 v_exp_f32 v0, v0
 v_mfma_f32_16x16x32_bf16 v[8:11], a[172:175], a[76:79], v[8:11]
 v_exp_f32 v1, v1
 v_mfma_f32_16x16x32_bf16 v[12:15], a[188:191], a[76:79], 0
 v_cvt_pk_bf16_f32 v28, v0, v1
 v_fma_f32 v3, v3, s24, v43
 v_mfma_f32_16x16x32_bf16 v[12:15], a[184:187], a[72:75], v[12:15]
 v_exp_f32 v2, v2
 v_mfma_f32_16x16x32_bf16 v[12:15], a[180:183], a[68:71], v[12:15]
 v_exp_f32 v3, v3
 v_mfma_f32_16x16x32_bf16 v[12:15], a[176:179], a[64:67], v[12:15]
 v_cvt_pk_bf16_f32 v29, v2, v3
 v_fma_f32 v4, v4, s24, v43
 v_mfma_f32_16x16x32_bf16 v[128:131], a[192:195], v[24:27], v[128:131]
 v_fma_f32 v5, v5, s24, v43
 v_fma_f32 v6, v6, s24, v43
 v_mfma_f32_16x16x32_bf16 v[132:135], a[196:199], v[24:27], v[132:135]
 v_exp_f32 v4, v4
 v_mfma_f32_16x16x32_bf16 v[136:139], a[200:203], v[24:27], v[136:139]
 v_exp_f32 v5, v5
 v_mfma_f32_16x16x32_bf16 v[140:143], a[204:207], v[24:27], v[140:143]
 v_cvt_pk_bf16_f32 v30, v4, v5
 v_fma_f32 v7, v7, s24, v43
 v_mfma_f32_16x16x32_bf16 v[144:147], a[208:211], v[24:27], v[144:147]
 v_exp_f32 v6, v6
 v_mfma_f32_16x16x32_bf16 v[148:151], a[212:215], v[24:27], v[148:151]
 v_exp_f32 v7, v7
 v_mfma_f32_16x16x32_bf16 v[152:155], a[216:219], v[24:27], v[152:155]
 s_waitcnt vmcnt(9)
 v_cvt_pk_bf16_f32 v31, v6, v7
 v_fma_f32 v8, v8, s24, v44
 v_mfma_f32_16x16x32_bf16 v[156:159], a[220:223], v[24:27], v[156:159]
 s_barrier
 buffer_load_dwordx4 v54, s[8:11], s30 offen offset:2048 nt lds
 v_mfma_f32_16x16x32_bf16 v[16:19], a[160:163], a[80:83], 0
 s_addk_i32 m0, 896
 ds_read_b128 a[160:163], v46 offset:49152
 v_fma_f32 v9, v9, s24, v44
 v_mfma_f32_16x16x32_bf16 v[16:19], a[164:167], a[84:87], v[16:19]
 v_exp_f32 v8, v8
 v_mfma_f32_16x16x32_bf16 v[16:19], a[168:171], a[88:91], v[16:19]
 ds_read_b128 a[164:167], v47 offset:49152
 v_fma_f32 v10, v10, s24, v44
 v_mfma_f32_16x16x32_bf16 v[16:19], a[172:175], a[92:95], v[16:19]
 v_exp_f32 v9, v9
 v_mfma_f32_16x16x32_bf16 v[20:23], a[188:191], a[92:95], 0
 ds_read_b128 a[168:171], v46 offset:50176
 v_cvt_pk_bf16_f32 v32, v8, v9
 v_mfma_f32_16x16x32_bf16 v[20:23], a[184:187], a[88:91], v[20:23]
 v_fma_f32 v11, v11, s24, v44
 v_fma_f32 v12, v12, s24, v44
 v_mfma_f32_16x16x32_bf16 v[20:23], a[180:183], a[84:87], v[20:23]
 ds_read_b128 a[172:175], v47 offset:50176
 v_fma_f32 v13, v13, s24, v44
 v_mfma_f32_16x16x32_bf16 v[20:23], a[176:179], a[80:83], v[20:23]
 v_exp_f32 v10, v10
 v_smfmac_f32_16x16x64_bf16 a[228:231], a[236:239], v[24:31], v55
 ds_read_b128 a[188:191], v47 offset:54272
 v_mfma_f32_16x16x32_bf16 v[160:163], a[192:195], v[28:31], v[160:163]
 v_exp_f32 v11, v11
 v_mfma_f32_16x16x32_bf16 v[164:167], a[196:199], v[28:31], v[164:167]
 ds_read_b128 a[184:187], v46 offset:54272
 v_cvt_pk_bf16_f32 v33, v10, v11
 v_mfma_f32_16x16x32_bf16 v[168:171], a[200:203], v[28:31], v[168:171]
 v_exp_f32 v12, v12
 v_mfma_f32_16x16x32_bf16 v[172:175], a[204:207], v[28:31], v[172:175]
 ds_read_b128 a[180:183], v47 offset:53248
 v_fma_f32 v14, v14, s24, v44
 v_mfma_f32_16x16x32_bf16 v[176:179], a[208:211], v[28:31], v[176:179]
 v_exp_f32 v13, v13
 v_mfma_f32_16x16x32_bf16 v[180:183], a[212:215], v[28:31], v[180:183]
 ds_read_b128 a[176:179], v46 offset:53248
 v_cvt_pk_bf16_f32 v34, v12, v13
 v_mfma_f32_16x16x32_bf16 v[184:187], a[216:219], v[28:31], v[184:187]
 v_fma_f32 v15, v15, s24, v44
 v_fma_f32 v16, v16, s24, v45
 v_mfma_f32_16x16x32_bf16 v[188:191], a[220:223], v[28:31], v[188:191]
 s_waitcnt lgkmcnt(3)
 v_exp_f32 v14, v14
 v_mfma_f32_16x16x32_bf16 v[0:3], a[160:163], a[0:3], v[56:59]
 v_exp_f32 v15, v15
 v_mfma_f32_16x16x32_bf16 v[0:3], a[164:167], a[4:7], v[0:3]
 v_cvt_pk_bf16_f32 v35, v14, v15
 v_fma_f32 v17, v17, s24, v45
 v_mfma_f32_16x16x32_bf16 v[0:3], a[168:171], a[8:11], v[0:3]
 v_exp_f32 v16, v16
 v_mfma_f32_16x16x32_bf16 v[0:3], a[172:175], a[12:15], v[0:3]
 buffer_load_dwordx4 v54, s[8:11], s30 offen offset:128 nt lds
 v_mfma_f32_16x16x32_bf16 v[4:7], a[188:191], a[12:15], v[56:59]
 s_waitcnt lgkmcnt(0)
 v_exp_f32 v17, v17
 v_mfma_f32_16x16x32_bf16 v[4:7], a[184:187], a[8:11], v[4:7]
 v_cvt_pk_bf16_f32 v36, v16, v17
 v_fma_f32 v18, v18, s24, v45
 v_mfma_f32_16x16x32_bf16 v[4:7], a[180:183], a[4:7], v[4:7]
 v_fma_f32 v19, v19, s24, v45
 v_fma_f32 v20, v20, s24, v45
 v_mfma_f32_16x16x32_bf16 v[4:7], a[176:179], a[0:3], v[4:7]
 v_exp_f32 v18, v18
 v_mfma_f32_16x16x32_bf16 v[192:195], a[192:195], v[32:35], v[192:195]
 v_exp_f32 v19, v19
 v_mfma_f32_16x16x32_bf16 v[196:199], a[196:199], v[32:35], v[196:199]
 v_cvt_pk_bf16_f32 v37, v18, v19
 v_fma_f32 v21, v21, s24, v45
 v_mfma_f32_16x16x32_bf16 v[200:203], a[200:203], v[32:35], v[200:203]
 v_exp_f32 v20, v20
 v_mfma_f32_16x16x32_bf16 v[204:207], a[204:207], v[32:35], v[204:207]
 v_exp_f32 v21, v21
 v_mfma_f32_16x16x32_bf16 v[208:211], a[208:211], v[32:35], v[208:211]
 v_cvt_pk_bf16_f32 v38, v20, v21
 v_fma_f32 v22, v22, s24, v45
 v_mfma_f32_16x16x32_bf16 v[212:215], a[212:215], v[32:35], v[212:215]
 v_exp_f32 v22, v22
 v_mfma_f32_16x16x32_bf16 v[216:219], a[216:219], v[32:35], v[216:219]
 v_exp_f32 v0, v0
 v_mfma_f32_16x16x32_bf16 v[220:223], a[220:223], v[32:35], v[220:223]
 v_exp_f32 v1, v1
 v_mfma_f32_16x16x32_bf16 v[8:11], a[160:163], a[16:19], v[60:63]
 v_fma_f32 v23, v23, s24, v45
 v_cvt_pk_bf16_f32 v24, v0, v1
 v_mfma_f32_16x16x32_bf16 v[8:11], a[164:167], a[20:23], v[8:11]
 v_exp_f32 v23, v23
 v_mfma_f32_16x16x32_bf16 v[8:11], a[168:171], a[24:27], v[8:11]
 v_exp_f32 v2, v2
 v_mfma_f32_16x16x32_bf16 v[8:11], a[172:175], a[28:31], v[8:11]
 v_exp_f32 v3, v3
 v_mfma_f32_16x16x32_bf16 v[12:15], a[188:191], a[28:31], v[60:63]
 v_cvt_pk_bf16_f32 v39, v22, v23
 v_cvt_pk_bf16_f32 v25, v2, v3
 v_mfma_f32_16x16x32_bf16 v[12:15], a[184:187], a[24:27], v[12:15]
 v_exp_f32 v4, v4
 v_mfma_f32_16x16x32_bf16 v[12:15], a[180:183], a[20:23], v[12:15]
 v_exp_f32 v5, v5
 v_mfma_f32_16x16x32_bf16 v[12:15], a[176:179], a[16:19], v[12:15]
 v_exp_f32 v6, v6
 v_smfmac_f32_16x16x64_bf16 a[232:235], a[236:239], v[32:39], v55
 buffer_load_dwordx4 v54, s[8:11], s30 offen offset:2176 nt lds
 v_mfma_f32_16x16x32_bf16 v[224:227], a[192:195], v[36:39], v[224:227]
 s_add_u32 m0, s26, 0
 ds_read_b64_tr_b16 a[192:193], v48 offset:49152
 ds_read_b64_tr_b16 a[194:195], v48 offset:53248
 v_mfma_f32_16x16x32_bf16 v[228:231], a[196:199], v[36:39], v[228:231]
 s_addk_i32 s30, 4096
 v_exp_f32 v7, v7
 v_mfma_f32_16x16x32_bf16 v[232:235], a[200:203], v[36:39], v[232:235]
 ds_read_b64_tr_b16 a[196:197], v49 offset:49152
 ds_read_b64_tr_b16 a[198:199], v49 offset:53248
 v_mfma_f32_16x16x32_bf16 v[236:239], a[204:207], v[36:39], v[236:239]
 v_cvt_pk_bf16_f32 v26, v4, v5
 v_cvt_pk_bf16_f32 v27, v6, v7
 v_mfma_f32_16x16x32_bf16 v[240:243], a[208:211], v[36:39], v[240:243]
 ds_read_b64_tr_b16 a[200:201], v50 offset:49152
 ds_read_b64_tr_b16 a[202:203], v50 offset:53248
 v_mfma_f32_16x16x32_bf16 v[244:247], a[212:215], v[36:39], v[244:247]
 v_exp_f32 v8, v8
 v_mfma_f32_16x16x32_bf16 v[248:251], a[216:219], v[36:39], v[248:251]
 ds_read_b64_tr_b16 a[204:205], v51 offset:49152
 ds_read_b64_tr_b16 a[206:207], v51 offset:53248
 v_mfma_f32_16x16x32_bf16 v[252:255], a[220:223], v[36:39], v[252:255]
 v_exp_f32 v9, v9
 v_mfma_f32_16x16x32_bf16 v[16:19], a[160:163], a[32:35], 0
 ds_read_b64_tr_b16 a[208:209], v48 offset:50176
 ds_read_b64_tr_b16 a[210:211], v48 offset:54272
 v_mfma_f32_16x16x32_bf16 v[16:19], a[164:167], a[36:39], v[16:19]
 v_exp_f32 v10, v10
 v_mfma_f32_16x16x32_bf16 v[16:19], a[168:171], a[40:43], v[16:19]
 ds_read_b64_tr_b16 a[212:213], v49 offset:50176
 ds_read_b64_tr_b16 a[214:215], v49 offset:54272
 v_mfma_f32_16x16x32_bf16 v[16:19], a[172:175], a[44:47], v[16:19]
 v_exp_f32 v11, v11
 v_mfma_f32_16x16x32_bf16 v[20:23], a[188:191], a[44:47], 0
 ds_read_b64_tr_b16 a[216:217], v50 offset:50176
 ds_read_b64_tr_b16 a[218:219], v50 offset:54272
 v_mfma_f32_16x16x32_bf16 v[20:23], a[184:187], a[40:43], v[20:23]
 v_cvt_pk_bf16_f32 v28, v8, v9
 v_cvt_pk_bf16_f32 v29, v10, v11
 v_mfma_f32_16x16x32_bf16 v[20:23], a[180:183], a[36:39], v[20:23]
 ds_read_b64_tr_b16 a[220:221], v51 offset:50176
 ds_read_b64_tr_b16 a[222:223], v51 offset:54272
 v_mfma_f32_16x16x32_bf16 v[20:23], a[176:179], a[32:35], v[20:23]
 s_waitcnt lgkmcnt(6)
 v_exp_f32 v12, v12
 v_mfma_f32_16x16x32_bf16 v[64:67], a[192:195], v[24:27], v[64:67]
L_stub3:
 s_cbranch_vccnz L_stub7
.if ((L_stub3-L_main)>>6) != 192
.error "stub misplaced"
.endif
 v_exp_f32 v13, v13
 v_mfma_f32_16x16x32_bf16 v[68:71], a[196:199], v[24:27], v[68:71]
 v_cvt_pk_bf16_f32 v30, v12, v13
 v_fma_f32 v16, v16, s24, v42
 v_mfma_f32_16x16x32_bf16 v[72:75], a[200:203], v[24:27], v[72:75]
 v_exp_f32 v14, v14
 v_mfma_f32_16x16x32_bf16 v[76:79], a[204:207], v[24:27], v[76:79]
 buffer_load_dwordx4 v54, s[12:15], s29 offen offset:0 nt lds
 v_mfma_f32_16x16x32_bf16 v[80:83], a[208:211], v[24:27], v[80:83]
 s_waitcnt lgkmcnt(2)
 v_exp_f32 v15, v15
 v_mfma_f32_16x16x32_bf16 v[84:87], a[212:215], v[24:27], v[84:87]
 v_cvt_pk_bf16_f32 v31, v14, v15
 v_fma_f32 v17, v17, s24, v42
 v_mfma_f32_16x16x32_bf16 v[88:91], a[216:219], v[24:27], v[88:91]
 s_waitcnt lgkmcnt(0)
 v_exp_f32 v16, v16
 v_mfma_f32_16x16x32_bf16 v[92:95], a[220:223], v[24:27], v[92:95]
 v_exp_f32 v17, v17
 v_mfma_f32_16x16x32_bf16 v[0:3], a[160:163], a[48:51], 0
 v_cvt_pk_bf16_f32 v32, v16, v17
 v_fma_f32 v18, v18, s24, v42
 v_mfma_f32_16x16x32_bf16 v[0:3], a[164:167], a[52:55], v[0:3]
 v_fma_f32 v19, v19, s24, v42
 v_fma_f32 v20, v20, s24, v42
 v_mfma_f32_16x16x32_bf16 v[0:3], a[168:171], a[56:59], v[0:3]
 v_exp_f32 v18, v18
 v_mfma_f32_16x16x32_bf16 v[0:3], a[172:175], a[60:63], v[0:3]
 v_exp_f32 v19, v19
 v_mfma_f32_16x16x32_bf16 v[4:7], a[188:191], a[60:63], 0
 v_cvt_pk_bf16_f32 v33, v18, v19
 v_fma_f32 v21, v21, s24, v42
 v_mfma_f32_16x16x32_bf16 v[4:7], a[184:187], a[56:59], v[4:7]
 v_exp_f32 v20, v20
 v_mfma_f32_16x16x32_bf16 v[4:7], a[180:183], a[52:55], v[4:7]
 v_exp_f32 v21, v21
 v_mfma_f32_16x16x32_bf16 v[4:7], a[176:179], a[48:51], v[4:7]
 buffer_load_dwordx4 v54, s[12:15], s29 offen offset:2048 nt lds
 v_smfmac_f32_16x16x64_bf16 a[224:227], a[236:239], v[24:31], v55
 s_add_u32 m0, s26, 65536
 v_cvt_pk_bf16_f32 v34, v20, v21
 v_mfma_f32_16x16x32_bf16 v[96:99], a[192:195], v[28:31], v[96:99]
 v_fma_f32 v22, v22, s24, v42
 v_fma_f32 v23, v23, s24, v42
 v_mfma_f32_16x16x32_bf16 v[100:103], a[196:199], v[28:31], v[100:103]
 v_exp_f32 v22, v22
 v_mfma_f32_16x16x32_bf16 v[104:107], a[200:203], v[28:31], v[104:107]
 v_exp_f32 v23, v23
 v_mfma_f32_16x16x32_bf16 v[108:111], a[204:207], v[28:31], v[108:111]
 v_cvt_pk_bf16_f32 v35, v22, v23
 v_fma_f32 v0, v0, s24, v43
 v_mfma_f32_16x16x32_bf16 v[112:115], a[208:211], v[28:31], v[112:115]
 v_fma_f32 v1, v1, s24, v43
 v_fma_f32 v2, v2, s24, v43
 v_mfma_f32_16x16x32_bf16 v[116:119], a[212:215], v[28:31], v[116:119]
 v_exp_f32 v0, v0
 v_mfma_f32_16x16x32_bf16 v[120:123], a[216:219], v[28:31], v[120:123]
 v_exp_f32 v1, v1
 v_mfma_f32_16x16x32_bf16 v[124:127], a[220:223], v[28:31], v[124:127]
 v_cvt_pk_bf16_f32 v36, v0, v1
 v_fma_f32 v3, v3, s24, v43
 v_mfma_f32_16x16x32_bf16 v[8:11], a[160:163], a[64:67], 0
 v_exp_f32 v2, v2
 v_mfma_f32_16x16x32_bf16 v[8:11], a[164:167], a[68:71], v[8:11]
 v_exp_f32 v3, v3
 v_mfma_f32_16x16x32_bf16 v[8:11], a[168:171], a[72:75], v[8:11]
 buffer_load_dwordx4 v54, s[16:19], s29 offen offset:0 nt lds
 v_mfma_f32_16x16x32_bf16 v[8:11], a[172:175], a[76:79], v[8:11]
 v_cvt_pk_bf16_f32 v37, v2, v3
 v_fma_f32 v4, v4, s24, v43
 v_mfma_f32_16x16x32_bf16 v[12:15], a[188:191], a[76:79], 0
 v_fma_f32 v5, v5, s24, v43
 v_fma_f32 v6, v6, s24, v43
 v_mfma_f32_16x16x32_bf16 v[12:15], a[184:187], a[72:75], v[12:15]
 v_exp_f32 v4, v4
 v_mfma_f32_16x16x32_bf16 v[12:15], a[180:183], a[68:71], v[12:15]
 v_exp_f32 v5, v5
 v_mfma_f32_16x16x32_bf16 v[12:15], a[176:179], a[64:67], v[12:15]
 v_cvt_pk_bf16_f32 v38, v4, v5
 v_fma_f32 v7, v7, s24, v43
 v_mfma_f32_16x16x32_bf16 v[128:131], a[192:195], v[32:35], v[128:131]
 v_exp_f32 v6, v6
 v_mfma_f32_16x16x32_bf16 v[132:135], a[196:199], v[32:35], v[132:135]
 v_exp_f32 v7, v7
 v_mfma_f32_16x16x32_bf16 v[136:139], a[200:203], v[32:35], v[136:139]
 v_cvt_pk_bf16_f32 v39, v6, v7
 v_fma_f32 v8, v8, s24, v44
 v_mfma_f32_16x16x32_bf16 v[140:143], a[204:207], v[32:35], v[140:143]
 v_fma_f32 v9, v9, s24, v44
 v_fma_f32 v10, v10, s24, v44
 v_mfma_f32_16x16x32_bf16 v[144:147], a[208:211], v[32:35], v[144:147]
 v_exp_f32 v8, v8
 v_mfma_f32_16x16x32_bf16 v[148:151], a[212:215], v[32:35], v[148:151]
 v_exp_f32 v9, v9
 v_mfma_f32_16x16x32_bf16 v[152:155], a[216:219], v[32:35], v[152:155]
 s_waitcnt vmcnt(11)
 buffer_load_dwordx4 v54, s[16:19], s29 offen offset:2048 nt lds
 v_mfma_f32_16x16x32_bf16 v[156:159], a[220:223], v[32:35], v[156:159]
 s_barrier
 v_cvt_pk_bf16_f32 v24, v8, v9
 v_fma_f32 v11, v11, s24, v44
 v_mfma_f32_16x16x32_bf16 v[16:19], a[160:163], a[80:83], 0
 s_add_u32 m0, s28, 135168
 ds_read_b128 a[160:163], v46 offset:57344
 v_fma_f32 v12, v12, s24, v44
 v_mfma_f32_16x16x32_bf16 v[16:19], a[164:167], a[84:87], v[16:19]
 s_addk_i32 s29, 8192
 v_exp_f32 v10, v10
 v_mfma_f32_16x16x32_bf16 v[16:19], a[168:171], a[88:91], v[16:19]
 ds_read_b128 a[164:167], v47 offset:57344
 v_fma_f32 v13, v13, s24, v44
 v_mfma_f32_16x16x32_bf16 v[16:19], a[172:175], a[92:95], v[16:19]
 v_exp_f32 v11, v11
 v_mfma_f32_16x16x32_bf16 v[20:23], a[188:191], a[92:95], 0
 ds_read_b128 a[168:171], v46 offset:58368
 v_cvt_pk_bf16_f32 v25, v10, v11
 v_mfma_f32_16x16x32_bf16 v[20:23], a[184:187], a[88:91], v[20:23]
 v_exp_f32 v12, v12
 v_mfma_f32_16x16x32_bf16 v[20:23], a[180:183], a[84:87], v[20:23]
 ds_read_b128 a[172:175], v47 offset:58368
 v_fma_f32 v14, v14, s24, v44
 v_mfma_f32_16x16x32_bf16 v[20:23], a[176:179], a[80:83], v[20:23]
 v_exp_f32 v13, v13
 v_smfmac_f32_16x16x64_bf16 a[228:231], a[236:239], v[32:39], v55
 ds_read_b128 a[188:191], v47 offset:62464
 v_mfma_f32_16x16x32_bf16 v[160:163], a[192:195], v[36:39], v[160:163]
 v_cvt_pk_bf16_f32 v26, v12, v13
 v_fma_f32 v15, v15, s24, v44
 v_mfma_f32_16x16x32_bf16 v[164:167], a[196:199], v[36:39], v[164:167]
 ds_read_b128 a[184:187], v46 offset:62464
 v_fma_f32 v16, v16, s24, v45
 v_mfma_f32_16x16x32_bf16 v[168:171], a[200:203], v[36:39], v[168:171]
 v_exp_f32 v14, v14
 v_mfma_f32_16x16x32_bf16 v[172:175], a[204:207], v[36:39], v[172:175]
 buffer_load_dwordx4 v54, s[8:11], s30 offen offset:0 nt lds
 v_mfma_f32_16x16x32_bf16 v[176:179], a[208:211], v[36:39], v[176:179]
 ds_read_b128 a[180:183], v47 offset:61440
 v_fma_f32 v17, v17, s24, v45
 v_mfma_f32_16x16x32_bf16 v[180:183], a[212:215], v[36:39], v[180:183]
 v_exp_f32 v15, v15
 v_mfma_f32_16x16x32_bf16 v[184:187], a[216:219], v[36:39], v[184:187]
 ds_read_b128 a[176:179], v46 offset:61440
 v_cvt_pk_bf16_f32 v27, v14, v15
 v_mfma_f32_16x16x32_bf16 v[188:191], a[220:223], v[36:39], v[188:191]
 s_waitcnt lgkmcnt(3)
 v_exp_f32 v16, v16
 v_mfma_f32_16x16x32_bf16 v[0:3], a[160:163], a[0:3], v[56:59]
 v_exp_f32 v17, v17
 v_mfma_f32_16x16x32_bf16 v[0:3], a[164:167], a[4:7], v[0:3]
 v_cvt_pk_bf16_f32 v28, v16, v17
 v_fma_f32 v18, v18, s24, v45
 v_mfma_f32_16x16x32_bf16 v[0:3], a[168:171], a[8:11], v[0:3]
 v_fma_f32 v19, v19, s24, v45
 v_fma_f32 v20, v20, s24, v45
 v_mfma_f32_16x16x32_bf16 v[0:3], a[172:175], a[12:15], v[0:3]
 v_exp_f32 v18, v18
 v_mfma_f32_16x16x32_bf16 v[4:7], a[188:191], a[12:15], v[56:59]
 s_waitcnt lgkmcnt(1)
 v_exp_f32 v19, v19
 v_mfma_f32_16x16x32_bf16 v[4:7], a[184:187], a[8:11], v[4:7]
 v_cvt_pk_bf16_f32 v29, v18, v19
 v_fma_f32 v21, v21, s24, v45
 v_mfma_f32_16x16x32_bf16 v[4:7], a[180:183], a[4:7], v[4:7]
 s_waitcnt lgkmcnt(0)
 v_exp_f32 v20, v20
 v_mfma_f32_16x16x32_bf16 v[4:7], a[176:179], a[0:3], v[4:7]
 v_exp_f32 v21, v21
 v_mfma_f32_16x16x32_bf16 v[192:195], a[192:195], v[24:27], v[192:195]
 v_cvt_pk_bf16_f32 v30, v20, v21
 v_fma_f32 v22, v22, s24, v45
 v_mfma_f32_16x16x32_bf16 v[196:199], a[196:199], v[24:27], v[196:199]
 v_exp_f32 v22, v22
 v_mfma_f32_16x16x32_bf16 v[200:203], a[200:203], v[24:27], v[200:203]
 v_exp_f32 v0, v0
 v_mfma_f32_16x16x32_bf16 v[204:207], a[204:207], v[24:27], v[204:207]
 v_exp_f32 v1, v1
 v_mfma_f32_16x16x32_bf16 v[208:211], a[208:211], v[24:27], v[208:211]
 v_fma_f32 v23, v23, s24, v45
 v_cvt_pk_bf16_f32 v32, v0, v1
 v_mfma_f32_16x16x32_bf16 v[212:215], a[212:215], v[24:27], v[212:215]
 v_exp_f32 v23, v23
 v_mfma_f32_16x16x32_bf16 v[216:219], a[216:219], v[24:27], v[216:219]
 v_exp_f32 v2, v2
 v_mfma_f32_16x16x32_bf16 v[220:223], a[220:223], v[24:27], v[220:223]
 buffer_load_dwordx4 v54, s[8:11], s30 offen offset:2048 nt lds
 v_mfma_f32_16x16x32_bf16 v[8:11], a[160:163], a[16:19], v[60:63]
 s_addk_i32 m0, 896
 v_exp_f32 v3, v3
 v_mfma_f32_16x16x32_bf16 v[8:11], a[164:167], a[20:23], v[8:11]
 v_cvt_pk_bf16_f32 v31, v22, v23
 v_cvt_pk_bf16_f32 v33, v2, v3
 v_mfma_f32_16x16x32_bf16 v[8:11], a[168:171], a[24:27], v[8:11]
 v_exp_f32 v4, v4
 v_mfma_f32_16x16x32_bf16 v[8:11], a[172:175], a[28:31], v[8:11]
 v_exp_f32 v5, v5
 v_mfma_f32_16x16x32_bf16 v[12:15], a[188:191], a[28:31], v[60:63]
 v_exp_f32 v6, v6
 v_mfma_f32_16x16x32_bf16 v[12:15], a[184:187], a[24:27], v[12:15]
 v_exp_f32 v7, v7
 v_mfma_f32_16x16x32_bf16 v[12:15], a[180:183], a[20:23], v[12:15]
 v_cvt_pk_bf16_f32 v34, v4, v5
 v_cvt_pk_bf16_f32 v35, v6, v7
 v_mfma_f32_16x16x32_bf16 v[12:15], a[176:179], a[16:19], v[12:15]
 v_exp_f32 v8, v8
 v_smfmac_f32_16x16x64_bf16 a[232:235], a[236:239], v[24:31], v55
 v_mfma_f32_16x16x32_bf16 v[224:227], a[192:195], v[28:31], v[224:227]
 ds_read_b64_tr_b16 a[192:193], v48 offset:57344
 ds_read_b64_tr_b16 a[194:195], v48 offset:61440
 v_mfma_f32_16x16x32_bf16 v[228:231], a[196:199], v[28:31], v[228:231]
 v_exp_f32 v9, v9
 v_mfma_f32_16x16x32_bf16 v[232:235], a[200:203], v[28:31], v[232:235]
 ds_read_b64_tr_b16 a[196:197], v49 offset:57344
 ds_read_b64_tr_b16 a[198:199], v49 offset:61440
 v_mfma_f32_16x16x32_bf16 v[236:239], a[204:207], v[28:31], v[236:239]
 v_exp_f32 v10, v10
 v_mfma_f32_16x16x32_bf16 v[240:243], a[208:211], v[28:31], v[240:243]
 ds_read_b64_tr_b16 a[200:201], v50 offset:57344
 ds_read_b64_tr_b16 a[202:203], v50 offset:61440
 v_mfma_f32_16x16x32_bf16 v[244:247], a[212:215], v[28:31], v[244:247]
 v_exp_f32 v11, v11
 v_mfma_f32_16x16x32_bf16 v[248:251], a[216:219], v[28:31], v[248:251]
 ds_read_b64_tr_b16 a[204:205], v51 offset:57344
 ds_read_b64_tr_b16 a[206:207], v51 offset:61440
 v_mfma_f32_16x16x32_bf16 v[252:255], a[220:223], v[28:31], v[252:255]
 v_cvt_pk_bf16_f32 v36, v8, v9
 v_cvt_pk_bf16_f32 v37, v10, v11
 v_mfma_f32_16x16x32_bf16 v[16:19], a[160:163], a[32:35], 0
 ds_read_b64_tr_b16 a[208:209], v48 offset:58368
 ds_read_b64_tr_b16 a[210:211], v48 offset:62464
 v_mfma_f32_16x16x32_bf16 v[16:19], a[164:167], a[36:39], v[16:19]
 v_exp_f32 v12, v12
 v_mfma_f32_16x16x32_bf16 v[16:19], a[168:171], a[40:43], v[16:19]
 ds_read_b64_tr_b16 a[212:213], v49 offset:58368
 ds_read_b64_tr_b16 a[214:215], v49 offset:62464
 v_mfma_f32_16x16x32_bf16 v[16:19], a[172:175], a[44:47], v[16:19]
 v_exp_f32 v13, v13
 v_mfma_f32_16x16x32_bf16 v[20:23], a[188:191], a[44:47], 0
 buffer_load_dwordx4 v54, s[8:11], s30 offen offset:128 nt lds
 v_mfma_f32_16x16x32_bf16 v[20:23], a[184:187], a[40:43], v[20:23]
 ds_read_b64_tr_b16 a[216:217], v50 offset:58368
 ds_read_b64_tr_b16 a[218:219], v50 offset:62464
 v_mfma_f32_16x16x32_bf16 v[20:23], a[180:183], a[36:39], v[20:23]
 ds_read_b64_tr_b16 a[220:221], v51 offset:58368
 ds_read_b64_tr_b16 a[222:223], v51 offset:62464
 v_mfma_f32_16x16x32_bf16 v[20:23], a[176:179], a[32:35], v[20:23]
 s_waitcnt lgkmcnt(6)
 v_cvt_pk_bf16_f32 v38, v12, v13
 v_fma_f32 v16, v16, s24, v42
 v_mfma_f32_16x16x32_bf16 v[64:67], a[192:195], v[32:35], v[64:67]
 v_exp_f32 v14, v14
 v_mfma_f32_16x16x32_bf16 v[68:71], a[196:199], v[32:35], v[68:71]
 v_exp_f32 v15, v15
 v_mfma_f32_16x16x32_bf16 v[72:75], a[200:203], v[32:35], v[72:75]
 v_cvt_pk_bf16_f32 v39, v14, v15
 v_fma_f32 v17, v17, s24, v42
 v_mfma_f32_16x16x32_bf16 v[76:79], a[204:207], v[32:35], v[76:79]
 v_exp_f32 v16, v16
 v_mfma_f32_16x16x32_bf16 v[80:83], a[208:211], v[32:35], v[80:83]
 s_waitcnt lgkmcnt(2)
 v_exp_f32 v17, v17
 v_mfma_f32_16x16x32_bf16 v[84:87], a[212:215], v[32:35], v[84:87]
 v_cvt_pk_bf16_f32 v24, v16, v17
 v_fma_f32 v18, v18, s24, v42
 v_mfma_f32_16x16x32_bf16 v[88:91], a[216:219], v[32:35], v[88:91]
 s_waitcnt lgkmcnt(0)
 v_fma_f32 v19, v19, s24, v42
 v_fma_f32 v20, v20, s24, v42
 v_mfma_f32_16x16x32_bf16 v[92:95], a[220:223], v[32:35], v[92:95]
 v_exp_f32 v18, v18
 v_mfma_f32_16x16x32_bf16 v[0:3], a[160:163], a[48:51], 0
 v_exp_f32 v19, v19
 v_mfma_f32_16x16x32_bf16 v[0:3], a[164:167], a[52:55], v[0:3]
 v_cvt_pk_bf16_f32 v25, v18, v19
 v_fma_f32 v21, v21, s24, v42
 v_mfma_f32_16x16x32_bf16 v[0:3], a[168:171], a[56:59], v[0:3]
 v_exp_f32 v20, v20
 v_mfma_f32_16x16x32_bf16 v[0:3], a[172:175], a[60:63], v[0:3]
 v_exp_f32 v21, v21
 v_mfma_f32_16x16x32_bf16 v[4:7], a[188:191], a[60:63], 0
 v_cvt_pk_bf16_f32 v26, v20, v21
 v_fma_f32 v22, v22, s24, v42
 v_mfma_f32_16x16x32_bf16 v[4:7], a[184:187], a[56:59], v[4:7]
 v_exp_f32 v22, v22
 v_mfma_f32_16x16x32_bf16 v[4:7], a[180:183], a[52:55], v[4:7]
 v_fma_f32 v23, v23, s24, v42
 v_fma_f32 v0, v0, s24, v43
 v_mfma_f32_16x16x32_bf16 v[4:7], a[176:179], a[48:51], v[4:7]
 v_exp_f32 v23, v23
 v_smfmac_f32_16x16x64_bf16 a[224:227], a[236:239], v[32:39], v55
 buffer_load_dwordx4 v54, s[8:11], s30 offen offset:2176 nt lds
 v_mfma_f32_16x16x32_bf16 v[96:99], a[192:195], v[36:39], v[96:99]
 s_add_u32 m0, s26, 8192
 v_cvt_pk_bf16_f32 v27, v22, v23
 v_fma_f32 v1, v1, s24, v43
 v_mfma_f32_16x16x32_bf16 v[100:103], a[196:199], v[36:39], v[100:103]
 s_addk_i32 s30, 4096
 v_exp_f32 v0, v0
 v_mfma_f32_16x16x32_bf16 v[104:107], a[200:203], v[36:39], v[104:107]
 v_exp_f32 v1, v1
 v_mfma_f32_16x16x32_bf16 v[108:111], a[204:207], v[36:39], v[108:111]
 v_cvt_pk_bf16_f32 v28, v0, v1
 v_fma_f32 v2, v2, s24, v43
 v_mfma_f32_16x16x32_bf16 v[112:115], a[208:211], v[36:39], v[112:115]
 v_fma_f32 v3, v3, s24, v43
 v_fma_f32 v4, v4, s24, v43
 v_mfma_f32_16x16x32_bf16 v[116:119], a[212:215], v[36:39], v[116:119]
 v_exp_f32 v2, v2
 v_mfma_f32_16x16x32_bf16 v[120:123], a[216:219], v[36:39], v[120:123]
 v_exp_f32 v3, v3
 v_mfma_f32_16x16x32_bf16 v[124:127], a[220:223], v[36:39], v[124:127]
 v_cvt_pk_bf16_f32 v29, v2, v3
 v_fma_f32 v5, v5, s24, v43
 v_mfma_f32_16x16x32_bf16 v[8:11], a[160:163], a[64:67], 0
 v_exp_f32 v4, v4
 v_mfma_f32_16x16x32_bf16 v[8:11], a[164:167], a[68:71], v[8:11]
 v_exp_f32 v5, v5
 v_mfma_f32_16x16x32_bf16 v[8:11], a[168:171], a[72:75], v[8:11]
 v_cvt_pk_bf16_f32 v30, v4, v5
 v_fma_f32 v6, v6, s24, v43
 v_mfma_f32_16x16x32_bf16 v[8:11], a[172:175], a[76:79], v[8:11]
 v_exp_f32 v6, v6
 v_mfma_f32_16x16x32_bf16 v[12:15], a[188:191], a[76:79], 0
 v_fma_f32 v7, v7, s24, v43
 v_mfma_f32_16x16x32_bf16 v[12:15], a[184:187], a[72:75], v[12:15]
 v_exp_f32 v7, v7
 v_mfma_f32_16x16x32_bf16 v[12:15], a[180:183], a[68:71], v[12:15]
 v_cvt_pk_bf16_f32 v31, v6, v7
 v_mfma_f32_16x16x32_bf16 v[12:15], a[176:179], a[64:67], v[12:15]
 v_fma_f32 v8, v8, s24, v44
 v_fma_f32 v9, v9, s24, v44
 v_mfma_f32_16x16x32_bf16 v[128:131], a[192:195], v[24:27], v[128:131]
 v_exp_f32 v8, v8
 v_mfma_f32_16x16x32_bf16 v[132:135], a[196:199], v[24:27], v[132:135]
 v_exp_f32 v9, v9
 v_mfma_f32_16x16x32_bf16 v[136:139], a[200:203], v[24:27], v[136:139]
 v_cvt_pk_bf16_f32 v32, v8, v9
 v_fma_f32 v10, v10, s24, v44
 v_mfma_f32_16x16x32_bf16 v[140:143], a[204:207], v[24:27], v[140:143]
 buffer_load_dwordx4 v54, s[12:15], s29 offen offset:0 nt lds
 v_mfma_f32_16x16x32_bf16 v[144:147], a[208:211], v[24:27], v[144:147]
 v_fma_f32 v11, v11, s24, v44
 v_fma_f32 v12, v12, s24, v44
 v_mfma_f32_16x16x32_bf16 v[148:151], a[212:215], v[24:27], v[148:151]
 v_exp_f32 v10, v10
 v_mfma_f32_16x16x32_bf16 v[152:155], a[216:219], v[24:27], v[152:155]
 s_waitcnt vmcnt(13)
 v_exp_f32 v11, v11
 v_mfma_f32_16x16x32_bf16 v[156:159], a[220:223], v[24:27], v[156:159]
 s_barrier
 v_cvt_pk_bf16_f32 v33, v10, v11
 v_fma_f32 v13, v13, s24, v44
 v_mfma_f32_16x16x32_bf16 v[16:19], a[160:163], a[80:83], 0
 ds_read_b128 a[160:163], v46 offset:32768
 v_fma_f32 v14, v14, s24, v44
 v_mfma_f32_16x16x32_bf16 v[16:19], a[164:167], a[84:87], v[16:19]
 v_exp_f32 v12, v12
 v_mfma_f32_16x16x32_bf16 v[16:19], a[168:171], a[88:91], v[16:19]
 ds_read_b128 a[164:167], v47 offset:32768
 v_fma_f32 v15, v15, s24, v44
 v_mfma_f32_16x16x32_bf16 v[16:19], a[172:175], a[92:95], v[16:19]
 v_exp_f32 v13, v13
 v_mfma_f32_16x16x32_bf16 v[20:23], a[188:191], a[92:95], 0
 ds_read_b128 a[168:171], v46 offset:33792
 v_cvt_pk_bf16_f32 v34, v12, v13
 v_mfma_f32_16x16x32_bf16 v[20:23], a[184:187], a[88:91], v[20:23]
 v_exp_f32 v14, v14
 v_mfma_f32_16x16x32_bf16 v[20:23], a[180:183], a[84:87], v[20:23]
 ds_read_b128 a[172:175], v47 offset:33792
 v_fma_f32 v16, v16, s24, v45
 v_mfma_f32_16x16x32_bf16 v[20:23], a[176:179], a[80:83], v[20:23]
 v_exp_f32 v15, v15
 v_smfmac_f32_16x16x64_bf16 a[228:231], a[236:239], v[24:31], v55
 buffer_load_dwordx4 v54, s[12:15], s29 offen offset:2048 nt lds
 v_mfma_f32_16x16x32_bf16 v[160:163], a[192:195], v[28:31], v[160:163]
 s_add_u32 m0, s26, 73728
 ds_read_b128 a[188:191], v47 offset:37888
 v_cvt_pk_bf16_f32 v35, v14, v15
 v_mfma_f32_16x16x32_bf16 v[164:167], a[196:199], v[28:31], v[164:167]
 v_fma_f32 v17, v17, s24, v45
 v_fma_f32 v18, v18, s24, v45
 v_mfma_f32_16x16x32_bf16 v[168:171], a[200:203], v[28:31], v[168:171]
 buffer_load_dwordx4 v54, s[16:19], s29 offen offset:0 nt lds
 v_mfma_f32_16x16x32_bf16 v[172:175], a[204:207], v[28:31], v[172:175]
 ds_read_b128 a[184:187], v46 offset:37888
 v_fma_f32 v19, v19, s24, v45
 v_mfma_f32_16x16x32_bf16 v[176:179], a[208:211], v[28:31], v[176:179]
 v_exp_f32 v16, v16
 v_mfma_f32_16x16x32_bf16 v[180:183], a[212:215], v[28:31], v[180:183]
 ds_read_b128 a[180:183], v47 offset:36864
 v_fma_f32 v20, v20, s24, v45
 v_mfma_f32_16x16x32_bf16 v[184:187], a[216:219], v[28:31], v[184:187]
 ds_read_b128 a[176:179], v46 offset:36864
 v_fma_f32 v21, v21, s24, v45
 v_mfma_f32_16x16x32_bf16 v[188:191], a[220:223], v[28:31], v[188:191]
 s_waitcnt lgkmcnt(3)
 v_exp_f32 v17, v17
 v_mfma_f32_16x16x32_bf16 v[0:3], a[160:163], a[0:3], v[56:59]
 v_cvt_pk_bf16_f32 v36, v16, v17
 v_fma_f32 v22, v22, s24, v45
 v_mfma_f32_16x16x32_bf16 v[0:3], a[164:167], a[4:7], v[0:3]
 v_exp_f32 v18, v18
 v_mfma_f32_16x16x32_bf16 v[0:3], a[168:171], a[8:11], v[0:3]
 s_waitcnt vmcnt(11) lgkmcnt(1)
 buffer_load_dwordx4 v54, s[16:19], s29 offen offset:2048 nt lds
 v_mfma_f32_16x16x32_bf16 v[0:3], a[172:175], a[12:15], v[0:3]
 s_add_u32 m0, s26, 16384
 ds_read_b128 a[96:99], v52 offset:0
 v_fma_f32 v23, v23, s24, v45
 v_mfma_f32_16x16x32_bf16 v[4:7], a[188:191], a[12:15], v[56:59]
 s_addk_i32 s29, 8192
 ds_read_b128 a[100:103], v53 offset:0
 v_mfma_f32_16x16x32_bf16 v[4:7], a[184:187], a[8:11], v[4:7]
 ds_read_b128 a[104:107], v52 offset:1024
 v_mfma_f32_16x16x32_bf16 v[4:7], a[180:183], a[4:7], v[4:7]
 s_waitcnt lgkmcnt(3)
 ds_read_b128 a[108:111], v53 offset:1024
 v_mfma_f32_16x16x32_bf16 v[4:7], a[176:179], a[0:3], v[4:7]
 v_exp_f32 v19, v19
 v_mfma_f32_16x16x32_bf16 v[192:195], a[192:195], v[32:35], v[192:195]
 v_exp_f32 v20, v20
 v_mfma_f32_16x16x32_bf16 v[196:199], a[196:199], v[32:35], v[196:199]
 v_exp_f32 v21, v21
 v_mfma_f32_16x16x32_bf16 v[200:203], a[200:203], v[32:35], v[200:203]
 v_cvt_pk_bf16_f32 v37, v18, v19
 v_cvt_pk_bf16_f32 v38, v20, v21
 v_mfma_f32_16x16x32_bf16 v[204:207], a[204:207], v[32:35], v[204:207]
 v_exp_f32 v22, v22
 v_mfma_f32_16x16x32_bf16 v[208:211], a[208:211], v[32:35], v[208:211]
 v_exp_f32 v23, v23
 v_mfma_f32_16x16x32_bf16 v[212:215], a[212:215], v[32:35], v[212:215]
 v_exp_f32 v0, v0
 v_mfma_f32_16x16x32_bf16 v[216:219], a[216:219], v[32:35], v[216:219]
 v_exp_f32 v1, v1
 v_mfma_f32_16x16x32_bf16 v[220:223], a[220:223], v[32:35], v[220:223]
 v_cvt_pk_bf16_f32 v39, v22, v23
 v_cvt_pk_bf16_f32 v24, v0, v1
 v_mfma_f32_16x16x32_bf16 v[8:11], a[160:163], a[16:19], v[60:63]
 v_exp_f32 v2, v2
 v_mfma_f32_16x16x32_bf16 v[8:11], a[164:167], a[20:23], v[8:11]
 v_exp_f32 v3, v3
 v_mfma_f32_16x16x32_bf16 v[8:11], a[168:171], a[24:27], v[8:11]
 v_exp_f32 v4, v4
 v_mfma_f32_16x16x32_bf16 v[8:11], a[172:175], a[28:31], v[8:11]
 v_exp_f32 v5, v5
 v_mfma_f32_16x16x32_bf16 v[12:15], a[188:191], a[28:31], v[60:63]
 v_cvt_pk_bf16_f32 v25, v2, v3
 v_cvt_pk_bf16_f32 v26, v4, v5
 v_mfma_f32_16x16x32_bf16 v[12:15], a[184:187], a[24:27], v[12:15]
 v_exp_f32 v6, v6
 v_mfma_f32_16x16x32_bf16 v[12:15], a[180:183], a[20:23], v[12:15]
 v_exp_f32 v7, v7
 v_mfma_f32_16x16x32_bf16 v[12:15], a[176:179], a[16:19], v[12:15]
 v_exp_f32 v8, v8
 v_smfmac_f32_16x16x64_bf16 a[232:235], a[236:239], v[32:39], v55
 v_cvt_pk_bf16_f32 v27, v6, v7
 v_mfma_f32_16x16x32_bf16 v[224:227], a[192:195], v[36:39], v[224:227]
 ds_read_b64_tr_b16 a[192:193], v48 offset:32768
 ds_read_b64_tr_b16 a[194:195], v48 offset:36864
 v_mfma_f32_16x16x32_bf16 v[228:231], a[196:199], v[36:39], v[228:231]
 v_exp_f32 v9, v9
 v_mfma_f32_16x16x32_bf16 v[232:235], a[200:203], v[36:39], v[232:235]
 buffer_load_dwordx4 v54, s[12:15], s29 offen offset:0 nt lds
 v_mfma_f32_16x16x32_bf16 v[236:239], a[204:207], v[36:39], v[236:239]
 ds_read_b64_tr_b16 a[196:197], v49 offset:32768
 ds_read_b64_tr_b16 a[198:199], v49 offset:36864
 v_mfma_f32_16x16x32_bf16 v[240:243], a[208:211], v[36:39], v[240:243]
 v_exp_f32 v10, v10
 v_mfma_f32_16x16x32_bf16 v[244:247], a[212:215], v[36:39], v[244:247]
 ds_read_b64_tr_b16 a[200:201], v50 offset:32768
 ds_read_b64_tr_b16 a[202:203], v50 offset:36864
 v_mfma_f32_16x16x32_bf16 v[248:251], a[216:219], v[36:39], v[248:251]
 v_exp_f32 v11, v11
 v_mfma_f32_16x16x32_bf16 v[252:255], a[220:223], v[36:39], v[252:255]
 ds_read_b64_tr_b16 a[204:205], v51 offset:32768
 ds_read_b64_tr_b16 a[206:207], v51 offset:36864
 v_mfma_f32_16x16x32_bf16 v[16:19], a[160:163], a[32:35], 0
 v_cvt_pk_bf16_f32 v28, v8, v9
 v_cvt_pk_bf16_f32 v29, v10, v11
 v_mfma_f32_16x16x32_bf16 v[16:19], a[164:167], a[36:39], v[16:19]
 ds_read_b64_tr_b16 a[208:209], v48 offset:33792
 ds_read_b64_tr_b16 a[210:211], v48 offset:37888
 v_mfma_f32_16x16x32_bf16 v[16:19], a[168:171], a[40:43], v[16:19]
 v_exp_f32 v12, v12
 v_mfma_f32_16x16x32_bf16 v[16:19], a[172:175], a[44:47], v[16:19]
 ds_read_b64_tr_b16 a[212:213], v49 offset:33792
 ds_read_b64_tr_b16 a[214:215], v49 offset:37888
 v_mfma_f32_16x16x32_bf16 v[20:23], a[188:191], a[44:47], 0
 v_exp_f32 v13, v13
 v_mfma_f32_16x16x32_bf16 v[20:23], a[184:187], a[40:43], v[20:23]
 ds_read_b64_tr_b16 a[216:217], v50 offset:33792
 ds_read_b64_tr_b16 a[218:219], v50 offset:37888
 v_mfma_f32_16x16x32_bf16 v[20:23], a[180:183], a[36:39], v[20:23]
 ds_read_b64_tr_b16 a[220:221], v51 offset:33792
 ds_read_b64_tr_b16 a[222:223], v51 offset:37888
 v_mfma_f32_16x16x32_bf16 v[20:23], a[176:179], a[32:35], v[20:23]
 s_waitcnt lgkmcnt(8)
 v_cvt_pk_bf16_f32 v30, v12, v13
 v_fma_f32 v16, v16, s24, v42
 v_mfma_f32_16x16x32_bf16 v[64:67], a[192:195], v[24:27], v[64:67]
 buffer_load_dwordx4 v54, s[12:15], s29 offen offset:2048 nt lds
 v_mfma_f32_16x16x32_bf16 v[68:71], a[196:199], v[24:27], v[68:71]
 s_add_u32 m0, s26, 81920
 v_exp_f32 v14, v14
 v_mfma_f32_16x16x32_bf16 v[72:75], a[200:203], v[24:27], v[72:75]
 v_exp_f32 v15, v15
 v_mfma_f32_16x16x32_bf16 v[76:79], a[204:207], v[24:27], v[76:79]
 s_waitcnt lgkmcnt(4)
 v_cvt_pk_bf16_f32 v31, v14, v15
 v_fma_f32 v17, v17, s24, v42
 v_mfma_f32_16x16x32_bf16 v[80:83], a[208:211], v[24:27], v[80:83]
 v_exp_f32 v16, v16
 v_mfma_f32_16x16x32_bf16 v[84:87], a[212:215], v[24:27], v[84:87]
 s_waitcnt lgkmcnt(0)
 v_exp_f32 v17, v17
 v_mfma_f32_16x16x32_bf16 v[88:91], a[216:219], v[24:27], v[88:91]
 v_cvt_pk_bf16_f32 v32, v16, v17
 v_fma_f32 v18, v18, s24, v42
 v_mfma_f32_16x16x32_bf16 v[92:95], a[220:223], v[24:27], v[92:95]
 v_fma_f32 v19, v19, s24, v42
 v_fma_f32 v20, v20, s24, v42
 v_mfma_f32_16x16x32_bf16 v[0:3], a[160:163], a[48:51], 0
 v_exp_f32 v18, v18
 v_mfma_f32_16x16x32_bf16 v[0:3], a[164:167], a[52:55], v[0:3]
 v_exp_f32 v19, v19
 v_mfma_f32_16x16x32_bf16 v[0:3], a[168:171], a[56:59], v[0:3]
 buffer_load_dwordx4 v54, s[16:19], s29 offen offset:0 nt lds
 v_mfma_f32_16x16x32_bf16 v[0:3], a[172:175], a[60:63], v[0:3]
 v_cvt_pk_bf16_f32 v33, v18, v19
 v_fma_f32 v21, v21, s24, v42
 v_mfma_f32_16x16x32_bf16 v[4:7], a[188:191], a[60:63], 0
 v_exp_f32 v20, v20
 v_mfma_f32_16x16x32_bf16 v[4:7], a[184:187], a[56:59], v[4:7]
 v_exp_f32 v21, v21
 v_mfma_f32_16x16x32_bf16 v[4:7], a[180:183], a[52:55], v[4:7]
 v_cvt_pk_bf16_f32 v34, v20, v21
 v_fma_f32 v22, v22, s24, v42
 v_mfma_f32_16x16x32_bf16 v[4:7], a[176:179], a[48:51], v[4:7]
 v_fma_f32 v23, v23, s24, v42
 v_fma_f32 v0, v0, s24, v43
 v_smfmac_f32_16x16x64_bf16 a[224:227], a[236:239], v[24:31], v55
 v_fma_f32 v1, v1, s24, v43
 v_mfma_f32_16x16x32_bf16 v[96:99], a[192:195], v[28:31], v[96:99]
 v_exp_f32 v22, v22
 v_mfma_f32_16x16x32_bf16 v[100:103], a[196:199], v[28:31], v[100:103]
 v_exp_f32 v23, v23
 v_mfma_f32_16x16x32_bf16 v[104:107], a[200:203], v[28:31], v[104:107]
 v_cvt_pk_bf16_f32 v35, v22, v23
 v_fma_f32 v2, v2, s24, v43
 v_mfma_f32_16x16x32_bf16 v[108:111], a[204:207], v[28:31], v[108:111]
 v_exp_f32 v0, v0
 v_mfma_f32_16x16x32_bf16 v[112:115], a[208:211], v[28:31], v[112:115]
 v_exp_f32 v1, v1
 v_mfma_f32_16x16x32_bf16 v[116:119], a[212:215], v[28:31], v[116:119]
 buffer_load_dwordx4 v54, s[16:19], s29 offen offset:2048 nt lds
 v_mfma_f32_16x16x32_bf16 v[120:123], a[216:219], v[28:31], v[120:123]
 s_add_u32 m0, s28, 131072
 v_cvt_pk_bf16_f32 v36, v0, v1
 v_fma_f32 v3, v3, s24, v43
 v_mfma_f32_16x16x32_bf16 v[124:127], a[220:223], v[28:31], v[124:127]
 s_addk_i32 s29, 8192
 v_exp_f32 v2, v2
 v_mfma_f32_16x16x32_bf16 v[8:11], a[160:163], a[64:67], 0
 v_exp_f32 v3, v3
 v_mfma_f32_16x16x32_bf16 v[8:11], a[164:167], a[68:71], v[8:11]
 v_cvt_pk_bf16_f32 v37, v2, v3
 v_fma_f32 v4, v4, s24, v43
 v_mfma_f32_16x16x32_bf16 v[8:11], a[168:171], a[72:75], v[8:11]
 v_fma_f32 v5, v5, s24, v43
 v_fma_f32 v6, v6, s24, v43
 v_mfma_f32_16x16x32_bf16 v[8:11], a[172:175], a[76:79], v[8:11]
 v_exp_f32 v4, v4
 v_mfma_f32_16x16x32_bf16 v[12:15], a[188:191], a[76:79], 0
 v_exp_f32 v5, v5
 v_mfma_f32_16x16x32_bf16 v[12:15], a[184:187], a[72:75], v[12:15]
 v_cvt_pk_bf16_f32 v38, v4, v5
 v_fma_f32 v7, v7, s24, v43
 v_mfma_f32_16x16x32_bf16 v[12:15], a[180:183], a[68:71], v[12:15]
L_stub4:
 s_cbranch_vccnz L_stub8
.if ((L_stub4-L_main)>>6) != 256
.error "stub misplaced"
.endif
 v_exp_f32 v6, v6
 v_mfma_f32_16x16x32_bf16 v[12:15], a[176:179], a[64:67], v[12:15]
 v_exp_f32 v7, v7
 v_mfma_f32_16x16x32_bf16 v[128:131], a[192:195], v[32:35], v[128:131]
 v_cvt_pk_bf16_f32 v39, v6, v7
 v_fma_f32 v8, v8, s24, v44
 v_mfma_f32_16x16x32_bf16 v[132:135], a[196:199], v[32:35], v[132:135]
 v_fma_f32 v9, v9, s24, v44
 v_fma_f32 v10, v10, s24, v44
 v_mfma_f32_16x16x32_bf16 v[136:139], a[200:203], v[32:35], v[136:139]
 v_exp_f32 v8, v8
 v_mfma_f32_16x16x32_bf16 v[140:143], a[204:207], v[32:35], v[140:143]
 buffer_load_dwordx4 v54, s[8:11], s30 offen offset:0 nt lds
 v_mfma_f32_16x16x32_bf16 v[144:147], a[208:211], v[32:35], v[144:147]
 v_exp_f32 v9, v9
 v_mfma_f32_16x16x32_bf16 v[148:151], a[212:215], v[32:35], v[148:151]
 v_cvt_pk_bf16_f32 v24, v8, v9
 v_fma_f32 v11, v11, s24, v44
 v_mfma_f32_16x16x32_bf16 v[152:155], a[216:219], v[32:35], v[152:155]
 s_waitcnt vmcnt(13)
 v_exp_f32 v10, v10
 v_mfma_f32_16x16x32_bf16 v[156:159], a[220:223], v[32:35], v[156:159]
 s_barrier
 v_exp_f32 v11, v11
 v_mfma_f32_16x16x32_bf16 v[16:19], a[160:163], a[80:83], 0
 ds_read_b128 a[160:163], v46 offset:0
 v_cvt_pk_bf16_f32 v25, v10, v11
 v_mfma_f32_16x16x32_bf16 v[16:19], a[164:167], a[84:87], v[16:19]
 v_fma_f32 v12, v12, s24, v44
 v_fma_f32 v13, v13, s24, v44
 v_mfma_f32_16x16x32_bf16 v[16:19], a[168:171], a[88:91], v[16:19]
 ds_read_b128 a[164:167], v47 offset:0
 v_fma_f32 v14, v14, s24, v44
 v_mfma_f32_16x16x32_bf16 v[16:19], a[172:175], a[92:95], v[16:19]
 v_exp_f32 v12, v12
 v_mfma_f32_16x16x32_bf16 v[20:23], a[188:191], a[92:95], 0
 ds_read_b128 a[168:171], v46 offset:1024
 v_fma_f32 v15, v15, s24, v44
 v_mfma_f32_16x16x32_bf16 v[20:23], a[184:187], a[88:91], v[20:23]
 v_exp_f32 v13, v13
 v_mfma_f32_16x16x32_bf16 v[20:23], a[180:183], a[84:87], v[20:23]
 ds_read_b128 a[172:175], v47 offset:1024
 v_cvt_pk_bf16_f32 v26, v12, v13
 v_mfma_f32_16x16x32_bf16 v[20:23], a[176:179], a[80:83], v[20:23]
 v_exp_f32 v14, v14
 v_smfmac_f32_16x16x64_bf16 a[228:231], a[236:239], v[32:39], v55
 ds_read_b128 a[188:191], v47 offset:5120
 v_mfma_f32_16x16x32_bf16 v[160:163], a[192:195], v[36:39], v[160:163]
 v_exp_f32 v15, v15
 v_mfma_f32_16x16x32_bf16 v[164:167], a[196:199], v[36:39], v[164:167]
 ds_read_b128 a[184:187], v46 offset:5120
 v_cvt_pk_bf16_f32 v27, v14, v15
 v_mfma_f32_16x16x32_bf16 v[168:171], a[200:203], v[36:39], v[168:171]
 v_fma_f32 v16, v16, s24, v45
 v_fma_f32 v17, v17, s24, v45
 v_mfma_f32_16x16x32_bf16 v[172:175], a[204:207], v[36:39], v[172:175]
 ds_read_b128 a[180:183], v47 offset:4096
 v_fma_f32 v18, v18, s24, v45
 v_mfma_f32_16x16x32_bf16 v[176:179], a[208:211], v[36:39], v[176:179]
 v_exp_f32 v16, v16
 v_mfma_f32_16x16x32_bf16 v[180:183], a[212:215], v[36:39], v[180:183]
 ds_read_b128 a[176:179], v46 offset:4096
 v_fma_f32 v19, v19, s24, v45
 v_mfma_f32_16x16x32_bf16 v[184:187], a[216:219], v[36:39], v[184:187]
 v_exp_f32 v17, v17
 v_mfma_f32_16x16x32_bf16 v[188:191], a[220:223], v[36:39], v[188:191]
 s_waitcnt lgkmcnt(3)
 buffer_load_dwordx4 v54, s[8:11], s30 offen offset:2048 nt lds
 v_mfma_f32_16x16x32_bf16 v[0:3], a[160:163], a[0:3], v[56:59]
 s_addk_i32 m0, 896
 v_cvt_pk_bf16_f32 v28, v16, v17
 v_fma_f32 v20, v20, s24, v45
 v_mfma_f32_16x16x32_bf16 v[0:3], a[164:167], a[4:7], v[0:3]
 v_exp_f32 v18, v18
 v_mfma_f32_16x16x32_bf16 v[0:3], a[168:171], a[8:11], v[0:3]
 v_exp_f32 v19, v19
 v_mfma_f32_16x16x32_bf16 v[0:3], a[172:175], a[12:15], v[0:3]
 v_cvt_pk_bf16_f32 v29, v18, v19
 v_fma_f32 v21, v21, s24, v45
 v_mfma_f32_16x16x32_bf16 v[4:7], a[188:191], a[12:15], v[56:59]
 s_waitcnt lgkmcnt(0)
 v_exp_f32 v20, v20
 v_mfma_f32_16x16x32_bf16 v[4:7], a[184:187], a[8:11], v[4:7]
 v_exp_f32 v21, v21
 v_mfma_f32_16x16x32_bf16 v[4:7], a[180:183], a[4:7], v[4:7]
 v_cvt_pk_bf16_f32 v30, v20, v21
 v_fma_f32 v22, v22, s24, v45
 v_mfma_f32_16x16x32_bf16 v[4:7], a[176:179], a[0:3], v[4:7]
 v_exp_f32 v22, v22
 v_mfma_f32_16x16x32_bf16 v[192:195], a[192:195], v[24:27], v[192:195]
 v_exp_f32 v0, v0
 v_mfma_f32_16x16x32_bf16 v[196:199], a[196:199], v[24:27], v[196:199]
 v_exp_f32 v1, v1
 v_mfma_f32_16x16x32_bf16 v[200:203], a[200:203], v[24:27], v[200:203]
 v_fma_f32 v23, v23, s24, v45
 v_cvt_pk_bf16_f32 v32, v0, v1
 v_mfma_f32_16x16x32_bf16 v[204:207], a[204:207], v[24:27], v[204:207]
 v_exp_f32 v23, v23
 v_mfma_f32_16x16x32_bf16 v[208:211], a[208:211], v[24:27], v[208:211]
 v_exp_f32 v2, v2
 v_mfma_f32_16x16x32_bf16 v[212:215], a[212:215], v[24:27], v[212:215]
 v_exp_f32 v3, v3
 v_mfma_f32_16x16x32_bf16 v[216:219], a[216:219], v[24:27], v[216:219]
 v_cvt_pk_bf16_f32 v31, v22, v23
 v_cvt_pk_bf16_f32 v33, v2, v3
 v_mfma_f32_16x16x32_bf16 v[220:223], a[220:223], v[24:27], v[220:223]
 v_exp_f32 v4, v4
 v_mfma_f32_16x16x32_bf16 v[8:11], a[160:163], a[16:19], v[60:63]
 v_exp_f32 v5, v5
 v_mfma_f32_16x16x32_bf16 v[8:11], a[164:167], a[20:23], v[8:11]
 v_exp_f32 v6, v6
 v_mfma_f32_16x16x32_bf16 v[8:11], a[168:171], a[24:27], v[8:11]
 v_exp_f32 v7, v7
 v_mfma_f32_16x16x32_bf16 v[8:11], a[172:175], a[28:31], v[8:11]
 v_cvt_pk_bf16_f32 v34, v4, v5
 v_cvt_pk_bf16_f32 v35, v6, v7
 v_mfma_f32_16x16x32_bf16 v[12:15], a[188:191], a[28:31], v[60:63]
 buffer_load_dwordx4 v54, s[8:11], s30 offen offset:128 nt lds
 v_mfma_f32_16x16x32_bf16 v[12:15], a[184:187], a[24:27], v[12:15]
 v_mfma_f32_16x16x32_bf16 v[12:15], a[180:183], a[20:23], v[12:15]
 v_mfma_f32_16x16x32_bf16 v[12:15], a[176:179], a[16:19], v[12:15]
 v_smfmac_f32_16x16x64_bf16 a[232:235], a[236:239], v[24:31], v55
 v_mfma_f32_16x16x32_bf16 v[224:227], a[192:195], v[28:31], v[224:227]
 ds_read_b64_tr_b16 a[192:193], v48 offset:0
 ds_read_b64_tr_b16 a[194:195], v48 offset:4096
 v_mfma_f32_16x16x32_bf16 v[228:231], a[196:199], v[28:31], v[228:231]
 v_exp_f32 v8, v8
 v_mfma_f32_16x16x32_bf16 v[232:235], a[200:203], v[28:31], v[232:235]
 ds_read_b64_tr_b16 a[196:197], v49 offset:0
 ds_read_b64_tr_b16 a[198:199], v49 offset:4096
 v_mfma_f32_16x16x32_bf16 v[236:239], a[204:207], v[28:31], v[236:239]
 v_exp_f32 v9, v9
 v_mfma_f32_16x16x32_bf16 v[240:243], a[208:211], v[28:31], v[240:243]
 s_waitcnt vmcnt(11)
 buffer_load_dwordx4 v54, s[8:11], s30 offen offset:2176 nt lds
 v_mfma_f32_16x16x32_bf16 v[244:247], a[212:215], v[28:31], v[244:247]
 s_add_u32 m0, s26, 24576
 ds_read_b128 a[112:115], v52 offset:4096
 v_cvt_pk_bf16_f32 v36, v8, v9
 v_mfma_f32_16x16x32_bf16 v[248:251], a[216:219], v[28:31], v[248:251]
 s_addk_i32 s30, 4096
 ds_read_b128 a[116:119], v53 offset:4096
 v_mfma_f32_16x16x32_bf16 v[252:255], a[220:223], v[28:31], v[252:255]
 ds_read_b128 a[120:123], v52 offset:5120
 v_mfma_f32_16x16x32_bf16 v[16:19], a[160:163], a[32:35], 0
 ds_read_b128 a[124:127], v53 offset:5120
 v_mfma_f32_16x16x32_bf16 v[16:19], a[164:167], a[36:39], v[16:19]
 ds_read_b64_tr_b16 a[200:201], v50 offset:0
 ds_read_b64_tr_b16 a[202:203], v50 offset:4096
 v_mfma_f32_16x16x32_bf16 v[16:19], a[168:171], a[40:43], v[16:19]
 ds_read_b64_tr_b16 a[204:205], v51 offset:0
 ds_read_b64_tr_b16 a[206:207], v51 offset:4096
 v_mfma_f32_16x16x32_bf16 v[16:19], a[172:175], a[44:47], v[16:19]
 ds_read_b64_tr_b16 a[208:209], v48 offset:1024
 ds_read_b64_tr_b16 a[210:211], v48 offset:5120
 v_mfma_f32_16x16x32_bf16 v[20:23], a[188:191], a[44:47], 0
 ds_read_b64_tr_b16 a[212:213], v49 offset:1024
 ds_read_b64_tr_b16 a[214:215], v49 offset:5120
 v_mfma_f32_16x16x32_bf16 v[20:23], a[184:187], a[40:43], v[20:23]
 ds_read_b64_tr_b16 a[216:217], v50 offset:1024
 ds_read_b64_tr_b16 a[218:219], v50 offset:5120
 v_mfma_f32_16x16x32_bf16 v[20:23], a[180:183], a[36:39], v[20:23]
 ds_read_b64_tr_b16 a[220:221], v51 offset:1024
 ds_read_b64_tr_b16 a[222:223], v51 offset:5120
 v_mfma_f32_16x16x32_bf16 v[20:23], a[176:179], a[32:35], v[20:23]
 s_waitcnt lgkmcnt(12)
 v_exp_f32 v10, v10
 v_mfma_f32_16x16x32_bf16 v[64:67], a[192:195], v[32:35], v[64:67]
 v_exp_f32 v11, v11
 v_mfma_f32_16x16x32_bf16 v[68:71], a[196:199], v[32:35], v[68:71]
 s_waitcnt lgkmcnt(8)
 v_cvt_pk_bf16_f32 v37, v10, v11
 v_fma_f32 v16, v16, s24, v42
 v_mfma_f32_16x16x32_bf16 v[72:75], a[200:203], v[32:35], v[72:75]
 v_exp_f32 v12, v12
 v_mfma_f32_16x16x32_bf16 v[76:79], a[204:207], v[32:35], v[76:79]
 s_waitcnt lgkmcnt(4)
 v_exp_f32 v13, v13
 v_mfma_f32_16x16x32_bf16 v[80:83], a[208:211], v[32:35], v[80:83]
 v_cvt_pk_bf16_f32 v38, v12, v13
 v_fma_f32 v17, v17, s24, v42
 v_mfma_f32_16x16x32_bf16 v[84:87], a[212:215], v[32:35], v[84:87]
 s_waitcnt lgkmcnt(0)
 v_exp_f32 v14, v14
 v_mfma_f32_16x16x32_bf16 v[88:91], a[216:219], v[32:35], v[88:91]
 v_exp_f32 v15, v15
 v_mfma_f32_16x16x32_bf16 v[92:95], a[220:223], v[32:35], v[92:95]
 v_cvt_pk_bf16_f32 v39, v14, v15
 v_fma_f32 v18, v18, s24, v42
 v_mfma_f32_16x16x32_bf16 v[0:3], a[160:163], a[48:51], 0
 v_exp_f32 v16, v16
 v_mfma_f32_16x16x32_bf16 v[0:3], a[164:167], a[52:55], v[0:3]
 v_exp_f32 v17, v17
 v_mfma_f32_16x16x32_bf16 v[0:3], a[168:171], a[56:59], v[0:3]
 v_cvt_pk_bf16_f32 v24, v16, v17
 v_fma_f32 v19, v19, s24, v42
 v_mfma_f32_16x16x32_bf16 v[0:3], a[172:175], a[60:63], v[0:3]
 v_exp_f32 v18, v18
 v_mfma_f32_16x16x32_bf16 v[4:7], a[188:191], a[60:63], 0
 v_exp_f32 v19, v19
 v_mfma_f32_16x16x32_bf16 v[4:7], a[184:187], a[56:59], v[4:7]
 v_cvt_pk_bf16_f32 v25, v18, v19
 v_fma_f32 v20, v20, s24, v42
 v_mfma_f32_16x16x32_bf16 v[4:7], a[180:183], a[52:55], v[4:7]
 v_fma_f32 v21, v21, s24, v42
 v_fma_f32 v22, v22, s24, v42
 v_mfma_f32_16x16x32_bf16 v[4:7], a[176:179], a[48:51], v[4:7]
 v_exp_f32 v20, v20
 v_smfmac_f32_16x16x64_bf16 a[224:227], a[236:239], v[32:39], v55
 v_fma_f32 v23, v23, s24, v42
 v_mfma_f32_16x16x32_bf16 v[96:99], a[192:195], v[36:39], v[96:99]
 v_exp_f32 v21, v21
 v_mfma_f32_16x16x32_bf16 v[100:103], a[196:199], v[36:39], v[100:103]
 v_cvt_pk_bf16_f32 v26, v20, v21
 v_fma_f32 v0, v0, s24, v43
 v_mfma_f32_16x16x32_bf16 v[104:107], a[200:203], v[36:39], v[104:107]
 buffer_load_dwordx4 v54, s[12:15], s29 offen offset:0 nt lds
 v_mfma_f32_16x16x32_bf16 v[108:111], a[204:207], v[36:39], v[108:111]
 v_exp_f32 v22, v22
 v_mfma_f32_16x16x32_bf16 v[112:115], a[208:211], v[36:39], v[112:115]
 v_exp_f32 v23, v23
 v_mfma_f32_16x16x32_bf16 v[116:119], a[212:215], v[36:39], v[116:119]
 v_cvt_pk_bf16_f32 v27, v22, v23
 v_fma_f32 v1, v1, s24, v43
 v_mfma_f32_16x16x32_bf16 v[120:123], a[216:219], v[36:39], v[120:123]
 v_exp_f32 v0, v0
 v_mfma_f32_16x16x32_bf16 v[124:127], a[220:223], v[36:39], v[124:127]
 v_exp_f32 v1, v1
 v_mfma_f32_16x16x32_bf16 v[8:11], a[160:163], a[64:67], 0
 v_cvt_pk_bf16_f32 v28, v0, v1
 v_fma_f32 v2, v2, s24, v43
 v_mfma_f32_16x16x32_bf16 v[8:11], a[164:167], a[68:71], v[8:11]
 v_fma_f32 v3, v3, s24, v43
 v_fma_f32 v4, v4, s24, v43
 v_mfma_f32_16x16x32_bf16 v[8:11], a[168:171], a[72:75], v[8:11]
 v_exp_f32 v2, v2
 v_mfma_f32_16x16x32_bf16 v[8:11], a[172:175], a[76:79], v[8:11]
 v_exp_f32 v3, v3
 v_mfma_f32_16x16x32_bf16 v[12:15], a[188:191], a[76:79], 0
 v_cvt_pk_bf16_f32 v29, v2, v3
 v_fma_f32 v5, v5, s24, v43
 v_mfma_f32_16x16x32_bf16 v[12:15], a[184:187], a[72:75], v[12:15]
 v_exp_f32 v4, v4
 v_mfma_f32_16x16x32_bf16 v[12:15], a[180:183], a[68:71], v[12:15]
 buffer_load_dwordx4 v54, s[12:15], s29 offen offset:2048 nt lds
 v_mfma_f32_16x16x32_bf16 v[12:15], a[176:179], a[64:67], v[12:15]
 s_add_u32 m0, s26, 90112
 v_exp_f32 v5, v5
 v_mfma_f32_16x16x32_bf16 v[128:131], a[192:195], v[24:27], v[128:131]
 v_cvt_pk_bf16_f32 v30, v4, v5
 v_fma_f32 v6, v6, s24, v43
 v_mfma_f32_16x16x32_bf16 v[132:135], a[196:199], v[24:27], v[132:135]
 v_fma_f32 v7, v7, s24, v43
 v_fma_f32 v8, v8, s24, v44
 v_mfma_f32_16x16x32_bf16 v[136:139], a[200:203], v[24:27], v[136:139]
 v_exp_f32 v6, v6
 v_mfma_f32_16x16x32_bf16 v[140:143], a[204:207], v[24:27], v[140:143]
 v_exp_f32 v7, v7
 v_mfma_f32_16x16x32_bf16 v[144:147], a[208:211], v[24:27], v[144:147]
 v_cvt_pk_bf16_f32 v31, v6, v7
 v_fma_f32 v9, v9, s24, v44
 v_mfma_f32_16x16x32_bf16 v[148:151], a[212:215], v[24:27], v[148:151]
 v_exp_f32 v8, v8
 v_mfma_f32_16x16x32_bf16 v[152:155], a[216:219], v[24:27], v[152:155]
 s_waitcnt vmcnt(10)
 v_exp_f32 v9, v9
 v_mfma_f32_16x16x32_bf16 v[156:159], a[220:223], v[24:27], v[156:159]
 s_barrier
 v_cvt_pk_bf16_f32 v32, v8, v9
 v_fma_f32 v10, v10, s24, v44
 v_mfma_f32_16x16x32_bf16 v[16:19], a[160:163], a[80:83], 0
 ds_read_b128 a[160:163], v46 offset:8192
 v_fma_f32 v11, v11, s24, v44
 v_mfma_f32_16x16x32_bf16 v[16:19], a[164:167], a[84:87], v[16:19]
 v_exp_f32 v10, v10
 v_mfma_f32_16x16x32_bf16 v[16:19], a[168:171], a[88:91], v[16:19]
 buffer_load_dwordx4 v54, s[16:19], s29 offen offset:0 nt lds
 v_mfma_f32_16x16x32_bf16 v[16:19], a[172:175], a[92:95], v[16:19]
 ds_read_b128 a[164:167], v47 offset:8192
 v_fma_f32 v12, v12, s24, v44
 v_mfma_f32_16x16x32_bf16 v[20:23], a[188:191], a[92:95], 0
 v_exp_f32 v11, v11
 v_mfma_f32_16x16x32_bf16 v[20:23], a[184:187], a[88:91], v[20:23]
 ds_read_b128 a[168:171], v46 offset:9216
 v_cvt_pk_bf16_f32 v33, v10, v11
 v_mfma_f32_16x16x32_bf16 v[20:23], a[180:183], a[84:87], v[20:23]
 v_fma_f32 v13, v13, s24, v44
 v_fma_f32 v14, v14, s24, v44
 v_mfma_f32_16x16x32_bf16 v[20:23], a[176:179], a[80:83], v[20:23]
 ds_read_b128 a[172:175], v47 offset:9216
 v_fma_f32 v15, v15, s24, v44
 v_smfmac_f32_16x16x64_bf16 a[228:231], a[236:239], v[24:31], v55
 v_fma_f32 v16, v16, s24, v45
 v_mfma_f32_16x16x32_bf16 v[160:163], a[192:195], v[28:31], v[160:163]
 ds_read_b128 a[188:191], v47 offset:13312
 v_fma_f32 v17, v17, s24, v45
 v_mfma_f32_16x16x32_bf16 v[164:167], a[196:199], v[28:31], v[164:167]
 v_exp_f32 v12, v12
 v_mfma_f32_16x16x32_bf16 v[168:171], a[200:203], v[28:31], v[168:171]
 ds_read_b128 a[184:187], v46 offset:13312
 v_fma_f32 v18, v18, s24, v45
 v_mfma_f32_16x16x32_bf16 v[172:175], a[204:207], v[28:31], v[172:175]
 v_exp_f32 v13, v13
 v_mfma_f32_16x16x32_bf16 v[176:179], a[208:211], v[28:31], v[176:179]
 ds_read_b128 a[180:183], v47 offset:12288
 v_cvt_pk_bf16_f32 v34, v12, v13
 v_mfma_f32_16x16x32_bf16 v[180:183], a[212:215], v[28:31], v[180:183]
 v_exp_f32 v14, v14
 v_mfma_f32_16x16x32_bf16 v[184:187], a[216:219], v[28:31], v[184:187]
 s_waitcnt lgkmcnt(2)
 buffer_load_dwordx4 v54, s[16:19], s29 offen offset:2048 nt lds
 v_mfma_f32_16x16x32_bf16 v[188:191], a[220:223], v[28:31], v[188:191]
 s_add_u32 m0, s26, 40960
 ds_read_b128 a[176:179], v46 offset:12288
 v_fma_f32 v19, v19, s24, v45
 v_mfma_f32_16x16x32_bf16 v[0:3], a[160:163], a[0:3], v[56:59]
 s_addk_i32 s29, 8192
 v_exp_f32 v15, v15
 v_mfma_f32_16x16x32_bf16 v[0:3], a[164:167], a[4:7], v[0:3]
 v_cvt_pk_bf16_f32 v35, v14, v15
 v_fma_f32 v20, v20, s24, v45
 v_mfma_f32_16x16x32_bf16 v[0:3], a[168:171], a[8:11], v[0:3]
 v_exp_f32 v16, v16
 v_mfma_f32_16x16x32_bf16 v[0:3], a[172:175], a[12:15], v[0:3]
 v_exp_f32 v17, v17
 v_mfma_f32_16x16x32_bf16 v[4:7], a[188:191], a[12:15], v[56:59]
 s_waitcnt lgkmcnt(1)
 v_cvt_pk_bf16_f32 v36, v16, v17
 v_fma_f32 v21, v21, s24, v45
 v_mfma_f32_16x16x32_bf16 v[4:7], a[184:187], a[8:11], v[4:7]
 v_exp_f32 v18, v18
 v_mfma_f32_16x16x32_bf16 v[4:7], a[180:183], a[4:7], v[4:7]
 s_waitcnt lgkmcnt(0)
 v_exp_f32 v19, v19
 v_mfma_f32_16x16x32_bf16 v[4:7], a[176:179], a[0:3], v[4:7]
 v_cvt_pk_bf16_f32 v37, v18, v19
 v_fma_f32 v22, v22, s24, v45
 v_mfma_f32_16x16x32_bf16 v[192:195], a[192:195], v[32:35], v[192:195]
 v_exp_f32 v20, v20
 v_mfma_f32_16x16x32_bf16 v[196:199], a[196:199], v[32:35], v[196:199]
 v_exp_f32 v21, v21
 v_mfma_f32_16x16x32_bf16 v[200:203], a[200:203], v[32:35], v[200:203]
 v_cvt_pk_bf16_f32 v38, v20, v21
 v_fma_f32 v23, v23, s24, v45
 v_mfma_f32_16x16x32_bf16 v[204:207], a[204:207], v[32:35], v[204:207]
 buffer_load_dwordx4 v54, s[12:15], s29 offen offset:0 nt lds
 v_mfma_f32_16x16x32_bf16 v[208:211], a[208:211], v[32:35], v[208:211]
 v_exp_f32 v22, v22
 v_mfma_f32_16x16x32_bf16 v[212:215], a[212:215], v[32:35], v[212:215]
 v_exp_f32 v23, v23
 v_mfma_f32_16x16x32_bf16 v[216:219], a[216:219], v[32:35], v[216:219]
 v_exp_f32 v0, v0
 v_mfma_f32_16x16x32_bf16 v[220:223], a[220:223], v[32:35], v[220:223]
 v_exp_f32 v1, v1
 v_mfma_f32_16x16x32_bf16 v[8:11], a[160:163], a[16:19], v[60:63]
 v_cvt_pk_bf16_f32 v39, v22, v23
 v_cvt_pk_bf16_f32 v24, v0, v1
 v_mfma_f32_16x16x32_bf16 v[8:11], a[164:167], a[20:23], v[8:11]
 v_exp_f32 v2, v2
 v_mfma_f32_16x16x32_bf16 v[8:11], a[168:171], a[24:27], v[8:11]
 v_exp_f32 v3, v3
 v_mfma_f32_16x16x32_bf16 v[8:11], a[172:175], a[28:31], v[8:11]
 v_exp_f32 v4, v4
 v_mfma_f32_16x16x32_bf16 v[12:15], a[188:191], a[28:31], v[60:63]
 v_exp_f32 v5, v5
 v_mfma_f32_16x16x32_bf16 v[12:15], a[184:187], a[24:27], v[12:15]
 v_cvt_pk_bf16_f32 v25, v2, v3
 v_cvt_pk_bf16_f32 v26, v4, v5
 v_mfma_f32_16x16x32_bf16 v[12:15], a[180:183], a[20:23], v[12:15]
 v_exp_f32 v6, v6
 v_mfma_f32_16x16x32_bf16 v[12:15], a[176:179], a[16:19], v[12:15]
 buffer_load_dwordx4 v54, s[12:15], s29 offen offset:2048 nt lds
 v_smfmac_f32_16x16x64_bf16 a[232:235], a[236:239], v[32:39], v55
 s_add_u32 m0, s26, 106496
 v_mfma_f32_16x16x32_bf16 v[224:227], a[192:195], v[36:39], v[224:227]
 ds_read_b64_tr_b16 a[192:193], v48 offset:8192
 ds_read_b64_tr_b16 a[194:195], v48 offset:12288
 v_mfma_f32_16x16x32_bf16 v[228:231], a[196:199], v[36:39], v[228:231]
 v_exp_f32 v7, v7
 v_mfma_f32_16x16x32_bf16 v[232:235], a[200:203], v[36:39], v[232:235]
 ds_read_b64_tr_b16 a[196:197], v49 offset:8192
 ds_read_b64_tr_b16 a[198:199], v49 offset:12288
 v_mfma_f32_16x16x32_bf16 v[236:239], a[204:207], v[36:39], v[236:239]
 v_exp_f32 v8, v8
 v_mfma_f32_16x16x32_bf16 v[240:243], a[208:211], v[36:39], v[240:243]
 ds_read_b64_tr_b16 a[200:201], v50 offset:8192
 ds_read_b64_tr_b16 a[202:203], v50 offset:12288
 v_mfma_f32_16x16x32_bf16 v[244:247], a[212:215], v[36:39], v[244:247]
 v_exp_f32 v9, v9
 v_mfma_f32_16x16x32_bf16 v[248:251], a[216:219], v[36:39], v[248:251]
 ds_read_b64_tr_b16 a[204:205], v51 offset:8192
 ds_read_b64_tr_b16 a[206:207], v51 offset:12288
 v_mfma_f32_16x16x32_bf16 v[252:255], a[220:223], v[36:39], v[252:255]
 v_cvt_pk_bf16_f32 v27, v6, v7
 v_cvt_pk_bf16_f32 v28, v8, v9
 v_mfma_f32_16x16x32_bf16 v[16:19], a[160:163], a[32:35], 0
 ds_read_b64_tr_b16 a[208:209], v48 offset:9216
 ds_read_b64_tr_b16 a[210:211], v48 offset:13312
 v_mfma_f32_16x16x32_bf16 v[16:19], a[164:167], a[36:39], v[16:19]
 v_exp_f32 v10, v10
 v_mfma_f32_16x16x32_bf16 v[16:19], a[168:171], a[40:43], v[16:19]
 buffer_load_dwordx4 v54, s[16:19], s29 offen offset:0 nt lds
 v_mfma_f32_16x16x32_bf16 v[16:19], a[172:175], a[44:47], v[16:19]
 ds_read_b64_tr_b16 a[212:213], v49 offset:9216
 ds_read_b64_tr_b16 a[214:215], v49 offset:13312
 v_mfma_f32_16x16x32_bf16 v[20:23], a[188:191], a[44:47], 0
 v_exp_f32 v11, v11
 v_mfma_f32_16x16x32_bf16 v[20:23], a[184:187], a[40:43], v[20:23]
 ds_read_b64_tr_b16 a[216:217], v50 offset:9216
 ds_read_b64_tr_b16 a[218:219], v50 offset:13312
 v_mfma_f32_16x16x32_bf16 v[20:23], a[180:183], a[36:39], v[20:23]
 ds_read_b64_tr_b16 a[220:221], v51 offset:9216
 ds_read_b64_tr_b16 a[222:223], v51 offset:13312
 v_mfma_f32_16x16x32_bf16 v[20:23], a[176:179], a[32:35], v[20:23]
 s_waitcnt lgkmcnt(6)
 v_cvt_pk_bf16_f32 v29, v10, v11
 v_fma_f32 v16, v16, s24, v42
 v_mfma_f32_16x16x32_bf16 v[64:67], a[192:195], v[24:27], v[64:67]
 v_exp_f32 v12, v12
 v_mfma_f32_16x16x32_bf16 v[68:71], a[196:199], v[24:27], v[68:71]
 v_exp_f32 v13, v13
 v_mfma_f32_16x16x32_bf16 v[72:75], a[200:203], v[24:27], v[72:75]
 v_cvt_pk_bf16_f32 v30, v12, v13
 v_fma_f32 v17, v17, s24, v42
 v_mfma_f32_16x16x32_bf16 v[76:79], a[204:207], v[24:27], v[76:79]
 v_exp_f32 v14, v14
 v_mfma_f32_16x16x32_bf16 v[80:83], a[208:211], v[24:27], v[80:83]
 s_waitcnt lgkmcnt(2)
 v_exp_f32 v15, v15
 v_mfma_f32_16x16x32_bf16 v[84:87], a[212:215], v[24:27], v[84:87]
 v_cvt_pk_bf16_f32 v31, v14, v15
 v_fma_f32 v18, v18, s24, v42
 v_mfma_f32_16x16x32_bf16 v[88:91], a[216:219], v[24:27], v[88:91]
 s_waitcnt lgkmcnt(0)
 buffer_load_dwordx4 v54, s[16:19], s29 offen offset:2048 nt lds
 v_mfma_f32_16x16x32_bf16 v[92:95], a[220:223], v[24:27], v[92:95]
 s_add_u32 m0, s28, 135168
 v_exp_f32 v16, v16
 v_mfma_f32_16x16x32_bf16 v[0:3], a[160:163], a[48:51], 0
 s_addk_i32 s29, 8192
 v_exp_f32 v17, v17
 v_mfma_f32_16x16x32_bf16 v[0:3], a[164:167], a[52:55], v[0:3]
 v_cvt_pk_bf16_f32 v32, v16, v17
 v_fma_f32 v19, v19, s24, v42
 v_mfma_f32_16x16x32_bf16 v[0:3], a[168:171], a[56:59], v[0:3]
 v_exp_f32 v18, v18
 v_mfma_f32_16x16x32_bf16 v[0:3], a[172:175], a[60:63], v[0:3]
 v_exp_f32 v19, v19
 v_mfma_f32_16x16x32_bf16 v[4:7], a[188:191], a[60:63], 0
 v_cvt_pk_bf16_f32 v33, v18, v19
 v_fma_f32 v20, v20, s24, v42
 v_mfma_f32_16x16x32_bf16 v[4:7], a[184:187], a[56:59], v[4:7]
 v_fma_f32 v21, v21, s24, v42
 v_fma_f32 v22, v22, s24, v42
 v_mfma_f32_16x16x32_bf16 v[4:7], a[180:183], a[52:55], v[4:7]
 v_exp_f32 v20, v20
 v_mfma_f32_16x16x32_bf16 v[4:7], a[176:179], a[48:51], v[4:7]
 v_exp_f32 v21, v21
 v_smfmac_f32_16x16x64_bf16 a[224:227], a[236:239], v[24:31], v55
 v_cvt_pk_bf16_f32 v34, v20, v21
 v_mfma_f32_16x16x32_bf16 v[96:99], a[192:195], v[28:31], v[96:99]
 v_fma_f32 v23, v23, s24, v42
 v_fma_f32 v0, v0, s24, v43
 v_mfma_f32_16x16x32_bf16 v[100:103], a[196:199], v[28:31], v[100:103]
 v_exp_f32 v22, v22
 v_mfma_f32_16x16x32_bf16 v[104:107], a[200:203], v[28:31], v[104:107]
 buffer_load_dwordx4 v54, s[8:11], s30 offen offset:0 nt lds
 v_mfma_f32_16x16x32_bf16 v[108:111], a[204:207], v[28:31], v[108:111]
 v_exp_f32 v23, v23
 v_mfma_f32_16x16x32_bf16 v[112:115], a[208:211], v[28:31], v[112:115]
 v_cvt_pk_bf16_f32 v35, v22, v23
 v_fma_f32 v1, v1, s24, v43
 v_mfma_f32_16x16x32_bf16 v[116:119], a[212:215], v[28:31], v[116:119]
 v_exp_f32 v0, v0
 v_mfma_f32_16x16x32_bf16 v[120:123], a[216:219], v[28:31], v[120:123]
 v_exp_f32 v1, v1
 v_mfma_f32_16x16x32_bf16 v[124:127], a[220:223], v[28:31], v[124:127]
 v_cvt_pk_bf16_f32 v36, v0, v1
 v_fma_f32 v2, v2, s24, v43
 v_mfma_f32_16x16x32_bf16 v[8:11], a[160:163], a[64:67], 0
 v_fma_f32 v3, v3, s24, v43
 v_fma_f32 v4, v4, s24, v43
 v_mfma_f32_16x16x32_bf16 v[8:11], a[164:167], a[68:71], v[8:11]
 v_exp_f32 v2, v2
 v_mfma_f32_16x16x32_bf16 v[8:11], a[168:171], a[72:75], v[8:11]
 v_exp_f32 v3, v3
 v_mfma_f32_16x16x32_bf16 v[8:11], a[172:175], a[76:79], v[8:11]
 v_cvt_pk_bf16_f32 v37, v2, v3
 v_fma_f32 v5, v5, s24, v43
 v_mfma_f32_16x16x32_bf16 v[12:15], a[188:191], a[76:79], 0
 v_exp_f32 v4, v4
 v_mfma_f32_16x16x32_bf16 v[12:15], a[184:187], a[72:75], v[12:15]
 v_exp_f32 v5, v5
 v_mfma_f32_16x16x32_bf16 v[12:15], a[180:183], a[68:71], v[12:15]
 v_cvt_pk_bf16_f32 v38, v4, v5
 v_fma_f32 v6, v6, s24, v43
 v_mfma_f32_16x16x32_bf16 v[12:15], a[176:179], a[64:67], v[12:15]
 v_fma_f32 v7, v7, s24, v43
 v_fma_f32 v8, v8, s24, v44
 v_mfma_f32_16x16x32_bf16 v[128:131], a[192:195], v[32:35], v[128:131]
 v_exp_f32 v6, v6
 v_mfma_f32_16x16x32_bf16 v[132:135], a[196:199], v[32:35], v[132:135]
 v_exp_f32 v7, v7
 v_mfma_f32_16x16x32_bf16 v[136:139], a[200:203], v[32:35], v[136:139]
 v_cvt_pk_bf16_f32 v39, v6, v7
 v_fma_f32 v9, v9, s24, v44
 v_mfma_f32_16x16x32_bf16 v[140:143], a[204:207], v[32:35], v[140:143]
 v_exp_f32 v8, v8
 v_mfma_f32_16x16x32_bf16 v[144:147], a[208:211], v[32:35], v[144:147]
 v_exp_f32 v9, v9
 v_mfma_f32_16x16x32_bf16 v[148:151], a[212:215], v[32:35], v[148:151]
 v_cvt_pk_bf16_f32 v24, v8, v9
 v_fma_f32 v10, v10, s24, v44
 v_mfma_f32_16x16x32_bf16 v[152:155], a[216:219], v[32:35], v[152:155]
 s_waitcnt vmcnt(13)
 v_fma_f32 v11, v11, s24, v44
 v_fma_f32 v12, v12, s24, v44
 v_mfma_f32_16x16x32_bf16 v[156:159], a[220:223], v[32:35], v[156:159]
 s_barrier
 buffer_load_dwordx4 v54, s[8:11], s30 offen offset:2048 nt lds
 v_mfma_f32_16x16x32_bf16 v[16:19], a[160:163], a[80:83], 0
 s_addk_i32 m0, 896
 ds_read_b128 a[160:163], v46 offset:16384
 v_fma_f32 v13, v13, s24, v44
 v_mfma_f32_16x16x32_bf16 v[16:19], a[164:167], a[84:87], v[16:19]
 v_exp_f32 v10, v10
 v_mfma_f32_16x16x32_bf16 v[16:19], a[168:171], a[88:91], v[16:19]
 ds_read_b128 a[164:167], v47 offset:16384
 v_fma_f32 v14, v14, s24, v44
 v_mfma_f32_16x16x32_bf16 v[16:19], a[172:175], a[92:95], v[16:19]
 v_exp_f32 v11, v11
 v_mfma_f32_16x16x32_bf16 v[20:23], a[188:191], a[92:95], 0
 ds_read_b128 a[168:171], v46 offset:17408
 v_cvt_pk_bf16_f32 v25, v10, v11
 v_mfma_f32_16x16x32_bf16 v[20:23], a[184:187], a[88:91], v[20:23]
 v_exp_f32 v12, v12
 v_mfma_f32_16x16x32_bf16 v[20:23], a[180:183], a[84:87], v[20:23]
 ds_read_b128 a[172:175], v47 offset:17408
 v_fma_f32 v15, v15, s24, v44
 v_mfma_f32_16x16x32_bf16 v[20:23], a[176:179], a[80:83], v[20:23]
 v_exp_f32 v13, v13
 v_smfmac_f32_16x16x64_bf16 a[228:231], a[236:239], v[32:39], v55
 ds_read_b128 a[188:191], v47 offset:21504
 v_mfma_f32_16x16x32_bf16 v[160:163], a[192:195], v[36:39], v[160:163]
 v_cvt_pk_bf16_f32 v26, v12, v13
 v_fma_f32 v16, v16, s24, v45
 v_mfma_f32_16x16x32_bf16 v[164:167], a[196:199], v[36:39], v[164:167]
 ds_read_b128 a[184:187], v46 offset:21504
 v_fma_f32 v17, v17, s24, v45
 v_mfma_f32_16x16x32_bf16 v[168:171], a[200:203], v[36:39], v[168:171]
 v_exp_f32 v14, v14
 v_mfma_f32_16x16x32_bf16 v[172:175], a[204:207], v[36:39], v[172:175]
 ds_read_b128 a[180:183], v47 offset:20480
 v_fma_f32 v18, v18, s24, v45
 v_mfma_f32_16x16x32_bf16 v[176:179], a[208:211], v[36:39], v[176:179]
 v_exp_f32 v15, v15
 v_mfma_f32_16x16x32_bf16 v[180:183], a[212:215], v[36:39], v[180:183]
 ds_read_b128 a[176:179], v46 offset:20480
 v_cvt_pk_bf16_f32 v27, v14, v15
 v_mfma_f32_16x16x32_bf16 v[184:187], a[216:219], v[36:39], v[184:187]
 v_exp_f32 v16, v16
 v_mfma_f32_16x16x32_bf16 v[188:191], a[220:223], v[36:39], v[188:191]
 s_waitcnt lgkmcnt(3)
 v_exp_f32 v17, v17
 v_mfma_f32_16x16x32_bf16 v[0:3], a[160:163], a[0:3], v[56:59]
 v_cvt_pk_bf16_f32 v28, v16, v17
 v_fma_f32 v19, v19, s24, v45
 v_mfma_f32_16x16x32_bf16 v[0:3], a[164:167], a[4:7], v[0:3]
 v_exp_f32 v18, v18
 v_mfma_f32_16x16x32_bf16 v[0:3], a[168:171], a[8:11], v[0:3]
 v_exp_f32 v19, v19
 v_mfma_f32_16x16x32_bf16 v[0:3], a[172:175], a[12:15], v[0:3]
 buffer_load_dwordx4 v54, s[8:11], s30 offen offset:128 nt lds
 v_mfma_f32_16x16x32_bf16 v[4:7], a[188:191], a[12:15], v[56:59]
 s_waitcnt lgkmcnt(0)
 v_cvt_pk_bf16_f32 v29, v18, v19
 v_fma_f32 v20, v20, s24, v45
 v_mfma_f32_16x16x32_bf16 v[4:7], a[184:187], a[8:11], v[4:7]
L_stub5:
 s_cbranch_vccnz L_stub9
.if ((L_stub5-L_main)>>6) != 320
.error "stub misplaced"
.endif
 v_fma_f32 v21, v21, s24, v45
 v_fma_f32 v22, v22, s24, v45
 v_mfma_f32_16x16x32_bf16 v[4:7], a[180:183], a[4:7], v[4:7]
 v_exp_f32 v20, v20
 v_mfma_f32_16x16x32_bf16 v[4:7], a[176:179], a[0:3], v[4:7]
 v_exp_f32 v21, v21
 v_mfma_f32_16x16x32_bf16 v[192:195], a[192:195], v[24:27], v[192:195]
 v_cvt_pk_bf16_f32 v30, v20, v21
 v_fma_f32 v23, v23, s24, v45
 v_mfma_f32_16x16x32_bf16 v[196:199], a[196:199], v[24:27], v[196:199]
 v_exp_f32 v22, v22
 v_mfma_f32_16x16x32_bf16 v[200:203], a[200:203], v[24:27], v[200:203]
 v_exp_f32 v23, v23
 v_mfma_f32_16x16x32_bf16 v[204:207], a[204:207], v[24:27], v[204:207]
 v_exp_f32 v0, v0
 v_mfma_f32_16x16x32_bf16 v[208:211], a[208:211], v[24:27], v[208:211]
 s_waitcnt vmcnt(11)
 buffer_load_dwordx4 v54, s[8:11], s30 offen offset:2176 nt lds
 v_mfma_f32_16x16x32_bf16 v[212:215], a[212:215], v[24:27], v[212:215]
 s_add_u32 m0, s26, 49152
 ds_read_b128 a[128:131], v52 offset:0
 v_cvt_pk_bf16_f32 v31, v22, v23
 v_mfma_f32_16x16x32_bf16 v[216:219], a[216:219], v[24:27], v[216:219]
 s_addk_i32 s30, 4096
 ds_read_b128 a[132:135], v53 offset:0
 v_mfma_f32_16x16x32_bf16 v[220:223], a[220:223], v[24:27], v[220:223]
 ds_read_b128 a[136:139], v52 offset:1024
 v_mfma_f32_16x16x32_bf16 v[8:11], a[160:163], a[16:19], v[60:63]
 ds_read_b128 a[140:143], v53 offset:1024
 v_mfma_f32_16x16x32_bf16 v[8:11], a[164:167], a[20:23], v[8:11]
 v_exp_f32 v1, v1
 v_mfma_f32_16x16x32_bf16 v[8:11], a[168:171], a[24:27], v[8:11]
 v_exp_f32 v2, v2
 v_mfma_f32_16x16x32_bf16 v[8:11], a[172:175], a[28:31], v[8:11]
 v_exp_f32 v3, v3
 v_mfma_f32_16x16x32_bf16 v[12:15], a[188:191], a[28:31], v[60:63]
 v_cvt_pk_bf16_f32 v32, v0, v1
 v_cvt_pk_bf16_f32 v33, v2, v3
 v_mfma_f32_16x16x32_bf16 v[12:15], a[184:187], a[24:27], v[12:15]
 v_exp_f32 v4, v4
 v_mfma_f32_16x16x32_bf16 v[12:15], a[180:183], a[20:23], v[12:15]
 v_exp_f32 v5, v5
 v_mfma_f32_16x16x32_bf16 v[12:15], a[176:179], a[16:19], v[12:15]
 v_exp_f32 v6, v6
 v_smfmac_f32_16x16x64_bf16 a[232:235], a[236:239], v[24:31], v55
 v_cvt_pk_bf16_f32 v34, v4, v5
 v_mfma_f32_16x16x32_bf16 v[224:227], a[192:195], v[28:31], v[224:227]
 ds_read_b64_tr_b16 a[192:193], v48 offset:16384
 ds_read_b64_tr_b16 a[194:195], v48 offset:20480
 v_mfma_f32_16x16x32_bf16 v[228:231], a[196:199], v[28:31], v[228:231]
 v_exp_f32 v7, v7
 v_mfma_f32_16x16x32_bf16 v[232:235], a[200:203], v[28:31], v[232:235]
 ds_read_b64_tr_b16 a[196:197], v49 offset:16384
 ds_read_b64_tr_b16 a[198:199], v49 offset:20480
 v_mfma_f32_16x16x32_bf16 v[236:239], a[204:207], v[28:31], v[236:239]
 v_exp_f32 v8, v8
 v_mfma_f32_16x16x32_bf16 v[240:243], a[208:211], v[28:31], v[240:243]
 ds_read_b64_tr_b16 a[200:201], v50 offset:16384
 ds_read_b64_tr_b16 a[202:203], v50 offset:20480
 v_mfma_f32_16x16x32_bf16 v[244:247], a[212:215], v[28:31], v[244:247]
 v_exp_f32 v9, v9
 v_mfma_f32_16x16x32_bf16 v[248:251], a[216:219], v[28:31], v[248:251]
 ds_read_b64_tr_b16 a[204:205], v51 offset:16384
 ds_read_b64_tr_b16 a[206:207], v51 offset:20480
 v_mfma_f32_16x16x32_bf16 v[252:255], a[220:223], v[28:31], v[252:255]
 v_cvt_pk_bf16_f32 v35, v6, v7
 v_cvt_pk_bf16_f32 v36, v8, v9
 v_mfma_f32_16x16x32_bf16 v[16:19], a[160:163], a[32:35], 0
 ds_read_b64_tr_b16 a[208:209], v48 offset:17408
 ds_read_b64_tr_b16 a[210:211], v48 offset:21504
 v_mfma_f32_16x16x32_bf16 v[16:19], a[164:167], a[36:39], v[16:19]
 v_exp_f32 v10, v10
 v_mfma_f32_16x16x32_bf16 v[16:19], a[168:171], a[40:43], v[16:19]
 ds_read_b64_tr_b16 a[212:213], v49 offset:17408
 ds_read_b64_tr_b16 a[214:215], v49 offset:21504
 v_mfma_f32_16x16x32_bf16 v[16:19], a[172:175], a[44:47], v[16:19]
 v_exp_f32 v11, v11
 v_mfma_f32_16x16x32_bf16 v[20:23], a[188:191], a[44:47], 0
 ds_read_b64_tr_b16 a[216:217], v50 offset:17408
 ds_read_b64_tr_b16 a[218:219], v50 offset:21504
 v_mfma_f32_16x16x32_bf16 v[20:23], a[184:187], a[40:43], v[20:23]
 v_exp_f32 v12, v12
 v_mfma_f32_16x16x32_bf16 v[20:23], a[180:183], a[36:39], v[20:23]
 ds_read_b64_tr_b16 a[220:221], v51 offset:17408
 ds_read_b64_tr_b16 a[222:223], v51 offset:21504
 v_mfma_f32_16x16x32_bf16 v[20:23], a[176:179], a[32:35], v[20:23]
 s_waitcnt lgkmcnt(6)
 v_cvt_pk_bf16_f32 v37, v10, v11
 v_fma_f32 v16, v16, s24, v42
 v_mfma_f32_16x16x32_bf16 v[64:67], a[192:195], v[32:35], v[64:67]
 v_exp_f32 v13, v13
 v_mfma_f32_16x16x32_bf16 v[68:71], a[196:199], v[32:35], v[68:71]
 v_cvt_pk_bf16_f32 v38, v12, v13
 v_fma_f32 v17, v17, s24, v42
 v_mfma_f32_16x16x32_bf16 v[72:75], a[200:203], v[32:35], v[72:75]
 v_exp_f32 v14, v14
 v_mfma_f32_16x16x32_bf16 v[76:79], a[204:207], v[32:35], v[76:79]
 buffer_load_dwordx4 v54, s[12:15], s29 offen offset:0 nt lds
 v_mfma_f32_16x16x32_bf16 v[80:83], a[208:211], v[32:35], v[80:83]
 s_waitcnt lgkmcnt(2)
 v_exp_f32 v15, v15
 v_mfma_f32_16x16x32_bf16 v[84:87], a[212:215], v[32:35], v[84:87]
 v_cvt_pk_bf16_f32 v39, v14, v15
 v_fma_f32 v18, v18, s24, v42
 v_mfma_f32_16x16x32_bf16 v[88:91], a[216:219], v[32:35], v[88:91]
 s_waitcnt lgkmcnt(0)
 v_exp_f32 v16, v16
 v_mfma_f32_16x16x32_bf16 v[92:95], a[220:223], v[32:35], v[92:95]
 v_exp_f32 v17, v17
 v_mfma_f32_16x16x32_bf16 v[0:3], a[160:163], a[48:51], 0
 v_cvt_pk_bf16_f32 v24, v16, v17
 v_fma_f32 v19, v19, s24, v42
 v_mfma_f32_16x16x32_bf16 v[0:3], a[164:167], a[52:55], v[0:3]
 v_exp_f32 v18, v18
 v_mfma_f32_16x16x32_bf16 v[0:3], a[168:171], a[56:59], v[0:3]
 v_exp_f32 v19, v19
 v_mfma_f32_16x16x32_bf16 v[0:3], a[172:175], a[60:63], v[0:3]
 v_cvt_pk_bf16_f32 v25, v18, v19
 v_fma_f32 v20, v20, s24, v42
 v_mfma_f32_16x16x32_bf16 v[4:7], a[188:191], a[60:63], 0
 v_fma_f32 v21, v21, s24, v42
 v_fma_f32 v22, v22, s24, v42
 v_mfma_f32_16x16x32_bf16 v[4:7], a[184:187], a[56:59], v[4:7]
 v_exp_f32 v20, v20
 v_mfma_f32_16x16x32_bf16 v[4:7], a[180:183], a[52:55], v[4:7]
 v_exp_f32 v21, v21
 v_mfma_f32_16x16x32_bf16 v[4:7], a[176:179], a[48:51], v[4:7]
 buffer_load_dwordx4 v54, s[12:15], s29 offen offset:2048 nt lds
 v_smfmac_f32_16x16x64_bf16 a[224:227], a[236:239], v[32:39], v55
 s_add_u32 m0, s26, 114688
 v_cvt_pk_bf16_f32 v26, v20, v21
 v_mfma_f32_16x16x32_bf16 v[96:99], a[192:195], v[36:39], v[96:99]
 v_fma_f32 v23, v23, s24, v42
 v_fma_f32 v0, v0, s24, v43
 v_mfma_f32_16x16x32_bf16 v[100:103], a[196:199], v[36:39], v[100:103]
 v_exp_f32 v22, v22
 v_mfma_f32_16x16x32_bf16 v[104:107], a[200:203], v[36:39], v[104:107]
 v_exp_f32 v23, v23
 v_mfma_f32_16x16x32_bf16 v[108:111], a[204:207], v[36:39], v[108:111]
 v_cvt_pk_bf16_f32 v27, v22, v23
 v_fma_f32 v1, v1, s24, v43
 v_mfma_f32_16x16x32_bf16 v[112:115], a[208:211], v[36:39], v[112:115]
 v_exp_f32 v0, v0
 v_mfma_f32_16x16x32_bf16 v[116:119], a[212:215], v[36:39], v[116:119]
 v_exp_f32 v1, v1
 v_mfma_f32_16x16x32_bf16 v[120:123], a[216:219], v[36:39], v[120:123]
 v_cvt_pk_bf16_f32 v28, v0, v1
 v_fma_f32 v2, v2, s24, v43
 v_mfma_f32_16x16x32_bf16 v[124:127], a[220:223], v[36:39], v[124:127]
 v_fma_f32 v3, v3, s24, v43
 v_fma_f32 v4, v4, s24, v43
 v_mfma_f32_16x16x32_bf16 v[8:11], a[160:163], a[64:67], 0
 v_exp_f32 v2, v2
 v_mfma_f32_16x16x32_bf16 v[8:11], a[164:167], a[68:71], v[8:11]
 v_exp_f32 v3, v3
 v_mfma_f32_16x16x32_bf16 v[8:11], a[168:171], a[72:75], v[8:11]
 buffer_load_dwordx4 v54, s[16:19], s29 offen offset:0 nt lds
 v_mfma_f32_16x16x32_bf16 v[8:11], a[172:175], a[76:79], v[8:11]
 v_cvt_pk_bf16_f32 v29, v2, v3
 v_fma_f32 v5, v5, s24, v43
 v_mfma_f32_16x16x32_bf16 v[12:15], a[188:191], a[76:79], 0
 v_exp_f32 v4, v4
 v_mfma_f32_16x16x32_bf16 v[12:15], a[184:187], a[72:75], v[12:15]
 v_exp_f32 v5, v5
 v_mfma_f32_16x16x32_bf16 v[12:15], a[180:183], a[68:71], v[12:15]
 v_cvt_pk_bf16_f32 v30, v4, v5
 v_fma_f32 v6, v6, s24, v43
 v_mfma_f32_16x16x32_bf16 v[12:15], a[176:179], a[64:67], v[12:15]
 v_fma_f32 v7, v7, s24, v43
 v_fma_f32 v8, v8, s24, v44
 v_mfma_f32_16x16x32_bf16 v[128:131], a[192:195], v[24:27], v[128:131]
 v_exp_f32 v6, v6
 v_mfma_f32_16x16x32_bf16 v[132:135], a[196:199], v[24:27], v[132:135]
 v_exp_f32 v7, v7
 v_mfma_f32_16x16x32_bf16 v[136:139], a[200:203], v[24:27], v[136:139]
 v_cvt_pk_bf16_f32 v31, v6, v7
 v_fma_f32 v9, v9, s24, v44
 v_mfma_f32_16x16x32_bf16 v[140:143], a[204:207], v[24:27], v[140:143]
 v_exp_f32 v8, v8
 v_mfma_f32_16x16x32_bf16 v[144:147], a[208:211], v[24:27], v[144:147]
 v_exp_f32 v9, v9
 v_mfma_f32_16x16x32_bf16 v[148:151], a[212:215], v[24:27], v[148:151]
 v_cvt_pk_bf16_f32 v32, v8, v9
 v_fma_f32 v10, v10, s24, v44
 v_mfma_f32_16x16x32_bf16 v[152:155], a[216:219], v[24:27], v[152:155]
 s_waitcnt vmcnt(11)
 buffer_load_dwordx4 v54, s[16:19], s29 offen offset:2048 nt lds
 v_mfma_f32_16x16x32_bf16 v[156:159], a[220:223], v[24:27], v[156:159]
 s_barrier
 v_fma_f32 v11, v11, s24, v44
 v_fma_f32 v12, v12, s24, v44
 v_mfma_f32_16x16x32_bf16 v[16:19], a[160:163], a[80:83], 0
 s_add_u32 m0, s28, 131072
 ds_read_b128 a[160:163], v46 offset:24576
 v_fma_f32 v13, v13, s24, v44
 v_mfma_f32_16x16x32_bf16 v[16:19], a[164:167], a[84:87], v[16:19]
 s_addk_i32 s29, 8192
 v_exp_f32 v10, v10
 v_mfma_f32_16x16x32_bf16 v[16:19], a[168:171], a[88:91], v[16:19]
 ds_read_b128 a[164:167], v47 offset:24576
 v_fma_f32 v14, v14, s24, v44
 v_mfma_f32_16x16x32_bf16 v[16:19], a[172:175], a[92:95], v[16:19]
 v_exp_f32 v11, v11
 v_mfma_f32_16x16x32_bf16 v[20:23], a[188:191], a[92:95], 0
 ds_read_b128 a[168:171], v46 offset:25600
 v_cvt_pk_bf16_f32 v33, v10, v11
 v_mfma_f32_16x16x32_bf16 v[20:23], a[184:187], a[88:91], v[20:23]
 v_exp_f32 v12, v12
 v_mfma_f32_16x16x32_bf16 v[20:23], a[180:183], a[84:87], v[20:23]
 ds_read_b128 a[172:175], v47 offset:25600
 v_fma_f32 v15, v15, s24, v44
 v_mfma_f32_16x16x32_bf16 v[20:23], a[176:179], a[80:83], v[20:23]
 v_exp_f32 v13, v13
 v_smfmac_f32_16x16x64_bf16 a[228:231], a[236:239], v[24:31], v55
 ds_read_b128 a[188:191], v47 offset:29696
 v_mfma_f32_16x16x32_bf16 v[160:163], a[192:195], v[28:31], v[160:163]
 v_cvt_pk_bf16_f32 v34, v12, v13
 v_fma_f32 v16, v16, s24, v45
 v_mfma_f32_16x16x32_bf16 v[164:167], a[196:199], v[28:31], v[164:167]
 ds_read_b128 a[184:187], v46 offset:29696
 v_fma_f32 v17, v17, s24, v45
 v_mfma_f32_16x16x32_bf16 v[168:171], a[200:203], v[28:31], v[168:171]
 v_exp_f32 v14, v14
 v_mfma_f32_16x16x32_bf16 v[172:175], a[204:207], v[28:31], v[172:175]
 buffer_load_dwordx4 v54, s[8:11], s30 offen offset:0 nt lds
 v_mfma_f32_16x16x32_bf16 v[176:179], a[208:211], v[28:31], v[176:179]
 ds_read_b128 a[180:183], v47 offset:28672
 v_fma_f32 v18, v18, s24, v45
 v_mfma_f32_16x16x32_bf16 v[180:183], a[212:215], v[28:31], v[180:183]
 v_exp_f32 v15, v15
 v_mfma_f32_16x16x32_bf16 v[184:187], a[216:219], v[28:31], v[184:187]
 ds_read_b128 a[176:179], v46 offset:28672
 v_cvt_pk_bf16_f32 v35, v14, v15
 v_mfma_f32_16x16x32_bf16 v[188:191], a[220:223], v[28:31], v[188:191]
 s_waitcnt lgkmcnt(3)
 v_exp_f32 v16, v16
 v_mfma_f32_16x16x32_bf16 v[0:3], a[160:163], a[0:3], v[56:59]
 v_exp_f32 v17, v17
 v_mfma_f32_16x16x32_bf16 v[0:3], a[164:167], a[4:7], v[0:3]
 v_cvt_pk_bf16_f32 v36, v16, v17
 v_fma_f32 v19, v19, s24, v45
 v_mfma_f32_16x16x32_bf16 v[0:3], a[168:171], a[8:11], v[0:3]
 v_exp_f32 v18, v18
 v_mfma_f32_16x16x32_bf16 v[0:3], a[172:175], a[12:15], v[0:3]
 v_exp_f32 v19, v19
 v_mfma_f32_16x16x32_bf16 v[4:7], a[188:191], a[12:15], v[56:59]
 s_waitcnt lgkmcnt(1)
 v_cvt_pk_bf16_f32 v37, v18, v19
 v_fma_f32 v20, v20, s24, v45
 v_mfma_f32_16x16x32_bf16 v[4:7], a[184:187], a[8:11], v[4:7]
 v_fma_f32 v21, v21, s24, v45
 v_fma_f32 v22, v22, s24, v45
 v_mfma_f32_16x16x32_bf16 v[4:7], a[180:183], a[4:7], v[4:7]
 s_waitcnt lgkmcnt(0)
 v_exp_f32 v20, v20
 v_mfma_f32_16x16x32_bf16 v[4:7], a[176:179], a[0:3], v[4:7]
 v_exp_f32 v21, v21
 v_mfma_f32_16x16x32_bf16 v[192:195], a[192:195], v[32:35], v[192:195]
 v_cvt_pk_bf16_f32 v38, v20, v21
 v_fma_f32 v23, v23, s24, v45
 v_mfma_f32_16x16x32_bf16 v[196:199], a[196:199], v[32:35], v[196:199]
 v_exp_f32 v22, v22
 v_mfma_f32_16x16x32_bf16 v[200:203], a[200:203], v[32:35], v[200:203]
 v_exp_f32 v23, v23
 v_mfma_f32_16x16x32_bf16 v[204:207], a[204:207], v[32:35], v[204:207]
 v_exp_f32 v0, v0
 v_mfma_f32_16x16x32_bf16 v[208:211], a[208:211], v[32:35], v[208:211]
 v_exp_f32 v1, v1
 v_mfma_f32_16x16x32_bf16 v[212:215], a[212:215], v[32:35], v[212:215]
 v_cvt_pk_bf16_f32 v39, v22, v23
 v_cvt_pk_bf16_f32 v24, v0, v1
 v_mfma_f32_16x16x32_bf16 v[216:219], a[216:219], v[32:35], v[216:219]
 v_exp_f32 v2, v2
 v_mfma_f32_16x16x32_bf16 v[220:223], a[220:223], v[32:35], v[220:223]
 buffer_load_dwordx4 v54, s[8:11], s30 offen offset:2048 nt lds
 v_mfma_f32_16x16x32_bf16 v[8:11], a[160:163], a[16:19], v[60:63]
 s_addk_i32 m0, 896
 v_exp_f32 v3, v3
 v_mfma_f32_16x16x32_bf16 v[8:11], a[164:167], a[20:23], v[8:11]
 v_exp_f32 v4, v4
 v_mfma_f32_16x16x32_bf16 v[8:11], a[168:171], a[24:27], v[8:11]
 v_exp_f32 v5, v5
 v_mfma_f32_16x16x32_bf16 v[8:11], a[172:175], a[28:31], v[8:11]
 v_cvt_pk_bf16_f32 v25, v2, v3
 v_cvt_pk_bf16_f32 v26, v4, v5
 v_mfma_f32_16x16x32_bf16 v[12:15], a[188:191], a[28:31], v[60:63]
 v_exp_f32 v6, v6
 v_mfma_f32_16x16x32_bf16 v[12:15], a[184:187], a[24:27], v[12:15]
 v_exp_f32 v7, v7
 v_mfma_f32_16x16x32_bf16 v[12:15], a[180:183], a[20:23], v[12:15]
 v_cvt_pk_bf16_f32 v27, v6, v7
 v_mfma_f32_16x16x32_bf16 v[12:15], a[176:179], a[16:19], v[12:15]
 v_exp_f32 v8, v8
 v_smfmac_f32_16x16x64_bf16 a[232:235], a[236:239], v[32:39], v55
 v_mfma_f32_16x16x32_bf16 v[224:227], a[192:195], v[36:39], v[224:227]
 ds_read_b64_tr_b16 a[192:193], v48 offset:24576
 ds_read_b64_tr_b16 a[194:195], v48 offset:28672
 v_mfma_f32_16x16x32_bf16 v[228:231], a[196:199], v[36:39], v[228:231]
 v_exp_f32 v9, v9
 v_mfma_f32_16x16x32_bf16 v[232:235], a[200:203], v[36:39], v[232:235]
 ds_read_b64_tr_b16 a[196:197], v49 offset:24576
 ds_read_b64_tr_b16 a[198:199], v49 offset:28672
 v_mfma_f32_16x16x32_bf16 v[236:239], a[204:207], v[36:39], v[236:239]
 v_exp_f32 v10, v10
 v_mfma_f32_16x16x32_bf16 v[240:243], a[208:211], v[36:39], v[240:243]
 ds_read_b64_tr_b16 a[200:201], v50 offset:24576
 ds_read_b64_tr_b16 a[202:203], v50 offset:28672
 v_mfma_f32_16x16x32_bf16 v[244:247], a[212:215], v[36:39], v[244:247]
 v_exp_f32 v11, v11
 v_mfma_f32_16x16x32_bf16 v[248:251], a[216:219], v[36:39], v[248:251]
 ds_read_b64_tr_b16 a[204:205], v51 offset:24576
 ds_read_b64_tr_b16 a[206:207], v51 offset:28672
 v_mfma_f32_16x16x32_bf16 v[252:255], a[220:223], v[36:39], v[252:255]
 v_cvt_pk_bf16_f32 v28, v8, v9
 v_cvt_pk_bf16_f32 v29, v10, v11
 v_mfma_f32_16x16x32_bf16 v[16:19], a[160:163], a[32:35], 0
 ds_read_b64_tr_b16 a[208:209], v48 offset:25600
 ds_read_b64_tr_b16 a[210:211], v48 offset:29696
 v_mfma_f32_16x16x32_bf16 v[16:19], a[164:167], a[36:39], v[16:19]
 v_exp_f32 v12, v12
 v_mfma_f32_16x16x32_bf16 v[16:19], a[168:171], a[40:43], v[16:19]
 ds_read_b64_tr_b16 a[212:213], v49 offset:25600
 ds_read_b64_tr_b16 a[214:215], v49 offset:29696
 v_mfma_f32_16x16x32_bf16 v[16:19], a[172:175], a[44:47], v[16:19]
 v_exp_f32 v13, v13
 v_mfma_f32_16x16x32_bf16 v[20:23], a[188:191], a[44:47], 0
 buffer_load_dwordx4 v54, s[8:11], s30 offen offset:128 nt lds
 v_mfma_f32_16x16x32_bf16 v[20:23], a[184:187], a[40:43], v[20:23]
 ds_read_b64_tr_b16 a[216:217], v50 offset:25600
 ds_read_b64_tr_b16 a[218:219], v50 offset:29696
 v_mfma_f32_16x16x32_bf16 v[20:23], a[180:183], a[36:39], v[20:23]
 ds_read_b64_tr_b16 a[220:221], v51 offset:25600
 ds_read_b64_tr_b16 a[222:223], v51 offset:29696
 v_mfma_f32_16x16x32_bf16 v[20:23], a[176:179], a[32:35], v[20:23]
 s_waitcnt lgkmcnt(6)
 v_cvt_pk_bf16_f32 v30, v12, v13
 v_fma_f32 v16, v16, s24, v42
 v_mfma_f32_16x16x32_bf16 v[64:67], a[192:195], v[24:27], v[64:67]
 v_exp_f32 v14, v14
 v_mfma_f32_16x16x32_bf16 v[68:71], a[196:199], v[24:27], v[68:71]
 v_exp_f32 v15, v15
 v_mfma_f32_16x16x32_bf16 v[72:75], a[200:203], v[24:27], v[72:75]
 v_cvt_pk_bf16_f32 v31, v14, v15
 v_fma_f32 v17, v17, s24, v42
 v_mfma_f32_16x16x32_bf16 v[76:79], a[204:207], v[24:27], v[76:79]
 v_exp_f32 v16, v16
 v_mfma_f32_16x16x32_bf16 v[80:83], a[208:211], v[24:27], v[80:83]
 s_waitcnt lgkmcnt(2)
 v_exp_f32 v17, v17
 v_mfma_f32_16x16x32_bf16 v[84:87], a[212:215], v[24:27], v[84:87]
 v_cvt_pk_bf16_f32 v32, v16, v17
 v_fma_f32 v18, v18, s24, v42
 v_mfma_f32_16x16x32_bf16 v[88:91], a[216:219], v[24:27], v[88:91]
 s_waitcnt lgkmcnt(0)
 v_fma_f32 v19, v19, s24, v42
 v_fma_f32 v20, v20, s24, v42
 v_mfma_f32_16x16x32_bf16 v[92:95], a[220:223], v[24:27], v[92:95]
 v_exp_f32 v18, v18
 v_mfma_f32_16x16x32_bf16 v[0:3], a[160:163], a[48:51], 0
 v_exp_f32 v19, v19
 v_mfma_f32_16x16x32_bf16 v[0:3], a[164:167], a[52:55], v[0:3]
 v_cvt_pk_bf16_f32 v33, v18, v19
 v_fma_f32 v21, v21, s24, v42
 v_mfma_f32_16x16x32_bf16 v[0:3], a[168:171], a[56:59], v[0:3]
 v_exp_f32 v20, v20
 v_mfma_f32_16x16x32_bf16 v[0:3], a[172:175], a[60:63], v[0:3]
 v_exp_f32 v21, v21
 v_mfma_f32_16x16x32_bf16 v[4:7], a[188:191], a[60:63], 0
 v_cvt_pk_bf16_f32 v34, v20, v21
 v_fma_f32 v22, v22, s24, v42
 v_mfma_f32_16x16x32_bf16 v[4:7], a[184:187], a[56:59], v[4:7]
 v_exp_f32 v22, v22
 v_mfma_f32_16x16x32_bf16 v[4:7], a[180:183], a[52:55], v[4:7]
 v_fma_f32 v23, v23, s24, v42
 v_fma_f32 v0, v0, s24, v43
 v_mfma_f32_16x16x32_bf16 v[4:7], a[176:179], a[48:51], v[4:7]
 v_exp_f32 v23, v23
 v_smfmac_f32_16x16x64_bf16 a[224:227], a[236:239], v[24:31], v55
 buffer_load_dwordx4 v54, s[8:11], s30 offen offset:2176 nt lds
 v_mfma_f32_16x16x32_bf16 v[96:99], a[192:195], v[28:31], v[96:99]
 s_add_u32 m0, s26, 57344
 v_cvt_pk_bf16_f32 v35, v22, v23
 v_fma_f32 v1, v1, s24, v43
 v_mfma_f32_16x16x32_bf16 v[100:103], a[196:199], v[28:31], v[100:103]
 s_addk_i32 s30, 4096
 v_exp_f32 v0, v0
 v_mfma_f32_16x16x32_bf16 v[104:107], a[200:203], v[28:31], v[104:107]
 v_exp_f32 v1, v1
 v_mfma_f32_16x16x32_bf16 v[108:111], a[204:207], v[28:31], v[108:111]
 v_cvt_pk_bf16_f32 v36, v0, v1
 v_fma_f32 v2, v2, s24, v43
 v_mfma_f32_16x16x32_bf16 v[112:115], a[208:211], v[28:31], v[112:115]
 v_fma_f32 v3, v3, s24, v43
 v_fma_f32 v4, v4, s24, v43
 v_mfma_f32_16x16x32_bf16 v[116:119], a[212:215], v[28:31], v[116:119]
 v_exp_f32 v2, v2
 v_mfma_f32_16x16x32_bf16 v[120:123], a[216:219], v[28:31], v[120:123]
 v_exp_f32 v3, v3
 v_mfma_f32_16x16x32_bf16 v[124:127], a[220:223], v[28:31], v[124:127]
 v_cvt_pk_bf16_f32 v37, v2, v3
 v_fma_f32 v5, v5, s24, v43
 v_mfma_f32_16x16x32_bf16 v[8:11], a[160:163], a[64:67], 0
 v_exp_f32 v4, v4
 v_mfma_f32_16x16x32_bf16 v[8:11], a[164:167], a[68:71], v[8:11]
 v_exp_f32 v5, v5
 v_mfma_f32_16x16x32_bf16 v[8:11], a[168:171], a[72:75], v[8:11]
 v_cvt_pk_bf16_f32 v38, v4, v5
 v_fma_f32 v6, v6, s24, v43
 v_mfma_f32_16x16x32_bf16 v[8:11], a[172:175], a[76:79], v[8:11]
 v_exp_f32 v6, v6
 v_mfma_f32_16x16x32_bf16 v[12:15], a[188:191], a[76:79], 0
 v_fma_f32 v7, v7, s24, v43
 v_mfma_f32_16x16x32_bf16 v[12:15], a[184:187], a[72:75], v[12:15]
 v_exp_f32 v7, v7
 v_mfma_f32_16x16x32_bf16 v[12:15], a[180:183], a[68:71], v[12:15]
 v_cvt_pk_bf16_f32 v39, v6, v7
 v_mfma_f32_16x16x32_bf16 v[12:15], a[176:179], a[64:67], v[12:15]
 v_fma_f32 v8, v8, s24, v44
 v_fma_f32 v9, v9, s24, v44
 v_mfma_f32_16x16x32_bf16 v[128:131], a[192:195], v[32:35], v[128:131]
 v_exp_f32 v8, v8
 v_mfma_f32_16x16x32_bf16 v[132:135], a[196:199], v[32:35], v[132:135]
 v_exp_f32 v9, v9
 v_mfma_f32_16x16x32_bf16 v[136:139], a[200:203], v[32:35], v[136:139]
 v_cvt_pk_bf16_f32 v24, v8, v9
 v_fma_f32 v10, v10, s24, v44
 v_mfma_f32_16x16x32_bf16 v[140:143], a[204:207], v[32:35], v[140:143]
 buffer_load_dwordx4 v54, s[12:15], s29 offen offset:0 nt lds
 v_mfma_f32_16x16x32_bf16 v[144:147], a[208:211], v[32:35], v[144:147]
 v_fma_f32 v11, v11, s24, v44
 v_fma_f32 v12, v12, s24, v44
 v_mfma_f32_16x16x32_bf16 v[148:151], a[212:215], v[32:35], v[148:151]
 v_exp_f32 v10, v10
 v_mfma_f32_16x16x32_bf16 v[152:155], a[216:219], v[32:35], v[152:155]
 s_waitcnt vmcnt(13)
 v_exp_f32 v11, v11
 v_mfma_f32_16x16x32_bf16 v[156:159], a[220:223], v[32:35], v[156:159]
 s_barrier
 v_cvt_pk_bf16_f32 v25, v10, v11
 v_fma_f32 v13, v13, s24, v44
 v_mfma_f32_16x16x32_bf16 v[16:19], a[160:163], a[80:83], 0
 ds_read_b128 a[160:163], v46 offset:40960
 v_fma_f32 v14, v14, s24, v44
 v_mfma_f32_16x16x32_bf16 v[16:19], a[164:167], a[84:87], v[16:19]
 v_exp_f32 v12, v12
 v_mfma_f32_16x16x32_bf16 v[16:19], a[168:171], a[88:91], v[16:19]
 ds_read_b128 a[164:167], v47 offset:40960
 v_fma_f32 v15, v15, s24, v44
 v_mfma_f32_16x16x32_bf16 v[16:19], a[172:175], a[92:95], v[16:19]
 v_exp_f32 v13, v13
 v_mfma_f32_16x16x32_bf16 v[20:23], a[188:191], a[92:95], 0
 ds_read_b128 a[168:171], v46 offset:41984
 v_cvt_pk_bf16_f32 v26, v12, v13
 v_mfma_f32_16x16x32_bf16 v[20:23], a[184:187], a[88:91], v[20:23]
 v_exp_f32 v14, v14
 v_mfma_f32_16x16x32_bf16 v[20:23], a[180:183], a[84:87], v[20:23]
 ds_read_b128 a[172:175], v47 offset:41984
 v_fma_f32 v16, v16, s24, v45
 v_mfma_f32_16x16x32_bf16 v[20:23], a[176:179], a[80:83], v[20:23]
 v_exp_f32 v15, v15
 v_smfmac_f32_16x16x64_bf16 a[228:231], a[236:239], v[32:39], v55
 buffer_load_dwordx4 v54, s[12:15], s29 offen offset:2048 nt lds
 v_mfma_f32_16x16x32_bf16 v[160:163], a[192:195], v[36:39], v[160:163]
 s_add_u32 m0, s26, 122880
 ds_read_b128 a[188:191], v47 offset:46080
 v_cvt_pk_bf16_f32 v27, v14, v15
 v_mfma_f32_16x16x32_bf16 v[164:167], a[196:199], v[36:39], v[164:167]
 v_fma_f32 v17, v17, s24, v45
 v_fma_f32 v18, v18, s24, v45
 v_mfma_f32_16x16x32_bf16 v[168:171], a[200:203], v[36:39], v[168:171]
 buffer_load_dwordx4 v54, s[16:19], s29 offen offset:0 nt lds
 v_mfma_f32_16x16x32_bf16 v[172:175], a[204:207], v[36:39], v[172:175]
 ds_read_b128 a[184:187], v46 offset:46080
 v_fma_f32 v19, v19, s24, v45
 v_mfma_f32_16x16x32_bf16 v[176:179], a[208:211], v[36:39], v[176:179]
 v_exp_f32 v16, v16
 v_mfma_f32_16x16x32_bf16 v[180:183], a[212:215], v[36:39], v[180:183]
 ds_read_b128 a[180:183], v47 offset:45056
 v_fma_f32 v20, v20, s24, v45
 v_mfma_f32_16x16x32_bf16 v[184:187], a[216:219], v[36:39], v[184:187]
 ds_read_b128 a[176:179], v46 offset:45056
 v_fma_f32 v21, v21, s24, v45
 v_mfma_f32_16x16x32_bf16 v[188:191], a[220:223], v[36:39], v[188:191]
 s_waitcnt lgkmcnt(3)
 v_exp_f32 v17, v17
 v_mfma_f32_16x16x32_bf16 v[0:3], a[160:163], a[0:3], v[56:59]
 v_cvt_pk_bf16_f32 v28, v16, v17
 v_fma_f32 v22, v22, s24, v45
 v_mfma_f32_16x16x32_bf16 v[0:3], a[164:167], a[4:7], v[0:3]
 v_exp_f32 v18, v18
 v_mfma_f32_16x16x32_bf16 v[0:3], a[168:171], a[8:11], v[0:3]
 s_waitcnt vmcnt(11) lgkmcnt(1)
 buffer_load_dwordx4 v54, s[16:19], s29 offen offset:2048 nt lds
 v_mfma_f32_16x16x32_bf16 v[0:3], a[172:175], a[12:15], v[0:3]
 s_add_u32 m0, s28, 135168
 ds_read_b128 a[144:147], v52 offset:4096
 v_fma_f32 v23, v23, s24, v45
 v_mfma_f32_16x16x32_bf16 v[4:7], a[188:191], a[12:15], v[56:59]
 s_addk_i32 s29, 8192
 ds_read_b128 a[148:151], v53 offset:4096
 v_mfma_f32_16x16x32_bf16 v[4:7], a[184:187], a[8:11], v[4:7]
 ds_read_b128 a[152:155], v52 offset:5120
 v_mfma_f32_16x16x32_bf16 v[4:7], a[180:183], a[4:7], v[4:7]
 s_waitcnt lgkmcnt(3)
 ds_read_b128 a[156:159], v53 offset:5120
 v_mfma_f32_16x16x32_bf16 v[4:7], a[176:179], a[0:3], v[4:7]
 v_exp_f32 v19, v19
 v_mfma_f32_16x16x32_bf16 v[192:195], a[192:195], v[24:27], v[192:195]
 v_exp_f32 v20, v20
 v_mfma_f32_16x16x32_bf16 v[196:199], a[196:199], v[24:27], v[196:199]
 v_exp_f32 v21, v21
 v_mfma_f32_16x16x32_bf16 v[200:203], a[200:203], v[24:27], v[200:203]
 v_cvt_pk_bf16_f32 v29, v18, v19
 v_cvt_pk_bf16_f32 v30, v20, v21
 v_mfma_f32_16x16x32_bf16 v[204:207], a[204:207], v[24:27], v[204:207]
 v_exp_f32 v22, v22
 v_mfma_f32_16x16x32_bf16 v[208:211], a[208:211], v[24:27], v[208:211]
 v_exp_f32 v23, v23
 v_mfma_f32_16x16x32_bf16 v[212:215], a[212:215], v[24:27], v[212:215]
 v_exp_f32 v0, v0
 v_mfma_f32_16x16x32_bf16 v[216:219], a[216:219], v[24:27], v[216:219]
 v_exp_f32 v1, v1
 v_mfma_f32_16x16x32_bf16 v[220:223], a[220:223], v[24:27], v[220:223]
 v_cvt_pk_bf16_f32 v31, v22, v23
 v_cvt_pk_bf16_f32 v32, v0, v1
 v_mfma_f32_16x16x32_bf16 v[8:11], a[160:163], a[16:19], v[60:63]
 v_exp_f32 v2, v2
 v_mfma_f32_16x16x32_bf16 v[8:11], a[164:167], a[20:23], v[8:11]
 v_exp_f32 v3, v3
 v_mfma_f32_16x16x32_bf16 v[8:11], a[168:171], a[24:27], v[8:11]
 v_exp_f32 v4, v4
 v_mfma_f32_16x16x32_bf16 v[8:11], a[172:175], a[28:31], v[8:11]
 v_exp_f32 v5, v5
 v_mfma_f32_16x16x32_bf16 v[12:15], a[188:191], a[28:31], v[60:63]
 v_cvt_pk_bf16_f32 v33, v2, v3
 v_cvt_pk_bf16_f32 v34, v4, v5
 v_mfma_f32_16x16x32_bf16 v[12:15], a[184:187], a[24:27], v[12:15]
 v_exp_f32 v6, v6
 v_mfma_f32_16x16x32_bf16 v[12:15], a[180:183], a[20:23], v[12:15]
 v_exp_f32 v7, v7
 v_mfma_f32_16x16x32_bf16 v[12:15], a[176:179], a[16:19], v[12:15]
 v_exp_f32 v8, v8
 v_smfmac_f32_16x16x64_bf16 a[232:235], a[236:239], v[24:31], v55
 v_cvt_pk_bf16_f32 v35, v6, v7
 v_mfma_f32_16x16x32_bf16 v[224:227], a[192:195], v[28:31], v[224:227]
 ds_read_b64_tr_b16 a[192:193], v48 offset:40960
 ds_read_b64_tr_b16 a[194:195], v48 offset:45056
 v_mfma_f32_16x16x32_bf16 v[228:231], a[196:199], v[28:31], v[228:231]
 v_exp_f32 v9, v9
 v_mfma_f32_16x16x32_bf16 v[232:235], a[200:203], v[28:31], v[232:235]
 s_waitcnt lgkmcnt(2)
 buffer_load_dwordx4 v54, s[8:11], s30 offen offset:0 nt lds
 v_mfma_f32_16x16x32_bf16 v[236:239], a[204:207], v[28:31], v[236:239]
 ds_read_b64_tr_b16 a[196:197], v49 offset:40960
 ds_read_b64_tr_b16 a[198:199], v49 offset:45056
 v_mfma_f32_16x16x32_bf16 v[240:243], a[208:211], v[28:31], v[240:243]
 v_exp_f32 v10, v10
 v_mfma_f32_16x16x32_bf16 v[244:247], a[212:215], v[28:31], v[244:247]
 ds_read_b64_tr_b16 a[200:201], v50 offset:40960
 ds_read_b64_tr_b16 a[202:203], v50 offset:45056
 v_mfma_f32_16x16x32_bf16 v[248:251], a[216:219], v[28:31], v[248:251]
 v_exp_f32 v11, v11
 v_mfma_f32_16x16x32_bf16 v[252:255], a[220:223], v[28:31], v[252:255]
 ds_read_b64_tr_b16 a[204:205], v51 offset:40960
 ds_read_b64_tr_b16 a[206:207], v51 offset:45056
 v_mfma_f32_16x16x32_bf16 v[16:19], a[160:163], a[32:35], 0
 v_cvt_pk_bf16_f32 v36, v8, v9
 v_cvt_pk_bf16_f32 v37, v10, v11
 v_mfma_f32_16x16x32_bf16 v[16:19], a[164:167], a[36:39], v[16:19]
 ds_read_b64_tr_b16 a[208:209], v48 offset:41984
 ds_read_b64_tr_b16 a[210:211], v48 offset:46080
 v_mfma_f32_16x16x32_bf16 v[16:19], a[168:171], a[40:43], v[16:19]
 v_exp_f32 v12, v12
 v_mfma_f32_16x16x32_bf16 v[16:19], a[172:175], a[44:47], v[16:19]
 ds_read_b64_tr_b16 a[212:213], v49 offset:41984
 ds_read_b64_tr_b16 a[214:215], v49 offset:46080
 v_mfma_f32_16x16x32_bf16 v[20:23], a[188:191], a[44:47], 0
 v_exp_f32 v13, v13
 v_mfma_f32_16x16x32_bf16 v[20:23], a[184:187], a[40:43], v[20:23]
 ds_read_b64_tr_b16 a[216:217], v50 offset:41984
 ds_read_b64_tr_b16 a[218:219], v50 offset:46080
 v_mfma_f32_16x16x32_bf16 v[20:23], a[180:183], a[36:39], v[20:23]
L_stub6:
 s_cbranch_vccnz L_stub10
.if ((L_stub6-L_main)>>6) != 384
.error "stub misplaced"
.endif
 ds_read_b64_tr_b16 a[220:221], v51 offset:41984
 ds_read_b64_tr_b16 a[222:223], v51 offset:46080
 v_mfma_f32_16x16x32_bf16 v[20:23], a[176:179], a[32:35], v[20:23]
 s_waitcnt lgkmcnt(8)
 v_cvt_pk_bf16_f32 v38, v12, v13
 v_fma_f32 v16, v16, s24, v42
 v_mfma_f32_16x16x32_bf16 v[64:67], a[192:195], v[32:35], v[64:67]
 v_exp_f32 v14, v14
 v_mfma_f32_16x16x32_bf16 v[68:71], a[196:199], v[32:35], v[68:71]
 v_exp_f32 v15, v15
 v_mfma_f32_16x16x32_bf16 v[72:75], a[200:203], v[32:35], v[72:75]
 v_cvt_pk_bf16_f32 v39, v14, v15
 v_fma_f32 v17, v17, s24, v42
 v_mfma_f32_16x16x32_bf16 v[76:79], a[204:207], v[32:35], v[76:79]
 s_waitcnt lgkmcnt(4)
 v_exp_f32 v16, v16
 v_mfma_f32_16x16x32_bf16 v[80:83], a[208:211], v[32:35], v[80:83]
 v_exp_f32 v17, v17
 v_mfma_f32_16x16x32_bf16 v[84:87], a[212:215], v[32:35], v[84:87]
 s_waitcnt lgkmcnt(0)
 v_cvt_pk_bf16_f32 v24, v16, v17
 v_fma_f32 v18, v18, s24, v42
 v_mfma_f32_16x16x32_bf16 v[88:91], a[216:219], v[32:35], v[88:91]
 v_fma_f32 v19, v19, s24, v42
 v_fma_f32 v20, v20, s24, v42
 v_mfma_f32_16x16x32_bf16 v[92:95], a[220:223], v[32:35], v[92:95]
 buffer_load_dwordx4 v54, s[8:11], s30 offen offset:2048 nt lds
 v_mfma_f32_16x16x32_bf16 v[0:3], a[160:163], a[48:51], 0
 s_addk_i32 m0, 896
 v_exp_f32 v18, v18
 v_mfma_f32_16x16x32_bf16 v[0:3], a[164:167], a[52:55], v[0:3]
 v_exp_f32 v19, v19
 v_mfma_f32_16x16x32_bf16 v[0:3], a[168:171], a[56:59], v[0:3]
 v_cvt_pk_bf16_f32 v25, v18, v19
 v_fma_f32 v21, v21, s24, v42
 v_mfma_f32_16x16x32_bf16 v[0:3], a[172:175], a[60:63], v[0:3]
 v_exp_f32 v20, v20
 v_mfma_f32_16x16x32_bf16 v[4:7], a[188:191], a[60:63], 0
 v_exp_f32 v21, v21
 v_mfma_f32_16x16x32_bf16 v[4:7], a[184:187], a[56:59], v[4:7]
 v_cvt_pk_bf16_f32 v26, v20, v21
 v_fma_f32 v22, v22, s24, v42
 v_mfma_f32_16x16x32_bf16 v[4:7], a[180:183], a[52:55], v[4:7]
 v_exp_f32 v22, v22
 v_mfma_f32_16x16x32_bf16 v[4:7], a[176:179], a[48:51], v[4:7]
 v_fma_f32 v23, v23, s24, v42
 v_fma_f32 v0, v0, s24, v43
 v_smfmac_f32_16x16x64_bf16 a[224:227], a[236:239], v[32:39], v55
 v_fma_f32 v1, v1, s24, v43
 v_mfma_f32_16x16x32_bf16 v[96:99], a[192:195], v[36:39], v[96:99]
 v_exp_f32 v23, v23
 v_mfma_f32_16x16x32_bf16 v[100:103], a[196:199], v[36:39], v[100:103]
 v_cvt_pk_bf16_f32 v27, v22, v23
 v_fma_f32 v2, v2, s24, v43
 v_mfma_f32_16x16x32_bf16 v[104:107], a[200:203], v[36:39], v[104:107]
 v_exp_f32 v0, v0
 v_mfma_f32_16x16x32_bf16 v[108:111], a[204:207], v[36:39], v[108:111]
 v_exp_f32 v1, v1
 v_mfma_f32_16x16x32_bf16 v[112:115], a[208:211], v[36:39], v[112:115]
 v_cvt_pk_bf16_f32 v28, v0, v1
 v_fma_f32 v3, v3, s24, v43
 v_mfma_f32_16x16x32_bf16 v[116:119], a[212:215], v[36:39], v[116:119]
 v_exp_f32 v2, v2
 v_mfma_f32_16x16x32_bf16 v[120:123], a[216:219], v[36:39], v[120:123]
 v_exp_f32 v3, v3
 v_mfma_f32_16x16x32_bf16 v[124:127], a[220:223], v[36:39], v[124:127]
 v_cvt_pk_bf16_f32 v29, v2, v3
 v_fma_f32 v4, v4, s24, v43
 v_mfma_f32_16x16x32_bf16 v[8:11], a[160:163], a[64:67], 0
 v_fma_f32 v5, v5, s24, v43
 v_fma_f32 v6, v6, s24, v43
 v_mfma_f32_16x16x32_bf16 v[8:11], a[164:167], a[68:71], v[8:11]
 v_exp_f32 v4, v4
 v_mfma_f32_16x16x32_bf16 v[8:11], a[168:171], a[72:75], v[8:11]
 v_exp_f32 v5, v5
 v_mfma_f32_16x16x32_bf16 v[8:11], a[172:175], a[76:79], v[8:11]
 buffer_load_dwordx4 v54, s[8:11], s30 offen offset:128 nt lds
 v_mfma_f32_16x16x32_bf16 v[12:15], a[188:191], a[76:79], 0
 v_cvt_pk_bf16_f32 v30, v4, v5
 v_fma_f32 v7, v7, s24, v43
 v_mfma_f32_16x16x32_bf16 v[12:15], a[184:187], a[72:75], v[12:15]
 v_exp_f32 v6, v6
 v_mfma_f32_16x16x32_bf16 v[12:15], a[180:183], a[68:71], v[12:15]
 v_exp_f32 v7, v7
 v_mfma_f32_16x16x32_bf16 v[12:15], a[176:179], a[64:67], v[12:15]
 v_cvt_pk_bf16_f32 v31, v6, v7
 v_fma_f32 v8, v8, s24, v44
 v_mfma_f32_16x16x32_bf16 v[128:131], a[192:195], v[24:27], v[128:131]
 v_fma_f32 v9, v9, s24, v44
 v_fma_f32 v10, v10, s24, v44
 v_mfma_f32_16x16x32_bf16 v[132:135], a[196:199], v[24:27], v[132:135]
 v_exp_f32 v8, v8
 v_mfma_f32_16x16x32_bf16 v[136:139], a[200:203], v[24:27], v[136:139]
 v_exp_f32 v9, v9
 v_mfma_f32_16x16x32_bf16 v[140:143], a[204:207], v[24:27], v[140:143]
 v_cvt_pk_bf16_f32 v32, v8, v9
 v_fma_f32 v11, v11, s24, v44
 v_mfma_f32_16x16x32_bf16 v[144:147], a[208:211], v[24:27], v[144:147]
 v_exp_f32 v10, v10
 v_mfma_f32_16x16x32_bf16 v[148:151], a[212:215], v[24:27], v[148:151]
 v_exp_f32 v11, v11
 v_mfma_f32_16x16x32_bf16 v[152:155], a[216:219], v[24:27], v[152:155]
 s_waitcnt vmcnt(11)
 v_cvt_pk_bf16_f32 v33, v10, v11
 v_fma_f32 v12, v12, s24, v44
 v_mfma_f32_16x16x32_bf16 v[156:159], a[220:223], v[24:27], v[156:159]
 s_barrier
 v_fma_f32 v13, v13, s24, v44
 v_fma_f32 v14, v14, s24, v44
 v_mfma_f32_16x16x32_bf16 v[16:19], a[160:163], a[80:83], 0
 ds_read_b128 a[160:163], v46 offset:49152
 v_fma_f32 v15, v15, s24, v44
 v_mfma_f32_16x16x32_bf16 v[16:19], a[164:167], a[84:87], v[16:19]
 v_exp_f32 v12, v12
 v_mfma_f32_16x16x32_bf16 v[16:19], a[168:171], a[88:91], v[16:19]
 ds_read_b128 a[164:167], v47 offset:49152
 v_mfma_f32_16x16x32_bf16 v[16:19], a[172:175], a[92:95], v[16:19]
 v_exp_f32 v13, v13
 v_mfma_f32_16x16x32_bf16 v[20:23], a[188:191], a[92:95], 0
 ds_read_b128 a[168:171], v46 offset:50176
 v_cvt_pk_bf16_f32 v34, v12, v13
 v_mfma_f32_16x16x32_bf16 v[20:23], a[184:187], a[88:91], v[20:23]
 v_exp_f32 v14, v14
 v_mfma_f32_16x16x32_bf16 v[20:23], a[180:183], a[84:87], v[20:23]
 ds_read_b128 a[172:175], v47 offset:50176
 v_fma_f32 v16, v16, s24, v45
 v_mfma_f32_16x16x32_bf16 v[20:23], a[176:179], a[80:83], v[20:23]
 v_exp_f32 v15, v15
 v_smfmac_f32_16x16x64_bf16 a[228:231], a[236:239], v[24:31], v55
 buffer_load_dwordx4 v54, s[8:11], s30 offen offset:2176 nt lds
 v_mfma_f32_16x16x32_bf16 v[160:163], a[192:195], v[28:31], v[160:163]
 s_add_u32 m0, s26, 32768
 ds_read_b128 a[188:191], v47 offset:54272
 v_cvt_pk_bf16_f32 v35, v14, v15
 v_mfma_f32_16x16x32_bf16 v[164:167], a[196:199], v[28:31], v[164:167]
 v_fma_f32 v17, v17, s24, v45
 v_fma_f32 v18, v18, s24, v45
 v_mfma_f32_16x16x32_bf16 v[168:171], a[200:203], v[28:31], v[168:171]
 ds_read_b128 a[184:187], v46 offset:54272
 v_fma_f32 v19, v19, s24, v45
 v_mfma_f32_16x16x32_bf16 v[172:175], a[204:207], v[28:31], v[172:175]
 v_exp_f32 v16, v16
 v_mfma_f32_16x16x32_bf16 v[176:179], a[208:211], v[28:31], v[176:179]
 ds_read_b128 a[180:183], v47 offset:53248
 v_fma_f32 v20, v20, s24, v45
 v_mfma_f32_16x16x32_bf16 v[180:183], a[212:215], v[28:31], v[180:183]
 v_exp_f32 v17, v17
 v_mfma_f32_16x16x32_bf16 v[184:187], a[216:219], v[28:31], v[184:187]
 ds_read_b128 a[176:179], v46 offset:53248
 v_cvt_pk_bf16_f32 v36, v16, v17
 v_mfma_f32_16x16x32_bf16 v[188:191], a[220:223], v[28:31], v[188:191]
 s_waitcnt lgkmcnt(3)
 v_exp_f32 v18, v18
 v_mfma_f32_16x16x32_bf16 v[0:3], a[160:163], a[0:3], v[56:59]
 v_exp_f32 v19, v19
 v_mfma_f32_16x16x32_bf16 v[0:3], a[164:167], a[4:7], v[0:3]
 v_cvt_pk_bf16_f32 v37, v18, v19
 v_fma_f32 v21, v21, s24, v45
 v_mfma_f32_16x16x32_bf16 v[0:3], a[168:171], a[8:11], v[0:3]
 v_exp_f32 v20, v20
 v_mfma_f32_16x16x32_bf16 v[0:3], a[172:175], a[12:15], v[0:3]
 v_exp_f32 v21, v21
 v_mfma_f32_16x16x32_bf16 v[4:7], a[188:191], a[12:15], v[56:59]
 s_waitcnt lgkmcnt(1)
 v_cvt_pk_bf16_f32 v38, v20, v21
 v_fma_f32 v22, v22, s24, v45
 v_mfma_f32_16x16x32_bf16 v[4:7], a[184:187], a[8:11], v[4:7]
 v_exp_f32 v22, v22
 v_mfma_f32_16x16x32_bf16 v[4:7], a[180:183], a[4:7], v[4:7]
 s_waitcnt lgkmcnt(0)
 v_fma_f32 v23, v23, s24, v45
 v_mfma_f32_16x16x32_bf16 v[4:7], a[176:179], a[0:3], v[4:7]
 v_exp_f32 v23, v23
 v_mfma_f32_16x16x32_bf16 v[192:195], a[192:195], v[32:35], v[192:195]
 v_exp_f32 v0, v0
 v_mfma_f32_16x16x32_bf16 v[196:199], a[196:199], v[32:35], v[196:199]
 v_exp_f32 v1, v1
 v_mfma_f32_16x16x32_bf16 v[200:203], a[200:203], v[32:35], v[200:203]
 v_cvt_pk_bf16_f32 v39, v22, v23
 v_cvt_pk_bf16_f32 v24, v0, v1
 v_mfma_f32_16x16x32_bf16 v[204:207], a[204:207], v[32:35], v[204:207]
 buffer_load_dwordx4 v54, s[12:15], s29 offen offset:0 nt lds
 v_mfma_f32_16x16x32_bf16 v[208:211], a[208:211], v[32:35], v[208:211]
 v_exp_f32 v2, v2
 v_mfma_f32_16x16x32_bf16 v[212:215], a[212:215], v[32:35], v[212:215]
 v_exp_f32 v3, v3
 v_mfma_f32_16x16x32_bf16 v[216:219], a[216:219], v[32:35], v[216:219]
 v_exp_f32 v4, v4
 v_mfma_f32_16x16x32_bf16 v[220:223], a[220:223], v[32:35], v[220:223]
 v_exp_f32 v5, v5
 v_mfma_f32_16x16x32_bf16 v[8:11], a[160:163], a[16:19], v[60:63]
 v_cvt_pk_bf16_f32 v25, v2, v3
 v_cvt_pk_bf16_f32 v26, v4, v5
 v_mfma_f32_16x16x32_bf16 v[8:11], a[164:167], a[20:23], v[8:11]
 v_exp_f32 v6, v6
 v_mfma_f32_16x16x32_bf16 v[8:11], a[168:171], a[24:27], v[8:11]
 v_exp_f32 v7, v7
 v_mfma_f32_16x16x32_bf16 v[8:11], a[172:175], a[28:31], v[8:11]
 v_cvt_pk_bf16_f32 v27, v6, v7
 v_mfma_f32_16x16x32_bf16 v[12:15], a[188:191], a[28:31], v[60:63]
 buffer_load_dwordx4 v54, s[12:15], s29 offen offset:2048 nt lds
 v_mfma_f32_16x16x32_bf16 v[12:15], a[184:187], a[24:27], v[12:15]
 s_add_u32 m0, s26, 98304
 v_mfma_f32_16x16x32_bf16 v[12:15], a[180:183], a[20:23], v[12:15]
 v_mfma_f32_16x16x32_bf16 v[12:15], a[176:179], a[16:19], v[12:15]
 buffer_load_dwordx4 v54, s[16:19], s29 offen offset:0 nt lds
 v_smfmac_f32_16x16x64_bf16 a[232:235], a[236:239], v[32:39], v55
 v_mfma_f32_16x16x32_bf16 v[224:227], a[192:195], v[36:39], v[224:227]
 ds_read_b64_tr_b16 a[192:193], v48 offset:49152
 ds_read_b64_tr_b16 a[194:195], v48 offset:53248
 v_mfma_f32_16x16x32_bf16 v[228:231], a[196:199], v[36:39], v[228:231]
 v_exp_f32 v8, v8
 v_mfma_f32_16x16x32_bf16 v[232:235], a[200:203], v[36:39], v[232:235]
 ds_read_b64_tr_b16 a[196:197], v49 offset:49152
 ds_read_b64_tr_b16 a[198:199], v49 offset:53248
 v_mfma_f32_16x16x32_bf16 v[236:239], a[204:207], v[36:39], v[236:239]
 v_exp_f32 v9, v9
 v_mfma_f32_16x16x32_bf16 v[240:243], a[208:211], v[36:39], v[240:243]
 ds_read_b64_tr_b16 a[200:201], v50 offset:49152
 ds_read_b64_tr_b16 a[202:203], v50 offset:53248
 v_mfma_f32_16x16x32_bf16 v[244:247], a[212:215], v[36:39], v[244:247]
 v_exp_f32 v10, v10
 v_mfma_f32_16x16x32_bf16 v[248:251], a[216:219], v[36:39], v[248:251]
 ds_read_b64_tr_b16 a[204:205], v51 offset:49152
 ds_read_b64_tr_b16 a[206:207], v51 offset:53248
 v_mfma_f32_16x16x32_bf16 v[252:255], a[220:223], v[36:39], v[252:255]
 v_exp_f32 v11, v11
 v_mfma_f32_16x16x32_bf16 v[16:19], a[160:163], a[32:35], 0
 ds_read_b64_tr_b16 a[208:209], v48 offset:50176
 ds_read_b64_tr_b16 a[210:211], v48 offset:54272
 v_mfma_f32_16x16x32_bf16 v[16:19], a[164:167], a[36:39], v[16:19]
 v_cvt_pk_bf16_f32 v28, v8, v9
 v_cvt_pk_bf16_f32 v29, v10, v11
 v_mfma_f32_16x16x32_bf16 v[16:19], a[168:171], a[40:43], v[16:19]
 ds_read_b64_tr_b16 a[212:213], v49 offset:50176
 ds_read_b64_tr_b16 a[214:215], v49 offset:54272
 v_mfma_f32_16x16x32_bf16 v[16:19], a[172:175], a[44:47], v[16:19]
 v_exp_f32 v12, v12
 v_mfma_f32_16x16x32_bf16 v[20:23], a[188:191], a[44:47], 0
 ds_read_b64_tr_b16 a[216:217], v50 offset:50176
 ds_read_b64_tr_b16 a[218:219], v50 offset:54272
 v_mfma_f32_16x16x32_bf16 v[20:23], a[184:187], a[40:43], v[20:23]
 v_exp_f32 v13, v13
 v_mfma_f32_16x16x32_bf16 v[20:23], a[180:183], a[36:39], v[20:23]
 ds_read_b64_tr_b16 a[220:221], v51 offset:50176
 ds_read_b64_tr_b16 a[222:223], v51 offset:54272
 v_mfma_f32_16x16x32_bf16 v[20:23], a[176:179], a[32:35], v[20:23]
 s_waitcnt lgkmcnt(6)
 v_cvt_pk_bf16_f32 v30, v12, v13
 v_fma_f32 v16, v16, s24, v42
 v_mfma_f32_16x16x32_bf16 v[64:67], a[192:195], v[24:27], v[64:67]
 v_exp_f32 v14, v14
 v_mfma_f32_16x16x32_bf16 v[68:71], a[196:199], v[24:27], v[68:71]
 v_exp_f32 v15, v15
 v_mfma_f32_16x16x32_bf16 v[72:75], a[200:203], v[24:27], v[72:75]
 v_cvt_pk_bf16_f32 v31, v14, v15
 v_fma_f32 v17, v17, s24, v42
 v_mfma_f32_16x16x32_bf16 v[76:79], a[204:207], v[24:27], v[76:79]
 v_exp_f32 v16, v16
 v_mfma_f32_16x16x32_bf16 v[80:83], a[208:211], v[24:27], v[80:83]
 s_waitcnt lgkmcnt(2)
 v_exp_f32 v17, v17
 v_mfma_f32_16x16x32_bf16 v[84:87], a[212:215], v[24:27], v[84:87]
 v_cvt_pk_bf16_f32 v32, v16, v17
 v_fma_f32 v18, v18, s24, v42
 v_mfma_f32_16x16x32_bf16 v[88:91], a[216:219], v[24:27], v[88:91]
 s_waitcnt lgkmcnt(0)
 buffer_load_dwordx4 v54, s[16:19], s29 offen offset:2048 nt lds
 v_mfma_f32_16x16x32_bf16 v[92:95], a[220:223], v[24:27], v[92:95]
 s_add_u32 m0, s26, 0
 v_fma_f32 v19, v19, s24, v42
 v_fma_f32 v20, v20, s24, v42
 v_mfma_f32_16x16x32_bf16 v[0:3], a[160:163], a[48:51], 0
 s_addk_i32 s29, 8192
 v_exp_f32 v18, v18
 v_mfma_f32_16x16x32_bf16 v[0:3], a[164:167], a[52:55], v[0:3]
 v_exp_f32 v19, v19
 v_mfma_f32_16x16x32_bf16 v[0:3], a[168:171], a[56:59], v[0:3]
 v_cvt_pk_bf16_f32 v33, v18, v19
 v_fma_f32 v21, v21, s24, v42
 v_mfma_f32_16x16x32_bf16 v[0:3], a[172:175], a[60:63], v[0:3]
 v_exp_f32 v20, v20
 v_mfma_f32_16x16x32_bf16 v[4:7], a[188:191], a[60:63], 0
 v_exp_f32 v21, v21
 v_mfma_f32_16x16x32_bf16 v[4:7], a[184:187], a[56:59], v[4:7]
 v_cvt_pk_bf16_f32 v34, v20, v21
 v_fma_f32 v22, v22, s24, v42
 v_mfma_f32_16x16x32_bf16 v[4:7], a[180:183], a[52:55], v[4:7]
 v_exp_f32 v22, v22
 v_mfma_f32_16x16x32_bf16 v[4:7], a[176:179], a[48:51], v[4:7]
 v_fma_f32 v23, v23, s24, v42
 v_fma_f32 v0, v0, s24, v43
 v_smfmac_f32_16x16x64_bf16 a[224:227], a[236:239], v[24:31], v55
 v_fma_f32 v1, v1, s24, v43
 v_mfma_f32_16x16x32_bf16 v[96:99], a[192:195], v[28:31], v[96:99]
 v_exp_f32 v23, v23
 v_mfma_f32_16x16x32_bf16 v[100:103], a[196:199], v[28:31], v[100:103]
 v_cvt_pk_bf16_f32 v35, v22, v23
 v_fma_f32 v2, v2, s24, v43
 v_mfma_f32_16x16x32_bf16 v[104:107], a[200:203], v[28:31], v[104:107]
 buffer_load_dwordx4 v54, s[12:15], s29 offen offset:0 nt lds
 v_mfma_f32_16x16x32_bf16 v[108:111], a[204:207], v[28:31], v[108:111]
 v_exp_f32 v0, v0
 v_mfma_f32_16x16x32_bf16 v[112:115], a[208:211], v[28:31], v[112:115]
 v_exp_f32 v1, v1
 v_mfma_f32_16x16x32_bf16 v[116:119], a[212:215], v[28:31], v[116:119]
 v_cvt_pk_bf16_f32 v36, v0, v1
 v_fma_f32 v3, v3, s24, v43
 v_mfma_f32_16x16x32_bf16 v[120:123], a[216:219], v[28:31], v[120:123]
 v_exp_f32 v2, v2
 v_mfma_f32_16x16x32_bf16 v[124:127], a[220:223], v[28:31], v[124:127]
 v_exp_f32 v3, v3
 v_mfma_f32_16x16x32_bf16 v[8:11], a[160:163], a[64:67], 0
 v_cvt_pk_bf16_f32 v37, v2, v3
 v_fma_f32 v4, v4, s24, v43
 v_mfma_f32_16x16x32_bf16 v[8:11], a[164:167], a[68:71], v[8:11]
 v_fma_f32 v5, v5, s24, v43
 v_fma_f32 v6, v6, s24, v43
 v_mfma_f32_16x16x32_bf16 v[8:11], a[168:171], a[72:75], v[8:11]
 v_exp_f32 v4, v4
 v_mfma_f32_16x16x32_bf16 v[8:11], a[172:175], a[76:79], v[8:11]
 v_exp_f32 v5, v5
 v_mfma_f32_16x16x32_bf16 v[12:15], a[188:191], a[76:79], 0
 v_cvt_pk_bf16_f32 v38, v4, v5
 v_fma_f32 v7, v7, s24, v43
 v_mfma_f32_16x16x32_bf16 v[12:15], a[184:187], a[72:75], v[12:15]
 v_exp_f32 v6, v6
 v_mfma_f32_16x16x32_bf16 v[12:15], a[180:183], a[68:71], v[12:15]
 buffer_load_dwordx4 v54, s[12:15], s29 offen offset:2048 nt lds
 v_mfma_f32_16x16x32_bf16 v[12:15], a[176:179], a[64:67], v[12:15]
 s_add_u32 m0, s26, 65536
 v_exp_f32 v7, v7
 v_mfma_f32_16x16x32_bf16 v[128:131], a[192:195], v[32:35], v[128:131]
 v_cvt_pk_bf16_f32 v39, v6, v7
 v_fma_f32 v8, v8, s24, v44
 v_mfma_f32_16x16x32_bf16 v[132:135], a[196:199], v[32:35], v[132:135]
 v_fma_f32 v9, v9, s24, v44
 v_fma_f32 v10, v10, s24, v44
 v_mfma_f32_16x16x32_bf16 v[136:139], a[200:203], v[32:35], v[136:139]
 v_exp_f32 v8, v8
 v_mfma_f32_16x16x32_bf16 v[140:143], a[204:207], v[32:35], v[140:143]
 v_exp_f32 v9, v9
 v_mfma_f32_16x16x32_bf16 v[144:147], a[208:211], v[32:35], v[144:147]
 v_cvt_pk_bf16_f32 v24, v8, v9
 v_fma_f32 v11, v11, s24, v44
 v_mfma_f32_16x16x32_bf16 v[148:151], a[212:215], v[32:35], v[148:151]
 v_exp_f32 v10, v10
 v_mfma_f32_16x16x32_bf16 v[152:155], a[216:219], v[32:35], v[152:155]
 s_waitcnt vmcnt(10)
 v_exp_f32 v11, v11
 v_mfma_f32_16x16x32_bf16 v[156:159], a[220:223], v[32:35], v[156:159]
 s_barrier
 v_cvt_pk_bf16_f32 v25, v10, v11
 v_fma_f32 v12, v12, s24, v44
 v_mfma_f32_16x16x32_bf16 v[16:19], a[160:163], a[80:83], 0
 ds_read_b128 a[160:163], v46 offset:57344
 v_fma_f32 v13, v13, s24, v44
 v_mfma_f32_16x16x32_bf16 v[16:19], a[164:167], a[84:87], v[16:19]
 v_exp_f32 v12, v12
 v_mfma_f32_16x16x32_bf16 v[16:19], a[168:171], a[88:91], v[16:19]
 buffer_load_dwordx4 v54, s[16:19], s29 offen offset:0 nt lds
 v_mfma_f32_16x16x32_bf16 v[16:19], a[172:175], a[92:95], v[16:19]
 ds_read_b128 a[164:167], v47 offset:57344
 v_fma_f32 v14, v14, s24, v44
 v_mfma_f32_16x16x32_bf16 v[20:23], a[188:191], a[92:95], 0
 v_exp_f32 v13, v13
 v_mfma_f32_16x16x32_bf16 v[20:23], a[184:187], a[88:91], v[20:23]
 ds_read_b128 a[168:171], v46 offset:58368
 v_cvt_pk_bf16_f32 v26, v12, v13
 v_mfma_f32_16x16x32_bf16 v[20:23], a[180:183], a[84:87], v[20:23]
 v_fma_f32 v15, v15, s24, v44
 v_fma_f32 v16, v16, s24, v45
 v_mfma_f32_16x16x32_bf16 v[20:23], a[176:179], a[80:83], v[20:23]
 ds_read_b128 a[172:175], v47 offset:58368
 v_fma_f32 v17, v17, s24, v45
 v_smfmac_f32_16x16x64_bf16 a[228:231], a[236:239], v[32:39], v55
 v_fma_f32 v18, v18, s24, v45
 v_mfma_f32_16x16x32_bf16 v[160:163], a[192:195], v[36:39], v[160:163]
 ds_read_b128 a[188:191], v47 offset:62464
 v_fma_f32 v19, v19, s24, v45
 v_mfma_f32_16x16x32_bf16 v[164:167], a[196:199], v[36:39], v[164:167]
 v_exp_f32 v14, v14
 v_mfma_f32_16x16x32_bf16 v[168:171], a[200:203], v[36:39], v[168:171]
 ds_read_b128 a[184:187], v46 offset:62464
 v_fma_f32 v20, v20, s24, v45
 v_mfma_f32_16x16x32_bf16 v[172:175], a[204:207], v[36:39], v[172:175]
 v_exp_f32 v15, v15
 v_mfma_f32_16x16x32_bf16 v[176:179], a[208:211], v[36:39], v[176:179]
 ds_read_b128 a[180:183], v47 offset:61440
 v_cvt_pk_bf16_f32 v27, v14, v15
 v_mfma_f32_16x16x32_bf16 v[180:183], a[212:215], v[36:39], v[180:183]
 v_exp_f32 v16, v16
 v_mfma_f32_16x16x32_bf16 v[184:187], a[216:219], v[36:39], v[184:187]
 s_waitcnt lgkmcnt(2)
 buffer_load_dwordx4 v54, s[16:19], s29 offen offset:2048 nt lds
 v_mfma_f32_16x16x32_bf16 v[188:191], a[220:223], v[36:39], v[188:191]
 s_add_u32 m0, s26, 8192
 ds_read_b128 a[176:179], v46 offset:61440
 v_fma_f32 v21, v21, s24, v45
 v_mfma_f32_16x16x32_bf16 v[0:3], a[160:163], a[0:3], v[56:59]
 s_addk_i32 s29, 8192
 v_exp_f32 v17, v17
 v_mfma_f32_16x16x32_bf16 v[0:3], a[164:167], a[4:7], v[0:3]
 v_cvt_pk_bf16_f32 v28, v16, v17
 v_fma_f32 v22, v22, s24, v45
 v_mfma_f32_16x16x32_bf16 v[0:3], a[168:171], a[8:11], v[0:3]
 v_exp_f32 v18, v18
 v_mfma_f32_16x16x32_bf16 v[0:3], a[172:175], a[12:15], v[0:3]
 v_exp_f32 v19, v19
 v_mfma_f32_16x16x32_bf16 v[4:7], a[188:191], a[12:15], v[56:59]
 s_waitcnt lgkmcnt(1)
 v_cvt_pk_bf16_f32 v29, v18, v19
 v_fma_f32 v23, v23, s24, v45
 v_mfma_f32_16x16x32_bf16 v[4:7], a[184:187], a[8:11], v[4:7]
 v_exp_f32 v20, v20
 v_mfma_f32_16x16x32_bf16 v[4:7], a[180:183], a[4:7], v[4:7]
 s_waitcnt lgkmcnt(0)
 v_exp_f32 v21, v21
 v_mfma_f32_16x16x32_bf16 v[4:7], a[176:179], a[0:3], v[4:7]
 v_cvt_pk_bf16_f32 v30, v20, v21
 v_accvgpr_read_b32 v56, a248
 v_mfma_f32_16x16x32_bf16 v[192:195], a[192:195], v[24:27], v[192:195]
 v_exp_f32 v22, v22
 v_mfma_f32_16x16x32_bf16 v[196:199], a[196:199], v[24:27], v[196:199]
 v_exp_f32 v23, v23
 v_mfma_f32_16x16x32_bf16 v[200:203], a[200:203], v[24:27], v[200:203]
 v_cvt_pk_bf16_f32 v31, v22, v23
 v_accvgpr_read_b32 v57, a249
 v_mfma_f32_16x16x32_bf16 v[204:207], a[204:207], v[24:27], v[204:207]
 buffer_load_dwordx4 v54, s[12:15], s29 offen offset:0 nt lds
 v_mfma_f32_16x16x32_bf16 v[208:211], a[208:211], v[24:27], v[208:211]
 v_exp_f32 v0, v0
 v_mfma_f32_16x16x32_bf16 v[212:215], a[212:215], v[24:27], v[212:215]
 v_exp_f32 v1, v1
 v_mfma_f32_16x16x32_bf16 v[216:219], a[216:219], v[24:27], v[216:219]
 v_cvt_pk_bf16_f32 v32, v0, v1
 v_accvgpr_read_b32 v59, a251
 v_mfma_f32_16x16x32_bf16 v[220:223], a[220:223], v[24:27], v[220:223]
 v_exp_f32 v2, v2
 v_mfma_f32_16x16x32_bf16 v[8:11], a[160:163], a[16:19], v[60:63]
 v_exp_f32 v3, v3
 v_mfma_f32_16x16x32_bf16 v[8:11], a[164:167], a[20:23], v[8:11]
 v_cvt_pk_bf16_f32 v33, v2, v3
 v_accvgpr_read_b32 v58, a250
 v_mfma_f32_16x16x32_bf16 v[8:11], a[168:171], a[24:27], v[8:11]
 v_exp_f32 v4, v4
 v_mfma_f32_16x16x32_bf16 v[8:11], a[172:175], a[28:31], v[8:11]
 v_exp_f32 v5, v5
 v_mfma_f32_16x16x32_bf16 v[12:15], a[188:191], a[28:31], v[60:63]
 v_exp_f32 v6, v6
 v_mfma_f32_16x16x32_bf16 v[12:15], a[184:187], a[24:27], v[12:15]
 v_exp_f32 v7, v7
 v_mfma_f32_16x16x32_bf16 v[12:15], a[180:183], a[20:23], v[12:15]
 v_cvt_pk_bf16_f32 v34, v4, v5
 v_cvt_pk_bf16_f32 v35, v6, v7
 v_mfma_f32_16x16x32_bf16 v[12:15], a[176:179], a[16:19], v[12:15]
 buffer_load_dwordx4 v54, s[12:15], s29 offen offset:2048 nt lds
 v_smfmac_f32_16x16x64_bf16 a[232:235], a[236:239], v[24:31], v55
 s_add_u32 m0, s26, 73728
 v_mfma_f32_16x16x32_bf16 v[224:227], a[192:195], v[28:31], v[224:227]
 ds_read_b64_tr_b16 a[192:193], v48 offset:57344
 ds_read_b64_tr_b16 a[194:195], v48 offset:61440
 v_mfma_f32_16x16x32_bf16 v[228:231], a[196:199], v[28:31], v[228:231]
 v_exp_f32 v8, v8
 v_mfma_f32_16x16x32_bf16 v[232:235], a[200:203], v[28:31], v[232:235]
 buffer_load_dwordx4 v54, s[16:19], s29 offen offset:0 nt lds
 v_mfma_f32_16x16x32_bf16 v[236:239], a[204:207], v[28:31], v[236:239]
 ds_read_b64_tr_b16 a[196:197], v49 offset:57344
 ds_read_b64_tr_b16 a[198:199], v49 offset:61440
 v_mfma_f32_16x16x32_bf16 v[240:243], a[208:211], v[28:31], v[240:243]
 v_exp_f32 v9, v9
 v_mfma_f32_16x16x32_bf16 v[244:247], a[212:215], v[28:31], v[244:247]
 ds_read_b64_tr_b16 a[200:201], v50 offset:57344
 ds_read_b64_tr_b16 a[202:203], v50 offset:61440
 v_mfma_f32_16x16x32_bf16 v[248:251], a[216:219], v[28:31], v[248:251]
 v_exp_f32 v10, v10
 v_mfma_f32_16x16x32_bf16 v[252:255], a[220:223], v[28:31], v[252:255]
 ds_read_b64_tr_b16 a[204:205], v51 offset:57344
 ds_read_b64_tr_b16 a[206:207], v51 offset:61440
 v_mfma_f32_16x16x32_bf16 v[16:19], a[160:163], a[32:35], 0
 v_exp_f32 v11, v11
 v_mfma_f32_16x16x32_bf16 v[16:19], a[164:167], a[36:39], v[16:19]
 ds_read_b64_tr_b16 a[208:209], v48 offset:58368
 ds_read_b64_tr_b16 a[210:211], v48 offset:62464
 v_mfma_f32_16x16x32_bf16 v[16:19], a[168:171], a[40:43], v[16:19]
 buffer_load_dwordx4 v54, s[16:19], s29 offen offset:2048 nt lds
 v_mfma_f32_16x16x32_bf16 v[16:19], a[172:175], a[44:47], v[16:19]
 s_add_u32 m0, s26, 16384
 ds_read_b128 a[0:3], v52 offset:0
 v_cvt_pk_bf16_f32 v36, v8, v9
 v_mfma_f32_16x16x32_bf16 v[20:23], a[188:191], a[44:47], 0
 s_addk_i32 s29, 8192
 ds_read_b128 a[4:7], v53 offset:0
 ds_read_b64_tr_b16 a[212:213], v49 offset:58368
 ds_read_b64_tr_b16 a[214:215], v49 offset:62464
 v_mfma_f32_16x16x32_bf16 v[20:23], a[184:187], a[40:43], v[20:23]
 ds_read_b128 a[8:11], v52 offset:1024
 ds_read_b64_tr_b16 a[216:217], v50 offset:58368
 ds_read_b64_tr_b16 a[218:219], v50 offset:62464
 v_mfma_f32_16x16x32_bf16 v[20:23], a[180:183], a[36:39], v[20:23]
 ds_read_b128 a[12:15], v53 offset:1024
 ds_read_b64_tr_b16 a[220:221], v51 offset:58368
 ds_read_b64_tr_b16 a[222:223], v51 offset:62464
 v_mfma_f32_16x16x32_bf16 v[20:23], a[176:179], a[32:35], v[20:23]
 s_waitcnt lgkmcnt(12)
 v_cvt_pk_bf16_f32 v37, v10, v11
 v_fma_f32 v16, v16, s24, v42
 v_mfma_f32_16x16x32_bf16 v[64:67], a[192:195], v[32:35], v[64:67]
 v_exp_f32 v12, v12
 v_mfma_f32_16x16x32_bf16 v[68:71], a[196:199], v[32:35], v[68:71]
 v_exp_f32 v13, v13
 v_mfma_f32_16x16x32_bf16 v[72:75], a[200:203], v[32:35], v[72:75]
 v_cvt_pk_bf16_f32 v38, v12, v13
 v_fma_f32 v17, v17, s24, v42
 v_mfma_f32_16x16x32_bf16 v[76:79], a[204:207], v[32:35], v[76:79]
 s_waitcnt vmcnt(12) lgkmcnt(6)
 ds_read_b128 a[16:19], v52 offset:4096
 v_fma_f32 v18, v18, s24, v42
 v_mfma_f32_16x16x32_bf16 v[80:83], a[208:211], v[32:35], v[80:83]
 ds_read_b128 a[20:23], v53 offset:4096
 v_fma_f32 v19, v19, s24, v42
 v_mfma_f32_16x16x32_bf16 v[84:87], a[212:215], v[32:35], v[84:87]
 s_waitcnt lgkmcnt(2)
 ds_read_b128 a[24:27], v52 offset:5120
 v_fma_f32 v20, v20, s24, v42
 v_mfma_f32_16x16x32_bf16 v[88:91], a[216:219], v[32:35], v[88:91]
 ds_read_b128 a[28:31], v53 offset:5120
 v_fma_f32 v21, v21, s24, v42
 v_mfma_f32_16x16x32_bf16 v[92:95], a[220:223], v[32:35], v[92:95]
 v_exp_f32 v14, v14
 v_mfma_f32_16x16x32_bf16 v[0:3], a[160:163], a[48:51], 0
 v_exp_f32 v15, v15
 v_mfma_f32_16x16x32_bf16 v[0:3], a[164:167], a[52:55], v[0:3]
 v_cvt_pk_bf16_f32 v39, v14, v15
 v_fma_f32 v22, v22, s24, v42
 v_mfma_f32_16x16x32_bf16 v[0:3], a[168:171], a[56:59], v[0:3]
 v_exp_f32 v16, v16
 v_mfma_f32_16x16x32_bf16 v[0:3], a[172:175], a[60:63], v[0:3]
 v_exp_f32 v17, v17
 v_mfma_f32_16x16x32_bf16 v[4:7], a[188:191], a[60:63], 0
 v_cvt_pk_bf16_f32 v24, v16, v17
 v_fma_f32 v23, v23, s24, v42
 v_mfma_f32_16x16x32_bf16 v[4:7], a[184:187], a[56:59], v[4:7]
 v_exp_f32 v18, v18
 v_mfma_f32_16x16x32_bf16 v[4:7], a[180:183], a[52:55], v[4:7]
 v_exp_f32 v19, v19
 v_mfma_f32_16x16x32_bf16 v[4:7], a[176:179], a[48:51], v[4:7]
 v_cvt_pk_bf16_f32 v25, v18, v19
 v_xor_b32 v52, 64, v56
 v_smfmac_f32_16x16x64_bf16 a[224:227], a[236:239], v[32:39], v55
 v_xor_b32 v53, 64, v57
 v_mfma_f32_16x16x32_bf16 v[96:99], a[192:195], v[36:39], v[96:99]
 v_exp_f32 v20, v20
 v_mfma_f32_16x16x32_bf16 v[100:103], a[196:199], v[36:39], v[100:103]
 v_exp_f32 v21, v21
 v_mfma_f32_16x16x32_bf16 v[104:107], a[200:203], v[36:39], v[104:107]
 buffer_load_dwordx4 v54, s[12:15], s29 offen offset:0 nt lds
 v_mfma_f32_16x16x32_bf16 v[108:111], a[204:207], v[36:39], v[108:111]
 v_cvt_pk_bf16_f32 v26, v20, v21
 v_fma_f32 v0, v0, s24, v43
 v_mfma_f32_16x16x32_bf16 v[112:115], a[208:211], v[36:39], v[112:115]
 v_exp_f32 v22, v22
 v_accvgpr_read_b32 v60, a224
 v_accvgpr_read_b32 v61, a225
 v_add_f32 v60, v60, v61
 v_cmp_ngt_f32_e64 s[40:41], s25, v60
 v_mfma_f32_16x16x32_bf16 v[116:119], a[212:215], v[36:39], v[116:119]
 v_rcp_f32 v60, v60
 v_mfma_f32_16x16x32_bf16 v[120:123], a[216:219], v[36:39], v[120:123]
 v_accvgpr_read_b32 v62, a226
 v_accvgpr_read_b32 v61, a227
 v_mfma_f32_16x16x32_bf16 v[124:127], a[220:223], v[36:39], v[124:127]
 v_add_f32 v62, v62, v61
 v_cmp_ngt_f32_e64 s[42:43], s25, v62
 v_rcp_f32 v62, v62
 v_fma_f32 v1, v1, s24, v43
 v_pk_mul_f32 v[64:65], v[64:65], v[60:61] op_sel_hi:[1,0]
 v_cvt_pk_bf16_f32 v64, v64, v65
 v_pk_mul_f32 v[66:67], v[66:67], v[60:61] op_sel_hi:[1,0]
 v_cvt_pk_bf16_f32 v65, v66, v67
 v_pk_mul_f32 v[68:69], v[68:69], v[60:61] op_sel_hi:[1,0]
 v_pk_mul_f32 v[70:71], v[70:71], v[60:61] op_sel_hi:[1,0]
 v_pk_mul_f32 v[72:73], v[72:73], v[60:61] op_sel_hi:[1,0]
 v_pk_mul_f32 v[74:75], v[74:75], v[60:61] op_sel_hi:[1,0]
L_stub7:
 s_cbranch_vccnz L_stub11
.if ((L_stub7-L_main)>>6) != 448
.error "stub misplaced"
.endif
 v_pk_mul_f32 v[76:77], v[76:77], v[60:61] op_sel_hi:[1,0]
 v_pk_mul_f32 v[78:79], v[78:79], v[60:61] op_sel_hi:[1,0]
 v_pk_mul_f32 v[80:81], v[80:81], v[60:61] op_sel_hi:[1,0]
 v_pk_mul_f32 v[82:83], v[82:83], v[60:61] op_sel_hi:[1,0]
 v_pk_mul_f32 v[84:85], v[84:85], v[60:61] op_sel_hi:[1,0]
 v_pk_mul_f32 v[86:87], v[86:87], v[60:61] op_sel_hi:[1,0]
 v_pk_mul_f32 v[88:89], v[88:89], v[60:61] op_sel_hi:[1,0]
 v_pk_mul_f32 v[90:91], v[90:91], v[60:61] op_sel_hi:[1,0]
 v_pk_mul_f32 v[92:93], v[92:93], v[60:61] op_sel_hi:[1,0]
 v_pk_mul_f32 v[94:95], v[94:95], v[60:61] op_sel_hi:[1,0]
 v_mfma_f32_16x16x32_bf16 v[8:11], a[160:163], a[64:67], 0
 v_cvt_pk_bf16_f32 v80, v80, v81
 v_cvt_pk_bf16_f32 v81, v82, v83
 v_mfma_f32_16x16x32_bf16 v[8:11], a[164:167], a[68:71], v[8:11]
 ds_write2st64_b64 v56, v[64:65], v[80:81] offset0:0 offset1:2
 v_mfma_f32_16x16x32_bf16 v[8:11], a[168:171], a[72:75], v[8:11]
 v_cvt_pk_bf16_f32 v68, v68, v69
 v_cvt_pk_bf16_f32 v69, v70, v71
 v_cvt_pk_bf16_f32 v84, v84, v85
 v_cvt_pk_bf16_f32 v85, v86, v87
 v_cvt_pk_bf16_f32 v72, v72, v73
 v_pk_mul_f32 v[96:97], v[96:97], v[62:63] op_sel_hi:[1,0]
 v_cvt_pk_bf16_f32 v96, v96, v97
 v_pk_mul_f32 v[98:99], v[98:99], v[62:63] op_sel_hi:[1,0]
 v_cvt_pk_bf16_f32 v97, v98, v99
 v_pk_mul_f32 v[100:101], v[100:101], v[62:63] op_sel_hi:[1,0]
 v_pk_mul_f32 v[102:103], v[102:103], v[62:63] op_sel_hi:[1,0]
 v_pk_mul_f32 v[104:105], v[104:105], v[62:63] op_sel_hi:[1,0]
 v_pk_mul_f32 v[106:107], v[106:107], v[62:63] op_sel_hi:[1,0]
 v_pk_mul_f32 v[108:109], v[108:109], v[62:63] op_sel_hi:[1,0]
 v_pk_mul_f32 v[110:111], v[110:111], v[62:63] op_sel_hi:[1,0]
 v_pk_mul_f32 v[112:113], v[112:113], v[62:63] op_sel_hi:[1,0]
 v_pk_mul_f32 v[114:115], v[114:115], v[62:63] op_sel_hi:[1,0]
 v_pk_mul_f32 v[116:117], v[116:117], v[62:63] op_sel_hi:[1,0]
 v_pk_mul_f32 v[118:119], v[118:119], v[62:63] op_sel_hi:[1,0]
 v_pk_mul_f32 v[120:121], v[120:121], v[62:63] op_sel_hi:[1,0]
 v_pk_mul_f32 v[122:123], v[122:123], v[62:63] op_sel_hi:[1,0]
 v_pk_mul_f32 v[124:125], v[124:125], v[62:63] op_sel_hi:[1,0]
 v_pk_mul_f32 v[126:127], v[126:127], v[62:63] op_sel_hi:[1,0]
 v_mfma_f32_16x16x32_bf16 v[8:11], a[172:175], a[76:79], v[8:11]
 v_cvt_pk_bf16_f32 v112, v112, v113
 v_cvt_pk_bf16_f32 v113, v114, v115
 v_mfma_f32_16x16x32_bf16 v[12:15], a[188:191], a[76:79], 0
 ds_write2st64_b64 v57, v[68:69], v[84:85] offset0:0 offset1:2
 v_mfma_f32_16x16x32_bf16 v[12:15], a[184:187], a[72:75], v[12:15]
 v_exp_f32 v23, v23
 v_cvt_pk_bf16_f32 v73, v74, v75
 v_cvt_pk_bf16_f32 v100, v100, v101
 v_cvt_pk_bf16_f32 v101, v102, v103
 v_mfma_f32_16x16x32_bf16 v[12:15], a[180:183], a[68:71], v[12:15]
 ds_write2st64_b64 v56, v[96:97], v[112:113] offset0:8 offset1:10
 v_cvt_pk_bf16_f32 v27, v22, v23
 v_cvt_pk_bf16_f32 v88, v88, v89
 v_cvt_pk_bf16_f32 v89, v90, v91
 v_cvt_pk_bf16_f32 v116, v116, v117
 v_cvt_pk_bf16_f32 v117, v118, v119
 v_mfma_f32_16x16x32_bf16 v[12:15], a[176:179], a[64:67], v[12:15]
 v_cvt_pk_bf16_f32 v76, v76, v77
 v_cvt_pk_bf16_f32 v77, v78, v79
 v_mfma_f32_16x16x32_bf16 v[128:131], a[192:195], v[24:27], v[128:131]
 buffer_load_dwordx4 v54, s[12:15], s29 offen offset:2048 nt lds
 v_cvt_pk_bf16_f32 v104, v104, v105
 v_cvt_pk_bf16_f32 v105, v106, v107
 v_mfma_f32_16x16x32_bf16 v[132:135], a[196:199], v[24:27], v[132:135]
 s_add_u32 m0, s26, 81920
 ds_write2st64_b64 v52, v[72:73], v[88:89] offset0:0 offset1:2
 v_cvt_pk_bf16_f32 v92, v92, v93
 v_cvt_pk_bf16_f32 v93, v94, v95
 v_cvt_pk_bf16_f32 v120, v120, v121
 v_cvt_pk_bf16_f32 v121, v122, v123
 v_mfma_f32_16x16x32_bf16 v[136:139], a[200:203], v[24:27], v[136:139]
 v_cvt_pk_bf16_f32 v108, v108, v109
 v_cvt_pk_bf16_f32 v109, v110, v111
 v_mfma_f32_16x16x32_bf16 v[140:143], a[204:207], v[24:27], v[140:143]
 ds_write2st64_b64 v57, v[100:101], v[116:117] offset0:8 offset1:10
 v_exp_f32 v0, v0
 v_mfma_f32_16x16x32_bf16 v[144:147], a[208:211], v[24:27], v[144:147]
 v_cvt_pk_bf16_f32 v124, v124, v125
 v_cvt_pk_bf16_f32 v125, v126, v127
 v_exp_f32 v1, v1
 v_mfma_f32_16x16x32_bf16 v[148:151], a[212:215], v[24:27], v[148:151]
 ds_write2st64_b64 v53, v[76:77], v[92:93] offset0:0 offset1:2
 v_cvt_pk_bf16_f32 v28, v0, v1
 v_fma_f32 v2, v2, s24, v43
 v_mfma_f32_16x16x32_bf16 v[152:155], a[216:219], v[24:27], v[152:155]
 s_waitcnt vmcnt(10)
 v_fma_f32 v3, v3, s24, v43
 v_exp_f32 v2, v2
 v_mfma_f32_16x16x32_bf16 v[156:159], a[220:223], v[24:27], v[156:159]
 s_barrier
 ds_write2st64_b64 v52, v[104:105], v[120:121] offset0:8 offset1:10
 v_exp_f32 v3, v3
 v_mfma_f32_16x16x32_bf16 v[16:19], a[160:163], a[80:83], 0
 ds_read_b128 a[32:35], v59 offset:0
 v_cvt_pk_bf16_f32 v29, v2, v3
 v_fma_f32 v4, v4, s24, v43
 v_mfma_f32_16x16x32_bf16 v[16:19], a[164:167], a[84:87], v[16:19]
 ds_write2st64_b64 v53, v[108:109], v[124:125] offset0:8 offset1:10
 v_fma_f32 v5, v5, s24, v43
 v_exp_f32 v4, v4
 v_mfma_f32_16x16x32_bf16 v[16:19], a[168:171], a[88:91], v[16:19]
 ds_read_b64 a[40:41], v59 offset:2056
 v_exp_f32 v5, v5
 v_mfma_f32_16x16x32_bf16 v[16:19], a[172:175], a[92:95], v[16:19]
 ds_read_b64 a[42:43], v59 offset:2048
 v_cvt_pk_bf16_f32 v30, v4, v5
 v_fma_f32 v6, v6, s24, v43
 v_mfma_f32_16x16x32_bf16 v[20:23], a[188:191], a[92:95], 0
 ds_read_b128 a[36:39], v59 offset:1024
 v_fma_f32 v7, v7, s24, v43
 v_exp_f32 v6, v6
 v_mfma_f32_16x16x32_bf16 v[20:23], a[184:187], a[88:91], v[20:23]
 ds_read_b64 a[44:45], v59 offset:3080
 v_exp_f32 v7, v7
 v_mfma_f32_16x16x32_bf16 v[20:23], a[180:183], a[84:87], v[20:23]
 ds_read_b64 a[46:47], v59 offset:3072
 v_cvt_pk_bf16_f32 v31, v6, v7
 v_mfma_f32_16x16x32_bf16 v[20:23], a[176:179], a[80:83], v[20:23]
 buffer_load_dwordx4 v54, s[16:19], s29 offen offset:0 nt lds
 v_smfmac_f32_16x16x64_bf16 a[228:231], a[236:239], v[24:31], v55
 ds_read_b128 a[48:51], v59 offset:4096
 ds_read_b128 a[160:163], v46 offset:32768
 v_mfma_f32_16x16x32_bf16 v[160:163], a[192:195], v[28:31], v[160:163]
 ds_read_b64 a[56:57], v59 offset:6152
 ds_read_b128 a[164:167], v47 offset:32768
 v_mfma_f32_16x16x32_bf16 v[164:167], a[196:199], v[28:31], v[164:167]
 ds_read_b64 a[58:59], v59 offset:6144
 ds_read_b128 a[168:171], v46 offset:33792
 v_mfma_f32_16x16x32_bf16 v[168:171], a[200:203], v[28:31], v[168:171]
 ds_read_b128 a[52:55], v59 offset:5120
 ds_read_b128 a[172:175], v47 offset:33792
 v_fma_f32 v8, v8, s24, v44
 v_mfma_f32_16x16x32_bf16 v[172:175], a[204:207], v[28:31], v[172:175]
 ds_read_b64 a[60:61], v59 offset:7176
 ds_read_b128 a[188:191], v47 offset:37888
 v_fma_f32 v9, v9, s24, v44
 v_exp_f32 v8, v8
 v_accvgpr_read_b32 v60, a228
 v_accvgpr_read_b32 v61, a229
 v_mfma_f32_16x16x32_bf16 v[176:179], a[208:211], v[28:31], v[176:179]
 ds_read_b64 a[62:63], v59 offset:7168
 ds_read_b128 a[184:187], v46 offset:37888
 v_exp_f32 v9, v9
 v_add_f32 v60, v60, v61
 v_cmp_ngt_f32_e64 s[44:45], s25, v60
 v_mfma_f32_16x16x32_bf16 v[180:183], a[212:215], v[28:31], v[180:183]
 ds_read_b128 a[180:183], v47 offset:36864
 v_cvt_pk_bf16_f32 v32, v8, v9
 v_fma_f32 v10, v10, s24, v44
 v_rcp_f32 v60, v60
 v_mfma_f32_16x16x32_bf16 v[184:187], a[216:219], v[28:31], v[184:187]
 ds_read_b128 a[176:179], v46 offset:36864
 v_fma_f32 v11, v11, s24, v44
 v_exp_f32 v10, v10
 v_accvgpr_read_b32 v62, a230
 v_accvgpr_read_b32 v61, a231
 v_mfma_f32_16x16x32_bf16 v[188:191], a[220:223], v[28:31], v[188:191]
 s_waitcnt lgkmcnt(10)
 v_exp_f32 v11, v11
 v_add_f32 v62, v62, v61
 v_cmp_ngt_f32_e64 s[46:47], s25, v62
 v_cvt_pk_bf16_f32 v33, v10, v11
 v_pk_mul_f32 v[128:129], v[128:129], v[60:61] op_sel_hi:[1,0]
 v_cvt_pk_bf16_f32 v128, v128, v129
 v_pk_mul_f32 v[130:131], v[130:131], v[60:61] op_sel_hi:[1,0]
 v_cvt_pk_bf16_f32 v129, v130, v131
 v_pk_mul_f32 v[132:133], v[132:133], v[60:61] op_sel_hi:[1,0]
 v_pk_mul_f32 v[134:135], v[134:135], v[60:61] op_sel_hi:[1,0]
 v_pk_mul_f32 v[136:137], v[136:137], v[60:61] op_sel_hi:[1,0]
 v_pk_mul_f32 v[138:139], v[138:139], v[60:61] op_sel_hi:[1,0]
 v_pk_mul_f32 v[140:141], v[140:141], v[60:61] op_sel_hi:[1,0]
 v_pk_mul_f32 v[142:143], v[142:143], v[60:61] op_sel_hi:[1,0]
 v_pk_mul_f32 v[144:145], v[144:145], v[60:61] op_sel_hi:[1,0]
 v_pk_mul_f32 v[146:147], v[146:147], v[60:61] op_sel_hi:[1,0]
 v_pk_mul_f32 v[148:149], v[148:149], v[60:61] op_sel_hi:[1,0]
 v_pk_mul_f32 v[150:151], v[150:151], v[60:61] op_sel_hi:[1,0]
 v_pk_mul_f32 v[152:153], v[152:153], v[60:61] op_sel_hi:[1,0]
 v_pk_mul_f32 v[154:155], v[154:155], v[60:61] op_sel_hi:[1,0]
 v_pk_mul_f32 v[156:157], v[156:157], v[60:61] op_sel_hi:[1,0]
 v_pk_mul_f32 v[158:159], v[158:159], v[60:61] op_sel_hi:[1,0]
 v_mfma_f32_16x16x32_bf16 v[0:3], a[160:163], a[96:99], 0
 s_waitcnt lgkmcnt(6)
 buffer_load_dwordx4 v54, s[16:19], s29 offen offset:2048 nt lds
 v_fma_f32 v12, v12, s24, v44
 v_cvt_pk_bf16_f32 v144, v144, v145
 v_cvt_pk_bf16_f32 v145, v146, v147
 v_rcp_f32 v62, v62
 v_mfma_f32_16x16x32_bf16 v[0:3], a[164:167], a[100:103], v[0:3]
 s_add_u32 m0, s26, 24576
 ds_write2st64_b64 v56, v[128:129], v[144:145] offset0:0 offset1:2
 v_fma_f32 v13, v13, s24, v44
 v_exp_f32 v12, v12
 v_mfma_f32_16x16x32_bf16 v[0:3], a[168:171], a[104:107], v[0:3]
 s_addk_i32 s29, 8192
 v_exp_f32_e64 v13, v13
 v_cvt_pk_bf16_f32 v132, v132, v133
 v_cvt_pk_bf16_f32 v133, v134, v135
 v_cvt_pk_bf16_f32 v34, v12, v13
 v_pk_mul_f32 v[160:161], v[160:161], v[62:63] op_sel_hi:[1,0]
 v_cvt_pk_bf16_f32 v160, v160, v161
 v_pk_mul_f32 v[162:163], v[162:163], v[62:63] op_sel_hi:[1,0]
 v_cvt_pk_bf16_f32 v161, v162, v163
 v_pk_mul_f32 v[164:165], v[164:165], v[62:63] op_sel_hi:[1,0]
 v_pk_mul_f32 v[166:167], v[166:167], v[62:63] op_sel_hi:[1,0]
 v_pk_mul_f32 v[168:169], v[168:169], v[62:63] op_sel_hi:[1,0]
 v_pk_mul_f32 v[170:171], v[170:171], v[62:63] op_sel_hi:[1,0]
 v_pk_mul_f32 v[172:173], v[172:173], v[62:63] op_sel_hi:[1,0]
 v_pk_mul_f32 v[174:175], v[174:175], v[62:63] op_sel_hi:[1,0]
 v_pk_mul_f32 v[176:177], v[176:177], v[62:63] op_sel_hi:[1,0]
 v_pk_mul_f32 v[178:179], v[178:179], v[62:63] op_sel_hi:[1,0]
 v_pk_mul_f32 v[180:181], v[180:181], v[62:63] op_sel_hi:[1,0]
 v_pk_mul_f32 v[182:183], v[182:183], v[62:63] op_sel_hi:[1,0]
 v_pk_mul_f32 v[184:185], v[184:185], v[62:63] op_sel_hi:[1,0]
 v_pk_mul_f32 v[186:187], v[186:187], v[62:63] op_sel_hi:[1,0]
 v_pk_mul_f32 v[188:189], v[188:189], v[62:63] op_sel_hi:[1,0]
 v_pk_mul_f32 v[190:191], v[190:191], v[62:63] op_sel_hi:[1,0]
 v_mfma_f32_16x16x32_bf16 v[0:3], a[172:175], a[108:111], v[0:3]
 s_waitcnt lgkmcnt(3)
 v_fma_f32 v14, v14, s24, v44
 v_cvt_pk_bf16_f32 v148, v148, v149
 v_cvt_pk_bf16_f32 v149, v150, v151
 v_cvt_pk_bf16_f32 v176, v176, v177
 v_cvt_pk_bf16_f32 v177, v178, v179
 v_mfma_f32_16x16x32_bf16 v[4:7], a[188:191], a[108:111], 0
 ds_write2st64_b64 v57, v[132:133], v[148:149] offset0:0 offset1:2
 v_fma_f32 v15, v15, s24, v44
 v_exp_f32 v14, v14
 v_mfma_f32_16x16x32_bf16 v[4:7], a[184:187], a[104:107], v[4:7]
 s_waitcnt lgkmcnt(2)
 v_exp_f32 v15, v15
 v_cvt_pk_bf16_f32 v136, v136, v137
 v_cvt_pk_bf16_f32 v137, v138, v139
 v_cvt_pk_bf16_f32 v164, v164, v165
 v_cvt_pk_bf16_f32 v165, v166, v167
 v_mfma_f32_16x16x32_bf16 v[4:7], a[180:183], a[100:103], v[4:7]
 ds_write2st64_b64 v56, v[160:161], v[176:177] offset0:8 offset1:10
 v_cvt_pk_bf16_f32 v35, v14, v15
 v_cvt_pk_bf16_f32 v152, v152, v153
 v_cvt_pk_bf16_f32 v153, v154, v155
 v_cvt_pk_bf16_f32 v180, v180, v181
 v_cvt_pk_bf16_f32 v181, v182, v183
 v_mfma_f32_16x16x32_bf16 v[4:7], a[176:179], a[96:99], v[4:7]
 v_cvt_pk_bf16_f32 v140, v140, v141
 v_cvt_pk_bf16_f32 v141, v142, v143
 v_mfma_f32_16x16x32_bf16 v[192:195], a[192:195], v[32:35], v[192:195]
 ds_write2st64_b64 v52, v[136:137], v[152:153] offset0:0 offset1:2
 v_cvt_pk_bf16_f32 v168, v168, v169
 v_cvt_pk_bf16_f32 v169, v170, v171
 v_mfma_f32_16x16x32_bf16 v[196:199], a[196:199], v[32:35], v[196:199]
 v_cvt_pk_bf16_f32 v156, v156, v157
 v_cvt_pk_bf16_f32 v157, v158, v159
 v_cvt_pk_bf16_f32 v184, v184, v185
 v_cvt_pk_bf16_f32 v185, v186, v187
 v_mfma_f32_16x16x32_bf16 v[200:203], a[200:203], v[32:35], v[200:203]
 ds_write2st64_b64 v57, v[164:165], v[180:181] offset0:8 offset1:10
 v_fma_f32 v16, v16, s24, v45
 v_mfma_f32_16x16x32_bf16 v[204:207], a[204:207], v[32:35], v[204:207]
 v_cvt_pk_bf16_f32 v172, v172, v173
 v_cvt_pk_bf16_f32 v173, v174, v175
 v_fma_f32 v17, v17, s24, v45
 v_exp_f32 v16, v16
 v_mfma_f32_16x16x32_bf16 v[208:211], a[208:211], v[32:35], v[208:211]
 ds_write2st64_b64 v53, v[140:141], v[156:157] offset0:0 offset1:2
 v_cvt_pk_bf16_f32 v188, v188, v189
 v_cvt_pk_bf16_f32 v189, v190, v191
 v_exp_f32 v17, v17
 v_mfma_f32_16x16x32_bf16 v[212:215], a[212:215], v[32:35], v[212:215]
 v_cvt_pk_bf16_f32 v36, v16, v17
 v_fma_f32 v18, v18, s24, v45
 v_mfma_f32_16x16x32_bf16 v[216:219], a[216:219], v[32:35], v[216:219]
 ds_write2st64_b64 v52, v[168:169], v[184:185] offset0:8 offset1:10
 v_fma_f32 v19, v19, s24, v45
 v_exp_f32 v18, v18
 v_mfma_f32_16x16x32_bf16 v[220:223], a[220:223], v[32:35], v[220:223]
 buffer_load_dwordx4 v54, s[12:15], s29 offen offset:0 nt lds
 v_exp_f32 v19, v19
 v_mfma_f32_16x16x32_bf16 v[8:11], a[160:163], a[112:115], 0
 ds_write2st64_b64 v53, v[172:173], v[188:189] offset0:8 offset1:10
 v_cvt_pk_bf16_f32 v37, v18, v19
 v_fma_f32 v20, v20, s24, v45
 v_mfma_f32_16x16x32_bf16 v[8:11], a[164:167], a[116:119], v[8:11]
 ds_read_b128 a[64:67], v59 offset:0
 v_fma_f32 v21, v21, s24, v45
 v_exp_f32 v20, v20
 v_mfma_f32_16x16x32_bf16 v[8:11], a[168:171], a[120:123], v[8:11]
 ds_read_b64 a[72:73], v59 offset:2056
 v_exp_f32 v21, v21
 v_max3_f32 v63, v0, v1, v2
 v_mfma_f32_16x16x32_bf16 v[8:11], a[172:175], a[124:127], v[8:11]
 ds_read_b64 a[74:75], v59 offset:2048
 v_cvt_pk_bf16_f32 v38, v20, v21
 v_fma_f32 v22, v22, s24, v45
 v_max_f32 v63, v63, v3
 v_mfma_f32_16x16x32_bf16 v[12:15], a[188:191], a[124:127], 0
 ds_read_b128 a[68:71], v59 offset:1024
 ds_bpermute_b32 v63, v40, v63
 v_fma_f32 v23, v23, s24, v45
 v_exp_f32 v22, v22
 v_mfma_f32_16x16x32_bf16 v[12:15], a[184:187], a[120:123], v[12:15]
 ds_read_b64 a[76:77], v59 offset:3080
 v_exp_f32 v23, v23
 v_mfma_f32_16x16x32_bf16 v[12:15], a[180:183], a[116:119], v[12:15]
 ds_read_b64 a[78:79], v59 offset:3072
 v_cvt_pk_bf16_f32 v39, v22, v23
 v_mfma_f32_16x16x32_bf16 v[12:15], a[176:179], a[112:115], v[12:15]
 ds_read_b128 a[80:83], v59 offset:4096
 v_max3_f32 v41, v8, v9, v10
 v_smfmac_f32_16x16x64_bf16 a[232:235], a[236:239], v[32:39], v55
 ds_read_b64 a[88:89], v59 offset:6152
 v_mfma_f32_16x16x32_bf16 v[224:227], a[192:195], v[36:39], v[224:227]
 s_waitcnt lgkmcnt(4)
 ds_read_b64 a[90:91], v59 offset:6144
 v_mul_f32 v63, 0xbe0293ee, v63
 v_mfma_f32_16x16x32_bf16 v[228:231], a[196:199], v[36:39], v[228:231]
 ds_read_b128 a[84:87], v59 offset:5120
 v_fma_f32 v0, v0, s24, v63
 v_mfma_f32_16x16x32_bf16 v[232:235], a[200:203], v[36:39], v[232:235]
 ds_read_b64 a[92:93], v59 offset:7176
 v_fma_f32 v1, v1, s24, v63
 v_mfma_f32_16x16x32_bf16 v[236:239], a[204:207], v[36:39], v[236:239]
 ds_read_b64 a[94:95], v59 offset:7168
 v_exp_f32 v0, v0
 v_accvgpr_read_b32 v60, a232
 v_accvgpr_read_b32 v61, a233
 v_mfma_f32_16x16x32_bf16 v[240:243], a[208:211], v[36:39], v[240:243]
 buffer_load_dwordx4 v54, s[12:15], s29 offen offset:2048 nt lds
 v_exp_f32 v1, v1
 v_add_f32 v60, v60, v61
 v_cmp_ngt_f32_e64 s[48:49], s25, v60
 v_mfma_f32_16x16x32_bf16 v[244:247], a[212:215], v[36:39], v[244:247]
 s_add_u32 m0, s26, 90112
 v_cvt_pk_bf16_f32 v24, v0, v1
 v_fma_f32 v2, v2, s24, v63
 v_rcp_f32 v60, v60
 v_mfma_f32_16x16x32_bf16 v[248:251], a[216:219], v[36:39], v[248:251]
 v_fma_f32 v3, v3, s24, v63
 v_exp_f32 v2, v2
 v_accvgpr_read_b32 v62, a234
 v_accvgpr_read_b32 v61, a235
 v_mfma_f32_16x16x32_bf16 v[252:255], a[220:223], v[36:39], v[252:255]
 ds_read_b64_tr_b16 a[192:193], v48 offset:32768
 ds_read_b64_tr_b16 a[194:195], v48 offset:36864
 v_exp_f32 v3, v3
 v_add_f32_e64 v62, v62, v61
 v_cmp_ngt_f32_e64 s[50:51], s25, v62
 v_pk_mul_f32 v[192:193], v[192:193], v[60:61] op_sel_hi:[1,0]
 v_cvt_pk_bf16_f32 v192, v192, v193
 v_pk_mul_f32 v[194:195], v[194:195], v[60:61] op_sel_hi:[1,0]
 v_cvt_pk_bf16_f32 v193, v194, v195
 v_pk_mul_f32 v[196:197], v[196:197], v[60:61] op_sel_hi:[1,0]
 v_pk_mul_f32 v[198:199], v[198:199], v[60:61] op_sel_hi:[1,0]
 v_pk_mul_f32 v[200:201], v[200:201], v[60:61] op_sel_hi:[1,0]
 v_pk_mul_f32 v[202:203], v[202:203], v[60:61] op_sel_hi:[1,0]
 v_pk_mul_f32 v[204:205], v[204:205], v[60:61] op_sel_hi:[1,0]
 v_pk_mul_f32 v[206:207], v[206:207], v[60:61] op_sel_hi:[1,0]
 v_pk_mul_f32 v[208:209], v[208:209], v[60:61] op_sel_hi:[1,0]
 v_pk_mul_f32 v[210:211], v[210:211], v[60:61] op_sel_hi:[1,0]
 v_pk_mul_f32 v[212:213], v[212:213], v[60:61] op_sel_hi:[1,0]
 v_pk_mul_f32 v[214:215], v[214:215], v[60:61] op_sel_hi:[1,0]
 v_pk_mul_f32 v[216:217], v[216:217], v[60:61] op_sel_hi:[1,0]
 v_pk_mul_f32 v[218:219], v[218:219], v[60:61] op_sel_hi:[1,0]
 v_pk_mul_f32 v[220:221], v[220:221], v[60:61] op_sel_hi:[1,0]
 v_pk_mul_f32 v[222:223], v[222:223], v[60:61] op_sel_hi:[1,0]
 v_mfma_f32_16x16x32_bf16 v[16:19], a[160:163], a[128:131], 0
 ds_read_b64_tr_b16 a[196:197], v49 offset:32768
 ds_read_b64_tr_b16 a[198:199], v49 offset:36864
 v_cvt_pk_bf16_f32 v25, v2, v3
 v_fma_f32 v4, v4, s24, v63
 v_cvt_pk_bf16_f32 v208, v208, v209
 v_cvt_pk_bf16_f32 v209, v210, v211
 v_rcp_f32 v62, v62
 v_mfma_f32_16x16x32_bf16 v[16:19], a[164:167], a[132:135], v[16:19]
 ds_write2st64_b64 v56, v[192:193], v[208:209] offset0:0 offset1:2
 v_fma_f32 v5, v5, s24, v63
 v_exp_f32 v4, v4
 v_mfma_f32_16x16x32_bf16 v[16:19], a[168:171], a[136:139], v[16:19]
 ds_read_b64_tr_b16 a[200:201], v50 offset:32768
 ds_read_b64_tr_b16 a[202:203], v50 offset:36864
 ds_read_b64_tr_b16 a[204:205], v51 offset:32768
 ds_read_b64_tr_b16 a[206:207], v51 offset:36864
 v_exp_f32 v5, v5
 v_cvt_pk_bf16_f32 v196, v196, v197
 v_cvt_pk_bf16_f32 v197, v198, v199
 v_max_f32 v41, v41, v11
 v_pk_mul_f32 v[224:225], v[224:225], v[62:63] op_sel_hi:[1,0]
 v_cvt_pk_bf16_f32 v224, v224, v225
 v_pk_mul_f32 v[226:227], v[226:227], v[62:63] op_sel_hi:[1,0]
 v_cvt_pk_bf16_f32 v225, v226, v227
 v_pk_mul_f32 v[228:229], v[228:229], v[62:63] op_sel_hi:[1,0]
 v_pk_mul_f32 v[230:231], v[230:231], v[62:63] op_sel_hi:[1,0]
 v_pk_mul_f32 v[232:233], v[232:233], v[62:63] op_sel_hi:[1,0]
 v_pk_mul_f32 v[234:235], v[234:235], v[62:63] op_sel_hi:[1,0]
 v_pk_mul_f32 v[236:237], v[236:237], v[62:63] op_sel_hi:[1,0]
 v_pk_mul_f32 v[238:239], v[238:239], v[62:63] op_sel_hi:[1,0]
 v_pk_mul_f32 v[240:241], v[240:241], v[62:63] op_sel_hi:[1,0]
 v_pk_mul_f32 v[242:243], v[242:243], v[62:63] op_sel_hi:[1,0]
 v_pk_mul_f32 v[244:245], v[244:245], v[62:63] op_sel_hi:[1,0]
 v_pk_mul_f32 v[246:247], v[246:247], v[62:63] op_sel_hi:[1,0]
 v_pk_mul_f32 v[248:249], v[248:249], v[62:63] op_sel_hi:[1,0]
 v_pk_mul_f32 v[250:251], v[250:251], v[62:63] op_sel_hi:[1,0]
 v_pk_mul_f32 v[252:253], v[252:253], v[62:63] op_sel_hi:[1,0]
 v_pk_mul_f32 v[254:255], v[254:255], v[62:63] op_sel_hi:[1,0]
 v_mfma_f32_16x16x32_bf16 v[16:19], a[172:175], a[140:143], v[16:19]
 ds_bpermute_b32 v41, v40, v41
 ds_read_b64_tr_b16 a[208:209], v48 offset:33792
 ds_read_b64_tr_b16 a[210:211], v48 offset:37888
 v_cvt_pk_bf16_f32 v26, v4, v5
 v_fma_f32 v6, v6, s24, v63
 v_cvt_pk_bf16_f32 v212, v212, v213
 v_cvt_pk_bf16_f32 v213, v214, v215
 v_cvt_pk_bf16_f32 v240, v240, v241
 v_cvt_pk_bf16_f32 v241, v242, v243
 v_mfma_f32_16x16x32_bf16 v[20:23], a[188:191], a[140:143], 0
 ds_write2st64_b64 v57, v[196:197], v[212:213] offset0:0 offset1:2
 v_fma_f32 v7, v7, s24, v63
 v_exp_f32 v6, v6
 v_mfma_f32_16x16x32_bf16 v[20:23], a[184:187], a[136:139], v[20:23]
 ds_read_b64_tr_b16 a[212:213], v49 offset:33792
 ds_read_b64_tr_b16 a[214:215], v49 offset:37888
 ds_read_b64_tr_b16 a[216:217], v50 offset:33792
 v_exp_f32 v7, v7
 v_cvt_pk_bf16_f32 v200, v200, v201
 v_cvt_pk_bf16_f32 v201, v202, v203
 v_cvt_pk_bf16_f32 v228, v228, v229
 v_cvt_pk_bf16_f32 v229, v230, v231
 v_mfma_f32_16x16x32_bf16 v[20:23], a[180:183], a[132:135], v[20:23]
 buffer_load_dwordx4 v54, s[16:19], s29 offen offset:0 nt lds
 v_cvt_pk_bf16_f32 v27, v6, v7
 v_cvt_pk_bf16_f32 v216, v216, v217
 v_cvt_pk_bf16_f32 v217, v218, v219
 v_cvt_pk_bf16_f32 v244, v244, v245
 v_cvt_pk_bf16_f32 v245, v246, v247
 v_mfma_f32_16x16x32_bf16 v[20:23], a[176:179], a[128:131], v[20:23]
 s_waitcnt lgkmcnt(12)
 ds_write2st64_b64 v56, v[224:225], v[240:241] offset0:8 offset1:10
 v_mfma_f32_16x16x32_bf16 v[64:67], a[192:195], v[24:27], 0
 ds_read_b64_tr_b16 a[218:219], v50 offset:37888
 ds_read_b64_tr_b16 a[220:221], v51 offset:33792
 ds_read_b64_tr_b16 a[222:223], v51 offset:37888
 v_cvt_pk_bf16_f32 v204, v204, v205
 v_cvt_pk_bf16_f32 v205, v206, v207
 v_cvt_pk_bf16_f32 v232, v232, v233
 v_cvt_pk_bf16_f32 v233, v234, v235
 v_mfma_f32_16x16x32_bf16 v[68:71], a[196:199], v[24:27], 0
 s_waitcnt lgkmcnt(10)
 ds_write2st64_b64 v52, v[200:201], v[216:217] offset0:0 offset1:2
 v_cvt_pk_bf16_f32 v220, v220, v221
 v_cvt_pk_bf16_f32 v221, v222, v223
 v_cvt_pk_bf16_f32 v248, v248, v249
 v_cvt_pk_bf16_f32 v249, v250, v251
 v_mul_f32 v41, 0xbe0293ee, v41
 v_mfma_f32_16x16x32_bf16 v[72:75], a[200:203], v[24:27], 0
 v_fma_f32 v8, v8, s24, v41
 v_cvt_pk_bf16_f32 v236, v236, v237
 v_mfma_f32_16x16x32_bf16 v[76:79], a[204:207], v[24:27], 0
 s_waitcnt lgkmcnt(8)
 ds_write2st64_b64 v57, v[228:229], v[244:245] offset0:8 offset1:10
 v_cvt_pk_bf16_f32 v237, v238, v239
 v_fma_f32 v9, v9, s24, v41
 v_exp_f32 v8, v8
 v_mfma_f32_16x16x32_bf16 v[80:83], a[208:211], v[24:27], 0
 s_waitcnt lgkmcnt(6)
 v_cvt_pk_bf16_f32 v252, v252, v253
 v_cvt_pk_bf16_f32 v253, v254, v255
 v_exp_f32 v9, v9
 v_mfma_f32_16x16x32_bf16 v[84:87], a[212:215], v[24:27], 0
 s_waitcnt lgkmcnt(4)
 ds_write2st64_b64 v53, v[204:205], v[220:221] offset0:0 offset1:2
 v_cvt_pk_bf16_f32 v28, v8, v9
 v_fma_f32 v10, v10, s24, v41
 v_mfma_f32_16x16x32_bf16 v[88:91], a[216:219], v[24:27], 0
 s_waitcnt lgkmcnt(3)
 v_fma_f32 v11, v11, s24, v41
 v_exp_f32 v10, v10
 v_mfma_f32_16x16x32_bf16 v[92:95], a[220:223], v[24:27], 0
 ds_write2st64_b64 v52, v[232:233], v[248:249] offset0:8 offset1:10
 v_exp_f32 v11, v11
 v_mfma_f32_16x16x32_bf16 v[0:3], a[160:163], a[144:147], 0
 v_cvt_pk_bf16_f32 v29, v10, v11
 v_fma_f32 v12, v12, s24, v41
 v_mfma_f32_16x16x32_bf16 v[0:3], a[164:167], a[148:151], v[0:3]
 ds_write2st64_b64 v53, v[236:237], v[252:253] offset0:8 offset1:10
 v_fma_f32 v13, v13, s24, v41
 v_exp_f32 v12, v12
 v_mfma_f32_16x16x32_bf16 v[0:3], a[168:171], a[152:155], v[0:3]
 buffer_load_dwordx4 v54, s[16:19], s29 offen offset:2048 nt lds
 v_exp_f32 v13, v13
 v_max3_f32 v42, v16, v17, v18
 v_mfma_f32_16x16x32_bf16 v[0:3], a[172:175], a[156:159], v[0:3]
 s_add_u32 m0, s26, 40960
 v_cvt_pk_bf16_f32 v30, v12, v13
 v_fma_f32 v14, v14, s24, v41
 v_max_f32 v42, v42, v19
 v_mfma_f32_16x16x32_bf16 v[4:7], a[188:191], a[156:159], 0
 s_addk_i32 s29, 8192
 ds_bpermute_b32 v42, v40, v42
 v_fma_f32 v15, v15, s24, v41
 v_exp_f32 v14, v14
 v_mfma_f32_16x16x32_bf16 v[4:7], a[184:187], a[152:155], v[4:7]
 v_exp_f32 v15, v15
 v_accvgpr_write_b32 a224, 0
 v_accvgpr_write_b32 a225, 0
 v_accvgpr_write_b32 a226, 0
 v_accvgpr_write_b32 a227, 0
 v_mfma_f32_16x16x32_bf16 v[4:7], a[180:183], a[148:151], v[4:7]
 v_cvt_pk_bf16_f32 v31, v14, v15
 v_max3_f32 v43, v0, v1, v2
 v_mfma_f32_16x16x32_bf16 v[4:7], a[176:179], a[144:147], v[4:7]
 v_max_f32 v43, v43, v3
 v_accvgpr_write_b32 a228, 0
 v_smfmac_f32_16x16x64_bf16 a[224:227], a[236:239], v[24:31], v55
 ds_bpermute_b32 v43, v40, v43
 v_mfma_f32_16x16x32_bf16 v[96:99], a[192:195], v[28:31], 0
 s_waitcnt lgkmcnt(1)
 v_mul_f32 v42, 0xbe0293ee, v42
 v_fma_f32 v16, v16, s24, v42
 v_mfma_f32_16x16x32_bf16 v[100:103], a[196:199], v[28:31], 0
 v_fma_f32 v17, v17, s24, v42
 v_fma_f32 v18, v18, s24, v42
 v_mfma_f32_16x16x32_bf16 v[104:107], a[200:203], v[28:31], 0
 buffer_load_dwordx4 v54, s[12:15], s29 offen offset:0 nt lds
 v_mfma_f32_16x16x32_bf16 v[108:111], a[204:207], v[28:31], 0
 v_exp_f32 v16, v16
 v_mfma_f32_16x16x32_bf16 v[112:115], a[208:211], v[28:31], 0
 v_exp_f32 v17, v17
 v_mfma_f32_16x16x32_bf16 v[116:119], a[212:215], v[28:31], 0
 v_cvt_pk_bf16_f32 v32, v16, v17
 v_fma_f32 v19, v19, s24, v42
 v_mfma_f32_16x16x32_bf16 v[120:123], a[216:219], v[28:31], 0
 v_exp_f32 v18, v18
 v_mfma_f32_16x16x32_bf16 v[124:127], a[220:223], v[28:31], 0
 v_exp_f32 v19, v19
 v_mfma_f32_16x16x32_bf16 v[8:11], a[160:163], a[0:3], 0
 v_cvt_pk_bf16_f32 v33, v18, v19
 v_fma_f32 v20, v20, s24, v42
 v_mfma_f32_16x16x32_bf16 v[8:11], a[164:167], a[4:7], v[8:11]
 v_fma_f32 v21, v21, s24, v42
 v_exp_f32 v20, v20
 v_mfma_f32_16x16x32_bf16 v[8:11], a[168:171], a[8:11], v[8:11]
 v_exp_f32 v21, v21
 v_mfma_f32_16x16x32_bf16 v[8:11], a[172:175], a[12:15], v[8:11]
L_stub8:
 s_cbranch_vccnz L_stub12
.if ((L_stub8-L_main)>>6) != 512
.error "stub misplaced"
.endif
 v_cvt_pk_bf16_f32 v34, v20, v21
 v_fma_f32 v22, v22, s24, v42
 v_mfma_f32_16x16x32_bf16 v[12:15], a[188:191], a[12:15], 0
 v_fma_f32 v23, v23, s24, v42
 v_exp_f32 v22, v22
 v_mfma_f32_16x16x32_bf16 v[12:15], a[184:187], a[8:11], v[12:15]
 v_exp_f32 v23, v23
 v_mfma_f32_16x16x32_bf16 v[12:15], a[180:183], a[4:7], v[12:15]
 s_waitcnt lgkmcnt(0)
 buffer_load_dwordx4 v54, s[12:15], s29 offen offset:2048 nt lds
 v_cvt_pk_bf16_f32 v35, v22, v23
 v_mfma_f32_16x16x32_bf16 v[12:15], a[176:179], a[0:3], v[12:15]
 s_add_u32 m0, s26, 106496
 v_mul_f32 v43, 0xbe0293ee, v43
 v_fma_f32 v0, v0, s24, v43
 v_mfma_f32_16x16x32_bf16 v[128:131], a[192:195], v[32:35], 0
 v_fma_f32 v1, v1, s24, v43
 v_fma_f32 v2, v2, s24, v43
 v_mfma_f32_16x16x32_bf16 v[132:135], a[196:199], v[32:35], 0
 v_exp_f32 v0, v0
 v_mfma_f32_16x16x32_bf16 v[136:139], a[200:203], v[32:35], 0
 v_exp_f32 v1, v1
 v_mfma_f32_16x16x32_bf16 v[140:143], a[204:207], v[32:35], 0
 v_cvt_pk_bf16_f32 v36, v0, v1
 v_fma_f32 v3, v3, s24, v43
 v_mfma_f32_16x16x32_bf16 v[144:147], a[208:211], v[32:35], 0
 v_exp_f32 v2, v2
 v_mfma_f32_16x16x32_bf16 v[148:151], a[212:215], v[32:35], 0
 v_exp_f32 v3, v3
 v_mfma_f32_16x16x32_bf16 v[152:155], a[216:219], v[32:35], 0
 s_waitcnt vmcnt(14)
 v_cvt_pk_bf16_f32 v37, v2, v3
 v_fma_f32 v4, v4, s24, v43
 v_mfma_f32_16x16x32_bf16 v[156:159], a[220:223], v[32:35], 0
 s_barrier
 v_fma_f32 v5, v5, s24, v43
 v_max3_f32 v44, v8, v9, v10
 v_mfma_f32_16x16x32_bf16 v[16:19], a[160:163], a[16:19], 0
 ds_read_b128 a[160:163], v46 offset:0
 v_fma_f32 v6, v6, s24, v43
 v_mfma_f32_16x16x32_bf16 v[16:19], a[164:167], a[20:23], v[16:19]
 v_exp_f32 v4, v4
 v_mfma_f32_16x16x32_bf16 v[16:19], a[168:171], a[24:27], v[16:19]
 buffer_load_dwordx4 v54, s[16:19], s29 offen offset:0 nt lds
 v_exp_f32 v5, v5
 v_mfma_f32_16x16x32_bf16 v[16:19], a[172:175], a[28:31], v[16:19]
 ds_read_b128 a[164:167], v47 offset:0
 v_cvt_pk_bf16_f32 v38, v4, v5
 v_max_f32 v44, v44, v11
 v_mfma_f32_16x16x32_bf16 v[20:23], a[188:191], a[28:31], 0
 ds_bpermute_b32 v44, v40, v44
 v_fma_f32 v7, v7, s24, v43
 v_exp_f32 v6, v6
 v_mfma_f32_16x16x32_bf16 v[20:23], a[184:187], a[24:27], v[20:23]
 ds_read_b128 a[168:171], v46 offset:1024
 v_exp_f32 v7, v7
 v_accvgpr_write_b32 a229, 0
 v_accvgpr_write_b32 a230, 0
 v_accvgpr_write_b32 a231, 0
 v_mfma_f32_16x16x32_bf16 v[20:23], a[180:183], a[20:23], v[20:23]
 v_cvt_pk_bf16_f32 v39, v6, v7
 v_max3_f32 v45, v16, v17, v18
 v_mfma_f32_16x16x32_bf16 v[20:23], a[176:179], a[16:19], v[20:23]
 ds_read_b128 a[172:175], v47 offset:1024
 v_max_f32 v45, v45, v19
 v_smfmac_f32_16x16x64_bf16 a[228:231], a[236:239], v[32:39], v55
 ds_bpermute_b32 v45, v40, v45
 v_mfma_f32_16x16x32_bf16 v[160:163], a[192:195], v[36:39], 0
 s_waitcnt lgkmcnt(3)
 ds_read_b128 a[188:191], v47 offset:5120
 v_mul_f32 v44, 0xbe0293ee, v44
 v_mfma_f32_16x16x32_bf16 v[164:167], a[196:199], v[36:39], 0
 v_fma_f32 v8, v8, s24, v44
 v_fma_f32 v9, v9, s24, v44
 v_mfma_f32_16x16x32_bf16 v[168:171], a[200:203], v[36:39], 0
 ds_read_b128 a[184:187], v46 offset:5120
 v_fma_f32 v10, v10, s24, v44
 v_mfma_f32_16x16x32_bf16 v[172:175], a[204:207], v[36:39], 0
 v_exp_f32 v8, v8
 v_mfma_f32_16x16x32_bf16 v[176:179], a[208:211], v[36:39], 0
 ds_read_b128 a[180:183], v47 offset:4096
 v_exp_f32 v9, v9
 v_mfma_f32_16x16x32_bf16 v[180:183], a[212:215], v[36:39], 0
 v_cvt_pk_bf16_f32 v24, v8, v9
 v_fma_f32 v11, v11, s24, v44
 v_mfma_f32_16x16x32_bf16 v[184:187], a[216:219], v[36:39], 0
 buffer_load_dwordx4 v54, s[16:19], s29 offen offset:2048 nt lds
 v_exp_f32 v10, v10
 v_mfma_f32_16x16x32_bf16 v[188:191], a[220:223], v[36:39], 0
 s_add_u32 m0, s26, 49152
 ds_read_b128 a[176:179], v46 offset:4096
 v_exp_f32 v11, v11
 v_mfma_f32_16x16x32_bf16 v[0:3], a[160:163], a[96:99], 0
 s_addk_i32 s29, 8192
 v_cvt_pk_bf16_f32 v25, v10, v11
 v_fma_f32 v12, v12, s24, v44
 v_mfma_f32_16x16x32_bf16 v[0:3], a[164:167], a[100:103], v[0:3]
 s_waitcnt lgkmcnt(2)
 buffer_store_dwordx4 a[32:35], v58, s[20:23], s31 offen offset:0 sc0 sc1 nt
 v_fma_f32 v13, v13, s24, v44
 v_exp_f32 v12, v12
 v_mfma_f32_16x16x32_bf16 v[0:3], a[168:171], a[104:107], v[0:3]
 v_exp_f32 v13, v13
 v_mfma_f32_16x16x32_bf16 v[0:3], a[172:175], a[108:111], v[0:3]
 v_cvt_pk_bf16_f32 v26, v12, v13
 v_fma_f32 v14, v14, s24, v44
 v_mfma_f32_16x16x32_bf16 v[4:7], a[188:191], a[108:111], 0
 v_fma_f32 v15, v15, s24, v44
 v_exp_f32 v14, v14
 v_mfma_f32_16x16x32_bf16 v[4:7], a[184:187], a[104:107], v[4:7]
 s_waitcnt lgkmcnt(1)
 v_exp_f32 v15, v15
 v_mfma_f32_16x16x32_bf16 v[4:7], a[180:183], a[100:103], v[4:7]
 s_waitcnt lgkmcnt(0)
 v_cvt_pk_bf16_f32 v27, v14, v15
 v_mul_f32 v45, 0xbe0293ee, v45
 v_mfma_f32_16x16x32_bf16 v[4:7], a[176:179], a[96:99], v[4:7]
 v_fma_f32 v16, v16, s24, v45
 v_fma_f32 v17, v17, s24, v45
 v_mfma_f32_16x16x32_bf16 v[192:195], a[192:195], v[24:27], 0
 v_exp_f32 v16, v16
 v_mfma_f32_16x16x32_bf16 v[196:199], a[196:199], v[24:27], 0
 v_exp_f32 v17, v17
 v_mfma_f32_16x16x32_bf16 v[200:203], a[200:203], v[24:27], 0
 v_cvt_pk_bf16_f32 v28, v16, v17
 v_fma_f32 v18, v18, s24, v45
 v_mfma_f32_16x16x32_bf16 v[204:207], a[204:207], v[24:27], 0
 buffer_load_dwordx4 v54, s[12:15], s29 offen offset:0 nt lds
 v_mfma_f32_16x16x32_bf16 v[208:211], a[208:211], v[24:27], 0
 v_fma_f32 v19, v19, s24, v45
 v_fma_f32 v20, v20, s24, v45
 v_mfma_f32_16x16x32_bf16 v[212:215], a[212:215], v[24:27], 0
 v_exp_f32 v18, v18
 v_mfma_f32_16x16x32_bf16 v[216:219], a[216:219], v[24:27], 0
 v_exp_f32 v19, v19
 v_mfma_f32_16x16x32_bf16 v[220:223], a[220:223], v[24:27], 0
 v_cvt_pk_bf16_f32 v29, v18, v19
 v_fma_f32 v21, v21, s24, v45
 v_mfma_f32_16x16x32_bf16 v[8:11], a[160:163], a[112:115], 0
 v_exp_f32 v20, v20
 v_mfma_f32_16x16x32_bf16 v[8:11], a[164:167], a[116:119], v[8:11]
 v_exp_f32 v21, v21
 v_mfma_f32_16x16x32_bf16 v[8:11], a[168:171], a[120:123], v[8:11]
 v_cvt_pk_bf16_f32 v30, v20, v21
 v_fma_f32 v22, v22, s24, v45
 v_mfma_f32_16x16x32_bf16 v[8:11], a[172:175], a[124:127], v[8:11]
 v_fma_f32 v23, v23, s24, v45
 v_accvgpr_write_b32 a232, 0
 v_mfma_f32_16x16x32_bf16 v[12:15], a[188:191], a[124:127], 0
 v_exp_f32 v22, v22
 v_mfma_f32_16x16x32_bf16 v[12:15], a[184:187], a[120:123], v[12:15]
 v_exp_f32 v23, v23
 v_accvgpr_write_b32 a233, 0
 v_accvgpr_write_b32 a234, 0
 v_accvgpr_write_b32 a235, 0
 v_mfma_f32_16x16x32_bf16 v[12:15], a[180:183], a[116:119], v[12:15]
 v_cvt_pk_bf16_f32 v31, v22, v23
 v_fma_f32 v0, v0, s24, v63
 v_mfma_f32_16x16x32_bf16 v[12:15], a[176:179], a[112:115], v[12:15]
 buffer_load_dwordx4 v54, s[12:15], s29 offen offset:2048 nt lds
 v_smfmac_f32_16x16x64_bf16 a[232:235], a[236:239], v[24:31], v55
 s_add_u32 m0, s26, 114688
 v_fma_f32 v1, v1, s24, v63
 v_mfma_f32_16x16x32_bf16 v[224:227], a[192:195], v[28:31], 0
 ds_read_b64_tr_b16 a[192:193], v48 offset:0
 ds_read_b64_tr_b16 a[194:195], v48 offset:4096
 v_mfma_f32_16x16x32_bf16 v[228:231], a[196:199], v[28:31], 0
 v_exp_f32 v0, v0
 v_mfma_f32_16x16x32_bf16 v[232:235], a[200:203], v[28:31], 0
 ds_read_b64_tr_b16 a[196:197], v49 offset:0
 ds_read_b64_tr_b16 a[198:199], v49 offset:4096
 v_mfma_f32_16x16x32_bf16 v[236:239], a[204:207], v[28:31], 0
 v_exp_f32 v1, v1
 v_mfma_f32_16x16x32_bf16 v[240:243], a[208:211], v[28:31], 0
 ds_read_b64_tr_b16 a[200:201], v50 offset:0
 ds_read_b64_tr_b16 a[202:203], v50 offset:4096
 v_mfma_f32_16x16x32_bf16 v[244:247], a[212:215], v[28:31], 0
 v_cvt_pk_bf16_f32 v32, v0, v1
 v_fma_f32 v2, v2, s24, v63
 v_mfma_f32_16x16x32_bf16 v[248:251], a[216:219], v[28:31], 0
 ds_read_b64_tr_b16 a[204:205], v51 offset:0
 ds_read_b64_tr_b16 a[206:207], v51 offset:4096
 v_fma_f32 v3, v3, s24, v63
 v_exp_f32 v2, v2
 v_mfma_f32_16x16x32_bf16 v[252:255], a[220:223], v[28:31], 0
 v_exp_f32_e64 v3, v3
 v_mfma_f32_16x16x32_bf16 v[16:19], a[160:163], a[128:131], 0
 ds_read_b64_tr_b16 a[208:209], v48 offset:1024
 ds_read_b64_tr_b16 a[210:211], v48 offset:5120
 v_cvt_pk_bf16_f32 v33, v2, v3
 v_fma_f32 v4, v4, s24, v63
 v_mfma_f32_16x16x32_bf16 v[16:19], a[164:167], a[132:135], v[16:19]
 v_fma_f32 v5, v5, s24, v63
 v_exp_f32 v4, v4
 v_mfma_f32_16x16x32_bf16 v[16:19], a[168:171], a[136:139], v[16:19]
 buffer_load_dwordx4 v54, s[16:19], s29 offen offset:0 nt lds
 v_exp_f32 v5, v5
 v_mfma_f32_16x16x32_bf16 v[16:19], a[172:175], a[140:143], v[16:19]
 ds_read_b64_tr_b16 a[212:213], v49 offset:1024
 ds_read_b64_tr_b16 a[214:215], v49 offset:5120
 v_cvt_pk_bf16_f32 v34, v4, v5
 v_fma_f32 v6, v6, s24, v63
 v_mfma_f32_16x16x32_bf16 v[20:23], a[188:191], a[140:143], 0
 v_fma_f32 v7, v7, s24, v63
 v_exp_f32 v6, v6
 v_mfma_f32_16x16x32_bf16 v[20:23], a[184:187], a[136:139], v[20:23]
 ds_read_b64_tr_b16 a[216:217], v50 offset:1024
 ds_read_b64_tr_b16 a[218:219], v50 offset:5120
 v_exp_f32 v7, v7
 v_mfma_f32_16x16x32_bf16 v[20:23], a[180:183], a[132:135], v[20:23]
 ds_read_b64_tr_b16 a[220:221], v51 offset:1024
 ds_read_b64_tr_b16 a[222:223], v51 offset:5120
 v_cvt_pk_bf16_f32 v35, v6, v7
 v_mfma_f32_16x16x32_bf16 v[20:23], a[176:179], a[128:131], v[20:23]
 s_waitcnt lgkmcnt(6)
 v_fma_f32 v8, v8, s24, v41
 v_fma_f32 v9, v9, s24, v41
 v_mfma_f32_16x16x32_bf16 v[64:67], a[192:195], v[32:35], v[64:67]
 buffer_store_dwordx4 a[40:43], v58, s[20:23], s31 offen offset:2048 sc0 sc1 nt
 v_exp_f32 v8, v8
 v_fma_f32 v10, v10, s24, v41
 v_mfma_f32_16x16x32_bf16 v[68:71], a[196:199], v[32:35], v[68:71]
 v_exp_f32 v9, v9
 v_mfma_f32_16x16x32_bf16 v[72:75], a[200:203], v[32:35], v[72:75]
 v_cvt_pk_bf16_f32 v36, v8, v9
 v_fma_f32 v11, v11, s24, v41
 v_mfma_f32_16x16x32_bf16 v[76:79], a[204:207], v[32:35], v[76:79]
 v_exp_f32 v10, v10
 v_mfma_f32_16x16x32_bf16 v[80:83], a[208:211], v[32:35], v[80:83]
 s_waitcnt lgkmcnt(2)
 v_exp_f32 v11, v11
 v_mfma_f32_16x16x32_bf16 v[84:87], a[212:215], v[32:35], v[84:87]
 v_cvt_pk_bf16_f32 v37, v10, v11
 v_fma_f32 v12, v12, s24, v41
 v_mfma_f32_16x16x32_bf16 v[88:91], a[216:219], v[32:35], v[88:91]
 s_waitcnt lgkmcnt(0)
 buffer_load_dwordx4 v54, s[16:19], s29 offen offset:2048 nt lds
 v_mfma_f32_16x16x32_bf16 v[92:95], a[220:223], v[32:35], v[92:95]
 s_add_u32 m0, s26, 57344
 v_fma_f32 v13, v13, s24, v41
 v_fma_f32 v14, v14, s24, v41
 v_mfma_f32_16x16x32_bf16 v[0:3], a[160:163], a[144:147], 0
 s_addk_i32 s29, 8192
 v_exp_f32 v12, v12
 v_mfma_f32_16x16x32_bf16 v[0:3], a[164:167], a[148:151], v[0:3]
 v_exp_f32 v13, v13
 v_mfma_f32_16x16x32_bf16 v[0:3], a[168:171], a[152:155], v[0:3]
 v_cvt_pk_bf16_f32 v38, v12, v13
 v_fma_f32 v15, v15, s24, v41
 v_mfma_f32_16x16x32_bf16 v[0:3], a[172:175], a[156:159], v[0:3]
 v_exp_f32 v14, v14
 v_mfma_f32_16x16x32_bf16 v[4:7], a[188:191], a[156:159], 0
 v_exp_f32 v15, v15
 v_mfma_f32_16x16x32_bf16 v[4:7], a[184:187], a[152:155], v[4:7]
 v_cvt_pk_bf16_f32 v39, v14, v15
 v_fma_f32 v16, v16, s24, v42
 v_mfma_f32_16x16x32_bf16 v[4:7], a[180:183], a[148:151], v[4:7]
 v_fma_f32 v17, v17, s24, v42
 v_fma_f32 v18, v18, s24, v42
 v_mfma_f32_16x16x32_bf16 v[4:7], a[176:179], a[144:147], v[4:7]
 v_exp_f32 v16, v16
 v_smfmac_f32_16x16x64_bf16 a[224:227], a[236:239], v[32:39], v55
 v_fma_f32 v19, v19, s24, v42
 v_mfma_f32_16x16x32_bf16 v[96:99], a[192:195], v[36:39], v[96:99]
 v_exp_f32 v17, v17
 v_mfma_f32_16x16x32_bf16 v[100:103], a[196:199], v[36:39], v[100:103]
 v_cvt_pk_bf16_f32 v24, v16, v17
 v_fma_f32 v20, v20, s24, v42
 v_mfma_f32_16x16x32_bf16 v[104:107], a[200:203], v[36:39], v[104:107]
 v_exp_f32 v18, v18
 v_mfma_f32_16x16x32_bf16 v[108:111], a[204:207], v[36:39], v[108:111]
 v_exp_f32 v19, v19
 v_mfma_f32_16x16x32_bf16 v[112:115], a[208:211], v[36:39], v[112:115]
 v_cvt_pk_bf16_f32 v25, v18, v19
 v_fma_f32 v21, v21, s24, v42
 v_mfma_f32_16x16x32_bf16 v[116:119], a[212:215], v[36:39], v[116:119]
 v_exp_f32 v20, v20
 v_mfma_f32_16x16x32_bf16 v[120:123], a[216:219], v[36:39], v[120:123]
 v_exp_f32 v21, v21
 v_mfma_f32_16x16x32_bf16 v[124:127], a[220:223], v[36:39], v[124:127]
 v_cvt_pk_bf16_f32 v26, v20, v21
 v_fma_f32 v22, v22, s24, v42
 v_mfma_f32_16x16x32_bf16 v[8:11], a[160:163], a[0:3], 0
 v_fma_f32 v23, v23, s24, v42
 v_fma_f32 v0, v0, s24, v43
 v_mfma_f32_16x16x32_bf16 v[8:11], a[164:167], a[4:7], v[8:11]
 v_exp_f32 v22, v22
 v_mfma_f32_16x16x32_bf16 v[8:11], a[168:171], a[8:11], v[8:11]
 v_exp_f32 v23, v23
 v_mfma_f32_16x16x32_bf16 v[8:11], a[172:175], a[12:15], v[8:11]
 v_cvt_pk_bf16_f32 v27, v22, v23
 v_fma_f32 v1, v1, s24, v43
 v_mfma_f32_16x16x32_bf16 v[12:15], a[188:191], a[12:15], 0
 v_exp_f32 v0, v0
 v_mfma_f32_16x16x32_bf16 v[12:15], a[184:187], a[8:11], v[12:15]
 v_exp_f32 v1, v1
 v_mfma_f32_16x16x32_bf16 v[12:15], a[180:183], a[4:7], v[12:15]
 v_cvt_pk_bf16_f32 v28, v0, v1
 v_fma_f32 v2, v2, s24, v43
 v_mfma_f32_16x16x32_bf16 v[12:15], a[176:179], a[0:3], v[12:15]
 v_fma_f32 v3, v3, s24, v43
 v_fma_f32 v4, v4, s24, v43
 v_mfma_f32_16x16x32_bf16 v[128:131], a[192:195], v[24:27], v[128:131]
 v_exp_f32 v2, v2
 v_mfma_f32_16x16x32_bf16 v[132:135], a[196:199], v[24:27], v[132:135]
 v_exp_f32 v3, v3
 v_mfma_f32_16x16x32_bf16 v[136:139], a[200:203], v[24:27], v[136:139]
 v_cvt_pk_bf16_f32 v29, v2, v3
 v_fma_f32 v5, v5, s24, v43
 v_mfma_f32_16x16x32_bf16 v[140:143], a[204:207], v[24:27], v[140:143]
 v_exp_f32 v4, v4
 v_mfma_f32_16x16x32_bf16 v[144:147], a[208:211], v[24:27], v[144:147]
 v_exp_f32 v5, v5
 v_mfma_f32_16x16x32_bf16 v[148:151], a[212:215], v[24:27], v[148:151]
 v_cvt_pk_bf16_f32 v30, v4, v5
 v_fma_f32 v6, v6, s24, v43
 v_mfma_f32_16x16x32_bf16 v[152:155], a[216:219], v[24:27], v[152:155]
 s_waitcnt vmcnt(16)
 v_fma_f32 v7, v7, s24, v43
 v_fma_f32 v8, v8, s24, v44
 v_mfma_f32_16x16x32_bf16 v[156:159], a[220:223], v[24:27], v[156:159]
 s_barrier
 buffer_store_dwordx4 a[36:39], v58, s[20:23], s31 offen offset:128 sc0 sc1 nt
 v_exp_f32 v6, v6
 v_fma_f32 v9, v9, s24, v44
 v_mfma_f32_16x16x32_bf16 v[16:19], a[160:163], a[16:19], 0
 ds_read_b128 a[160:163], v46 offset:8192
 v_fma_f32 v10, v10, s24, v44
 v_mfma_f32_16x16x32_bf16 v[16:19], a[164:167], a[20:23], v[16:19]
 v_exp_f32 v7, v7
 v_mfma_f32_16x16x32_bf16 v[16:19], a[168:171], a[24:27], v[16:19]
 ds_read_b128 a[164:167], v47 offset:8192
 v_cvt_pk_bf16_f32 v31, v6, v7
 v_mfma_f32_16x16x32_bf16 v[16:19], a[172:175], a[28:31], v[16:19]
 v_exp_f32 v8, v8
 v_mfma_f32_16x16x32_bf16 v[20:23], a[188:191], a[28:31], 0
 ds_read_b128 a[168:171], v46 offset:9216
 v_fma_f32 v11, v11, s24, v44
 v_mfma_f32_16x16x32_bf16 v[20:23], a[184:187], a[24:27], v[20:23]
 v_exp_f32 v9, v9
 v_mfma_f32_16x16x32_bf16 v[20:23], a[180:183], a[20:23], v[20:23]
 ds_read_b128 a[172:175], v47 offset:9216
 v_cvt_pk_bf16_f32 v32, v8, v9
 v_mfma_f32_16x16x32_bf16 v[20:23], a[176:179], a[16:19], v[20:23]
 v_exp_f32 v10, v10
 v_smfmac_f32_16x16x64_bf16 a[228:231], a[236:239], v[24:31], v55
 ds_read_b128 a[188:191], v47 offset:13312
 v_mfma_f32_16x16x32_bf16 v[160:163], a[192:195], v[28:31], v[160:163]
 v_exp_f32 v11, v11
 v_mfma_f32_16x16x32_bf16 v[164:167], a[196:199], v[28:31], v[164:167]
 ds_read_b128 a[184:187], v46 offset:13312
 v_cvt_pk_bf16_f32 v33, v10, v11
 v_mfma_f32_16x16x32_bf16 v[168:171], a[200:203], v[28:31], v[168:171]
 v_fma_f32 v12, v12, s24, v44
 v_fma_f32 v13, v13, s24, v44
 v_mfma_f32_16x16x32_bf16 v[172:175], a[204:207], v[28:31], v[172:175]
 ds_read_b128 a[180:183], v47 offset:12288
 v_fma_f32 v14, v14, s24, v44
 v_mfma_f32_16x16x32_bf16 v[176:179], a[208:211], v[28:31], v[176:179]
 v_exp_f32 v12, v12
 v_mfma_f32_16x16x32_bf16 v[180:183], a[212:215], v[28:31], v[180:183]
 ds_read_b128 a[176:179], v46 offset:12288
 v_fma_f32 v15, v15, s24, v44
 v_mfma_f32_16x16x32_bf16 v[184:187], a[216:219], v[28:31], v[184:187]
 v_exp_f32 v13, v13
 v_mfma_f32_16x16x32_bf16 v[188:191], a[220:223], v[28:31], v[188:191]
 s_waitcnt lgkmcnt(3)
 v_cvt_pk_bf16_f32 v34, v12, v13
 v_fma_f32 v16, v16, s24, v45
 v_mfma_f32_16x16x32_bf16 v[0:3], a[160:163], a[96:99], 0
 v_exp_f32 v14, v14
 v_mfma_f32_16x16x32_bf16 v[0:3], a[164:167], a[100:103], v[0:3]
 v_exp_f32 v15, v15
 v_mfma_f32_16x16x32_bf16 v[0:3], a[168:171], a[104:107], v[0:3]
 v_cvt_pk_bf16_f32 v35, v14, v15
 v_fma_f32 v17, v17, s24, v45
 v_mfma_f32_16x16x32_bf16 v[0:3], a[172:175], a[108:111], v[0:3]
 v_exp_f32 v16, v16
 v_mfma_f32_16x16x32_bf16 v[4:7], a[188:191], a[108:111], 0
 s_waitcnt lgkmcnt(0)
 v_exp_f32 v17, v17
 v_mfma_f32_16x16x32_bf16 v[4:7], a[184:187], a[104:107], v[4:7]
 v_cvt_pk_bf16_f32 v36, v16, v17
 v_fma_f32 v18, v18, s24, v45
 v_mfma_f32_16x16x32_bf16 v[4:7], a[180:183], a[100:103], v[4:7]
 v_fma_f32 v19, v19, s24, v45
 v_fma_f32 v20, v20, s24, v45
 v_mfma_f32_16x16x32_bf16 v[4:7], a[176:179], a[96:99], v[4:7]
 v_exp_f32 v18, v18
 v_mfma_f32_16x16x32_bf16 v[192:195], a[192:195], v[32:35], v[192:195]
 v_exp_f32 v19, v19
 v_mfma_f32_16x16x32_bf16 v[196:199], a[196:199], v[32:35], v[196:199]
 v_cvt_pk_bf16_f32 v37, v18, v19
 v_fma_f32 v21, v21, s24, v45
 v_mfma_f32_16x16x32_bf16 v[200:203], a[200:203], v[32:35], v[200:203]
 v_exp_f32 v20, v20
 v_mfma_f32_16x16x32_bf16 v[204:207], a[204:207], v[32:35], v[204:207]
 buffer_load_dwordx4 v54, s[12:15], s29 offen offset:0 nt lds
 v_mfma_f32_16x16x32_bf16 v[208:211], a[208:211], v[32:35], v[208:211]
 v_exp_f32 v21, v21
 v_mfma_f32_16x16x32_bf16 v[212:215], a[212:215], v[32:35], v[212:215]
 v_cvt_pk_bf16_f32 v38, v20, v21
 v_fma_f32 v22, v22, s24, v45
 v_mfma_f32_16x16x32_bf16 v[216:219], a[216:219], v[32:35], v[216:219]
 v_fma_f32 v23, v23, s24, v45
 v_fma_f32 v0, v0, s24, v63
 v_mfma_f32_16x16x32_bf16 v[220:223], a[220:223], v[32:35], v[220:223]
 v_exp_f32 v22, v22
 v_mfma_f32_16x16x32_bf16 v[8:11], a[160:163], a[112:115], 0
 v_exp_f32 v23, v23
 v_mfma_f32_16x16x32_bf16 v[8:11], a[164:167], a[116:119], v[8:11]
 v_cvt_pk_bf16_f32 v39, v22, v23
 v_fma_f32 v1, v1, s24, v63
 v_mfma_f32_16x16x32_bf16 v[8:11], a[168:171], a[120:123], v[8:11]
 v_exp_f32 v0, v0
 v_mfma_f32_16x16x32_bf16 v[8:11], a[172:175], a[124:127], v[8:11]
 v_exp_f32 v1, v1
 v_mfma_f32_16x16x32_bf16 v[12:15], a[188:191], a[124:127], 0
 v_cvt_pk_bf16_f32 v24, v0, v1
 v_fma_f32 v2, v2, s24, v63
 v_mfma_f32_16x16x32_bf16 v[12:15], a[184:187], a[120:123], v[12:15]
 v_fma_f32 v3, v3, s24, v63
 v_fma_f32 v4, v4, s24, v63
 v_mfma_f32_16x16x32_bf16 v[12:15], a[180:183], a[116:119], v[12:15]
 buffer_store_dwordx4 a[44:47], v58, s[20:23], s31 offen offset:2176 sc0 sc1 nt
 v_exp_f32 v2, v2
 v_fma_f32 v5, v5, s24, v63
 v_mfma_f32_16x16x32_bf16 v[12:15], a[176:179], a[112:115], v[12:15]
 s_addk_i32 s31, 4096
 buffer_load_dwordx4 v54, s[12:15], s29 offen offset:2048 nt lds
 v_smfmac_f32_16x16x64_bf16 a[232:235], a[236:239], v[32:39], v55
 s_add_u32 m0, s26, 122880
 v_fma_f32 v6, v6, s24, v63
 v_mfma_f32_16x16x32_bf16 v[224:227], a[192:195], v[36:39], v[224:227]
 ds_read_b64_tr_b16 a[192:193], v48 offset:8192
 ds_read_b64_tr_b16 a[194:195], v48 offset:12288
 v_mfma_f32_16x16x32_bf16 v[228:231], a[196:199], v[36:39], v[228:231]
 v_exp_f32 v3, v3
 v_mfma_f32_16x16x32_bf16 v[232:235], a[200:203], v[36:39], v[232:235]
 ds_read_b64_tr_b16 a[196:197], v49 offset:8192
 ds_read_b64_tr_b16 a[198:199], v49 offset:12288
 v_mfma_f32_16x16x32_bf16 v[236:239], a[204:207], v[36:39], v[236:239]
 v_cvt_pk_bf16_f32 v25, v2, v3
 v_fma_f32 v7, v7, s24, v63
 v_mfma_f32_16x16x32_bf16 v[240:243], a[208:211], v[36:39], v[240:243]
 ds_read_b64_tr_b16 a[200:201], v50 offset:8192
 ds_read_b64_tr_b16 a[202:203], v50 offset:12288
 v_mfma_f32_16x16x32_bf16 v[244:247], a[212:215], v[36:39], v[244:247]
 v_exp_f32 v4, v4
 v_mfma_f32_16x16x32_bf16 v[248:251], a[216:219], v[36:39], v[248:251]
 ds_read_b64_tr_b16 a[204:205], v51 offset:8192
 ds_read_b64_tr_b16 a[206:207], v51 offset:12288
 v_mfma_f32_16x16x32_bf16 v[252:255], a[220:223], v[36:39], v[252:255]
 v_exp_f32 v5, v5
 v_mfma_f32_16x16x32_bf16 v[16:19], a[160:163], a[128:131], 0
 ds_read_b64_tr_b16 a[208:209], v48 offset:9216
 ds_read_b64_tr_b16 a[210:211], v48 offset:13312
 v_mfma_f32_16x16x32_bf16 v[16:19], a[164:167], a[132:135], v[16:19]
 v_cvt_pk_bf16_f32 v26, v4, v5
 v_fma_f32 v8, v8, s24, v41
 v_mfma_f32_16x16x32_bf16 v[16:19], a[168:171], a[136:139], v[16:19]
 buffer_load_dwordx4 v54, s[16:19], s29 offen offset:0 nt lds
 v_mfma_f32_16x16x32_bf16 v[16:19], a[172:175], a[140:143], v[16:19]
 ds_read_b64_tr_b16 a[212:213], v49 offset:9216
 ds_read_b64_tr_b16 a[214:215], v49 offset:13312
 v_mfma_f32_16x16x32_bf16 v[20:23], a[188:191], a[140:143], 0
 v_exp_f32 v6, v6
 v_mfma_f32_16x16x32_bf16 v[20:23], a[184:187], a[136:139], v[20:23]
 ds_read_b64_tr_b16 a[216:217], v50 offset:9216
 ds_read_b64_tr_b16 a[218:219], v50 offset:13312
 v_exp_f32 v7, v7
 v_mfma_f32_16x16x32_bf16 v[20:23], a[180:183], a[132:135], v[20:23]
 ds_read_b64_tr_b16 a[220:221], v51 offset:9216
 ds_read_b64_tr_b16 a[222:223], v51 offset:13312
 v_cvt_pk_bf16_f32 v27, v6, v7
 v_mfma_f32_16x16x32_bf16 v[20:23], a[176:179], a[128:131], v[20:23]
 s_waitcnt lgkmcnt(6)
 v_fma_f32 v9, v9, s24, v41
 v_fma_f32 v10, v10, s24, v41
 v_mfma_f32_16x16x32_bf16 v[64:67], a[192:195], v[24:27], v[64:67]
 v_exp_f32 v8, v8
 v_mfma_f32_16x16x32_bf16 v[68:71], a[196:199], v[24:27], v[68:71]
 v_exp_f32 v9, v9
 v_mfma_f32_16x16x32_bf16 v[72:75], a[200:203], v[24:27], v[72:75]
 v_cvt_pk_bf16_f32 v28, v8, v9
 v_fma_f32 v11, v11, s24, v41
 v_mfma_f32_16x16x32_bf16 v[76:79], a[204:207], v[24:27], v[76:79]
 v_exp_f32 v10, v10
 v_mfma_f32_16x16x32_bf16 v[80:83], a[208:211], v[24:27], v[80:83]
 s_waitcnt lgkmcnt(2)
 v_exp_f32 v11, v11
 v_mfma_f32_16x16x32_bf16 v[84:87], a[212:215], v[24:27], v[84:87]
 v_cvt_pk_bf16_f32 v29, v10, v11
 v_fma_f32 v12, v12, s24, v41
 v_mfma_f32_16x16x32_bf16 v[88:91], a[216:219], v[24:27], v[88:91]
 s_waitcnt lgkmcnt(0)
 buffer_load_dwordx4 v54, s[16:19], s29 offen offset:2048 nt lds
 v_mfma_f32_16x16x32_bf16 v[92:95], a[220:223], v[24:27], v[92:95]
 s_add_u32 m0, s26, 32768
 v_fma_f32 v13, v13, s24, v41
 v_fma_f32 v14, v14, s24, v41
 v_mfma_f32_16x16x32_bf16 v[0:3], a[160:163], a[144:147], 0
 s_addk_i32 s29, 8192
 v_exp_f32 v12, v12
 v_mfma_f32_16x16x32_bf16 v[0:3], a[164:167], a[148:151], v[0:3]
 v_exp_f32 v13, v13
 v_mfma_f32_16x16x32_bf16 v[0:3], a[168:171], a[152:155], v[0:3]
 v_cvt_pk_bf16_f32 v30, v12, v13
 v_fma_f32 v15, v15, s24, v41
 v_mfma_f32_16x16x32_bf16 v[0:3], a[172:175], a[156:159], v[0:3]
 v_exp_f32 v14, v14
 v_mfma_f32_16x16x32_bf16 v[4:7], a[188:191], a[156:159], 0
 v_exp_f32 v15, v15
 v_mfma_f32_16x16x32_bf16 v[4:7], a[184:187], a[152:155], v[4:7]
 v_cvt_pk_bf16_f32 v31, v14, v15
 v_fma_f32 v16, v16, s24, v42
 v_mfma_f32_16x16x32_bf16 v[4:7], a[180:183], a[148:151], v[4:7]
 v_fma_f32 v17, v17, s24, v42
 v_fma_f32 v18, v18, s24, v42
 v_mfma_f32_16x16x32_bf16 v[4:7], a[176:179], a[144:147], v[4:7]
 v_exp_f32 v16, v16
 v_smfmac_f32_16x16x64_bf16 a[224:227], a[236:239], v[24:31], v55
 v_fma_f32 v19, v19, s24, v42
 v_mfma_f32_16x16x32_bf16 v[96:99], a[192:195], v[28:31], v[96:99]
 v_exp_f32 v17, v17
 v_mfma_f32_16x16x32_bf16 v[100:103], a[196:199], v[28:31], v[100:103]
 v_cvt_pk_bf16_f32 v32, v16, v17
 v_fma_f32 v20, v20, s24, v42
 v_mfma_f32_16x16x32_bf16 v[104:107], a[200:203], v[28:31], v[104:107]
 v_exp_f32 v18, v18
 v_mfma_f32_16x16x32_bf16 v[108:111], a[204:207], v[28:31], v[108:111]
 v_exp_f32 v19, v19
 v_mfma_f32_16x16x32_bf16 v[112:115], a[208:211], v[28:31], v[112:115]
 v_cvt_pk_bf16_f32 v33, v18, v19
 v_fma_f32 v21, v21, s24, v42
 v_mfma_f32_16x16x32_bf16 v[116:119], a[212:215], v[28:31], v[116:119]
 v_exp_f32 v20, v20
 v_mfma_f32_16x16x32_bf16 v[120:123], a[216:219], v[28:31], v[120:123]
 v_exp_f32 v21, v21
 v_mfma_f32_16x16x32_bf16 v[124:127], a[220:223], v[28:31], v[124:127]
 v_cvt_pk_bf16_f32 v34, v20, v21
 v_fma_f32 v22, v22, s24, v42
 v_mfma_f32_16x16x32_bf16 v[8:11], a[160:163], a[0:3], 0
 v_fma_f32 v23, v23, s24, v42
 v_fma_f32 v0, v0, s24, v43
 v_mfma_f32_16x16x32_bf16 v[8:11], a[164:167], a[4:7], v[8:11]
 buffer_store_dwordx4 a[48:51], v58, s[20:23], s31 offen offset:0 sc0 sc1 nt
 v_exp_f32 v22, v22
 v_fma_f32 v1, v1, s24, v43
 v_mfma_f32_16x16x32_bf16 v[8:11], a[168:171], a[8:11], v[8:11]
 v_exp_f32 v23, v23
 v_mfma_f32_16x16x32_bf16 v[8:11], a[172:175], a[12:15], v[8:11]
 v_cvt_pk_bf16_f32 v35, v22, v23
 v_fma_f32 v2, v2, s24, v43
 v_mfma_f32_16x16x32_bf16 v[12:15], a[188:191], a[12:15], 0
 v_exp_f32 v0, v0
 v_mfma_f32_16x16x32_bf16 v[12:15], a[184:187], a[8:11], v[12:15]
 v_exp_f32 v1, v1
 v_mfma_f32_16x16x32_bf16 v[12:15], a[180:183], a[4:7], v[12:15]
 v_cvt_pk_bf16_f32 v36, v0, v1
 v_fma_f32 v3, v3, s24, v43
 v_mfma_f32_16x16x32_bf16 v[12:15], a[176:179], a[0:3], v[12:15]
 v_exp_f32 v2, v2
 v_mfma_f32_16x16x32_bf16 v[128:131], a[192:195], v[32:35], v[128:131]
 v_exp_f32 v3, v3
 v_mfma_f32_16x16x32_bf16 v[132:135], a[196:199], v[32:35], v[132:135]
 v_cvt_pk_bf16_f32 v37, v2, v3
 v_fma_f32 v4, v4, s24, v43
 v_mfma_f32_16x16x32_bf16 v[136:139], a[200:203], v[32:35], v[136:139]
 v_fma_f32 v5, v5, s24, v43
 v_fma_f32 v6, v6, s24, v43
 v_mfma_f32_16x16x32_bf16 v[140:143], a[204:207], v[32:35], v[140:143]
 v_exp_f32 v4, v4
 v_mfma_f32_16x16x32_bf16 v[144:147], a[208:211], v[32:35], v[144:147]
L_stub9:
 s_cbranch_vccnz L_stub13
.if ((L_stub9-L_main)>>6) != 576
.error "stub misplaced"
.endif
 v_exp_f32 v5, v5
 v_mfma_f32_16x16x32_bf16 v[148:151], a[212:215], v[32:35], v[148:151]
 v_cvt_pk_bf16_f32 v38, v4, v5
 v_fma_f32 v7, v7, s24, v43
 v_mfma_f32_16x16x32_bf16 v[152:155], a[216:219], v[32:35], v[152:155]
 s_waitcnt vmcnt(15)
 v_exp_f32 v6, v6
 v_mfma_f32_16x16x32_bf16 v[156:159], a[220:223], v[32:35], v[156:159]
 s_barrier
 v_exp_f32 v7, v7
 v_mfma_f32_16x16x32_bf16 v[16:19], a[160:163], a[16:19], 0
 ds_read_b128 a[160:163], v46 offset:16384
 v_cvt_pk_bf16_f32 v39, v6, v7
 v_mfma_f32_16x16x32_bf16 v[16:19], a[164:167], a[20:23], v[16:19]
 v_fma_f32 v8, v8, s24, v44
 v_fma_f32 v9, v9, s24, v44
 v_mfma_f32_16x16x32_bf16 v[16:19], a[168:171], a[24:27], v[16:19]
 ds_read_b128 a[164:167], v47 offset:16384
 v_fma_f32 v10, v10, s24, v44
 v_mfma_f32_16x16x32_bf16 v[16:19], a[172:175], a[28:31], v[16:19]
 v_exp_f32 v8, v8
 v_mfma_f32_16x16x32_bf16 v[20:23], a[188:191], a[28:31], 0
 ds_read_b128 a[168:171], v46 offset:17408
 v_fma_f32 v11, v11, s24, v44
 v_mfma_f32_16x16x32_bf16 v[20:23], a[184:187], a[24:27], v[20:23]
 v_exp_f32 v9, v9
 v_mfma_f32_16x16x32_bf16 v[20:23], a[180:183], a[20:23], v[20:23]
 ds_read_b128 a[172:175], v47 offset:17408
 v_cvt_pk_bf16_f32 v24, v8, v9
 v_mfma_f32_16x16x32_bf16 v[20:23], a[176:179], a[16:19], v[20:23]
 v_exp_f32 v10, v10
 v_smfmac_f32_16x16x64_bf16 a[228:231], a[236:239], v[32:39], v55
 ds_read_b128 a[188:191], v47 offset:21504
 v_mfma_f32_16x16x32_bf16 v[160:163], a[192:195], v[36:39], v[160:163]
 v_exp_f32 v11, v11
 v_mfma_f32_16x16x32_bf16 v[164:167], a[196:199], v[36:39], v[164:167]
 ds_read_b128 a[184:187], v46 offset:21504
 v_cvt_pk_bf16_f32 v25, v10, v11
 v_mfma_f32_16x16x32_bf16 v[168:171], a[200:203], v[36:39], v[168:171]
 v_fma_f32 v12, v12, s24, v44
 v_fma_f32 v13, v13, s24, v44
 v_mfma_f32_16x16x32_bf16 v[172:175], a[204:207], v[36:39], v[172:175]
 ds_read_b128 a[180:183], v47 offset:20480
 v_fma_f32 v14, v14, s24, v44
 v_mfma_f32_16x16x32_bf16 v[176:179], a[208:211], v[36:39], v[176:179]
 v_exp_f32 v12, v12
 v_mfma_f32_16x16x32_bf16 v[180:183], a[212:215], v[36:39], v[180:183]
 ds_read_b128 a[176:179], v46 offset:20480
 v_fma_f32 v15, v15, s24, v44
 v_mfma_f32_16x16x32_bf16 v[184:187], a[216:219], v[36:39], v[184:187]
 v_exp_f32 v13, v13
 v_mfma_f32_16x16x32_bf16 v[188:191], a[220:223], v[36:39], v[188:191]
 s_waitcnt lgkmcnt(3)
 v_cvt_pk_bf16_f32 v26, v12, v13
 v_fma_f32 v16, v16, s24, v45
 v_mfma_f32_16x16x32_bf16 v[0:3], a[160:163], a[96:99], 0
 v_exp_f32 v14, v14
 v_mfma_f32_16x16x32_bf16 v[0:3], a[164:167], a[100:103], v[0:3]
 v_exp_f32 v15, v15
 v_mfma_f32_16x16x32_bf16 v[0:3], a[168:171], a[104:107], v[0:3]
 v_cvt_pk_bf16_f32 v27, v14, v15
 v_fma_f32 v17, v17, s24, v45
 v_mfma_f32_16x16x32_bf16 v[0:3], a[172:175], a[108:111], v[0:3]
 v_exp_f32 v16, v16
 v_mfma_f32_16x16x32_bf16 v[4:7], a[188:191], a[108:111], 0
 s_waitcnt lgkmcnt(0)
 v_exp_f32 v17, v17
 v_mfma_f32_16x16x32_bf16 v[4:7], a[184:187], a[104:107], v[4:7]
 v_cvt_pk_bf16_f32 v28, v16, v17
 v_fma_f32 v18, v18, s24, v45
 v_mfma_f32_16x16x32_bf16 v[4:7], a[180:183], a[100:103], v[4:7]
 v_fma_f32 v19, v19, s24, v45
 v_fma_f32 v20, v20, s24, v45
 v_mfma_f32_16x16x32_bf16 v[4:7], a[176:179], a[96:99], v[4:7]
 v_exp_f32 v18, v18
 v_mfma_f32_16x16x32_bf16 v[192:195], a[192:195], v[24:27], v[192:195]
 buffer_store_dwordx4 a[56:59], v58, s[20:23], s31 offen offset:2048 sc0 sc1 nt
 v_exp_f32 v19, v19
 v_fma_f32 v21, v21, s24, v45
 v_mfma_f32_16x16x32_bf16 v[196:199], a[196:199], v[24:27], v[196:199]
 v_cvt_pk_bf16_f32 v29, v18, v19
 v_fma_f32 v22, v22, s24, v45
 v_mfma_f32_16x16x32_bf16 v[200:203], a[200:203], v[24:27], v[200:203]
 v_exp_f32 v20, v20
 v_mfma_f32_16x16x32_bf16 v[204:207], a[204:207], v[24:27], v[204:207]
 buffer_load_dwordx4 v54, s[12:15], s29 offen offset:0 nt lds
 v_mfma_f32_16x16x32_bf16 v[208:211], a[208:211], v[24:27], v[208:211]
 v_exp_f32 v21, v21
 v_mfma_f32_16x16x32_bf16 v[212:215], a[212:215], v[24:27], v[212:215]
 v_cvt_pk_bf16_f32 v30, v20, v21
 v_fma_f32 v23, v23, s24, v45
 v_mfma_f32_16x16x32_bf16 v[216:219], a[216:219], v[24:27], v[216:219]
 v_exp_f32 v22, v22
 v_mfma_f32_16x16x32_bf16 v[220:223], a[220:223], v[24:27], v[220:223]
 v_exp_f32 v23, v23
 v_mfma_f32_16x16x32_bf16 v[8:11], a[160:163], a[112:115], 0
 v_cvt_pk_bf16_f32 v31, v22, v23
 v_fma_f32 v0, v0, s24, v63
 v_mfma_f32_16x16x32_bf16 v[8:11], a[164:167], a[116:119], v[8:11]
 v_fma_f32 v1, v1, s24, v63
 v_fma_f32 v2, v2, s24, v63
 v_mfma_f32_16x16x32_bf16 v[8:11], a[168:171], a[120:123], v[8:11]
 v_exp_f32 v0, v0
 v_mfma_f32_16x16x32_bf16 v[8:11], a[172:175], a[124:127], v[8:11]
 v_exp_f32 v1, v1
 v_mfma_f32_16x16x32_bf16 v[12:15], a[188:191], a[124:127], 0
 v_cvt_pk_bf16_f32 v32, v0, v1
 v_fma_f32 v3, v3, s24, v63
 v_mfma_f32_16x16x32_bf16 v[12:15], a[184:187], a[120:123], v[12:15]
 v_exp_f32 v2, v2
 v_mfma_f32_16x16x32_bf16 v[12:15], a[180:183], a[116:119], v[12:15]
 v_exp_f32 v3, v3
 v_mfma_f32_16x16x32_bf16 v[12:15], a[176:179], a[112:115], v[12:15]
 buffer_load_dwordx4 v54, s[12:15], s29 offen offset:2048 nt lds
 v_smfmac_f32_16x16x64_bf16 a[232:235], a[236:239], v[24:31], v55
 s_add_u32 m0, s26, 98304
 v_cvt_pk_bf16_f32 v33, v2, v3
 v_mfma_f32_16x16x32_bf16 v[224:227], a[192:195], v[28:31], v[224:227]
 ds_read_b64_tr_b16 a[192:193], v48 offset:16384
 ds_read_b64_tr_b16 a[194:195], v48 offset:20480
 v_mfma_f32_16x16x32_bf16 v[228:231], a[196:199], v[28:31], v[228:231]
 v_fma_f32 v4, v4, s24, v63
 v_fma_f32 v5, v5, s24, v63
 v_mfma_f32_16x16x32_bf16 v[232:235], a[200:203], v[28:31], v[232:235]
 ds_read_b64_tr_b16 a[196:197], v49 offset:16384
 ds_read_b64_tr_b16 a[198:199], v49 offset:20480
 v_mfma_f32_16x16x32_bf16 v[236:239], a[204:207], v[28:31], v[236:239]
 v_exp_f32 v4, v4
 v_mfma_f32_16x16x32_bf16 v[240:243], a[208:211], v[28:31], v[240:243]
 ds_read_b64_tr_b16 a[200:201], v50 offset:16384
 ds_read_b64_tr_b16 a[202:203], v50 offset:20480
 v_mfma_f32_16x16x32_bf16 v[244:247], a[212:215], v[28:31], v[244:247]
 v_exp_f32 v5, v5
 v_mfma_f32_16x16x32_bf16 v[248:251], a[216:219], v[28:31], v[248:251]
 ds_read_b64_tr_b16 a[204:205], v51 offset:16384
 ds_read_b64_tr_b16 a[206:207], v51 offset:20480
 v_mfma_f32_16x16x32_bf16 v[252:255], a[220:223], v[28:31], v[252:255]
 v_cvt_pk_bf16_f32 v34, v4, v5
 v_fma_f32 v6, v6, s24, v63
 v_mfma_f32_16x16x32_bf16 v[16:19], a[160:163], a[128:131], 0
 ds_read_b64_tr_b16 a[208:209], v48 offset:17408
 ds_read_b64_tr_b16 a[210:211], v48 offset:21504
 v_mfma_f32_16x16x32_bf16 v[16:19], a[164:167], a[132:135], v[16:19]
 v_fma_f32 v7, v7, s24, v63
 v_fma_f32 v8, v8, s24, v41
 v_mfma_f32_16x16x32_bf16 v[16:19], a[168:171], a[136:139], v[16:19]
 buffer_load_dwordx4 v54, s[16:19], s29 offen offset:0 nt lds
 v_mfma_f32_16x16x32_bf16 v[16:19], a[172:175], a[140:143], v[16:19]
 ds_read_b64_tr_b16 a[212:213], v49 offset:17408
 ds_read_b64_tr_b16 a[214:215], v49 offset:21504
 v_mfma_f32_16x16x32_bf16 v[20:23], a[188:191], a[140:143], 0
 v_exp_f32 v6, v6
 v_mfma_f32_16x16x32_bf16 v[20:23], a[184:187], a[136:139], v[20:23]
 ds_read_b64_tr_b16 a[216:217], v50 offset:17408
 ds_read_b64_tr_b16 a[218:219], v50 offset:21504
 v_exp_f32 v7, v7
 v_mfma_f32_16x16x32_bf16 v[20:23], a[180:183], a[132:135], v[20:23]
 ds_read_b64_tr_b16 a[220:221], v51 offset:17408
 ds_read_b64_tr_b16 a[222:223], v51 offset:21504
 v_cvt_pk_bf16_f32 v35, v6, v7
 v_mfma_f32_16x16x32_bf16 v[20:23], a[176:179], a[128:131], v[20:23]
 s_waitcnt lgkmcnt(6)
 v_fma_f32 v9, v9, s24, v41
 v_fma_f32 v10, v10, s24, v41
 v_mfma_f32_16x16x32_bf16 v[64:67], a[192:195], v[32:35], v[64:67]
 v_exp_f32 v8, v8
 v_mfma_f32_16x16x32_bf16 v[68:71], a[196:199], v[32:35], v[68:71]
 v_exp_f32 v9, v9
 v_mfma_f32_16x16x32_bf16 v[72:75], a[200:203], v[32:35], v[72:75]
 v_cvt_pk_bf16_f32 v36, v8, v9
 v_fma_f32 v11, v11, s24, v41
 v_mfma_f32_16x16x32_bf16 v[76:79], a[204:207], v[32:35], v[76:79]
 v_exp_f32 v10, v10
 v_mfma_f32_16x16x32_bf16 v[80:83], a[208:211], v[32:35], v[80:83]
 s_waitcnt lgkmcnt(2)
 v_exp_f32 v11, v11
 v_mfma_f32_16x16x32_bf16 v[84:87], a[212:215], v[32:35], v[84:87]
 v_cvt_pk_bf16_f32 v37, v10, v11
 v_fma_f32 v12, v12, s24, v41
 v_mfma_f32_16x16x32_bf16 v[88:91], a[216:219], v[32:35], v[88:91]
 s_waitcnt lgkmcnt(0)
 buffer_load_dwordx4 v54, s[16:19], s29 offen offset:2048 nt lds
 v_mfma_f32_16x16x32_bf16 v[92:95], a[220:223], v[32:35], v[92:95]
 s_add_u32 m0, s26, 0
 buffer_store_dwordx4 a[52:55], v58, s[20:23], s31 offen offset:128 sc0 sc1 nt
 v_fma_f32 v13, v13, s24, v41
 v_exp_f32 v12, v12
 v_mfma_f32_16x16x32_bf16 v[0:3], a[160:163], a[144:147], 0
 s_addk_i32 s29, 8192
 v_exp_f32 v13, v13
 v_mfma_f32_16x16x32_bf16 v[0:3], a[164:167], a[148:151], v[0:3]
 v_cvt_pk_bf16_f32 v38, v12, v13
 v_fma_f32 v14, v14, s24, v41
 v_mfma_f32_16x16x32_bf16 v[0:3], a[168:171], a[152:155], v[0:3]
 v_fma_f32 v15, v15, s24, v41
 v_fma_f32 v16, v16, s24, v42
 v_mfma_f32_16x16x32_bf16 v[0:3], a[172:175], a[156:159], v[0:3]
 v_exp_f32 v14, v14
 v_mfma_f32_16x16x32_bf16 v[4:7], a[188:191], a[156:159], 0
 v_exp_f32 v15, v15
 v_mfma_f32_16x16x32_bf16 v[4:7], a[184:187], a[152:155], v[4:7]
 v_cvt_pk_bf16_f32 v39, v14, v15
 v_fma_f32 v17, v17, s24, v42
 v_mfma_f32_16x16x32_bf16 v[4:7], a[180:183], a[148:151], v[4:7]
 v_exp_f32 v16, v16
 v_mfma_f32_16x16x32_bf16 v[4:7], a[176:179], a[144:147], v[4:7]
 v_exp_f32 v17, v17
 v_smfmac_f32_16x16x64_bf16 a[224:227], a[236:239], v[32:39], v55
 v_cvt_pk_bf16_f32 v24, v16, v17
 v_mfma_f32_16x16x32_bf16 v[96:99], a[192:195], v[36:39], v[96:99]
 v_fma_f32 v18, v18, s24, v42
 v_fma_f32 v19, v19, s24, v42
 v_mfma_f32_16x16x32_bf16 v[100:103], a[196:199], v[36:39], v[100:103]
 v_exp_f32 v18, v18
 v_mfma_f32_16x16x32_bf16 v[104:107], a[200:203], v[36:39], v[104:107]
 v_exp_f32 v19, v19
 v_mfma_f32_16x16x32_bf16 v[108:111], a[204:207], v[36:39], v[108:111]
 v_cvt_pk_bf16_f32 v25, v18, v19
 v_fma_f32 v20, v20, s24, v42
 v_mfma_f32_16x16x32_bf16 v[112:115], a[208:211], v[36:39], v[112:115]
 v_fma_f32 v21, v21, s24, v42
 v_fma_f32 v22, v22, s24, v42
 v_mfma_f32_16x16x32_bf16 v[116:119], a[212:215], v[36:39], v[116:119]
 v_exp_f32 v20, v20
 v_mfma_f32_16x16x32_bf16 v[120:123], a[216:219], v[36:39], v[120:123]
 v_exp_f32 v21, v21
 v_mfma_f32_16x16x32_bf16 v[124:127], a[220:223], v[36:39], v[124:127]
 v_cvt_pk_bf16_f32 v26, v20, v21
 v_fma_f32 v23, v23, s24, v42
 v_mfma_f32_16x16x32_bf16 v[8:11], a[160:163], a[0:3], 0
 v_exp_f32 v22, v22
 v_mfma_f32_16x16x32_bf16 v[8:11], a[164:167], a[4:7], v[8:11]
 v_exp_f32 v23, v23
 v_mfma_f32_16x16x32_bf16 v[8:11], a[168:171], a[8:11], v[8:11]
 v_cvt_pk_bf16_f32 v27, v22, v23
 v_fma_f32 v0, v0, s24, v43
 v_mfma_f32_16x16x32_bf16 v[8:11], a[172:175], a[12:15], v[8:11]
 v_fma_f32 v1, v1, s24, v43
 v_fma_f32 v2, v2, s24, v43
 v_mfma_f32_16x16x32_bf16 v[12:15], a[188:191], a[12:15], 0
 v_exp_f32 v0, v0
 v_mfma_f32_16x16x32_bf16 v[12:15], a[184:187], a[8:11], v[12:15]
 v_exp_f32 v1, v1
 v_mfma_f32_16x16x32_bf16 v[12:15], a[180:183], a[4:7], v[12:15]
 v_cvt_pk_bf16_f32 v28, v0, v1
 v_fma_f32 v3, v3, s24, v43
 v_mfma_f32_16x16x32_bf16 v[12:15], a[176:179], a[0:3], v[12:15]
 v_exp_f32 v2, v2
 v_mfma_f32_16x16x32_bf16 v[128:131], a[192:195], v[24:27], v[128:131]
 v_exp_f32 v3, v3
 v_mfma_f32_16x16x32_bf16 v[132:135], a[196:199], v[24:27], v[132:135]
 v_cvt_pk_bf16_f32 v29, v2, v3
 v_fma_f32 v4, v4, s24, v43
 v_mfma_f32_16x16x32_bf16 v[136:139], a[200:203], v[24:27], v[136:139]
 v_fma_f32 v5, v5, s24, v43
 v_fma_f32 v6, v6, s24, v43
 v_mfma_f32_16x16x32_bf16 v[140:143], a[204:207], v[24:27], v[140:143]
 v_exp_f32 v4, v4
 v_mfma_f32_16x16x32_bf16 v[144:147], a[208:211], v[24:27], v[144:147]
 v_exp_f32 v5, v5
 v_mfma_f32_16x16x32_bf16 v[148:151], a[212:215], v[24:27], v[148:151]
 v_cvt_pk_bf16_f32 v30, v4, v5
 v_fma_f32 v7, v7, s24, v43
 v_mfma_f32_16x16x32_bf16 v[152:155], a[216:219], v[24:27], v[152:155]
 v_exp_f32 v6, v6
 v_mfma_f32_16x16x32_bf16 v[156:159], a[220:223], v[24:27], v[156:159]
 v_exp_f32 v7, v7
 v_mfma_f32_16x16x32_bf16 v[16:19], a[160:163], a[16:19], 0
 ds_read_b128 a[160:163], v46 offset:24576
 v_cvt_pk_bf16_f32 v31, v6, v7
 v_mfma_f32_16x16x32_bf16 v[16:19], a[164:167], a[20:23], v[16:19]
 v_fma_f32 v8, v8, s24, v44
 v_fma_f32 v9, v9, s24, v44
 v_mfma_f32_16x16x32_bf16 v[16:19], a[168:171], a[24:27], v[16:19]
 ds_read_b128 a[164:167], v47 offset:24576
 v_fma_f32 v10, v10, s24, v44
 v_mfma_f32_16x16x32_bf16 v[16:19], a[172:175], a[28:31], v[16:19]
 v_exp_f32 v8, v8
 v_mfma_f32_16x16x32_bf16 v[20:23], a[188:191], a[28:31], 0
 ds_read_b128 a[168:171], v46 offset:25600
 v_fma_f32 v11, v11, s24, v44
 v_mfma_f32_16x16x32_bf16 v[20:23], a[184:187], a[24:27], v[20:23]
 v_exp_f32_e64 v9, v9
 v_mfma_f32_16x16x32_bf16 v[20:23], a[180:183], a[20:23], v[20:23]
 buffer_store_dwordx4 a[60:63], v58, s[20:23], s31 offen offset:2176 sc0 sc1 nt
 ds_read_b128 a[172:175], v47 offset:25600
 v_cvt_pk_bf16_f32 v32, v8, v9
 v_fma_f32 v12, v12, s24, v44
 v_mfma_f32_16x16x32_bf16 v[20:23], a[176:179], a[16:19], v[20:23]
 s_addk_i32 s31, 4096
 v_exp_f32 v10, v10
 v_smfmac_f32_16x16x64_bf16 a[228:231], a[236:239], v[24:31], v55
 ds_read_b128 a[188:191], v47 offset:29696
 v_mfma_f32_16x16x32_bf16 v[160:163], a[192:195], v[28:31], v[160:163]
 v_exp_f32 v11, v11
 v_mfma_f32_16x16x32_bf16 v[164:167], a[196:199], v[28:31], v[164:167]
 ds_read_b128 a[184:187], v46 offset:29696
 v_cvt_pk_bf16_f32 v33, v10, v11
 v_mfma_f32_16x16x32_bf16 v[168:171], a[200:203], v[28:31], v[168:171]
 v_fma_f32 v13, v13, s24, v44
 v_fma_f32 v14, v14, s24, v44
 v_mfma_f32_16x16x32_bf16 v[172:175], a[204:207], v[28:31], v[172:175]
 ds_read_b128 a[180:183], v47 offset:28672
 v_fma_f32 v15, v15, s24, v44
 v_mfma_f32_16x16x32_bf16 v[176:179], a[208:211], v[28:31], v[176:179]
 v_exp_f32 v12, v12
 v_mfma_f32_16x16x32_bf16 v[180:183], a[212:215], v[28:31], v[180:183]
 ds_read_b128 a[176:179], v46 offset:28672
 v_fma_f32 v16, v16, s24, v45
 v_mfma_f32_16x16x32_bf16 v[184:187], a[216:219], v[28:31], v[184:187]
 v_exp_f32 v13, v13
 v_mfma_f32_16x16x32_bf16 v[188:191], a[220:223], v[28:31], v[188:191]
 s_waitcnt lgkmcnt(3)
 v_cvt_pk_bf16_f32 v34, v12, v13
 v_fma_f32 v17, v17, s24, v45
 v_mfma_f32_16x16x32_bf16 v[0:3], a[160:163], a[96:99], 0
 v_exp_f32 v14, v14
 v_mfma_f32_16x16x32_bf16 v[0:3], a[164:167], a[100:103], v[0:3]
 v_exp_f32 v15, v15
 v_mfma_f32_16x16x32_bf16 v[0:3], a[168:171], a[104:107], v[0:3]
 v_cvt_pk_bf16_f32 v35, v14, v15
 v_fma_f32 v18, v18, s24, v45
 v_mfma_f32_16x16x32_bf16 v[0:3], a[172:175], a[108:111], v[0:3]
 v_exp_f32 v16, v16
 v_mfma_f32_16x16x32_bf16 v[4:7], a[188:191], a[108:111], 0
 s_waitcnt lgkmcnt(0)
 v_exp_f32 v17, v17
 v_mfma_f32_16x16x32_bf16 v[4:7], a[184:187], a[104:107], v[4:7]
 v_cvt_pk_bf16_f32 v36, v16, v17
 v_fma_f32 v19, v19, s24, v45
 v_mfma_f32_16x16x32_bf16 v[4:7], a[180:183], a[100:103], v[4:7]
 v_exp_f32 v18, v18
 v_mfma_f32_16x16x32_bf16 v[4:7], a[176:179], a[96:99], v[4:7]
 v_exp_f32 v19, v19
 v_mfma_f32_16x16x32_bf16 v[192:195], a[192:195], v[32:35], v[192:195]
 v_cvt_pk_bf16_f32 v37, v18, v19
 v_fma_f32 v20, v20, s24, v45
 v_mfma_f32_16x16x32_bf16 v[196:199], a[196:199], v[32:35], v[196:199]
 v_fma_f32 v21, v21, s24, v45
 v_fma_f32 v22, v22, s24, v45
 v_mfma_f32_16x16x32_bf16 v[200:203], a[200:203], v[32:35], v[200:203]
 v_exp_f32 v20, v20
 v_mfma_f32_16x16x32_bf16 v[204:207], a[204:207], v[32:35], v[204:207]
 buffer_load_dwordx4 v54, s[12:15], s29 offen offset:0 nt lds
 v_mfma_f32_16x16x32_bf16 v[208:211], a[208:211], v[32:35], v[208:211]
 v_exp_f32 v21, v21
 v_mfma_f32_16x16x32_bf16 v[212:215], a[212:215], v[32:35], v[212:215]
 v_cvt_pk_bf16_f32 v38, v20, v21
 v_fma_f32 v23, v23, s24, v45
 v_mfma_f32_16x16x32_bf16 v[216:219], a[216:219], v[32:35], v[216:219]
 v_exp_f32 v22, v22
 v_mfma_f32_16x16x32_bf16 v[220:223], a[220:223], v[32:35], v[220:223]
 v_exp_f32 v23, v23
 v_mfma_f32_16x16x32_bf16 v[8:11], a[160:163], a[112:115], 0
 v_cvt_pk_bf16_f32 v39, v22, v23
 v_fma_f32 v0, v0, s24, v63
 v_mfma_f32_16x16x32_bf16 v[8:11], a[164:167], a[116:119], v[8:11]
 v_fma_f32 v1, v1, s24, v63
 v_fma_f32 v2, v2, s24, v63
 v_mfma_f32_16x16x32_bf16 v[8:11], a[168:171], a[120:123], v[8:11]
 v_exp_f32 v0, v0
 v_mfma_f32_16x16x32_bf16 v[8:11], a[172:175], a[124:127], v[8:11]
 v_exp_f32 v1, v1
 v_mfma_f32_16x16x32_bf16 v[12:15], a[188:191], a[124:127], 0
 v_cvt_pk_bf16_f32 v24, v0, v1
 v_fma_f32 v3, v3, s24, v63
 v_mfma_f32_16x16x32_bf16 v[12:15], a[184:187], a[120:123], v[12:15]
 v_exp_f32 v2, v2
 v_mfma_f32_16x16x32_bf16 v[12:15], a[180:183], a[116:119], v[12:15]
 v_exp_f32 v3, v3
 v_mfma_f32_16x16x32_bf16 v[12:15], a[176:179], a[112:115], v[12:15]
 buffer_load_dwordx4 v54, s[12:15], s29 offen offset:2048 nt lds
 v_smfmac_f32_16x16x64_bf16 a[232:235], a[236:239], v[32:39], v55
 s_add_u32 m0, s26, 65536
 v_cvt_pk_bf16_f32 v25, v2, v3
 v_mfma_f32_16x16x32_bf16 v[224:227], a[192:195], v[36:39], v[224:227]
 ds_read_b64_tr_b16 a[192:193], v48 offset:24576
 ds_read_b64_tr_b16 a[194:195], v48 offset:28672
 v_mfma_f32_16x16x32_bf16 v[228:231], a[196:199], v[36:39], v[228:231]
 v_fma_f32 v4, v4, s24, v63
 v_fma_f32 v5, v5, s24, v63
 v_mfma_f32_16x16x32_bf16 v[232:235], a[200:203], v[36:39], v[232:235]
 ds_read_b64_tr_b16 a[196:197], v49 offset:24576
 ds_read_b64_tr_b16 a[198:199], v49 offset:28672
 v_mfma_f32_16x16x32_bf16 v[236:239], a[204:207], v[36:39], v[236:239]
 v_exp_f32 v4, v4
 v_mfma_f32_16x16x32_bf16 v[240:243], a[208:211], v[36:39], v[240:243]
 ds_read_b64_tr_b16 a[200:201], v50 offset:24576
 ds_read_b64_tr_b16 a[202:203], v50 offset:28672
 v_mfma_f32_16x16x32_bf16 v[244:247], a[212:215], v[36:39], v[244:247]
 v_exp_f32_e64 v5, v5
 v_mfma_f32_16x16x32_bf16 v[248:251], a[216:219], v[36:39], v[248:251]
 ds_read_b64_tr_b16 a[204:205], v51 offset:24576
 ds_read_b64_tr_b16 a[206:207], v51 offset:28672
 v_mfma_f32_16x16x32_bf16 v[252:255], a[220:223], v[36:39], v[252:255]
 v_cvt_pk_bf16_f32 v26, v4, v5
 v_fma_f32 v6, v6, s24, v63
 v_mfma_f32_16x16x32_bf16 v[16:19], a[160:163], a[128:131], 0
 ds_read_b64_tr_b16 a[208:209], v48 offset:25600
 ds_read_b64_tr_b16 a[210:211], v48 offset:29696
 v_mfma_f32_16x16x32_bf16 v[16:19], a[164:167], a[132:135], v[16:19]
 buffer_store_dwordx4 a[64:67], v58, s[20:23], s31 offen offset:0 sc0 sc1 nt
 ds_read_b64_tr_b16 a[212:213], v49 offset:25600
 v_fma_f32 v7, v7, s24, v63
 v_fma_f32 v8, v8, s24, v41
 v_mfma_f32_16x16x32_bf16 v[16:19], a[168:171], a[136:139], v[16:19]
 v_exp_f32 v6, v6
 v_mfma_f32_16x16x32_bf16 v[16:19], a[172:175], a[140:143], v[16:19]
 buffer_load_dwordx4 v54, s[16:19], s29 offen offset:0 nt lds
 v_mfma_f32_16x16x32_bf16 v[20:23], a[188:191], a[140:143], 0
 ds_read_b64_tr_b16 a[214:215], v49 offset:29696
 ds_read_b64_tr_b16 a[216:217], v50 offset:25600
 v_mfma_f32_16x16x32_bf16 v[20:23], a[184:187], a[136:139], v[20:23]
 ds_read_b64_tr_b16 a[218:219], v50 offset:29696
 v_exp_f32 v7, v7
 v_mfma_f32_16x16x32_bf16 v[20:23], a[180:183], a[132:135], v[20:23]
 ds_read_b64_tr_b16 a[220:221], v51 offset:25600
 ds_read_b64_tr_b16 a[222:223], v51 offset:29696
 v_cvt_pk_bf16_f32 v27, v6, v7
 v_mfma_f32_16x16x32_bf16 v[20:23], a[176:179], a[128:131], v[20:23]
 s_waitcnt lgkmcnt(6)
 v_fma_f32 v9, v9, s24, v41
 v_fma_f32 v10, v10, s24, v41
 v_mfma_f32_16x16x32_bf16 v[64:67], a[192:195], v[24:27], v[64:67]
 v_exp_f32 v8, v8
 v_mfma_f32_16x16x32_bf16 v[68:71], a[196:199], v[24:27], v[68:71]
 v_exp_f32 v9, v9
 v_mfma_f32_16x16x32_bf16 v[72:75], a[200:203], v[24:27], v[72:75]
 v_cvt_pk_bf16_f32 v28, v8, v9
 v_fma_f32 v11, v11, s24, v41
 v_mfma_f32_16x16x32_bf16 v[76:79], a[204:207], v[24:27], v[76:79]
 v_exp_f32 v10, v10
 v_mfma_f32_16x16x32_bf16 v[80:83], a[208:211], v[24:27], v[80:83]
 s_waitcnt lgkmcnt(2)
 v_exp_f32 v11, v11
 v_mfma_f32_16x16x32_bf16 v[84:87], a[212:215], v[24:27], v[84:87]
 v_cvt_pk_bf16_f32 v29, v10, v11
 v_fma_f32 v12, v12, s24, v41
 v_mfma_f32_16x16x32_bf16 v[88:91], a[216:219], v[24:27], v[88:91]
 s_waitcnt lgkmcnt(0)
 buffer_load_dwordx4 v54, s[16:19], s29 offen offset:2048 nt lds
 v_mfma_f32_16x16x32_bf16 v[92:95], a[220:223], v[24:27], v[92:95]
 s_add_u32 m0, s26, 8192
 v_fma_f32 v13, v13, s24, v41
 v_fma_f32 v14, v14, s24, v41
 v_mfma_f32_16x16x32_bf16 v[0:3], a[160:163], a[144:147], 0
 s_addk_i32 s29, 8192
 v_exp_f32 v12, v12
 v_mfma_f32_16x16x32_bf16 v[0:3], a[164:167], a[148:151], v[0:3]
 v_exp_f32 v13, v13
 v_mfma_f32_16x16x32_bf16 v[0:3], a[168:171], a[152:155], v[0:3]
 v_cvt_pk_bf16_f32 v30, v12, v13
 v_fma_f32 v15, v15, s24, v41
 v_mfma_f32_16x16x32_bf16 v[0:3], a[172:175], a[156:159], v[0:3]
 v_exp_f32 v14, v14
 v_mfma_f32_16x16x32_bf16 v[4:7], a[188:191], a[156:159], 0
 v_exp_f32 v15, v15
 v_mfma_f32_16x16x32_bf16 v[4:7], a[184:187], a[152:155], v[4:7]
 v_cvt_pk_bf16_f32 v31, v14, v15
 v_fma_f32 v16, v16, s24, v42
 v_mfma_f32_16x16x32_bf16 v[4:7], a[180:183], a[148:151], v[4:7]
 v_fma_f32 v17, v17, s24, v42
 v_fma_f32 v18, v18, s24, v42
 v_mfma_f32_16x16x32_bf16 v[4:7], a[176:179], a[144:147], v[4:7]
 v_exp_f32 v16, v16
 v_smfmac_f32_16x16x64_bf16 a[224:227], a[236:239], v[24:31], v55
 v_fma_f32 v19, v19, s24, v42
 v_mfma_f32_16x16x32_bf16 v[96:99], a[192:195], v[28:31], v[96:99]
 v_exp_f32 v17, v17
 v_mfma_f32_16x16x32_bf16 v[100:103], a[196:199], v[28:31], v[100:103]
 v_cvt_pk_bf16_f32 v32, v16, v17
 v_fma_f32 v20, v20, s24, v42
 v_mfma_f32_16x16x32_bf16 v[104:107], a[200:203], v[28:31], v[104:107]
 v_exp_f32 v18, v18
 v_mfma_f32_16x16x32_bf16 v[108:111], a[204:207], v[28:31], v[108:111]
 v_exp_f32 v19, v19
 v_mfma_f32_16x16x32_bf16 v[112:115], a[208:211], v[28:31], v[112:115]
 v_cvt_pk_bf16_f32 v33, v18, v19
 v_fma_f32 v21, v21, s24, v42
 v_mfma_f32_16x16x32_bf16 v[116:119], a[212:215], v[28:31], v[116:119]
 v_exp_f32 v20, v20
 v_mfma_f32_16x16x32_bf16 v[120:123], a[216:219], v[28:31], v[120:123]
 v_exp_f32 v21, v21
 v_mfma_f32_16x16x32_bf16 v[124:127], a[220:223], v[28:31], v[124:127]
 v_cvt_pk_bf16_f32 v34, v20, v21
 v_fma_f32 v22, v22, s24, v42
 v_mfma_f32_16x16x32_bf16 v[8:11], a[160:163], a[0:3], 0
 v_fma_f32 v23, v23, s24, v42
 v_fma_f32 v0, v0, s24, v43
 v_mfma_f32_16x16x32_bf16 v[8:11], a[164:167], a[4:7], v[8:11]
 v_exp_f32 v22, v22
 v_mfma_f32_16x16x32_bf16 v[8:11], a[168:171], a[8:11], v[8:11]
 v_exp_f32 v23, v23
 v_mfma_f32_16x16x32_bf16 v[8:11], a[172:175], a[12:15], v[8:11]
 v_cvt_pk_bf16_f32 v35, v22, v23
 v_fma_f32 v1, v1, s24, v43
 v_mfma_f32_16x16x32_bf16 v[12:15], a[188:191], a[12:15], 0
 v_exp_f32 v0, v0
 v_mfma_f32_16x16x32_bf16 v[12:15], a[184:187], a[8:11], v[12:15]
 v_exp_f32 v1, v1
 v_mfma_f32_16x16x32_bf16 v[12:15], a[180:183], a[4:7], v[12:15]
 v_cvt_pk_bf16_f32 v36, v0, v1
 v_fma_f32 v2, v2, s24, v43
 v_mfma_f32_16x16x32_bf16 v[12:15], a[176:179], a[0:3], v[12:15]
 v_fma_f32 v3, v3, s24, v43
 v_fma_f32 v4, v4, s24, v43
 v_mfma_f32_16x16x32_bf16 v[128:131], a[192:195], v[32:35], v[128:131]
 buffer_store_dwordx4 a[72:75], v58, s[20:23], s31 offen offset:2048 sc0 sc1 nt
 v_exp_f32 v2, v2
 v_fma_f32 v5, v5, s24, v43
 v_mfma_f32_16x16x32_bf16 v[132:135], a[196:199], v[32:35], v[132:135]
 v_exp_f32 v3, v3
 v_mfma_f32_16x16x32_bf16 v[136:139], a[200:203], v[32:35], v[136:139]
 v_cvt_pk_bf16_f32 v37, v2, v3
 v_fma_f32 v6, v6, s24, v43
 v_mfma_f32_16x16x32_bf16 v[140:143], a[204:207], v[32:35], v[140:143]
 v_exp_f32 v4, v4
 v_mfma_f32_16x16x32_bf16 v[144:147], a[208:211], v[32:35], v[144:147]
 v_exp_f32 v5, v5
 v_mfma_f32_16x16x32_bf16 v[148:151], a[212:215], v[32:35], v[148:151]
 v_cvt_pk_bf16_f32 v38, v4, v5
 v_fma_f32 v7, v7, s24, v43
 v_mfma_f32_16x16x32_bf16 v[152:155], a[216:219], v[32:35], v[152:155]
 s_waitcnt vmcnt(14)
 v_exp_f32 v6, v6
 v_mfma_f32_16x16x32_bf16 v[156:159], a[220:223], v[32:35], v[156:159]
 s_barrier
 v_exp_f32 v7, v7
 v_mfma_f32_16x16x32_bf16 v[16:19], a[160:163], a[16:19], 0
 ds_read_b128 a[160:163], v46 offset:40960
 v_cvt_pk_bf16_f32 v39, v6, v7
 v_mfma_f32_16x16x32_bf16 v[16:19], a[164:167], a[20:23], v[16:19]
 v_fma_f32 v8, v8, s24, v44
 v_fma_f32 v9, v9, s24, v44
 v_mfma_f32_16x16x32_bf16 v[16:19], a[168:171], a[24:27], v[16:19]
 ds_read_b128 a[164:167], v47 offset:40960
 v_fma_f32 v10, v10, s24, v44
 v_mfma_f32_16x16x32_bf16 v[16:19], a[172:175], a[28:31], v[16:19]
 v_exp_f32 v8, v8
 v_mfma_f32_16x16x32_bf16 v[20:23], a[188:191], a[28:31], 0
 ds_read_b128 a[168:171], v46 offset:41984
 v_fma_f32 v11, v11, s24, v44
 v_mfma_f32_16x16x32_bf16 v[20:23], a[184:187], a[24:27], v[20:23]
 v_exp_f32 v9, v9
 v_mfma_f32_16x16x32_bf16 v[20:23], a[180:183], a[20:23], v[20:23]
 ds_read_b128 a[172:175], v47 offset:41984
 v_cvt_pk_bf16_f32 v24, v8, v9
 v_mfma_f32_16x16x32_bf16 v[20:23], a[176:179], a[16:19], v[20:23]
 v_exp_f32 v10, v10
 v_smfmac_f32_16x16x64_bf16 a[228:231], a[236:239], v[32:39], v55
 ds_read_b128 a[188:191], v47 offset:46080
 v_mfma_f32_16x16x32_bf16 v[160:163], a[192:195], v[36:39], v[160:163]
 v_exp_f32 v11, v11
 v_mfma_f32_16x16x32_bf16 v[164:167], a[196:199], v[36:39], v[164:167]
 ds_read_b128 a[184:187], v46 offset:46080
 v_cvt_pk_bf16_f32 v25, v10, v11
 v_mfma_f32_16x16x32_bf16 v[168:171], a[200:203], v[36:39], v[168:171]
 v_fma_f32 v12, v12, s24, v44
 v_fma_f32 v13, v13, s24, v44
 v_mfma_f32_16x16x32_bf16 v[172:175], a[204:207], v[36:39], v[172:175]
 ds_read_b128 a[180:183], v47 offset:45056
 v_fma_f32 v14, v14, s24, v44
 v_mfma_f32_16x16x32_bf16 v[176:179], a[208:211], v[36:39], v[176:179]
 v_exp_f32 v12, v12
 v_mfma_f32_16x16x32_bf16 v[180:183], a[212:215], v[36:39], v[180:183]
 ds_read_b128 a[176:179], v46 offset:45056
 v_fma_f32 v15, v15, s24, v44
 v_mfma_f32_16x16x32_bf16 v[184:187], a[216:219], v[36:39], v[184:187]
 v_exp_f32 v13, v13
 v_mfma_f32_16x16x32_bf16 v[188:191], a[220:223], v[36:39], v[188:191]
 s_waitcnt lgkmcnt(3)
 v_cvt_pk_bf16_f32 v26, v12, v13
 v_fma_f32 v16, v16, s24, v45
 v_mfma_f32_16x16x32_bf16 v[0:3], a[160:163], a[96:99], 0
L_stub10:
 s_cbranch_vccnz L_stub14
.if ((L_stub10-L_main)>>6) != 640
.error "stub misplaced"
.endif
 v_exp_f32 v14, v14
 v_mfma_f32_16x16x32_bf16 v[0:3], a[164:167], a[100:103], v[0:3]
 v_exp_f32 v15, v15
 v_mfma_f32_16x16x32_bf16 v[0:3], a[168:171], a[104:107], v[0:3]
 v_cvt_pk_bf16_f32 v27, v14, v15
 v_fma_f32 v17, v17, s24, v45
 v_mfma_f32_16x16x32_bf16 v[0:3], a[172:175], a[108:111], v[0:3]
 v_exp_f32 v16, v16
 v_mfma_f32_16x16x32_bf16 v[4:7], a[188:191], a[108:111], 0
 s_waitcnt lgkmcnt(0)
 v_exp_f32 v17, v17
 v_mfma_f32_16x16x32_bf16 v[4:7], a[184:187], a[104:107], v[4:7]
 v_cvt_pk_bf16_f32 v28, v16, v17
 v_fma_f32 v18, v18, s24, v45
 v_mfma_f32_16x16x32_bf16 v[4:7], a[180:183], a[100:103], v[4:7]
 v_fma_f32 v19, v19, s24, v45
 v_fma_f32 v20, v20, s24, v45
 v_mfma_f32_16x16x32_bf16 v[4:7], a[176:179], a[96:99], v[4:7]
 v_exp_f32 v18, v18
 v_mfma_f32_16x16x32_bf16 v[192:195], a[192:195], v[24:27], v[192:195]
 v_exp_f32 v19, v19
 v_mfma_f32_16x16x32_bf16 v[196:199], a[196:199], v[24:27], v[196:199]
 v_cvt_pk_bf16_f32 v29, v18, v19
 v_fma_f32 v21, v21, s24, v45
 v_mfma_f32_16x16x32_bf16 v[200:203], a[200:203], v[24:27], v[200:203]
 v_exp_f32 v20, v20
 v_mfma_f32_16x16x32_bf16 v[204:207], a[204:207], v[24:27], v[204:207]
 buffer_load_dwordx4 v54, s[12:15], s29 offen offset:0 nt lds
 v_mfma_f32_16x16x32_bf16 v[208:211], a[208:211], v[24:27], v[208:211]
 v_exp_f32 v21, v21
 v_mfma_f32_16x16x32_bf16 v[212:215], a[212:215], v[24:27], v[212:215]
 v_cvt_pk_bf16_f32 v30, v20, v21
 v_fma_f32 v22, v22, s24, v45
 v_mfma_f32_16x16x32_bf16 v[216:219], a[216:219], v[24:27], v[216:219]
 v_fma_f32 v23, v23, s24, v45
 v_fma_f32 v0, v0, s24, v63
 v_mfma_f32_16x16x32_bf16 v[220:223], a[220:223], v[24:27], v[220:223]
 buffer_store_dwordx4 a[68:71], v58, s[20:23], s31 offen offset:128 sc0 sc1 nt
 v_exp_f32 v22, v22
 v_fma_f32 v1, v1, s24, v63
 v_mfma_f32_16x16x32_bf16 v[8:11], a[160:163], a[112:115], 0
 v_exp_f32 v23, v23
 v_mfma_f32_16x16x32_bf16 v[8:11], a[164:167], a[116:119], v[8:11]
 v_cvt_pk_bf16_f32 v31, v22, v23
 v_fma_f32 v2, v2, s24, v63
 v_mfma_f32_16x16x32_bf16 v[8:11], a[168:171], a[120:123], v[8:11]
 v_exp_f32 v0, v0
 v_mfma_f32_16x16x32_bf16 v[8:11], a[172:175], a[124:127], v[8:11]
 v_exp_f32 v1, v1
 v_mfma_f32_16x16x32_bf16 v[12:15], a[188:191], a[124:127], 0
 v_cvt_pk_bf16_f32 v32, v0, v1
 v_fma_f32 v3, v3, s24, v63
 v_mfma_f32_16x16x32_bf16 v[12:15], a[184:187], a[120:123], v[12:15]
 v_exp_f32 v2, v2
 v_mfma_f32_16x16x32_bf16 v[12:15], a[180:183], a[116:119], v[12:15]
 v_exp_f32 v3, v3
 v_mfma_f32_16x16x32_bf16 v[12:15], a[176:179], a[112:115], v[12:15]
 buffer_load_dwordx4 v54, s[12:15], s29 offen offset:2048 nt lds
 v_smfmac_f32_16x16x64_bf16 a[232:235], a[236:239], v[24:31], v55
 s_add_u32 m0, s26, 73728
 v_cvt_pk_bf16_f32 v33, v2, v3
 v_mfma_f32_16x16x32_bf16 v[224:227], a[192:195], v[28:31], v[224:227]
 ds_read_b64_tr_b16 a[192:193], v48 offset:40960
 ds_read_b64_tr_b16 a[194:195], v48 offset:45056
 v_mfma_f32_16x16x32_bf16 v[228:231], a[196:199], v[28:31], v[228:231]
 v_fma_f32 v4, v4, s24, v63
 v_fma_f32 v5, v5, s24, v63
 v_mfma_f32_16x16x32_bf16 v[232:235], a[200:203], v[28:31], v[232:235]
 ds_read_b64_tr_b16 a[196:197], v49 offset:40960
 ds_read_b64_tr_b16 a[198:199], v49 offset:45056
 v_mfma_f32_16x16x32_bf16 v[236:239], a[204:207], v[28:31], v[236:239]
 v_exp_f32 v4, v4
 v_mfma_f32_16x16x32_bf16 v[240:243], a[208:211], v[28:31], v[240:243]
 ds_read_b64_tr_b16 a[200:201], v50 offset:40960
 ds_read_b64_tr_b16 a[202:203], v50 offset:45056
 v_mfma_f32_16x16x32_bf16 v[244:247], a[212:215], v[28:31], v[244:247]
 v_exp_f32 v5, v5
 v_mfma_f32_16x16x32_bf16 v[248:251], a[216:219], v[28:31], v[248:251]
 ds_read_b64_tr_b16 a[204:205], v51 offset:40960
 ds_read_b64_tr_b16 a[206:207], v51 offset:45056
 v_mfma_f32_16x16x32_bf16 v[252:255], a[220:223], v[28:31], v[252:255]
 v_cvt_pk_bf16_f32 v34, v4, v5
 v_fma_f32 v6, v6, s24, v63
 v_mfma_f32_16x16x32_bf16 v[16:19], a[160:163], a[128:131], 0
 ds_read_b64_tr_b16 a[208:209], v48 offset:41984
 ds_read_b64_tr_b16 a[210:211], v48 offset:46080
 v_mfma_f32_16x16x32_bf16 v[16:19], a[164:167], a[132:135], v[16:19]
 v_fma_f32 v7, v7, s24, v63
 v_fma_f32 v8, v8, s24, v41
 v_mfma_f32_16x16x32_bf16 v[16:19], a[168:171], a[136:139], v[16:19]
 buffer_load_dwordx4 v54, s[16:19], s29 offen offset:0 nt lds
 v_mfma_f32_16x16x32_bf16 v[16:19], a[172:175], a[140:143], v[16:19]
 ds_read_b64_tr_b16 a[212:213], v49 offset:41984
 ds_read_b64_tr_b16 a[214:215], v49 offset:46080
 v_mfma_f32_16x16x32_bf16 v[20:23], a[188:191], a[140:143], 0
 v_exp_f32 v6, v6
 v_mfma_f32_16x16x32_bf16 v[20:23], a[184:187], a[136:139], v[20:23]
 ds_read_b64_tr_b16 a[216:217], v50 offset:41984
 ds_read_b64_tr_b16 a[218:219], v50 offset:46080
 v_exp_f32 v7, v7
 v_mfma_f32_16x16x32_bf16 v[20:23], a[180:183], a[132:135], v[20:23]
 ds_read_b64_tr_b16 a[220:221], v51 offset:41984
 ds_read_b64_tr_b16 a[222:223], v51 offset:46080
 v_cvt_pk_bf16_f32 v35, v6, v7
 v_mfma_f32_16x16x32_bf16 v[20:23], a[176:179], a[128:131], v[20:23]
 s_waitcnt lgkmcnt(6)
 v_fma_f32 v9, v9, s24, v41
 v_fma_f32 v10, v10, s24, v41
 v_mfma_f32_16x16x32_bf16 v[64:67], a[192:195], v[32:35], v[64:67]
 v_exp_f32 v8, v8
 v_mfma_f32_16x16x32_bf16 v[68:71], a[196:199], v[32:35], v[68:71]
 v_exp_f32 v9, v9
 v_mfma_f32_16x16x32_bf16 v[72:75], a[200:203], v[32:35], v[72:75]
 v_cvt_pk_bf16_f32 v36, v8, v9
 v_fma_f32 v11, v11, s24, v41
 v_mfma_f32_16x16x32_bf16 v[76:79], a[204:207], v[32:35], v[76:79]
 v_exp_f32 v10, v10
 v_mfma_f32_16x16x32_bf16 v[80:83], a[208:211], v[32:35], v[80:83]
 s_waitcnt lgkmcnt(2)
 v_exp_f32 v11, v11
 v_mfma_f32_16x16x32_bf16 v[84:87], a[212:215], v[32:35], v[84:87]
 v_cvt_pk_bf16_f32 v37, v10, v11
 v_fma_f32 v12, v12, s24, v41
 v_mfma_f32_16x16x32_bf16 v[88:91], a[216:219], v[32:35], v[88:91]
 s_waitcnt lgkmcnt(0)
 buffer_load_dwordx4 v54, s[16:19], s29 offen offset:2048 nt lds
 v_mfma_f32_16x16x32_bf16 v[92:95], a[220:223], v[32:35], v[92:95]
 s_add_u32 m0, s26, 16384
 v_fma_f32 v13, v13, s24, v41
 v_fma_f32 v14, v14, s24, v41
 v_mfma_f32_16x16x32_bf16 v[0:3], a[160:163], a[144:147], 0
 s_addk_i32 s29, 8192
 v_exp_f32 v12, v12
 v_mfma_f32_16x16x32_bf16 v[0:3], a[164:167], a[148:151], v[0:3]
 v_exp_f32 v13, v13
 v_mfma_f32_16x16x32_bf16 v[0:3], a[168:171], a[152:155], v[0:3]
 v_cvt_pk_bf16_f32 v38, v12, v13
 v_fma_f32 v15, v15, s24, v41
 v_mfma_f32_16x16x32_bf16 v[0:3], a[172:175], a[156:159], v[0:3]
 v_exp_f32 v14, v14
 v_mfma_f32_16x16x32_bf16 v[4:7], a[188:191], a[156:159], 0
 v_exp_f32 v15, v15
 v_mfma_f32_16x16x32_bf16 v[4:7], a[184:187], a[152:155], v[4:7]
 v_cvt_pk_bf16_f32 v39, v14, v15
 v_fma_f32 v16, v16, s24, v42
 v_mfma_f32_16x16x32_bf16 v[4:7], a[180:183], a[148:151], v[4:7]
 buffer_store_dwordx4 a[76:79], v58, s[20:23], s31 offen offset:2176 sc0 sc1 nt
 v_fma_f32 v17, v17, s24, v42
 v_exp_f32 v16, v16
 v_mfma_f32_16x16x32_bf16 v[4:7], a[176:179], a[144:147], v[4:7]
 s_addk_i32 s31, 4096
 v_exp_f32 v17, v17
 v_smfmac_f32_16x16x64_bf16 a[224:227], a[236:239], v[32:39], v55
 v_cvt_pk_bf16_f32 v24, v16, v17
 v_mfma_f32_16x16x32_bf16 v[96:99], a[192:195], v[36:39], v[96:99]
 v_fma_f32 v18, v18, s24, v42
 v_fma_f32 v19, v19, s24, v42
 v_mfma_f32_16x16x32_bf16 v[100:103], a[196:199], v[36:39], v[100:103]
 v_exp_f32 v18, v18
 v_mfma_f32_16x16x32_bf16 v[104:107], a[200:203], v[36:39], v[104:107]
 v_exp_f32 v19, v19
 v_mfma_f32_16x16x32_bf16 v[108:111], a[204:207], v[36:39], v[108:111]
 v_cvt_pk_bf16_f32 v25, v18, v19
 v_fma_f32 v20, v20, s24, v42
 v_mfma_f32_16x16x32_bf16 v[112:115], a[208:211], v[36:39], v[112:115]
 v_fma_f32 v21, v21, s24, v42
 v_fma_f32 v22, v22, s24, v42
 v_mfma_f32_16x16x32_bf16 v[116:119], a[212:215], v[36:39], v[116:119]
 v_exp_f32 v20, v20
 v_mfma_f32_16x16x32_bf16 v[120:123], a[216:219], v[36:39], v[120:123]
 v_exp_f32 v21, v21
 v_mfma_f32_16x16x32_bf16 v[124:127], a[220:223], v[36:39], v[124:127]
 v_cvt_pk_bf16_f32 v26, v20, v21
 v_fma_f32 v23, v23, s24, v42
 v_mfma_f32_16x16x32_bf16 v[8:11], a[160:163], a[0:3], 0
 v_exp_f32 v22, v22
 v_mfma_f32_16x16x32_bf16 v[8:11], a[164:167], a[4:7], v[8:11]
 v_exp_f32 v23, v23
 v_mfma_f32_16x16x32_bf16 v[8:11], a[168:171], a[8:11], v[8:11]
 v_cvt_pk_bf16_f32 v27, v22, v23
 v_fma_f32 v0, v0, s24, v43
 v_mfma_f32_16x16x32_bf16 v[8:11], a[172:175], a[12:15], v[8:11]
 v_fma_f32 v1, v1, s24, v43
 v_fma_f32 v2, v2, s24, v43
 v_mfma_f32_16x16x32_bf16 v[12:15], a[188:191], a[12:15], 0
 v_exp_f32 v0, v0
 v_mfma_f32_16x16x32_bf16 v[12:15], a[184:187], a[8:11], v[12:15]
 v_exp_f32 v1, v1
 v_mfma_f32_16x16x32_bf16 v[12:15], a[180:183], a[4:7], v[12:15]
 v_cvt_pk_bf16_f32 v28, v0, v1
 v_fma_f32 v3, v3, s24, v43
 v_mfma_f32_16x16x32_bf16 v[12:15], a[176:179], a[0:3], v[12:15]
 v_exp_f32 v2, v2
 v_mfma_f32_16x16x32_bf16 v[128:131], a[192:195], v[24:27], v[128:131]
 v_exp_f32 v3, v3
 v_mfma_f32_16x16x32_bf16 v[132:135], a[196:199], v[24:27], v[132:135]
 v_cvt_pk_bf16_f32 v29, v2, v3
 v_fma_f32 v4, v4, s24, v43
 v_mfma_f32_16x16x32_bf16 v[136:139], a[200:203], v[24:27], v[136:139]
 v_fma_f32 v5, v5, s24, v43
 v_fma_f32 v6, v6, s24, v43
 v_mfma_f32_16x16x32_bf16 v[140:143], a[204:207], v[24:27], v[140:143]
 v_exp_f32 v4, v4
 v_mfma_f32_16x16x32_bf16 v[144:147], a[208:211], v[24:27], v[144:147]
 v_exp_f32 v5, v5
 v_mfma_f32_16x16x32_bf16 v[148:151], a[212:215], v[24:27], v[148:151]
 v_cvt_pk_bf16_f32 v30, v4, v5
 v_fma_f32 v7, v7, s24, v43
 v_mfma_f32_16x16x32_bf16 v[152:155], a[216:219], v[24:27], v[152:155]
 v_exp_f32 v6, v6
 v_mfma_f32_16x16x32_bf16 v[156:159], a[220:223], v[24:27], v[156:159]
 v_exp_f32 v7, v7
 v_mfma_f32_16x16x32_bf16 v[16:19], a[160:163], a[16:19], 0
 ds_read_b128 a[160:163], v46 offset:49152
 v_cvt_pk_bf16_f32 v31, v6, v7
 v_mfma_f32_16x16x32_bf16 v[16:19], a[164:167], a[20:23], v[16:19]
 v_fma_f32 v8, v8, s24, v44
 v_fma_f32 v9, v9, s24, v44
 v_mfma_f32_16x16x32_bf16 v[16:19], a[168:171], a[24:27], v[16:19]
 ds_read_b128 a[164:167], v47 offset:49152
 v_fma_f32 v10, v10, s24, v44
 v_mfma_f32_16x16x32_bf16 v[16:19], a[172:175], a[28:31], v[16:19]
 v_exp_f32 v8, v8
 v_mfma_f32_16x16x32_bf16 v[20:23], a[188:191], a[28:31], 0
 ds_read_b128 a[168:171], v46 offset:50176
 v_fma_f32 v11, v11, s24, v44
 v_mfma_f32_16x16x32_bf16 v[20:23], a[184:187], a[24:27], v[20:23]
 v_exp_f32 v9, v9
 v_mfma_f32_16x16x32_bf16 v[20:23], a[180:183], a[20:23], v[20:23]
 ds_read_b128 a[172:175], v47 offset:50176
 v_cvt_pk_bf16_f32 v32, v8, v9
 v_mfma_f32_16x16x32_bf16 v[20:23], a[176:179], a[16:19], v[20:23]
 v_exp_f32 v10, v10
 v_smfmac_f32_16x16x64_bf16 a[228:231], a[236:239], v[24:31], v55
 ds_read_b128 a[188:191], v47 offset:54272
 v_mfma_f32_16x16x32_bf16 v[160:163], a[192:195], v[28:31], v[160:163]
 v_exp_f32 v11, v11
 v_mfma_f32_16x16x32_bf16 v[164:167], a[196:199], v[28:31], v[164:167]
 ds_read_b128 a[184:187], v46 offset:54272
 v_cvt_pk_bf16_f32 v33, v10, v11
 v_mfma_f32_16x16x32_bf16 v[168:171], a[200:203], v[28:31], v[168:171]
 v_fma_f32 v12, v12, s24, v44
 v_fma_f32 v13, v13, s24, v44
 v_mfma_f32_16x16x32_bf16 v[172:175], a[204:207], v[28:31], v[172:175]
 ds_read_b128 a[180:183], v47 offset:53248
 v_fma_f32 v14, v14, s24, v44
 v_mfma_f32_16x16x32_bf16 v[176:179], a[208:211], v[28:31], v[176:179]
 v_exp_f32 v12, v12
 v_mfma_f32_16x16x32_bf16 v[180:183], a[212:215], v[28:31], v[180:183]
 ds_read_b128 a[176:179], v46 offset:53248
 v_fma_f32 v15, v15, s24, v44
 v_mfma_f32_16x16x32_bf16 v[184:187], a[216:219], v[28:31], v[184:187]
 v_exp_f32 v13, v13
 v_mfma_f32_16x16x32_bf16 v[188:191], a[220:223], v[28:31], v[188:191]
 s_waitcnt lgkmcnt(3)
 v_cvt_pk_bf16_f32 v34, v12, v13
 v_fma_f32 v16, v16, s24, v45
 v_mfma_f32_16x16x32_bf16 v[0:3], a[160:163], a[96:99], 0
 v_exp_f32 v14, v14
 v_mfma_f32_16x16x32_bf16 v[0:3], a[164:167], a[100:103], v[0:3]
 buffer_store_dwordx4 a[80:83], v58, s[20:23], s31 offen offset:0 sc0 sc1 nt
 v_exp_f32 v15, v15
 v_fma_f32 v17, v17, s24, v45
 v_mfma_f32_16x16x32_bf16 v[0:3], a[168:171], a[104:107], v[0:3]
 v_cvt_pk_bf16_f32 v35, v14, v15
 v_fma_f32 v18, v18, s24, v45
 v_mfma_f32_16x16x32_bf16 v[0:3], a[172:175], a[108:111], v[0:3]
 v_exp_f32 v16, v16
 v_mfma_f32_16x16x32_bf16 v[4:7], a[188:191], a[108:111], 0
 s_waitcnt lgkmcnt(0)
 v_exp_f32 v17, v17
 v_mfma_f32_16x16x32_bf16 v[4:7], a[184:187], a[104:107], v[4:7]
 v_cvt_pk_bf16_f32 v36, v16, v17
 v_fma_f32 v19, v19, s24, v45
 v_mfma_f32_16x16x32_bf16 v[4:7], a[180:183], a[100:103], v[4:7]
 v_exp_f32 v18, v18
 v_mfma_f32_16x16x32_bf16 v[4:7], a[176:179], a[96:99], v[4:7]
 v_exp_f32 v19, v19
 v_mfma_f32_16x16x32_bf16 v[192:195], a[192:195], v[32:35], v[192:195]
 v_cvt_pk_bf16_f32 v37, v18, v19
 v_fma_f32 v20, v20, s24, v45
 v_mfma_f32_16x16x32_bf16 v[196:199], a[196:199], v[32:35], v[196:199]
 v_fma_f32 v21, v21, s24, v45
 v_fma_f32 v22, v22, s24, v45
 v_mfma_f32_16x16x32_bf16 v[200:203], a[200:203], v[32:35], v[200:203]
 v_exp_f32 v20, v20
 v_mfma_f32_16x16x32_bf16 v[204:207], a[204:207], v[32:35], v[204:207]
 buffer_load_dwordx4 v54, s[12:15], s29 offen offset:0 nt lds
 v_mfma_f32_16x16x32_bf16 v[208:211], a[208:211], v[32:35], v[208:211]
 v_exp_f32 v21, v21
 v_mfma_f32_16x16x32_bf16 v[212:215], a[212:215], v[32:35], v[212:215]
 v_cvt_pk_bf16_f32 v38, v20, v21
 v_fma_f32 v23, v23, s24, v45
 v_mfma_f32_16x16x32_bf16 v[216:219], a[216:219], v[32:35], v[216:219]
 v_exp_f32 v22, v22
 v_mfma_f32_16x16x32_bf16 v[220:223], a[220:223], v[32:35], v[220:223]
 v_exp_f32 v23, v23
 v_mfma_f32_16x16x32_bf16 v[8:11], a[160:163], a[112:115], 0
 v_cvt_pk_bf16_f32 v39, v22, v23
 v_fma_f32 v0, v0, s24, v63
 v_mfma_f32_16x16x32_bf16 v[8:11], a[164:167], a[116:119], v[8:11]
 v_fma_f32 v1, v1, s24, v63
 v_fma_f32 v2, v2, s24, v63
 v_mfma_f32_16x16x32_bf16 v[8:11], a[168:171], a[120:123], v[8:11]
 v_exp_f32 v0, v0
 v_mfma_f32_16x16x32_bf16 v[8:11], a[172:175], a[124:127], v[8:11]
 v_exp_f32 v1, v1
 v_mfma_f32_16x16x32_bf16 v[12:15], a[188:191], a[124:127], 0
 v_cvt_pk_bf16_f32 v24, v0, v1
 v_fma_f32 v3, v3, s24, v63
 v_mfma_f32_16x16x32_bf16 v[12:15], a[184:187], a[120:123], v[12:15]
 v_exp_f32 v2, v2
 v_mfma_f32_16x16x32_bf16 v[12:15], a[180:183], a[116:119], v[12:15]
 v_exp_f32 v3, v3
 v_mfma_f32_16x16x32_bf16 v[12:15], a[176:179], a[112:115], v[12:15]
 buffer_load_dwordx4 v54, s[12:15], s29 offen offset:2048 nt lds
 v_smfmac_f32_16x16x64_bf16 a[232:235], a[236:239], v[32:39], v55
 s_add_u32 m0, s26, 81920
 v_cvt_pk_bf16_f32 v25, v2, v3
 v_mfma_f32_16x16x32_bf16 v[224:227], a[192:195], v[36:39], v[224:227]
 ds_read_b64_tr_b16 a[192:193], v48 offset:49152
 ds_read_b64_tr_b16 a[194:195], v48 offset:53248
 v_mfma_f32_16x16x32_bf16 v[228:231], a[196:199], v[36:39], v[228:231]
 v_fma_f32 v4, v4, s24, v63
 v_fma_f32 v5, v5, s24, v63
 v_mfma_f32_16x16x32_bf16 v[232:235], a[200:203], v[36:39], v[232:235]
 ds_read_b64_tr_b16 a[196:197], v49 offset:49152
 ds_read_b64_tr_b16 a[198:199], v49 offset:53248
 v_mfma_f32_16x16x32_bf16 v[236:239], a[204:207], v[36:39], v[236:239]
 v_exp_f32 v4, v4
 v_mfma_f32_16x16x32_bf16 v[240:243], a[208:211], v[36:39], v[240:243]
 ds_read_b64_tr_b16 a[200:201], v50 offset:49152
 ds_read_b64_tr_b16 a[202:203], v50 offset:53248
 v_mfma_f32_16x16x32_bf16 v[244:247], a[212:215], v[36:39], v[244:247]
 v_exp_f32 v5, v5
 v_mfma_f32_16x16x32_bf16 v[248:251], a[216:219], v[36:39], v[248:251]
 ds_read_b64_tr_b16 a[204:205], v51 offset:49152
 ds_read_b64_tr_b16 a[206:207], v51 offset:53248
 v_mfma_f32_16x16x32_bf16 v[252:255], a[220:223], v[36:39], v[252:255]
 v_cvt_pk_bf16_f32 v26, v4, v5
 v_fma_f32 v6, v6, s24, v63
 v_mfma_f32_16x16x32_bf16 v[16:19], a[160:163], a[128:131], 0
 ds_read_b64_tr_b16 a[208:209], v48 offset:50176
 ds_read_b64_tr_b16 a[210:211], v48 offset:54272
 v_mfma_f32_16x16x32_bf16 v[16:19], a[164:167], a[132:135], v[16:19]
 v_fma_f32 v7, v7, s24, v63
 v_fma_f32 v8, v8, s24, v41
 v_mfma_f32_16x16x32_bf16 v[16:19], a[168:171], a[136:139], v[16:19]
 buffer_load_dwordx4 v54, s[16:19], s29 offen offset:0 nt lds
 v_mfma_f32_16x16x32_bf16 v[16:19], a[172:175], a[140:143], v[16:19]
 ds_read_b64_tr_b16 a[212:213], v49 offset:50176
 ds_read_b64_tr_b16 a[214:215], v49 offset:54272
 v_mfma_f32_16x16x32_bf16 v[20:23], a[188:191], a[140:143], 0
 v_exp_f32 v6, v6
 v_mfma_f32_16x16x32_bf16 v[20:23], a[184:187], a[136:139], v[20:23]
 ds_read_b64_tr_b16 a[216:217], v50 offset:50176
 ds_read_b64_tr_b16 a[218:219], v50 offset:54272
 v_exp_f32 v7, v7
 v_mfma_f32_16x16x32_bf16 v[20:23], a[180:183], a[132:135], v[20:23]
 ds_read_b64_tr_b16 a[220:221], v51 offset:50176
 ds_read_b64_tr_b16 a[222:223], v51 offset:54272
 v_cvt_pk_bf16_f32 v27, v6, v7
 v_mfma_f32_16x16x32_bf16 v[20:23], a[176:179], a[128:131], v[20:23]
 s_waitcnt lgkmcnt(6)
 v_fma_f32 v9, v9, s24, v41
 v_fma_f32 v10, v10, s24, v41
 v_mfma_f32_16x16x32_bf16 v[64:67], a[192:195], v[24:27], v[64:67]
 buffer_store_dwordx4 a[88:91], v58, s[20:23], s31 offen offset:2048 sc0 sc1 nt
 v_exp_f32 v8, v8
 v_fma_f32 v11, v11, s24, v41
 v_mfma_f32_16x16x32_bf16 v[68:71], a[196:199], v[24:27], v[68:71]
 v_exp_f32 v9, v9
 v_mfma_f32_16x16x32_bf16 v[72:75], a[200:203], v[24:27], v[72:75]
 v_cvt_pk_bf16_f32 v28, v8, v9
 v_fma_f32 v12, v12, s24, v41
 v_mfma_f32_16x16x32_bf16 v[76:79], a[204:207], v[24:27], v[76:79]
 v_exp_f32 v10, v10
 v_mfma_f32_16x16x32_bf16 v[80:83], a[208:211], v[24:27], v[80:83]
 s_waitcnt lgkmcnt(2)
 v_exp_f32 v11, v11
 v_mfma_f32_16x16x32_bf16 v[84:87], a[212:215], v[24:27], v[84:87]
 v_cvt_pk_bf16_f32 v29, v10, v11
 v_fma_f32 v13, v13, s24, v41
 v_mfma_f32_16x16x32_bf16 v[88:91], a[216:219], v[24:27], v[88:91]
 s_waitcnt lgkmcnt(0)
 buffer_load_dwordx4 v54, s[16:19], s29 offen offset:2048 nt lds
 v_mfma_f32_16x16x32_bf16 v[92:95], a[220:223], v[24:27], v[92:95]
 s_add_u32 m0, s26, 24576
 v_exp_f32 v12, v12
 v_mfma_f32_16x16x32_bf16 v[0:3], a[160:163], a[144:147], 0
 s_addk_i32 s29, 8192
 v_exp_f32 v13, v13
 v_mfma_f32_16x16x32_bf16 v[0:3], a[164:167], a[148:151], v[0:3]
 v_cvt_pk_bf16_f32 v30, v12, v13
 v_fma_f32 v14, v14, s24, v41
 v_mfma_f32_16x16x32_bf16 v[0:3], a[168:171], a[152:155], v[0:3]
 v_fma_f32 v15, v15, s24, v41
 v_fma_f32 v16, v16, s24, v42
 v_mfma_f32_16x16x32_bf16 v[0:3], a[172:175], a[156:159], v[0:3]
 v_exp_f32 v14, v14
 v_mfma_f32_16x16x32_bf16 v[4:7], a[188:191], a[156:159], 0
 v_exp_f32 v15, v15
 v_mfma_f32_16x16x32_bf16 v[4:7], a[184:187], a[152:155], v[4:7]
 v_cvt_pk_bf16_f32 v31, v14, v15
 v_fma_f32 v17, v17, s24, v42
 v_mfma_f32_16x16x32_bf16 v[4:7], a[180:183], a[148:151], v[4:7]
 v_exp_f32 v16, v16
 v_mfma_f32_16x16x32_bf16 v[4:7], a[176:179], a[144:147], v[4:7]
 v_exp_f32 v17, v17
 v_smfmac_f32_16x16x64_bf16 a[224:227], a[236:239], v[24:31], v55
 v_cvt_pk_bf16_f32 v32, v16, v17
 v_mfma_f32_16x16x32_bf16 v[96:99], a[192:195], v[28:31], v[96:99]
 v_fma_f32 v18, v18, s24, v42
 v_fma_f32 v19, v19, s24, v42
 v_mfma_f32_16x16x32_bf16 v[100:103], a[196:199], v[28:31], v[100:103]
 v_exp_f32 v18, v18
 v_mfma_f32_16x16x32_bf16 v[104:107], a[200:203], v[28:31], v[104:107]
 v_exp_f32 v19, v19
 v_mfma_f32_16x16x32_bf16 v[108:111], a[204:207], v[28:31], v[108:111]
 v_cvt_pk_bf16_f32 v33, v18, v19
 v_fma_f32 v20, v20, s24, v42
 v_mfma_f32_16x16x32_bf16 v[112:115], a[208:211], v[28:31], v[112:115]
 v_fma_f32 v21, v21, s24, v42
 v_fma_f32 v22, v22, s24, v42
 v_mfma_f32_16x16x32_bf16 v[116:119], a[212:215], v[28:31], v[116:119]
 v_exp_f32 v20, v20
 v_mfma_f32_16x16x32_bf16 v[120:123], a[216:219], v[28:31], v[120:123]
 v_exp_f32 v21, v21
 v_mfma_f32_16x16x32_bf16 v[124:127], a[220:223], v[28:31], v[124:127]
 v_cvt_pk_bf16_f32 v34, v20, v21
 v_fma_f32 v23, v23, s24, v42
 v_mfma_f32_16x16x32_bf16 v[8:11], a[160:163], a[0:3], 0
 v_exp_f32 v22, v22
 v_mfma_f32_16x16x32_bf16 v[8:11], a[164:167], a[4:7], v[8:11]
 v_exp_f32 v23, v23
 v_mfma_f32_16x16x32_bf16 v[8:11], a[168:171], a[8:11], v[8:11]
 v_cvt_pk_bf16_f32 v35, v22, v23
 v_fma_f32 v0, v0, s24, v43
 v_mfma_f32_16x16x32_bf16 v[8:11], a[172:175], a[12:15], v[8:11]
 v_fma_f32 v1, v1, s24, v43
 v_fma_f32 v2, v2, s24, v43
 v_mfma_f32_16x16x32_bf16 v[12:15], a[188:191], a[12:15], 0
 v_exp_f32 v0, v0
 v_mfma_f32_16x16x32_bf16 v[12:15], a[184:187], a[8:11], v[12:15]
 v_exp_f32 v1, v1
 v_mfma_f32_16x16x32_bf16 v[12:15], a[180:183], a[4:7], v[12:15]
 v_cvt_pk_bf16_f32 v36, v0, v1
 v_fma_f32 v3, v3, s24, v43
 v_mfma_f32_16x16x32_bf16 v[12:15], a[176:179], a[0:3], v[12:15]
 v_exp_f32 v2, v2
 v_mfma_f32_16x16x32_bf16 v[128:131], a[192:195], v[32:35], v[128:131]
 v_exp_f32 v3, v3
 v_mfma_f32_16x16x32_bf16 v[132:135], a[196:199], v[32:35], v[132:135]
 v_cvt_pk_bf16_f32 v37, v2, v3
 v_fma_f32 v4, v4, s24, v43
 v_mfma_f32_16x16x32_bf16 v[136:139], a[200:203], v[32:35], v[136:139]
 v_fma_f32 v5, v5, s24, v43
 v_fma_f32 v6, v6, s24, v43
 v_mfma_f32_16x16x32_bf16 v[140:143], a[204:207], v[32:35], v[140:143]
 v_exp_f32 v4, v4
 v_mfma_f32_16x16x32_bf16 v[144:147], a[208:211], v[32:35], v[144:147]
 v_exp_f32 v5, v5
 v_mfma_f32_16x16x32_bf16 v[148:151], a[212:215], v[32:35], v[148:151]
 v_cvt_pk_bf16_f32 v38, v4, v5
 v_fma_f32 v7, v7, s24, v43
 v_mfma_f32_16x16x32_bf16 v[152:155], a[216:219], v[32:35], v[152:155]
 v_exp_f32 v6, v6
 v_mfma_f32_16x16x32_bf16 v[156:159], a[220:223], v[32:35], v[156:159]
 buffer_store_dwordx4 a[84:87], v58, s[20:23], s31 offen offset:128 sc0 sc1 nt
 v_exp_f32 v7, v7
 v_fma_f32 v8, v8, s24, v44
 v_mfma_f32_16x16x32_bf16 v[16:19], a[160:163], a[16:19], 0
 ds_read_b128 a[160:163], v46 offset:57344
 v_cvt_pk_bf16_f32 v39, v6, v7
 v_mfma_f32_16x16x32_bf16 v[16:19], a[164:167], a[20:23], v[16:19]
 v_fma_f32 v9, v9, s24, v44
 v_fma_f32 v10, v10, s24, v44
 v_mfma_f32_16x16x32_bf16 v[16:19], a[168:171], a[24:27], v[16:19]
 ds_read_b128 a[164:167], v47 offset:57344
 v_fma_f32 v11, v11, s24, v44
 v_mfma_f32_16x16x32_bf16 v[16:19], a[172:175], a[28:31], v[16:19]
 v_exp_f32 v8, v8
 v_mfma_f32_16x16x32_bf16 v[20:23], a[188:191], a[28:31], 0
 ds_read_b128 a[168:171], v46 offset:58368
 v_fma_f32 v12, v12, s24, v44
 v_mfma_f32_16x16x32_bf16 v[20:23], a[184:187], a[24:27], v[20:23]
 v_exp_f32 v9, v9
 v_mfma_f32_16x16x32_bf16 v[20:23], a[180:183], a[20:23], v[20:23]
 ds_read_b128 a[172:175], v47 offset:58368
 v_cvt_pk_bf16_f32 v24, v8, v9
 v_mfma_f32_16x16x32_bf16 v[20:23], a[176:179], a[16:19], v[20:23]
 v_exp_f32 v10, v10
 v_smfmac_f32_16x16x64_bf16 a[228:231], a[236:239], v[32:39], v55
 ds_read_b128 a[188:191], v47 offset:62464
 v_mfma_f32_16x16x32_bf16 v[160:163], a[192:195], v[36:39], v[160:163]
 v_exp_f32 v11, v11
 v_mfma_f32_16x16x32_bf16 v[164:167], a[196:199], v[36:39], v[164:167]
 ds_read_b128 a[184:187], v46 offset:62464
 v_cvt_pk_bf16_f32 v25, v10, v11
 v_mfma_f32_16x16x32_bf16 v[168:171], a[200:203], v[36:39], v[168:171]
 v_fma_f32 v13, v13, s24, v44
 v_fma_f32 v14, v14, s24, v44
 v_mfma_f32_16x16x32_bf16 v[172:175], a[204:207], v[36:39], v[172:175]
 ds_read_b128 a[180:183], v47 offset:61440
 v_fma_f32 v15, v15, s24, v44
 v_mfma_f32_16x16x32_bf16 v[176:179], a[208:211], v[36:39], v[176:179]
 v_exp_f32 v12, v12
 v_mfma_f32_16x16x32_bf16 v[180:183], a[212:215], v[36:39], v[180:183]
 ds_read_b128 a[176:179], v46 offset:61440
 v_fma_f32 v16, v16, s24, v45
 v_mfma_f32_16x16x32_bf16 v[184:187], a[216:219], v[36:39], v[184:187]
 v_exp_f32 v13, v13
 v_mfma_f32_16x16x32_bf16 v[188:191], a[220:223], v[36:39], v[188:191]
 s_waitcnt lgkmcnt(3)
 v_cvt_pk_bf16_f32 v26, v12, v13
 v_fma_f32 v17, v17, s24, v45
 v_mfma_f32_16x16x32_bf16 v[0:3], a[160:163], a[96:99], 0
 v_exp_f32 v14, v14
 v_mfma_f32_16x16x32_bf16 v[0:3], a[164:167], a[100:103], v[0:3]
 v_exp_f32 v15, v15
 v_mfma_f32_16x16x32_bf16 v[0:3], a[168:171], a[104:107], v[0:3]
 v_cvt_pk_bf16_f32 v27, v14, v15
 v_fma_f32 v18, v18, s24, v45
 v_mfma_f32_16x16x32_bf16 v[0:3], a[172:175], a[108:111], v[0:3]
 v_exp_f32 v16, v16
 v_mfma_f32_16x16x32_bf16 v[4:7], a[188:191], a[108:111], 0
 s_waitcnt lgkmcnt(0)
 v_exp_f32 v17, v17
 v_mfma_f32_16x16x32_bf16 v[4:7], a[184:187], a[104:107], v[4:7]
 v_cvt_pk_bf16_f32 v28, v16, v17
 v_fma_f32 v19, v19, s24, v45
 v_mfma_f32_16x16x32_bf16 v[4:7], a[180:183], a[100:103], v[4:7]
 v_exp_f32 v18, v18
 v_mfma_f32_16x16x32_bf16 v[4:7], a[176:179], a[96:99], v[4:7]
 v_exp_f32 v19, v19
 v_mfma_f32_16x16x32_bf16 v[192:195], a[192:195], v[24:27], v[192:195]
 v_cvt_pk_bf16_f32 v29, v18, v19
 v_fma_f32 v20, v20, s24, v45
 v_mfma_f32_16x16x32_bf16 v[196:199], a[196:199], v[24:27], v[196:199]
 v_fma_f32 v21, v21, s24, v45
 v_fma_f32 v22, v22, s24, v45
 v_mfma_f32_16x16x32_bf16 v[200:203], a[200:203], v[24:27], v[200:203]
 v_exp_f32 v20, v20
 v_mfma_f32_16x16x32_bf16 v[204:207], a[204:207], v[24:27], v[204:207]
 buffer_load_dwordx4 v54, s[12:15], s29 offen offset:0 nt lds
 v_mfma_f32_16x16x32_bf16 v[208:211], a[208:211], v[24:27], v[208:211]
 v_exp_f32 v21, v21
 v_mfma_f32_16x16x32_bf16 v[212:215], a[212:215], v[24:27], v[212:215]
 v_cvt_pk_bf16_f32 v30, v20, v21
 v_fma_f32 v23, v23, s24, v45
 v_mfma_f32_16x16x32_bf16 v[216:219], a[216:219], v[24:27], v[216:219]
 v_exp_f32 v22, v22
 v_mfma_f32_16x16x32_bf16 v[220:223], a[220:223], v[24:27], v[220:223]
 v_exp_f32 v23, v23
 v_mfma_f32_16x16x32_bf16 v[8:11], a[160:163], a[112:115], 0
 v_cvt_pk_bf16_f32 v31, v22, v23
 v_fma_f32 v0, v0, s24, v63
 v_mfma_f32_16x16x32_bf16 v[8:11], a[164:167], a[116:119], v[8:11]
 v_fma_f32 v1, v1, s24, v63
 v_fma_f32 v2, v2, s24, v63
 v_mfma_f32_16x16x32_bf16 v[8:11], a[168:171], a[120:123], v[8:11]
 v_exp_f32 v0, v0
 v_mfma_f32_16x16x32_bf16 v[8:11], a[172:175], a[124:127], v[8:11]
 ds_read_b128 a[32:35], v59 offset:0
 v_fma_f32 v3, v3, s24, v63
 v_mfma_f32_16x16x32_bf16 v[12:15], a[188:191], a[124:127], 0
 ds_read_b64 a[40:41], v59 offset:2056
 v_fma_f32 v4, v4, s24, v63
 v_mfma_f32_16x16x32_bf16 v[12:15], a[184:187], a[120:123], v[12:15]
 ds_read_b64 a[42:43], v59 offset:2048
 v_fma_f32 v5, v5, s24, v63
 v_mfma_f32_16x16x32_bf16 v[12:15], a[180:183], a[116:119], v[12:15]
L_stub11:
 s_cbranch_vccnz L_stub15
.if ((L_stub11-L_main)>>6) != 704
.error "stub misplaced"
.endif
 ds_read_b128 a[36:39], v59 offset:1024
 v_fma_f32 v6, v6, s24, v63
 v_mfma_f32_16x16x32_bf16 v[12:15], a[176:179], a[112:115], v[12:15]
 ds_read_b64 a[44:45], v59 offset:3080
 v_fma_f32 v7, v7, s24, v63
 v_smfmac_f32_16x16x64_bf16 a[232:235], a[236:239], v[24:31], v55
 ds_read_b64 a[46:47], v59 offset:3072
 v_mfma_f32_16x16x32_bf16 v[224:227], a[192:195], v[28:31], v[224:227]
 buffer_store_dwordx4 a[92:95], v58, s[20:23], s31 offen offset:2176 sc0 sc1 nt
 v_exp_f32 v1, v1
 v_fma_f32 v8, v8, s24, v41
 v_mfma_f32_16x16x32_bf16 v[228:231], a[196:199], v[28:31], v[228:231]
 s_addk_i32 s31, 4096
 buffer_load_dwordx4 v54, s[12:15], s29 offen offset:2048 nt lds
 v_mfma_f32_16x16x32_bf16 v[232:235], a[200:203], v[28:31], v[232:235]
 s_add_u32 m0, s26, 90112
 ds_read_b64_tr_b16 a[192:193], v48 offset:57344
 ds_read_b64_tr_b16 a[194:195], v48 offset:61440
 v_mfma_f32_16x16x32_bf16 v[236:239], a[204:207], v[28:31], v[236:239]
 v_cvt_pk_bf16_f32 v32, v0, v1
 v_fma_f32 v9, v9, s24, v41
 v_mfma_f32_16x16x32_bf16 v[240:243], a[208:211], v[28:31], v[240:243]
 ds_read_b64_tr_b16 a[196:197], v49 offset:57344
 ds_read_b64_tr_b16 a[198:199], v49 offset:61440
 v_mfma_f32_16x16x32_bf16 v[244:247], a[212:215], v[28:31], v[244:247]
 v_exp_f32 v2, v2
 v_mfma_f32_16x16x32_bf16 v[248:251], a[216:219], v[28:31], v[248:251]
 ds_read_b64_tr_b16 a[200:201], v50 offset:57344
 ds_read_b64_tr_b16 a[202:203], v50 offset:61440
 v_mfma_f32_16x16x32_bf16 v[252:255], a[220:223], v[28:31], v[252:255]
 v_exp_f32 v3, v3
 v_mfma_f32_16x16x32_bf16 v[16:19], a[160:163], a[128:131], 0
 ds_read_b64_tr_b16 a[204:205], v51 offset:57344
 ds_read_b64_tr_b16 a[206:207], v51 offset:61440
 v_cvt_pk_bf16_f32 v33, v2, v3
 v_mfma_f32_16x16x32_bf16 v[16:19], a[164:167], a[132:135], v[16:19]
 v_exp_f32 v4, v4
 v_mfma_f32_16x16x32_bf16 v[16:19], a[168:171], a[136:139], v[16:19]
 buffer_load_dwordx4 v54, s[16:19], s29 offen offset:0 nt lds
 v_exp_f32 v5, v5
 v_mfma_f32_16x16x32_bf16 v[16:19], a[172:175], a[140:143], v[16:19]
 ds_read_b64_tr_b16 a[208:209], v48 offset:58368
 ds_read_b64_tr_b16 a[210:211], v48 offset:62464
 v_cvt_pk_bf16_f32 v34, v4, v5
 v_mfma_f32_16x16x32_bf16 v[20:23], a[188:191], a[140:143], 0
 ds_read_b64_tr_b16 a[212:213], v49 offset:58368
 ds_read_b64_tr_b16 a[214:215], v49 offset:62464
 v_exp_f32 v6, v6
 v_mfma_f32_16x16x32_bf16 v[20:23], a[184:187], a[136:139], v[20:23]
 ds_read_b64_tr_b16 a[216:217], v50 offset:58368
 ds_read_b64_tr_b16 a[218:219], v50 offset:62464
 v_exp_f32 v7, v7
 v_mfma_f32_16x16x32_bf16 v[20:23], a[180:183], a[132:135], v[20:23]
 ds_read_b64_tr_b16 a[220:221], v51 offset:58368
 ds_read_b64_tr_b16 a[222:223], v51 offset:62464
 v_cvt_pk_bf16_f32 v35, v6, v7
 v_mfma_f32_16x16x32_bf16 v[20:23], a[176:179], a[128:131], v[20:23]
 s_waitcnt lgkmcnt(8)
 v_exp_f32 v8, v8
 v_mfma_f32_16x16x32_bf16 v[64:67], a[192:195], v[32:35], v[64:67]
 v_exp_f32 v9, v9
 v_mfma_f32_16x16x32_bf16 v[68:71], a[196:199], v[32:35], v[68:71]
 v_cvt_pk_bf16_f32 v36, v8, v9
 v_fma_f32 v10, v10, s24, v41
 v_mfma_f32_16x16x32_bf16 v[72:75], a[200:203], v[32:35], v[72:75]
 v_fma_f32 v11, v11, s24, v41
 v_fma_f32 v12, v12, s24, v41
 v_mfma_f32_16x16x32_bf16 v[76:79], a[204:207], v[32:35], v[76:79]
 s_waitcnt lgkmcnt(4)
 v_exp_f32 v10, v10
 v_mfma_f32_16x16x32_bf16 v[80:83], a[208:211], v[32:35], v[80:83]
 v_exp_f32 v11, v11
 v_mfma_f32_16x16x32_bf16 v[84:87], a[212:215], v[32:35], v[84:87]
 s_waitcnt lgkmcnt(0)
 v_cvt_pk_bf16_f32 v37, v10, v11
 v_fma_f32 v13, v13, s24, v41
 v_mfma_f32_16x16x32_bf16 v[88:91], a[216:219], v[32:35], v[88:91]
 buffer_load_dwordx4 v54, s[16:19], s29 offen offset:2048 nt lds
 v_mfma_f32_16x16x32_bf16 v[92:95], a[220:223], v[32:35], v[92:95]
 s_add_u32 m0, s26, 40960
 v_exp_f32 v12, v12
 v_mfma_f32_16x16x32_bf16 v[0:3], a[160:163], a[144:147], 0
 s_addk_i32 s29, 8192
 v_exp_f32 v13, v13
 v_mfma_f32_16x16x32_bf16 v[0:3], a[164:167], a[148:151], v[0:3]
 v_cvt_pk_bf16_f32 v38, v12, v13
 v_fma_f32 v14, v14, s24, v41
 v_mfma_f32_16x16x32_bf16 v[0:3], a[168:171], a[152:155], v[0:3]
 v_fma_f32 v15, v15, s24, v41
 v_fma_f32 v16, v16, s24, v42
 v_mfma_f32_16x16x32_bf16 v[0:3], a[172:175], a[156:159], v[0:3]
 v_exp_f32 v14, v14
 v_mfma_f32_16x16x32_bf16 v[4:7], a[188:191], a[156:159], 0
 v_exp_f32 v15, v15
 v_mfma_f32_16x16x32_bf16 v[4:7], a[184:187], a[152:155], v[4:7]
 v_cvt_pk_bf16_f32 v39, v14, v15
 v_fma_f32 v17, v17, s24, v42
 v_mfma_f32_16x16x32_bf16 v[4:7], a[180:183], a[148:151], v[4:7]
 v_exp_f32 v16, v16
 v_mfma_f32_16x16x32_bf16 v[4:7], a[176:179], a[144:147], v[4:7]
 v_exp_f32 v17, v17
 v_smfmac_f32_16x16x64_bf16 a[224:227], a[236:239], v[32:39], v55
 v_cvt_pk_bf16_f32 v24, v16, v17
 v_mfma_f32_16x16x32_bf16 v[96:99], a[192:195], v[36:39], v[96:99]
 v_fma_f32 v18, v18, s24, v42
 v_fma_f32 v19, v19, s24, v42
 v_mfma_f32_16x16x32_bf16 v[100:103], a[196:199], v[36:39], v[100:103]
 v_exp_f32 v18, v18
 v_mfma_f32_16x16x32_bf16 v[104:107], a[200:203], v[36:39], v[104:107]
 v_exp_f32 v19, v19
 v_mfma_f32_16x16x32_bf16 v[108:111], a[204:207], v[36:39], v[108:111]
 v_cvt_pk_bf16_f32 v25, v18, v19
 v_fma_f32 v20, v20, s24, v42
 v_mfma_f32_16x16x32_bf16 v[112:115], a[208:211], v[36:39], v[112:115]
 v_fma_f32 v21, v21, s24, v42
 v_fma_f32 v22, v22, s24, v42
 v_mfma_f32_16x16x32_bf16 v[116:119], a[212:215], v[36:39], v[116:119]
 v_exp_f32 v20, v20
 v_mfma_f32_16x16x32_bf16 v[120:123], a[216:219], v[36:39], v[120:123]
 v_exp_f32 v21, v21
 v_mfma_f32_16x16x32_bf16 v[124:127], a[220:223], v[36:39], v[124:127]
 v_cvt_pk_bf16_f32 v26, v20, v21
 v_fma_f32 v23, v23, s24, v42
 v_mfma_f32_16x16x32_bf16 v[8:11], a[160:163], a[0:3], 0
 v_exp_f32 v22, v22
 v_mfma_f32_16x16x32_bf16 v[8:11], a[164:167], a[4:7], v[8:11]
 buffer_store_dwordx4 a[32:35], v58, s[20:23], s31 offen offset:0 sc0 sc1 nt
 v_exp_f32 v23, v23
 v_fma_f32 v0, v0, s24, v43
 v_mfma_f32_16x16x32_bf16 v[8:11], a[168:171], a[8:11], v[8:11]
 v_cvt_pk_bf16_f32 v27, v22, v23
 v_fma_f32 v1, v1, s24, v43
 v_mfma_f32_16x16x32_bf16 v[8:11], a[172:175], a[12:15], v[8:11]
 v_exp_f32 v0, v0
 v_mfma_f32_16x16x32_bf16 v[12:15], a[188:191], a[12:15], 0
 v_exp_f32 v1, v1
 v_mfma_f32_16x16x32_bf16 v[12:15], a[184:187], a[8:11], v[12:15]
 v_cvt_pk_bf16_f32 v28, v0, v1
 v_fma_f32 v2, v2, s24, v43
 v_mfma_f32_16x16x32_bf16 v[12:15], a[180:183], a[4:7], v[12:15]
 v_fma_f32 v3, v3, s24, v43
 v_fma_f32 v4, v4, s24, v43
 v_mfma_f32_16x16x32_bf16 v[12:15], a[176:179], a[0:3], v[12:15]
 v_exp_f32 v2, v2
 v_mfma_f32_16x16x32_bf16 v[128:131], a[192:195], v[24:27], v[128:131]
 v_exp_f32 v3, v3
 v_mfma_f32_16x16x32_bf16 v[132:135], a[196:199], v[24:27], v[132:135]
 v_cvt_pk_bf16_f32 v29, v2, v3
 v_fma_f32 v5, v5, s24, v43
 v_mfma_f32_16x16x32_bf16 v[136:139], a[200:203], v[24:27], v[136:139]
 v_exp_f32 v4, v4
 v_mfma_f32_16x16x32_bf16 v[140:143], a[204:207], v[24:27], v[140:143]
 v_exp_f32 v5, v5
 v_mfma_f32_16x16x32_bf16 v[144:147], a[208:211], v[24:27], v[144:147]
 v_cvt_pk_bf16_f32 v30, v4, v5
 v_fma_f32 v6, v6, s24, v43
 v_mfma_f32_16x16x32_bf16 v[148:151], a[212:215], v[24:27], v[148:151]
 v_fma_f32 v7, v7, s24, v43
 v_fma_f32 v8, v8, s24, v44
 v_mfma_f32_16x16x32_bf16 v[152:155], a[216:219], v[24:27], v[152:155]
 s_waitcnt vmcnt(14)
 v_exp_f32 v6, v6
 v_mfma_f32_16x16x32_bf16 v[156:159], a[220:223], v[24:27], v[156:159]
 s_barrier
 v_exp_f32 v7, v7
 v_mfma_f32_16x16x32_bf16 v[16:19], a[160:163], a[16:19], 0
 ds_read_b128 a[160:163], v46 offset:32768
 v_cvt_pk_bf16_f32 v31, v6, v7
 v_mfma_f32_16x16x32_bf16 v[16:19], a[164:167], a[20:23], v[16:19]
 v_fma_f32 v9, v9, s24, v44
 v_fma_f32 v10, v10, s24, v44
 v_mfma_f32_16x16x32_bf16 v[16:19], a[168:171], a[24:27], v[16:19]
 ds_read_b128 a[164:167], v47 offset:32768
 v_fma_f32 v11, v11, s24, v44
 v_mfma_f32_16x16x32_bf16 v[16:19], a[172:175], a[28:31], v[16:19]
 v_exp_f32 v8, v8
 v_mfma_f32_16x16x32_bf16 v[20:23], a[188:191], a[28:31], 0
 ds_read_b128 a[168:171], v46 offset:33792
 v_fma_f32 v12, v12, s24, v44
 v_mfma_f32_16x16x32_bf16 v[20:23], a[184:187], a[24:27], v[20:23]
 v_exp_f32 v9, v9
 v_mfma_f32_16x16x32_bf16 v[20:23], a[180:183], a[20:23], v[20:23]
 ds_read_b128 a[172:175], v47 offset:33792
 v_cvt_pk_bf16_f32 v32, v8, v9
 v_mfma_f32_16x16x32_bf16 v[20:23], a[176:179], a[16:19], v[20:23]
 v_exp_f32 v10, v10
 v_smfmac_f32_16x16x64_bf16 a[228:231], a[236:239], v[24:31], v55
 ds_read_b128 a[188:191], v47 offset:37888
 v_mfma_f32_16x16x32_bf16 v[160:163], a[192:195], v[28:31], v[160:163]
 v_exp_f32 v11, v11
 v_mfma_f32_16x16x32_bf16 v[164:167], a[196:199], v[28:31], v[164:167]
 ds_read_b128 a[184:187], v46 offset:37888
 v_cvt_pk_bf16_f32 v33, v10, v11
 v_mfma_f32_16x16x32_bf16 v[168:171], a[200:203], v[28:31], v[168:171]
 v_fma_f32 v13, v13, s24, v44
 v_fma_f32 v14, v14, s24, v44
 v_mfma_f32_16x16x32_bf16 v[172:175], a[204:207], v[28:31], v[172:175]
 ds_read_b128 a[180:183], v47 offset:36864
 v_fma_f32 v15, v15, s24, v44
 v_mfma_f32_16x16x32_bf16 v[176:179], a[208:211], v[28:31], v[176:179]
 v_exp_f32 v12, v12
 v_mfma_f32_16x16x32_bf16 v[180:183], a[212:215], v[28:31], v[180:183]
 ds_read_b128 a[176:179], v46 offset:36864
 v_fma_f32 v16, v16, s24, v45
 v_mfma_f32_16x16x32_bf16 v[184:187], a[216:219], v[28:31], v[184:187]
 v_exp_f32 v13, v13
 v_mfma_f32_16x16x32_bf16 v[188:191], a[220:223], v[28:31], v[188:191]
 s_waitcnt lgkmcnt(3)
 v_cvt_pk_bf16_f32 v34, v12, v13
 v_fma_f32 v17, v17, s24, v45
 v_mfma_f32_16x16x32_bf16 v[0:3], a[160:163], a[96:99], 0
 v_exp_f32 v14, v14
 v_mfma_f32_16x16x32_bf16 v[0:3], a[164:167], a[100:103], v[0:3]
 v_exp_f32 v15, v15
 v_mfma_f32_16x16x32_bf16 v[0:3], a[168:171], a[104:107], v[0:3]
 v_cvt_pk_bf16_f32 v35, v14, v15
 v_fma_f32 v18, v18, s24, v45
 v_mfma_f32_16x16x32_bf16 v[0:3], a[172:175], a[108:111], v[0:3]
 v_exp_f32 v16, v16
 v_mfma_f32_16x16x32_bf16 v[4:7], a[188:191], a[108:111], 0
 s_waitcnt lgkmcnt(0)
 v_exp_f32 v17, v17
 v_mfma_f32_16x16x32_bf16 v[4:7], a[184:187], a[104:107], v[4:7]
 v_cvt_pk_bf16_f32 v36, v16, v17
 v_fma_f32 v19, v19, s24, v45
 v_mfma_f32_16x16x32_bf16 v[4:7], a[180:183], a[100:103], v[4:7]
 v_exp_f32 v18, v18
 v_mfma_f32_16x16x32_bf16 v[4:7], a[176:179], a[96:99], v[4:7]
 v_exp_f32 v19, v19
 v_mfma_f32_16x16x32_bf16 v[192:195], a[192:195], v[32:35], v[192:195]
 buffer_store_dwordx4 a[40:43], v58, s[20:23], s31 offen offset:2048 sc0 sc1 nt
 v_cvt_pk_bf16_f32 v37, v18, v19
 v_fma_f32 v20, v20, s24, v45
 v_fma_f32 v21, v21, s24, v45
 v_mfma_f32_16x16x32_bf16 v[196:199], a[196:199], v[32:35], v[196:199]
 v_exp_f32 v20, v20
 v_mfma_f32_16x16x32_bf16 v[200:203], a[200:203], v[32:35], v[200:203]
 v_exp_f32 v21, v21
 v_mfma_f32_16x16x32_bf16 v[204:207], a[204:207], v[32:35], v[204:207]
 buffer_load_dwordx4 v54, s[12:15], s29 offen offset:0 nt lds
 v_mfma_f32_16x16x32_bf16 v[208:211], a[208:211], v[32:35], v[208:211]
 v_cvt_pk_bf16_f32 v38, v20, v21
 v_fma_f32 v22, v22, s24, v45
 v_mfma_f32_16x16x32_bf16 v[212:215], a[212:215], v[32:35], v[212:215]
 v_fma_f32 v23, v23, s24, v45
 v_fma_f32 v0, v0, s24, v63
 v_mfma_f32_16x16x32_bf16 v[216:219], a[216:219], v[32:35], v[216:219]
 v_exp_f32 v22, v22
 v_mfma_f32_16x16x32_bf16 v[220:223], a[220:223], v[32:35], v[220:223]
 v_exp_f32 v23, v23
 v_mfma_f32_16x16x32_bf16 v[8:11], a[160:163], a[112:115], 0
 v_cvt_pk_bf16_f32 v39, v22, v23
 v_fma_f32 v1, v1, s24, v63
 v_mfma_f32_16x16x32_bf16 v[8:11], a[164:167], a[116:119], v[8:11]
 v_exp_f32 v0, v0
 v_mfma_f32_16x16x32_bf16 v[8:11], a[168:171], a[120:123], v[8:11]
 v_exp_f32 v1, v1
 v_mfma_f32_16x16x32_bf16 v[8:11], a[172:175], a[124:127], v[8:11]
 v_cvt_pk_bf16_f32 v24, v0, v1
 v_fma_f32 v2, v2, s24, v63
 v_mfma_f32_16x16x32_bf16 v[12:15], a[188:191], a[124:127], 0
 v_fma_f32 v3, v3, s24, v63
 v_fma_f32 v4, v4, s24, v63
 v_mfma_f32_16x16x32_bf16 v[12:15], a[184:187], a[120:123], v[12:15]
 v_exp_f32 v2, v2
 v_mfma_f32_16x16x32_bf16 v[12:15], a[180:183], a[116:119], v[12:15]
 v_exp_f32 v3, v3
 v_mfma_f32_16x16x32_bf16 v[12:15], a[176:179], a[112:115], v[12:15]
 buffer_load_dwordx4 v54, s[12:15], s29 offen offset:2048 nt lds
 v_smfmac_f32_16x16x64_bf16 a[232:235], a[236:239], v[32:39], v55
 s_add_u32 m0, s26, 106496
 v_cvt_pk_bf16_f32 v25, v2, v3
 v_mfma_f32_16x16x32_bf16 v[224:227], a[192:195], v[36:39], v[224:227]
 ds_read_b64_tr_b16 a[192:193], v48 offset:32768
 ds_read_b64_tr_b16 a[194:195], v48 offset:36864
 v_mfma_f32_16x16x32_bf16 v[228:231], a[196:199], v[36:39], v[228:231]
 v_fma_f32 v5, v5, s24, v63
 v_fma_f32 v6, v6, s24, v63
 v_mfma_f32_16x16x32_bf16 v[232:235], a[200:203], v[36:39], v[232:235]
 ds_read_b64_tr_b16 a[196:197], v49 offset:32768
 ds_read_b64_tr_b16 a[198:199], v49 offset:36864
 v_mfma_f32_16x16x32_bf16 v[236:239], a[204:207], v[36:39], v[236:239]
 v_exp_f32 v4, v4
 v_mfma_f32_16x16x32_bf16 v[240:243], a[208:211], v[36:39], v[240:243]
 ds_read_b64_tr_b16 a[200:201], v50 offset:32768
 ds_read_b64_tr_b16 a[202:203], v50 offset:36864
 v_mfma_f32_16x16x32_bf16 v[244:247], a[212:215], v[36:39], v[244:247]
 v_exp_f32 v5, v5
 v_mfma_f32_16x16x32_bf16 v[248:251], a[216:219], v[36:39], v[248:251]
 ds_read_b64_tr_b16 a[204:205], v51 offset:32768
 ds_read_b64_tr_b16 a[206:207], v51 offset:36864
 v_mfma_f32_16x16x32_bf16 v[252:255], a[220:223], v[36:39], v[252:255]
 v_cvt_pk_bf16_f32 v26, v4, v5
 v_fma_f32 v7, v7, s24, v63
 v_mfma_f32_16x16x32_bf16 v[16:19], a[160:163], a[128:131], 0
 ds_read_b64_tr_b16 a[208:209], v48 offset:33792
 ds_read_b64_tr_b16 a[210:211], v48 offset:37888
 v_mfma_f32_16x16x32_bf16 v[16:19], a[164:167], a[132:135], v[16:19]
 v_exp_f32 v6, v6
 v_mfma_f32_16x16x32_bf16 v[16:19], a[168:171], a[136:139], v[16:19]
 buffer_load_dwordx4 v54, s[16:19], s29 offen offset:0 nt lds
 v_mfma_f32_16x16x32_bf16 v[16:19], a[172:175], a[140:143], v[16:19]
 ds_read_b64_tr_b16 a[212:213], v49 offset:33792
 ds_read_b64_tr_b16 a[214:215], v49 offset:37888
 v_mfma_f32_16x16x32_bf16 v[20:23], a[188:191], a[140:143], 0
 v_exp_f32 v7, v7
 v_mfma_f32_16x16x32_bf16 v[20:23], a[184:187], a[136:139], v[20:23]
 ds_read_b64_tr_b16 a[216:217], v50 offset:33792
 ds_read_b64_tr_b16 a[218:219], v50 offset:37888
 v_mfma_f32_16x16x32_bf16 v[20:23], a[180:183], a[132:135], v[20:23]
 ds_read_b64_tr_b16 a[220:221], v51 offset:33792
 ds_read_b64_tr_b16 a[222:223], v51 offset:37888
 v_cvt_pk_bf16_f32 v27, v6, v7
 v_mfma_f32_16x16x32_bf16 v[20:23], a[176:179], a[128:131], v[20:23]
 s_waitcnt lgkmcnt(6)
 v_fma_f32 v8, v8, s24, v41
 v_fma_f32 v9, v9, s24, v41
 v_mfma_f32_16x16x32_bf16 v[64:67], a[192:195], v[24:27], v[64:67]
 v_exp_f32 v8, v8
 v_mfma_f32_16x16x32_bf16 v[68:71], a[196:199], v[24:27], v[68:71]
 v_exp_f32 v9, v9
 v_mfma_f32_16x16x32_bf16 v[72:75], a[200:203], v[24:27], v[72:75]
 v_cvt_pk_bf16_f32 v28, v8, v9
 v_fma_f32 v10, v10, s24, v41
 v_mfma_f32_16x16x32_bf16 v[76:79], a[204:207], v[24:27], v[76:79]
 v_fma_f32 v11, v11, s24, v41
 v_fma_f32 v12, v12, s24, v41
 v_mfma_f32_16x16x32_bf16 v[80:83], a[208:211], v[24:27], v[80:83]
 s_waitcnt lgkmcnt(2)
 v_exp_f32 v10, v10
 v_mfma_f32_16x16x32_bf16 v[84:87], a[212:215], v[24:27], v[84:87]
 v_exp_f32_e64 v11, v11
 v_mfma_f32_16x16x32_bf16 v[88:91], a[216:219], v[24:27], v[88:91]
 s_waitcnt lgkmcnt(0)
 buffer_load_dwordx4 v54, s[16:19], s29 offen offset:2048 nt lds
 v_mfma_f32_16x16x32_bf16 v[92:95], a[220:223], v[24:27], v[92:95]
 s_add_u32 m0, s26, 49152
 buffer_store_dwordx4 a[36:39], v58, s[20:23], s31 offen offset:128 sc0 sc1 nt
 v_cvt_pk_bf16_f32 v29, v10, v11
 v_fma_f32 v13, v13, s24, v41
 v_fma_f32 v14, v14, s24, v41
 v_mfma_f32_16x16x32_bf16 v[0:3], a[160:163], a[144:147], 0
 s_addk_i32 s29, 8192
 v_exp_f32 v12, v12
 v_mfma_f32_16x16x32_bf16 v[0:3], a[164:167], a[148:151], v[0:3]
 v_exp_f32 v13, v13
 v_mfma_f32_16x16x32_bf16 v[0:3], a[168:171], a[152:155], v[0:3]
 v_cvt_pk_bf16_f32 v30, v12, v13
 v_fma_f32 v15, v15, s24, v41
 v_mfma_f32_16x16x32_bf16 v[0:3], a[172:175], a[156:159], v[0:3]
 v_exp_f32 v14, v14
 v_mfma_f32_16x16x32_bf16 v[4:7], a[188:191], a[156:159], 0
 v_exp_f32 v15, v15
 v_mfma_f32_16x16x32_bf16 v[4:7], a[184:187], a[152:155], v[4:7]
 v_cvt_pk_bf16_f32 v31, v14, v15
 v_fma_f32 v16, v16, s24, v42
 v_mfma_f32_16x16x32_bf16 v[4:7], a[180:183], a[148:151], v[4:7]
 v_fma_f32 v17, v17, s24, v42
 v_fma_f32 v18, v18, s24, v42
 v_mfma_f32_16x16x32_bf16 v[4:7], a[176:179], a[144:147], v[4:7]
 v_exp_f32 v16, v16
 v_smfmac_f32_16x16x64_bf16 a[224:227], a[236:239], v[24:31], v55
 v_fma_f32 v19, v19, s24, v42
 v_mfma_f32_16x16x32_bf16 v[96:99], a[192:195], v[28:31], v[96:99]
 v_exp_f32 v17, v17
 v_mfma_f32_16x16x32_bf16 v[100:103], a[196:199], v[28:31], v[100:103]
 v_cvt_pk_bf16_f32 v32, v16, v17
 v_fma_f32 v20, v20, s24, v42
 v_mfma_f32_16x16x32_bf16 v[104:107], a[200:203], v[28:31], v[104:107]
 v_exp_f32 v18, v18
 v_mfma_f32_16x16x32_bf16 v[108:111], a[204:207], v[28:31], v[108:111]
 v_exp_f32 v19, v19
 v_mfma_f32_16x16x32_bf16 v[112:115], a[208:211], v[28:31], v[112:115]
 v_cvt_pk_bf16_f32 v33, v18, v19
 v_fma_f32 v21, v21, s24, v42
 v_mfma_f32_16x16x32_bf16 v[116:119], a[212:215], v[28:31], v[116:119]
 v_exp_f32 v20, v20
 v_mfma_f32_16x16x32_bf16 v[120:123], a[216:219], v[28:31], v[120:123]
 v_exp_f32 v21, v21
 v_mfma_f32_16x16x32_bf16 v[124:127], a[220:223], v[28:31], v[124:127]
 v_cvt_pk_bf16_f32 v34, v20, v21
 v_fma_f32 v22, v22, s24, v42
 v_mfma_f32_16x16x32_bf16 v[8:11], a[160:163], a[0:3], 0
 v_fma_f32 v23, v23, s24, v42
 v_fma_f32 v0, v0, s24, v43
 v_mfma_f32_16x16x32_bf16 v[8:11], a[164:167], a[4:7], v[8:11]
 v_exp_f32 v22, v22
 v_mfma_f32_16x16x32_bf16 v[8:11], a[168:171], a[8:11], v[8:11]
 v_exp_f32 v23, v23
 v_mfma_f32_16x16x32_bf16 v[8:11], a[172:175], a[12:15], v[8:11]
 v_cvt_pk_bf16_f32 v35, v22, v23
 v_fma_f32 v1, v1, s24, v43
 v_mfma_f32_16x16x32_bf16 v[12:15], a[188:191], a[12:15], 0
 v_exp_f32 v0, v0
 v_mfma_f32_16x16x32_bf16 v[12:15], a[184:187], a[8:11], v[12:15]
 v_exp_f32 v1, v1
 v_mfma_f32_16x16x32_bf16 v[12:15], a[180:183], a[4:7], v[12:15]
 v_cvt_pk_bf16_f32 v36, v0, v1
 v_fma_f32 v2, v2, s24, v43
 v_mfma_f32_16x16x32_bf16 v[12:15], a[176:179], a[0:3], v[12:15]
 v_fma_f32 v3, v3, s24, v43
 v_fma_f32 v4, v4, s24, v43
 v_mfma_f32_16x16x32_bf16 v[128:131], a[192:195], v[32:35], v[128:131]
 v_exp_f32 v2, v2
 v_mfma_f32_16x16x32_bf16 v[132:135], a[196:199], v[32:35], v[132:135]
 v_exp_f32 v3, v3
 v_mfma_f32_16x16x32_bf16 v[136:139], a[200:203], v[32:35], v[136:139]
 v_cvt_pk_bf16_f32 v37, v2, v3
 v_fma_f32 v5, v5, s24, v43
 v_mfma_f32_16x16x32_bf16 v[140:143], a[204:207], v[32:35], v[140:143]
 v_exp_f32 v4, v4
 v_mfma_f32_16x16x32_bf16 v[144:147], a[208:211], v[32:35], v[144:147]
 v_exp_f32 v5, v5
 v_mfma_f32_16x16x32_bf16 v[148:151], a[212:215], v[32:35], v[148:151]
 v_cvt_pk_bf16_f32 v38, v4, v5
 v_fma_f32 v6, v6, s24, v43
 v_mfma_f32_16x16x32_bf16 v[152:155], a[216:219], v[32:35], v[152:155]
 v_fma_f32 v7, v7, s24, v43
 v_fma_f32 v8, v8, s24, v44
 v_mfma_f32_16x16x32_bf16 v[156:159], a[220:223], v[32:35], v[156:159]
 v_exp_f32 v6, v6
 v_mfma_f32_16x16x32_bf16 v[16:19], a[160:163], a[16:19], 0
 ds_read_b128 a[160:163], v46 offset:0
 v_fma_f32 v9, v9, s24, v44
 v_mfma_f32_16x16x32_bf16 v[16:19], a[164:167], a[20:23], v[16:19]
 v_exp_f32 v7, v7
 v_mfma_f32_16x16x32_bf16 v[16:19], a[168:171], a[24:27], v[16:19]
 ds_read_b128 a[164:167], v47 offset:0
 v_cvt_pk_bf16_f32 v39, v6, v7
 v_mfma_f32_16x16x32_bf16 v[16:19], a[172:175], a[28:31], v[16:19]
 ds_read_b128 a[48:51], v59 offset:4096
 v_fma_f32 v10, v10, s24, v44
 v_mfma_f32_16x16x32_bf16 v[20:23], a[188:191], a[28:31], 0
 ds_read_b64 a[56:57], v59 offset:6152
 v_fma_f32 v11, v11, s24, v44
 v_mfma_f32_16x16x32_bf16 v[20:23], a[184:187], a[24:27], v[20:23]
 ds_read_b64 a[58:59], v59 offset:6144
 v_fma_f32 v12, v12, s24, v44
 v_mfma_f32_16x16x32_bf16 v[20:23], a[180:183], a[20:23], v[20:23]
 ds_read_b128 a[52:55], v59 offset:5120
 v_fma_f32 v13, v13, s24, v44
 v_mfma_f32_16x16x32_bf16 v[20:23], a[176:179], a[16:19], v[20:23]
 ds_read_b64 a[60:61], v59 offset:7176
 v_fma_f32 v14, v14, s24, v44
 v_smfmac_f32_16x16x64_bf16 a[228:231], a[236:239], v[32:39], v55
 ds_read_b64 a[62:63], v59 offset:7168
 v_mfma_f32_16x16x32_bf16 v[160:163], a[192:195], v[36:39], v[160:163]
 buffer_store_dwordx4 a[44:47], v58, s[20:23], s31 offen offset:2176 sc0 sc1 nt
 v_exp_f32 v8, v8
 v_fma_f32 v15, v15, s24, v44
 v_mfma_f32_16x16x32_bf16 v[164:167], a[196:199], v[36:39], v[164:167]
 s_addk_i32 s31, 4096
 ds_read_b128 a[168:171], v46 offset:1024
 v_fma_f32 v16, v16, s24, v45
 v_mfma_f32_16x16x32_bf16 v[168:171], a[200:203], v[36:39], v[168:171]
 ds_read_b128 a[172:175], v47 offset:1024
 v_fma_f32 v17, v17, s24, v45
 v_mfma_f32_16x16x32_bf16 v[172:175], a[204:207], v[36:39], v[172:175]
 ds_read_b128 a[188:191], v47 offset:5120
 v_fma_f32 v18, v18, s24, v45
 v_mfma_f32_16x16x32_bf16 v[176:179], a[208:211], v[36:39], v[176:179]
 ds_read_b128 a[184:187], v46 offset:5120
 v_exp_f32 v9, v9
 v_mfma_f32_16x16x32_bf16 v[180:183], a[212:215], v[36:39], v[180:183]
 ds_read_b128 a[180:183], v47 offset:4096
 v_cvt_pk_bf16_f32 v24, v8, v9
 v_mfma_f32_16x16x32_bf16 v[184:187], a[216:219], v[36:39], v[184:187]
 ds_read_b128 a[176:179], v46 offset:4096
 v_exp_f32 v10, v10
 v_mfma_f32_16x16x32_bf16 v[188:191], a[220:223], v[36:39], v[188:191]
 s_waitcnt lgkmcnt(6)
 v_exp_f32 v11, v11
 v_mfma_f32_16x16x32_bf16 v[0:3], a[160:163], a[96:99], 0
 v_cvt_pk_bf16_f32 v25, v10, v11
 v_fma_f32 v19, v19, s24, v45
 v_mfma_f32_16x16x32_bf16 v[0:3], a[164:167], a[100:103], v[0:3]
 s_waitcnt lgkmcnt(4)
 v_exp_f32 v12, v12
 v_mfma_f32_16x16x32_bf16 v[0:3], a[168:171], a[104:107], v[0:3]
 v_exp_f32 v13, v13
 v_mfma_f32_16x16x32_bf16 v[0:3], a[172:175], a[108:111], v[0:3]
 s_waitcnt lgkmcnt(2)
 v_cvt_pk_bf16_f32 v26, v12, v13
 v_fma_f32 v20, v20, s24, v45
 v_mfma_f32_16x16x32_bf16 v[4:7], a[188:191], a[108:111], 0
 v_exp_f32 v14, v14
 v_mfma_f32_16x16x32_bf16 v[4:7], a[184:187], a[104:107], v[4:7]
 s_waitcnt lgkmcnt(0)
 v_exp_f32 v15, v15
 v_mfma_f32_16x16x32_bf16 v[4:7], a[180:183], a[100:103], v[4:7]
 v_cvt_pk_bf16_f32 v27, v14, v15
 v_fma_f32 v21, v21, s24, v45
 v_mfma_f32_16x16x32_bf16 v[4:7], a[176:179], a[96:99], v[4:7]
 v_exp_f32 v16, v16
 v_mfma_f32_16x16x32_bf16 v[192:195], a[192:195], v[24:27], v[192:195]
 v_exp_f32 v17, v17
 v_mfma_f32_16x16x32_bf16 v[196:199], a[196:199], v[24:27], v[196:199]
 v_cvt_pk_bf16_f32 v28, v16, v17
 v_fma_f32 v22, v22, s24, v45
 v_mfma_f32_16x16x32_bf16 v[200:203], a[200:203], v[24:27], v[200:203]
 v_exp_f32 v18, v18
 v_mfma_f32_16x16x32_bf16 v[204:207], a[204:207], v[24:27], v[204:207]
 buffer_load_dwordx4 v54, s[12:15], s29 offen offset:0 nt lds
 v_mfma_f32_16x16x32_bf16 v[208:211], a[208:211], v[24:27], v[208:211]
 v_exp_f32 v19, v19
 v_mfma_f32_16x16x32_bf16 v[212:215], a[212:215], v[24:27], v[212:215]
 v_cvt_pk_bf16_f32 v29, v18, v19
 v_fma_f32 v23, v23, s24, v45
 v_mfma_f32_16x16x32_bf16 v[216:219], a[216:219], v[24:27], v[216:219]
 v_exp_f32 v20, v20
 v_mfma_f32_16x16x32_bf16 v[220:223], a[220:223], v[24:27], v[220:223]
 v_exp_f32 v21, v21
 v_mfma_f32_16x16x32_bf16 v[8:11], a[160:163], a[112:115], 0
 v_cvt_pk_bf16_f32 v30, v20, v21
 v_fma_f32 v0, v0, s24, v63
 v_mfma_f32_16x16x32_bf16 v[8:11], a[164:167], a[116:119], v[8:11]
 v_exp_f32 v22, v22
 v_mfma_f32_16x16x32_bf16 v[8:11], a[168:171], a[120:123], v[8:11]
 v_exp_f32 v23, v23
 v_mfma_f32_16x16x32_bf16 v[8:11], a[172:175], a[124:127], v[8:11]
 v_cvt_pk_bf16_f32 v31, v22, v23
 v_fma_f32 v1, v1, s24, v63
 v_mfma_f32_16x16x32_bf16 v[12:15], a[188:191], a[124:127], 0
 v_exp_f32 v0, v0
 v_mfma_f32_16x16x32_bf16 v[12:15], a[184:187], a[120:123], v[12:15]
 v_exp_f32 v1, v1
 v_mfma_f32_16x16x32_bf16 v[12:15], a[180:183], a[116:119], v[12:15]
 v_cvt_pk_bf16_f32 v32, v0, v1
 v_fma_f32 v2, v2, s24, v63
 v_mfma_f32_16x16x32_bf16 v[12:15], a[176:179], a[112:115], v[12:15]
 buffer_load_dwordx4 v54, s[12:15], s29 offen offset:2048 nt lds
 v_smfmac_f32_16x16x64_bf16 a[232:235], a[236:239], v[24:31], v55
 s_add_u32 m0, s26, 114688
 v_fma_f32 v3, v3, s24, v63
 v_mfma_f32_16x16x32_bf16 v[224:227], a[192:195], v[28:31], v[224:227]
 ds_read_b64_tr_b16 a[192:193], v48 offset:0
 ds_read_b64_tr_b16 a[194:195], v48 offset:4096
 v_mfma_f32_16x16x32_bf16 v[228:231], a[196:199], v[28:31], v[228:231]
 v_exp_f32 v2, v2
 v_mfma_f32_16x16x32_bf16 v[232:235], a[200:203], v[28:31], v[232:235]
 ds_read_b64_tr_b16 a[196:197], v49 offset:0
 ds_read_b64_tr_b16 a[198:199], v49 offset:4096
 v_mfma_f32_16x16x32_bf16 v[236:239], a[204:207], v[28:31], v[236:239]
 v_exp_f32 v3, v3
 v_mfma_f32_16x16x32_bf16 v[240:243], a[208:211], v[28:31], v[240:243]
 ds_read_b64_tr_b16 a[200:201], v50 offset:0
 ds_read_b64_tr_b16 a[202:203], v50 offset:4096
 v_mfma_f32_16x16x32_bf16 v[244:247], a[212:215], v[28:31], v[244:247]
 v_cvt_pk_bf16_f32 v33, v2, v3
 v_fma_f32 v4, v4, s24, v63
 v_mfma_f32_16x16x32_bf16 v[248:251], a[216:219], v[28:31], v[248:251]
 ds_read_b64_tr_b16 a[204:205], v51 offset:0
 ds_read_b64_tr_b16 a[206:207], v51 offset:4096
 v_mfma_f32_16x16x32_bf16 v[252:255], a[220:223], v[28:31], v[252:255]
 v_fma_f32 v5, v5, s24, v63
 v_fma_f32 v6, v6, s24, v63
 v_mfma_f32_16x16x32_bf16 v[16:19], a[160:163], a[128:131], 0
 ds_read_b64_tr_b16 a[208:209], v48 offset:1024
 ds_read_b64_tr_b16 a[210:211], v48 offset:5120
 v_mfma_f32_16x16x32_bf16 v[16:19], a[164:167], a[132:135], v[16:19]
 buffer_store_dwordx4 a[48:51], v58, s[20:23], s31 offen offset:0 sc0 sc1 nt
 ds_read_b64_tr_b16 a[212:213], v49 offset:1024
 v_exp_f32 v4, v4
 v_mfma_f32_16x16x32_bf16 v[16:19], a[168:171], a[136:139], v[16:19]
 v_exp_f32 v5, v5
 v_mfma_f32_16x16x32_bf16 v[16:19], a[172:175], a[140:143], v[16:19]
 buffer_load_dwordx4 v54, s[16:19], s29 offen offset:0 nt lds
 v_cvt_pk_bf16_f32 v34, v4, v5
 v_mfma_f32_16x16x32_bf16 v[20:23], a[188:191], a[140:143], 0
L_stub12:
 s_cbranch_vccnz L_back0
.if ((L_stub12-L_main)>>6) != 768
.error "stub misplaced"
.endif
 ds_read_b64_tr_b16 a[214:215], v49 offset:5120
 ds_read_b64_tr_b16 a[216:217], v50 offset:1024
 v_fma_f32 v7, v7, s24, v63
 v_exp_f32 v6, v6
 v_mfma_f32_16x16x32_bf16 v[20:23], a[184:187], a[136:139], v[20:23]
 ds_read_b64_tr_b16 a[218:219], v50 offset:5120
 v_exp_f32 v7, v7
 v_mfma_f32_16x16x32_bf16 v[20:23], a[180:183], a[132:135], v[20:23]
 ds_read_b64_tr_b16 a[220:221], v51 offset:1024
 ds_read_b64_tr_b16 a[222:223], v51 offset:5120
 v_cvt_pk_bf16_f32 v35, v6, v7
 v_mfma_f32_16x16x32_bf16 v[20:23], a[176:179], a[128:131], v[20:23]
 s_waitcnt lgkmcnt(6)
 v_fma_f32 v8, v8, s24, v41
 v_fma_f32 v9, v9, s24, v41
 v_mfma_f32_16x16x32_bf16 v[64:67], a[192:195], v[32:35], v[64:67]
 v_exp_f32 v8, v8
 v_mfma_f32_16x16x32_bf16 v[68:71], a[196:199], v[32:35], v[68:71]
 v_exp_f32 v9, v9
 v_mfma_f32_16x16x32_bf16 v[72:75], a[200:203], v[32:35], v[72:75]
 v_cvt_pk_bf16_f32 v36, v8, v9
 v_fma_f32 v10, v10, s24, v41
 v_mfma_f32_16x16x32_bf16 v[76:79], a[204:207], v[32:35], v[76:79]
 v_fma_f32 v11, v11, s24, v41
 v_fma_f32 v12, v12, s24, v41
 v_mfma_f32_16x16x32_bf16 v[80:83], a[208:211], v[32:35], v[80:83]
 s_waitcnt lgkmcnt(2)
 v_exp_f32 v10, v10
 v_mfma_f32_16x16x32_bf16 v[84:87], a[212:215], v[32:35], v[84:87]
 v_exp_f32 v11, v11
 v_mfma_f32_16x16x32_bf16 v[88:91], a[216:219], v[32:35], v[88:91]
 s_waitcnt lgkmcnt(0)
 buffer_load_dwordx4 v54, s[16:19], s29 offen offset:2048 nt lds
 v_mfma_f32_16x16x32_bf16 v[92:95], a[220:223], v[32:35], v[92:95]
 s_add_u32 m0, s26, 57344
 v_cvt_pk_bf16_f32 v37, v10, v11
 v_fma_f32 v13, v13, s24, v41
 v_mfma_f32_16x16x32_bf16 v[0:3], a[160:163], a[144:147], 0
 s_addk_i32 s29, 8192
 v_exp_f32 v12, v12
 v_mfma_f32_16x16x32_bf16 v[0:3], a[164:167], a[148:151], v[0:3]
 v_exp_f32 v13, v13
 v_mfma_f32_16x16x32_bf16 v[0:3], a[168:171], a[152:155], v[0:3]
 v_cvt_pk_bf16_f32 v38, v12, v13
 v_fma_f32 v14, v14, s24, v41
 v_mfma_f32_16x16x32_bf16 v[0:3], a[172:175], a[156:159], v[0:3]
 v_fma_f32 v15, v15, s24, v41
 v_fma_f32 v16, v16, s24, v42
 v_mfma_f32_16x16x32_bf16 v[4:7], a[188:191], a[156:159], 0
 v_exp_f32 v14, v14
 v_mfma_f32_16x16x32_bf16 v[4:7], a[184:187], a[152:155], v[4:7]
 v_exp_f32 v15, v15
 v_mfma_f32_16x16x32_bf16 v[4:7], a[180:183], a[148:151], v[4:7]
 v_cvt_pk_bf16_f32 v39, v14, v15
 v_fma_f32 v17, v17, s24, v42
 v_mfma_f32_16x16x32_bf16 v[4:7], a[176:179], a[144:147], v[4:7]
 v_exp_f32 v16, v16
 v_smfmac_f32_16x16x64_bf16 a[224:227], a[236:239], v[32:39], v55
 v_fma_f32 v18, v18, s24, v42
 v_mfma_f32_16x16x32_bf16 v[96:99], a[192:195], v[36:39], v[96:99]
 v_exp_f32 v17, v17
 v_mfma_f32_16x16x32_bf16 v[100:103], a[196:199], v[36:39], v[100:103]
 v_cvt_pk_bf16_f32 v24, v16, v17
 v_fma_f32 v19, v19, s24, v42
 v_mfma_f32_16x16x32_bf16 v[104:107], a[200:203], v[36:39], v[104:107]
 v_exp_f32 v18, v18
 v_mfma_f32_16x16x32_bf16 v[108:111], a[204:207], v[36:39], v[108:111]
 v_exp_f32 v19, v19
 v_mfma_f32_16x16x32_bf16 v[112:115], a[208:211], v[36:39], v[112:115]
 v_cvt_pk_bf16_f32 v25, v18, v19
 v_fma_f32 v20, v20, s24, v42
 v_mfma_f32_16x16x32_bf16 v[116:119], a[212:215], v[36:39], v[116:119]
 v_fma_f32 v21, v21, s24, v42
 v_fma_f32 v22, v22, s24, v42
 v_mfma_f32_16x16x32_bf16 v[120:123], a[216:219], v[36:39], v[120:123]
 v_exp_f32 v20, v20
 v_mfma_f32_16x16x32_bf16 v[124:127], a[220:223], v[36:39], v[124:127]
 v_exp_f32 v21, v21
 v_mfma_f32_16x16x32_bf16 v[8:11], a[160:163], a[0:3], 0
 v_cvt_pk_bf16_f32 v26, v20, v21
 v_fma_f32 v23, v23, s24, v42
 v_mfma_f32_16x16x32_bf16 v[8:11], a[164:167], a[4:7], v[8:11]
 v_exp_f32 v22, v22
 v_mfma_f32_16x16x32_bf16 v[8:11], a[168:171], a[8:11], v[8:11]
 v_exp_f32 v23, v23
 v_mfma_f32_16x16x32_bf16 v[8:11], a[172:175], a[12:15], v[8:11]
 v_cvt_pk_bf16_f32 v27, v22, v23
 v_fma_f32 v0, v0, s24, v43
 v_mfma_f32_16x16x32_bf16 v[12:15], a[188:191], a[12:15], 0
 v_fma_f32 v1, v1, s24, v43
 v_fma_f32 v2, v2, s24, v43
 v_mfma_f32_16x16x32_bf16 v[12:15], a[184:187], a[8:11], v[12:15]
 v_exp_f32 v0, v0
 v_mfma_f32_16x16x32_bf16 v[12:15], a[180:183], a[4:7], v[12:15]
 v_exp_f32 v1, v1
 v_mfma_f32_16x16x32_bf16 v[12:15], a[176:179], a[0:3], v[12:15]
 v_cvt_pk_bf16_f32 v28, v0, v1
 v_fma_f32 v3, v3, s24, v43
 v_mfma_f32_16x16x32_bf16 v[128:131], a[192:195], v[24:27], v[128:131]
 buffer_store_dwordx4 a[56:59], v58, s[20:23], s31 offen offset:2048 sc0 sc1 nt
 v_exp_f32 v2, v2
 v_fma_f32 v4, v4, s24, v43
 v_mfma_f32_16x16x32_bf16 v[132:135], a[196:199], v[24:27], v[132:135]
 v_exp_f32 v3, v3
 v_mfma_f32_16x16x32_bf16 v[136:139], a[200:203], v[24:27], v[136:139]
 v_cvt_pk_bf16_f32 v29, v2, v3
 v_fma_f32 v5, v5, s24, v43
 v_mfma_f32_16x16x32_bf16 v[140:143], a[204:207], v[24:27], v[140:143]
 v_exp_f32 v4, v4
 v_mfma_f32_16x16x32_bf16 v[144:147], a[208:211], v[24:27], v[144:147]
 v_exp_f32 v5, v5
 v_mfma_f32_16x16x32_bf16 v[148:151], a[212:215], v[24:27], v[148:151]
 v_cvt_pk_bf16_f32 v30, v4, v5
 v_fma_f32 v6, v6, s24, v43
 v_mfma_f32_16x16x32_bf16 v[152:155], a[216:219], v[24:27], v[152:155]
 v_fma_f32 v7, v7, s24, v43
 v_fma_f32 v8, v8, s24, v44
 v_mfma_f32_16x16x32_bf16 v[156:159], a[220:223], v[24:27], v[156:159]
 v_exp_f32 v6, v6
 v_mfma_f32_16x16x32_bf16 v[16:19], a[160:163], a[16:19], 0
 ds_read_b128 a[160:163], v46 offset:8192
 v_fma_f32 v9, v9, s24, v44
 v_mfma_f32_16x16x32_bf16 v[16:19], a[164:167], a[20:23], v[16:19]
 v_exp_f32 v7, v7
 v_mfma_f32_16x16x32_bf16 v[16:19], a[168:171], a[24:27], v[16:19]
 ds_read_b128 a[164:167], v47 offset:8192
 v_cvt_pk_bf16_f32 v31, v6, v7
 v_mfma_f32_16x16x32_bf16 v[16:19], a[172:175], a[28:31], v[16:19]
 v_exp_f32 v8, v8
 v_mfma_f32_16x16x32_bf16 v[20:23], a[188:191], a[28:31], 0
 ds_read_b128 a[168:171], v46 offset:9216
 v_fma_f32 v10, v10, s24, v44
 v_mfma_f32_16x16x32_bf16 v[20:23], a[184:187], a[24:27], v[20:23]
 v_exp_f32 v9, v9
 v_mfma_f32_16x16x32_bf16 v[20:23], a[180:183], a[20:23], v[20:23]
 ds_read_b128 a[172:175], v47 offset:9216
 v_cvt_pk_bf16_f32 v32, v8, v9
 v_mfma_f32_16x16x32_bf16 v[20:23], a[176:179], a[16:19], v[20:23]
 v_fma_f32 v11, v11, s24, v44
 v_fma_f32 v12, v12, s24, v44
 v_smfmac_f32_16x16x64_bf16 a[228:231], a[236:239], v[24:31], v55
 ds_read_b128 a[188:191], v47 offset:13312
 v_mfma_f32_16x16x32_bf16 v[160:163], a[192:195], v[28:31], v[160:163]
 v_exp_f32 v10, v10
 v_mfma_f32_16x16x32_bf16 v[164:167], a[196:199], v[28:31], v[164:167]
 ds_read_b128 a[184:187], v46 offset:13312
 v_fma_f32 v13, v13, s24, v44
 v_mfma_f32_16x16x32_bf16 v[168:171], a[200:203], v[28:31], v[168:171]
 v_exp_f32 v11, v11
 v_mfma_f32_16x16x32_bf16 v[172:175], a[204:207], v[28:31], v[172:175]
 ds_read_b128 a[180:183], v47 offset:12288
 v_cvt_pk_bf16_f32 v33, v10, v11
 v_mfma_f32_16x16x32_bf16 v[176:179], a[208:211], v[28:31], v[176:179]
 v_exp_f32 v12, v12
 v_mfma_f32_16x16x32_bf16 v[180:183], a[212:215], v[28:31], v[180:183]
 ds_read_b128 a[176:179], v46 offset:12288
 v_fma_f32 v14, v14, s24, v44
 v_mfma_f32_16x16x32_bf16 v[184:187], a[216:219], v[28:31], v[184:187]
 v_exp_f32 v13, v13
 v_mfma_f32_16x16x32_bf16 v[188:191], a[220:223], v[28:31], v[188:191]
 s_waitcnt lgkmcnt(3)
 v_cvt_pk_bf16_f32 v34, v12, v13
 v_fma_f32 v15, v15, s24, v44
 v_mfma_f32_16x16x32_bf16 v[0:3], a[160:163], a[96:99], 0
 v_exp_f32 v14, v14
 v_mfma_f32_16x16x32_bf16 v[0:3], a[164:167], a[100:103], v[0:3]
 v_exp_f32 v15, v15
 v_mfma_f32_16x16x32_bf16 v[0:3], a[168:171], a[104:107], v[0:3]
 v_cvt_pk_bf16_f32 v35, v14, v15
 v_fma_f32 v16, v16, s24, v45
 v_mfma_f32_16x16x32_bf16 v[0:3], a[172:175], a[108:111], v[0:3]
 v_fma_f32 v17, v17, s24, v45
 v_fma_f32 v18, v18, s24, v45
 v_mfma_f32_16x16x32_bf16 v[4:7], a[188:191], a[108:111], 0
 s_waitcnt lgkmcnt(0)
 v_exp_f32 v16, v16
 v_mfma_f32_16x16x32_bf16 v[4:7], a[184:187], a[104:107], v[4:7]
 v_exp_f32 v17, v17
 v_mfma_f32_16x16x32_bf16 v[4:7], a[180:183], a[100:103], v[4:7]
 v_cvt_pk_bf16_f32 v36, v16, v17
 v_fma_f32 v19, v19, s24, v45
 v_mfma_f32_16x16x32_bf16 v[4:7], a[176:179], a[96:99], v[4:7]
 v_exp_f32 v18, v18
 v_mfma_f32_16x16x32_bf16 v[192:195], a[192:195], v[32:35], v[192:195]
 v_exp_f32 v19, v19
 v_mfma_f32_16x16x32_bf16 v[196:199], a[196:199], v[32:35], v[196:199]
 v_cvt_pk_bf16_f32 v37, v18, v19
 v_fma_f32 v20, v20, s24, v45
 v_mfma_f32_16x16x32_bf16 v[200:203], a[200:203], v[32:35], v[200:203]
 v_fma_f32 v21, v21, s24, v45
 v_fma_f32 v22, v22, s24, v45
 v_mfma_f32_16x16x32_bf16 v[204:207], a[204:207], v[32:35], v[204:207]
 buffer_load_dwordx4 v54, s[12:15], s29 offen offset:0 nt lds
 v_mfma_f32_16x16x32_bf16 v[208:211], a[208:211], v[32:35], v[208:211]
 v_exp_f32 v20, v20
 v_mfma_f32_16x16x32_bf16 v[212:215], a[212:215], v[32:35], v[212:215]
 v_exp_f32 v21, v21
 v_mfma_f32_16x16x32_bf16 v[216:219], a[216:219], v[32:35], v[216:219]
 v_cvt_pk_bf16_f32 v38, v20, v21
 v_fma_f32 v23, v23, s24, v45
 v_mfma_f32_16x16x32_bf16 v[220:223], a[220:223], v[32:35], v[220:223]
 buffer_store_dwordx4 a[52:55], v58, s[20:23], s31 offen offset:128 sc0 sc1 nt
 v_exp_f32 v22, v22
 v_fma_f32 v0, v0, s24, v63
 v_mfma_f32_16x16x32_bf16 v[8:11], a[160:163], a[112:115], 0
 v_exp_f32 v23, v23
 v_mfma_f32_16x16x32_bf16 v[8:11], a[164:167], a[116:119], v[8:11]
 v_cvt_pk_bf16_f32 v39, v22, v23
 v_fma_f32 v1, v1, s24, v63
 v_mfma_f32_16x16x32_bf16 v[8:11], a[168:171], a[120:123], v[8:11]
 v_exp_f32 v0, v0
 v_mfma_f32_16x16x32_bf16 v[8:11], a[172:175], a[124:127], v[8:11]
 v_exp_f32 v1, v1
 v_mfma_f32_16x16x32_bf16 v[12:15], a[188:191], a[124:127], 0
 v_cvt_pk_bf16_f32 v24, v0, v1
 v_fma_f32 v2, v2, s24, v63
 v_mfma_f32_16x16x32_bf16 v[12:15], a[184:187], a[120:123], v[12:15]
 v_fma_f32 v3, v3, s24, v63
 v_fma_f32 v4, v4, s24, v63
 v_mfma_f32_16x16x32_bf16 v[12:15], a[180:183], a[116:119], v[12:15]
 v_exp_f32 v2, v2
 v_mfma_f32_16x16x32_bf16 v[12:15], a[176:179], a[112:115], v[12:15]
 buffer_load_dwordx4 v54, s[12:15], s29 offen offset:2048 nt lds
 v_smfmac_f32_16x16x64_bf16 a[232:235], a[236:239], v[32:39], v55
 s_add_u32 m0, s26, 122880
 v_fma_f32 v5, v5, s24, v63
 v_mfma_f32_16x16x32_bf16 v[224:227], a[192:195], v[36:39], v[224:227]
 ds_read_b64_tr_b16 a[192:193], v48 offset:8192
 ds_read_b64_tr_b16 a[194:195], v48 offset:12288
 v_mfma_f32_16x16x32_bf16 v[228:231], a[196:199], v[36:39], v[228:231]
 v_exp_f32 v3, v3
 v_mfma_f32_16x16x32_bf16 v[232:235], a[200:203], v[36:39], v[232:235]
 ds_read_b64_tr_b16 a[196:197], v49 offset:8192
 ds_read_b64_tr_b16 a[198:199], v49 offset:12288
 v_mfma_f32_16x16x32_bf16 v[236:239], a[204:207], v[36:39], v[236:239]
 v_cvt_pk_bf16_f32 v25, v2, v3
 v_fma_f32 v6, v6, s24, v63
 v_mfma_f32_16x16x32_bf16 v[240:243], a[208:211], v[36:39], v[240:243]
 ds_read_b64_tr_b16 a[200:201], v50 offset:8192
 ds_read_b64_tr_b16 a[202:203], v50 offset:12288
 v_mfma_f32_16x16x32_bf16 v[244:247], a[212:215], v[36:39], v[244:247]
 v_exp_f32 v4, v4
 v_mfma_f32_16x16x32_bf16 v[248:251], a[216:219], v[36:39], v[248:251]
 ds_read_b64_tr_b16 a[204:205], v51 offset:8192
 ds_read_b64_tr_b16 a[206:207], v51 offset:12288
 v_mfma_f32_16x16x32_bf16 v[252:255], a[220:223], v[36:39], v[252:255]
 v_exp_f32 v5, v5
 v_mfma_f32_16x16x32_bf16 v[16:19], a[160:163], a[128:131], 0
 ds_read_b64_tr_b16 a[208:209], v48 offset:9216
 ds_read_b64_tr_b16 a[210:211], v48 offset:13312
 v_mfma_f32_16x16x32_bf16 v[16:19], a[164:167], a[132:135], v[16:19]
 v_cvt_pk_bf16_f32 v26, v4, v5
 v_fma_f32 v7, v7, s24, v63
 v_mfma_f32_16x16x32_bf16 v[16:19], a[168:171], a[136:139], v[16:19]
 buffer_load_dwordx4 v54, s[16:19], s29 offen offset:0 nt lds
 v_mfma_f32_16x16x32_bf16 v[16:19], a[172:175], a[140:143], v[16:19]
 ds_read_b64_tr_b16 a[212:213], v49 offset:9216
 ds_read_b64_tr_b16 a[214:215], v49 offset:13312
 v_mfma_f32_16x16x32_bf16 v[20:23], a[188:191], a[140:143], 0
 v_exp_f32 v6, v6
 v_mfma_f32_16x16x32_bf16 v[20:23], a[184:187], a[136:139], v[20:23]
 ds_read_b64_tr_b16 a[216:217], v50 offset:9216
 ds_read_b64_tr_b16 a[218:219], v50 offset:13312
 v_exp_f32 v7, v7
 v_mfma_f32_16x16x32_bf16 v[20:23], a[180:183], a[132:135], v[20:23]
 ds_read_b64_tr_b16 a[220:221], v51 offset:9216
 ds_read_b64_tr_b16 a[222:223], v51 offset:13312
 v_cvt_pk_bf16_f32 v27, v6, v7
 v_mfma_f32_16x16x32_bf16 v[20:23], a[176:179], a[128:131], v[20:23]
 s_waitcnt lgkmcnt(6)
 v_fma_f32 v8, v8, s24, v41
 v_fma_f32 v9, v9, s24, v41
 v_mfma_f32_16x16x32_bf16 v[64:67], a[192:195], v[24:27], v[64:67]
 v_exp_f32 v8, v8
 v_mfma_f32_16x16x32_bf16 v[68:71], a[196:199], v[24:27], v[68:71]
 v_exp_f32 v9, v9
 v_mfma_f32_16x16x32_bf16 v[72:75], a[200:203], v[24:27], v[72:75]
 v_cvt_pk_bf16_f32 v28, v8, v9
 v_fma_f32 v10, v10, s24, v41
 v_mfma_f32_16x16x32_bf16 v[76:79], a[204:207], v[24:27], v[76:79]
 v_fma_f32 v11, v11, s24, v41
 v_fma_f32 v12, v12, s24, v41
 v_mfma_f32_16x16x32_bf16 v[80:83], a[208:211], v[24:27], v[80:83]
 s_waitcnt lgkmcnt(2)
 v_exp_f32 v10, v10
 v_mfma_f32_16x16x32_bf16 v[84:87], a[212:215], v[24:27], v[84:87]
 v_exp_f32 v11, v11
 v_mfma_f32_16x16x32_bf16 v[88:91], a[216:219], v[24:27], v[88:91]
 s_waitcnt lgkmcnt(0)
 buffer_load_dwordx4 v54, s[16:19], s29 offen offset:2048 nt lds
 v_mfma_f32_16x16x32_bf16 v[92:95], a[220:223], v[24:27], v[92:95]
 v_cvt_pk_bf16_f32 v29, v10, v11
 v_fma_f32 v13, v13, s24, v41
 v_mfma_f32_16x16x32_bf16 v[0:3], a[160:163], a[144:147], 0
 v_exp_f32 v12, v12
 v_mfma_f32_16x16x32_bf16 v[0:3], a[164:167], a[148:151], v[0:3]
 v_exp_f32 v13, v13
 v_mfma_f32_16x16x32_bf16 v[0:3], a[168:171], a[152:155], v[0:3]
 v_cvt_pk_bf16_f32 v30, v12, v13
 v_fma_f32 v14, v14, s24, v41
 v_mfma_f32_16x16x32_bf16 v[0:3], a[172:175], a[156:159], v[0:3]
 v_fma_f32 v15, v15, s24, v41
 v_fma_f32 v16, v16, s24, v42
 v_mfma_f32_16x16x32_bf16 v[4:7], a[188:191], a[156:159], 0
 v_exp_f32 v14, v14
 v_mfma_f32_16x16x32_bf16 v[4:7], a[184:187], a[152:155], v[4:7]
 v_exp_f32 v15, v15
 v_mfma_f32_16x16x32_bf16 v[4:7], a[180:183], a[148:151], v[4:7]
 buffer_store_dwordx4 a[60:63], v58, s[20:23], s31 offen offset:2176 sc0 sc1 nt
 v_cvt_pk_bf16_f32 v31, v14, v15
 v_fma_f32 v17, v17, s24, v42
 v_fma_f32 v18, v18, s24, v42
 v_mfma_f32_16x16x32_bf16 v[4:7], a[176:179], a[144:147], v[4:7]
 s_mov_b32 s31, 196608
 v_exp_f32 v16, v16
 v_smfmac_f32_16x16x64_bf16 a[224:227], a[236:239], v[24:31], v55
 v_fma_f32 v19, v19, s24, v42
 v_mfma_f32_16x16x32_bf16 v[96:99], a[192:195], v[28:31], v[96:99]
 v_exp_f32 v17, v17
 v_mfma_f32_16x16x32_bf16 v[100:103], a[196:199], v[28:31], v[100:103]
 v_cvt_pk_bf16_f32 v32, v16, v17
 v_fma_f32 v20, v20, s24, v42
 v_mfma_f32_16x16x32_bf16 v[104:107], a[200:203], v[28:31], v[104:107]
 v_exp_f32 v18, v18
 v_mfma_f32_16x16x32_bf16 v[108:111], a[204:207], v[28:31], v[108:111]
 v_exp_f32 v19, v19
 v_mfma_f32_16x16x32_bf16 v[112:115], a[208:211], v[28:31], v[112:115]
 v_cvt_pk_bf16_f32 v33, v18, v19
 v_fma_f32 v21, v21, s24, v42
 v_mfma_f32_16x16x32_bf16 v[116:119], a[212:215], v[28:31], v[116:119]
 v_exp_f32 v20, v20
 v_mfma_f32_16x16x32_bf16 v[120:123], a[216:219], v[28:31], v[120:123]
 v_exp_f32 v21, v21
 v_mfma_f32_16x16x32_bf16 v[124:127], a[220:223], v[28:31], v[124:127]
 v_cvt_pk_bf16_f32 v34, v20, v21
 v_fma_f32 v22, v22, s24, v42
 v_mfma_f32_16x16x32_bf16 v[8:11], a[160:163], a[0:3], 0
 v_fma_f32 v23, v23, s24, v42
 v_fma_f32 v0, v0, s24, v43
 v_mfma_f32_16x16x32_bf16 v[8:11], a[164:167], a[4:7], v[8:11]
 v_exp_f32 v22, v22
 v_mfma_f32_16x16x32_bf16 v[8:11], a[168:171], a[8:11], v[8:11]
 v_exp_f32 v23, v23
 v_mfma_f32_16x16x32_bf16 v[8:11], a[172:175], a[12:15], v[8:11]
 v_cvt_pk_bf16_f32 v35, v22, v23
 v_fma_f32 v1, v1, s24, v43
 v_mfma_f32_16x16x32_bf16 v[12:15], a[188:191], a[12:15], 0
 v_exp_f32 v0, v0
 v_mfma_f32_16x16x32_bf16 v[12:15], a[184:187], a[8:11], v[12:15]
 v_exp_f32 v1, v1
 v_mfma_f32_16x16x32_bf16 v[12:15], a[180:183], a[4:7], v[12:15]
 v_cvt_pk_bf16_f32 v36, v0, v1
 v_fma_f32 v2, v2, s24, v43
 v_mfma_f32_16x16x32_bf16 v[12:15], a[176:179], a[0:3], v[12:15]
 v_fma_f32 v3, v3, s24, v43
 v_fma_f32 v4, v4, s24, v43
 v_mfma_f32_16x16x32_bf16 v[128:131], a[192:195], v[32:35], v[128:131]
 v_exp_f32 v2, v2
 v_mfma_f32_16x16x32_bf16 v[132:135], a[196:199], v[32:35], v[132:135]
 v_exp_f32 v3, v3
 v_mfma_f32_16x16x32_bf16 v[136:139], a[200:203], v[32:35], v[136:139]
 v_cvt_pk_bf16_f32 v37, v2, v3
 v_fma_f32 v5, v5, s24, v43
 v_mfma_f32_16x16x32_bf16 v[140:143], a[204:207], v[32:35], v[140:143]
 v_exp_f32 v4, v4
 v_mfma_f32_16x16x32_bf16 v[144:147], a[208:211], v[32:35], v[144:147]
 v_exp_f32 v5, v5
 v_mfma_f32_16x16x32_bf16 v[148:151], a[212:215], v[32:35], v[148:151]
 v_cvt_pk_bf16_f32 v38, v4, v5
 v_fma_f32 v6, v6, s24, v43
 v_mfma_f32_16x16x32_bf16 v[152:155], a[216:219], v[32:35], v[152:155]
 s_waitcnt vmcnt(16)
 v_fma_f32 v7, v7, s24, v43
 v_fma_f32 v8, v8, s24, v44
 v_mfma_f32_16x16x32_bf16 v[156:159], a[220:223], v[32:35], v[156:159]
 s_barrier
 v_exp_f32 v6, v6
 v_mfma_f32_16x16x32_bf16 v[16:19], a[160:163], a[16:19], 0
 ds_read_b128 a[160:163], v46 offset:16384
 v_fma_f32 v9, v9, s24, v44
 v_mfma_f32_16x16x32_bf16 v[16:19], a[164:167], a[20:23], v[16:19]
 v_exp_f32 v7, v7
 v_mfma_f32_16x16x32_bf16 v[16:19], a[168:171], a[24:27], v[16:19]
 ds_read_b128 a[164:167], v47 offset:16384
 v_cvt_pk_bf16_f32 v39, v6, v7
 v_mfma_f32_16x16x32_bf16 v[16:19], a[172:175], a[28:31], v[16:19]
 v_exp_f32 v8, v8
 v_mfma_f32_16x16x32_bf16 v[20:23], a[188:191], a[28:31], 0
 ds_read_b128 a[168:171], v46 offset:17408
 v_fma_f32 v10, v10, s24, v44
 v_mfma_f32_16x16x32_bf16 v[20:23], a[184:187], a[24:27], v[20:23]
 v_exp_f32 v9, v9
 v_mfma_f32_16x16x32_bf16 v[20:23], a[180:183], a[20:23], v[20:23]
 ds_read_b128 a[172:175], v47 offset:17408
 v_cvt_pk_bf16_f32 v24, v8, v9
 v_mfma_f32_16x16x32_bf16 v[20:23], a[176:179], a[16:19], v[20:23]
 v_fma_f32 v11, v11, s24, v44
 v_fma_f32 v12, v12, s24, v44
 v_smfmac_f32_16x16x64_bf16 a[228:231], a[236:239], v[32:39], v55
 ds_read_b128 a[188:191], v47 offset:21504
 v_mfma_f32_16x16x32_bf16 v[160:163], a[192:195], v[36:39], v[160:163]
 v_exp_f32 v10, v10
 v_mfma_f32_16x16x32_bf16 v[164:167], a[196:199], v[36:39], v[164:167]
 ds_read_b128 a[184:187], v46 offset:21504
 v_fma_f32 v13, v13, s24, v44
 v_mfma_f32_16x16x32_bf16 v[168:171], a[200:203], v[36:39], v[168:171]
 v_exp_f32 v11, v11
 v_mfma_f32_16x16x32_bf16 v[172:175], a[204:207], v[36:39], v[172:175]
 ds_read_b128 a[180:183], v47 offset:20480
 v_cvt_pk_bf16_f32 v25, v10, v11
 v_mfma_f32_16x16x32_bf16 v[176:179], a[208:211], v[36:39], v[176:179]
 v_exp_f32 v12, v12
 v_mfma_f32_16x16x32_bf16 v[180:183], a[212:215], v[36:39], v[180:183]
 ds_read_b128 a[176:179], v46 offset:20480
 v_fma_f32 v14, v14, s24, v44
 v_mfma_f32_16x16x32_bf16 v[184:187], a[216:219], v[36:39], v[184:187]
 v_exp_f32 v13, v13
 v_mfma_f32_16x16x32_bf16 v[188:191], a[220:223], v[36:39], v[188:191]
 s_waitcnt lgkmcnt(3)
 v_cvt_pk_bf16_f32 v26, v12, v13
 v_fma_f32 v15, v15, s24, v44
 v_mfma_f32_16x16x32_bf16 v[0:3], a[160:163], a[96:99], 0
 v_exp_f32 v14, v14
 v_mfma_f32_16x16x32_bf16 v[0:3], a[164:167], a[100:103], v[0:3]
 v_exp_f32 v15, v15
 v_mfma_f32_16x16x32_bf16 v[0:3], a[168:171], a[104:107], v[0:3]
 v_cvt_pk_bf16_f32 v27, v14, v15
 v_fma_f32 v16, v16, s24, v45
 v_mfma_f32_16x16x32_bf16 v[0:3], a[172:175], a[108:111], v[0:3]
 v_fma_f32 v17, v17, s24, v45
 v_fma_f32 v18, v18, s24, v45
 v_mfma_f32_16x16x32_bf16 v[4:7], a[188:191], a[108:111], 0
 s_waitcnt lgkmcnt(0)
 v_exp_f32 v16, v16
 v_mfma_f32_16x16x32_bf16 v[4:7], a[184:187], a[104:107], v[4:7]
 v_exp_f32 v17, v17
 v_mfma_f32_16x16x32_bf16 v[4:7], a[180:183], a[100:103], v[4:7]
 v_cvt_pk_bf16_f32 v28, v16, v17
 v_fma_f32 v19, v19, s24, v45
 v_mfma_f32_16x16x32_bf16 v[4:7], a[176:179], a[96:99], v[4:7]
 v_exp_f32 v18, v18
 v_mfma_f32_16x16x32_bf16 v[192:195], a[192:195], v[24:27], v[192:195]
 v_exp_f32 v19, v19
 v_mfma_f32_16x16x32_bf16 v[196:199], a[196:199], v[24:27], v[196:199]
 v_cvt_pk_bf16_f32 v29, v18, v19
 v_fma_f32 v20, v20, s24, v45
 v_mfma_f32_16x16x32_bf16 v[200:203], a[200:203], v[24:27], v[200:203]
 v_fma_f32 v21, v21, s24, v45
 v_fma_f32 v22, v22, s24, v45
 v_mfma_f32_16x16x32_bf16 v[204:207], a[204:207], v[24:27], v[204:207]
 v_exp_f32 v20, v20
 v_mfma_f32_16x16x32_bf16 v[208:211], a[208:211], v[24:27], v[208:211]
 v_exp_f32 v21, v21
 v_mfma_f32_16x16x32_bf16 v[212:215], a[212:215], v[24:27], v[212:215]
 v_cvt_pk_bf16_f32 v30, v20, v21
 v_fma_f32 v23, v23, s24, v45
 v_mfma_f32_16x16x32_bf16 v[216:219], a[216:219], v[24:27], v[216:219]
 v_exp_f32 v22, v22
 v_mfma_f32_16x16x32_bf16 v[220:223], a[220:223], v[24:27], v[220:223]
 v_exp_f32 v23, v23
 v_mfma_f32_16x16x32_bf16 v[8:11], a[160:163], a[112:115], 0
 v_cvt_pk_bf16_f32 v31, v22, v23
 v_fma_f32 v0, v0, s24, v63
 v_mfma_f32_16x16x32_bf16 v[8:11], a[164:167], a[116:119], v[8:11]
 v_fma_f32 v1, v1, s24, v63
 v_fma_f32 v2, v2, s24, v63
 v_mfma_f32_16x16x32_bf16 v[8:11], a[168:171], a[120:123], v[8:11]
 v_exp_f32 v0, v0
 v_mfma_f32_16x16x32_bf16 v[8:11], a[172:175], a[124:127], v[8:11]
 v_exp_f32 v1, v1
 v_mfma_f32_16x16x32_bf16 v[12:15], a[188:191], a[124:127], 0
 v_cvt_pk_bf16_f32 v32, v0, v1
 v_fma_f32 v3, v3, s24, v63
 v_mfma_f32_16x16x32_bf16 v[12:15], a[184:187], a[120:123], v[12:15]
 v_exp_f32 v2, v2
 v_mfma_f32_16x16x32_bf16 v[12:15], a[180:183], a[116:119], v[12:15]
 v_exp_f32 v3, v3
 v_mfma_f32_16x16x32_bf16 v[12:15], a[176:179], a[112:115], v[12:15]
 v_cvt_pk_bf16_f32 v33, v2, v3
 v_fma_f32 v4, v4, s24, v63
 v_smfmac_f32_16x16x64_bf16 a[232:235], a[236:239], v[24:31], v55
 v_fma_f32 v5, v5, s24, v63
 v_mfma_f32_16x16x32_bf16 v[224:227], a[192:195], v[28:31], v[224:227]
 ds_read_b64_tr_b16 a[192:193], v48 offset:16384
 ds_read_b64_tr_b16 a[194:195], v48 offset:20480
 v_mfma_f32_16x16x32_bf16 v[228:231], a[196:199], v[28:31], v[228:231]
 v_exp_f32 v4, v4
 v_mfma_f32_16x16x32_bf16 v[232:235], a[200:203], v[28:31], v[232:235]
 ds_read_b64_tr_b16 a[196:197], v49 offset:16384
 ds_read_b64_tr_b16 a[198:199], v49 offset:20480
 v_mfma_f32_16x16x32_bf16 v[236:239], a[204:207], v[28:31], v[236:239]
 v_exp_f32 v5, v5
 v_mfma_f32_16x16x32_bf16 v[240:243], a[208:211], v[28:31], v[240:243]
 ds_read_b64_tr_b16 a[200:201], v50 offset:16384
 ds_read_b64_tr_b16 a[202:203], v50 offset:20480
 v_mfma_f32_16x16x32_bf16 v[244:247], a[212:215], v[28:31], v[244:247]
 v_cvt_pk_bf16_f32 v34, v4, v5
 v_fma_f32 v6, v6, s24, v63
 v_mfma_f32_16x16x32_bf16 v[248:251], a[216:219], v[28:31], v[248:251]
 ds_read_b64_tr_b16 a[204:205], v51 offset:16384
 ds_read_b64_tr_b16 a[206:207], v51 offset:20480
 v_mfma_f32_16x16x32_bf16 v[252:255], a[220:223], v[28:31], v[252:255]
 v_fma_f32 v7, v7, s24, v63
 v_fma_f32 v8, v8, s24, v41
 v_mfma_f32_16x16x32_bf16 v[16:19], a[160:163], a[128:131], 0
 ds_read_b64_tr_b16 a[208:209], v48 offset:17408
 ds_read_b64_tr_b16 a[210:211], v48 offset:21504
 v_mfma_f32_16x16x32_bf16 v[16:19], a[164:167], a[132:135], v[16:19]
 v_exp_f32 v6, v6
 v_mfma_f32_16x16x32_bf16 v[16:19], a[168:171], a[136:139], v[16:19]
 ds_read_b64_tr_b16 a[212:213], v49 offset:17408
 ds_read_b64_tr_b16 a[214:215], v49 offset:21504
 v_mfma_f32_16x16x32_bf16 v[16:19], a[172:175], a[140:143], v[16:19]
 v_exp_f32 v7, v7
 v_mfma_f32_16x16x32_bf16 v[20:23], a[188:191], a[140:143], 0
 ds_read_b64_tr_b16 a[216:217], v50 offset:17408
 ds_read_b64_tr_b16 a[218:219], v50 offset:21504
 v_mfma_f32_16x16x32_bf16 v[20:23], a[184:187], a[136:139], v[20:23]
 v_cvt_pk_bf16_f32 v35, v6, v7
 v_fma_f32 v9, v9, s24, v41
 v_mfma_f32_16x16x32_bf16 v[20:23], a[180:183], a[132:135], v[20:23]
 ds_read_b64_tr_b16 a[220:221], v51 offset:17408
 ds_read_b64_tr_b16 a[222:223], v51 offset:21504
 v_mfma_f32_16x16x32_bf16 v[20:23], a[176:179], a[128:131], v[20:23]
 s_waitcnt lgkmcnt(6)
 v_exp_f32 v8, v8
 v_mfma_f32_16x16x32_bf16 v[64:67], a[192:195], v[32:35], v[64:67]
 v_exp_f32 v9, v9
 v_mfma_f32_16x16x32_bf16 v[68:71], a[196:199], v[32:35], v[68:71]
 v_cvt_pk_bf16_f32 v36, v8, v9
 v_fma_f32 v10, v10, s24, v41
 v_mfma_f32_16x16x32_bf16 v[72:75], a[200:203], v[32:35], v[72:75]
 v_fma_f32 v11, v11, s24, v41
 v_fma_f32 v12, v12, s24, v41
 v_mfma_f32_16x16x32_bf16 v[76:79], a[204:207], v[32:35], v[76:79]
 v_exp_f32 v10, v10
 v_mfma_f32_16x16x32_bf16 v[80:83], a[208:211], v[32:35], v[80:83]
 s_waitcnt lgkmcnt(2)
 v_exp_f32 v11, v11
 v_mfma_f32_16x16x32_bf16 v[84:87], a[212:215], v[32:35], v[84:87]
 v_cvt_pk_bf16_f32 v37, v10, v11
 v_fma_f32 v13, v13, s24, v41
 v_mfma_f32_16x16x32_bf16 v[88:91], a[216:219], v[32:35], v[88:91]
 s_waitcnt lgkmcnt(0)
 v_exp_f32 v12, v12
 v_mfma_f32_16x16x32_bf16 v[92:95], a[220:223], v[32:35], v[92:95]
 v_exp_f32 v13, v13
 v_mfma_f32_16x16x32_bf16 v[0:3], a[160:163], a[144:147], 0
 v_cvt_pk_bf16_f32 v38, v12, v13
 v_fma_f32 v14, v14, s24, v41
 v_mfma_f32_16x16x32_bf16 v[0:3], a[164:167], a[148:151], v[0:3]
 v_fma_f32 v15, v15, s24, v41
 v_fma_f32 v16, v16, s24, v42
 v_mfma_f32_16x16x32_bf16 v[0:3], a[168:171], a[152:155], v[0:3]
 v_exp_f32 v14, v14
 v_mfma_f32_16x16x32_bf16 v[0:3], a[172:175], a[156:159], v[0:3]
 v_exp_f32 v15, v15
 v_mfma_f32_16x16x32_bf16 v[4:7], a[188:191], a[156:159], 0
 v_cvt_pk_bf16_f32 v39, v14, v15
 v_fma_f32 v17, v17, s24, v42
 v_mfma_f32_16x16x32_bf16 v[4:7], a[184:187], a[152:155], v[4:7]
 v_exp_f32 v16, v16
 v_mfma_f32_16x16x32_bf16 v[4:7], a[180:183], a[148:151], v[4:7]
 v_exp_f32 v17, v17
 v_mfma_f32_16x16x32_bf16 v[4:7], a[176:179], a[144:147], v[4:7]
 v_cvt_pk_bf16_f32 v24, v16, v17
 v_fma_f32 v18, v18, s24, v42
 v_smfmac_f32_16x16x64_bf16 a[224:227], a[236:239], v[32:39], v55
 v_fma_f32 v19, v19, s24, v42
 v_mfma_f32_16x16x32_bf16 v[96:99], a[192:195], v[36:39], v[96:99]
 v_exp_f32 v18, v18
 v_mfma_f32_16x16x32_bf16 v[100:103], a[196:199], v[36:39], v[100:103]
 v_exp_f32 v19, v19
 v_mfma_f32_16x16x32_bf16 v[104:107], a[200:203], v[36:39], v[104:107]
 v_cvt_pk_bf16_f32 v25, v18, v19
 v_fma_f32 v20, v20, s24, v42
 v_mfma_f32_16x16x32_bf16 v[108:111], a[204:207], v[36:39], v[108:111]
L_stub13:
 s_cbranch_vccnz L_back0
.if ((L_stub13-L_main)>>6) != 832
.error "stub misplaced"
.endif
 v_fma_f32 v21, v21, s24, v42
 v_fma_f32 v22, v22, s24, v42
 v_mfma_f32_16x16x32_bf16 v[112:115], a[208:211], v[36:39], v[112:115]
 v_exp_f32 v20, v20
 v_mfma_f32_16x16x32_bf16 v[116:119], a[212:215], v[36:39], v[116:119]
 v_exp_f32 v21, v21
 v_mfma_f32_16x16x32_bf16 v[120:123], a[216:219], v[36:39], v[120:123]
 v_cvt_pk_bf16_f32 v26, v20, v21
 v_fma_f32 v23, v23, s24, v42
 v_mfma_f32_16x16x32_bf16 v[124:127], a[220:223], v[36:39], v[124:127]
 v_exp_f32 v22, v22
 v_mfma_f32_16x16x32_bf16 v[8:11], a[160:163], a[0:3], 0
 v_exp_f32 v23, v23
 v_mfma_f32_16x16x32_bf16 v[8:11], a[164:167], a[4:7], v[8:11]
 v_cvt_pk_bf16_f32 v27, v22, v23
 v_fma_f32 v0, v0, s24, v43
 v_mfma_f32_16x16x32_bf16 v[8:11], a[168:171], a[8:11], v[8:11]
 v_fma_f32 v1, v1, s24, v43
 v_fma_f32 v2, v2, s24, v43
 v_mfma_f32_16x16x32_bf16 v[8:11], a[172:175], a[12:15], v[8:11]
 v_exp_f32 v0, v0
 v_mfma_f32_16x16x32_bf16 v[12:15], a[188:191], a[12:15], 0
 v_exp_f32 v1, v1
 v_mfma_f32_16x16x32_bf16 v[12:15], a[184:187], a[8:11], v[12:15]
 v_cvt_pk_bf16_f32 v28, v0, v1
 v_fma_f32 v3, v3, s24, v43
 v_mfma_f32_16x16x32_bf16 v[12:15], a[180:183], a[4:7], v[12:15]
 v_exp_f32 v2, v2
 v_mfma_f32_16x16x32_bf16 v[12:15], a[176:179], a[0:3], v[12:15]
 v_exp_f32 v3, v3
 v_mfma_f32_16x16x32_bf16 v[128:131], a[192:195], v[24:27], v[128:131]
 v_cvt_pk_bf16_f32 v29, v2, v3
 v_fma_f32 v4, v4, s24, v43
 v_mfma_f32_16x16x32_bf16 v[132:135], a[196:199], v[24:27], v[132:135]
 v_fma_f32 v5, v5, s24, v43
 v_fma_f32 v6, v6, s24, v43
 v_mfma_f32_16x16x32_bf16 v[136:139], a[200:203], v[24:27], v[136:139]
 v_exp_f32 v4, v4
 v_mfma_f32_16x16x32_bf16 v[140:143], a[204:207], v[24:27], v[140:143]
 v_exp_f32 v5, v5
 v_mfma_f32_16x16x32_bf16 v[144:147], a[208:211], v[24:27], v[144:147]
 v_cvt_pk_bf16_f32 v30, v4, v5
 v_fma_f32 v7, v7, s24, v43
 v_mfma_f32_16x16x32_bf16 v[148:151], a[212:215], v[24:27], v[148:151]
 v_exp_f32 v6, v6
 v_mfma_f32_16x16x32_bf16 v[152:155], a[216:219], v[24:27], v[152:155]
 v_exp_f32 v7, v7
 v_mfma_f32_16x16x32_bf16 v[156:159], a[220:223], v[24:27], v[156:159]
 v_cvt_pk_bf16_f32 v31, v6, v7
 v_fma_f32 v8, v8, s24, v44
 v_mfma_f32_16x16x32_bf16 v[16:19], a[160:163], a[16:19], 0
 ds_read_b128 a[160:163], v46 offset:24576
 v_fma_f32 v9, v9, s24, v44
 v_mfma_f32_16x16x32_bf16 v[16:19], a[164:167], a[20:23], v[16:19]
 v_exp_f32 v8, v8
 v_mfma_f32_16x16x32_bf16 v[16:19], a[168:171], a[24:27], v[16:19]
 ds_read_b128 a[164:167], v47 offset:24576
 v_fma_f32 v10, v10, s24, v44
 v_mfma_f32_16x16x32_bf16 v[16:19], a[172:175], a[28:31], v[16:19]
 v_exp_f32 v9, v9
 v_mfma_f32_16x16x32_bf16 v[20:23], a[188:191], a[28:31], 0
 ds_read_b128 a[168:171], v46 offset:25600
 v_cvt_pk_bf16_f32 v32, v8, v9
 v_mfma_f32_16x16x32_bf16 v[20:23], a[184:187], a[24:27], v[20:23]
 v_fma_f32 v11, v11, s24, v44
 v_fma_f32 v12, v12, s24, v44
 v_mfma_f32_16x16x32_bf16 v[20:23], a[180:183], a[20:23], v[20:23]
 ds_read_b128 a[172:175], v47 offset:25600
 v_fma_f32 v13, v13, s24, v44
 v_mfma_f32_16x16x32_bf16 v[20:23], a[176:179], a[16:19], v[20:23]
 v_exp_f32 v10, v10
 v_smfmac_f32_16x16x64_bf16 a[228:231], a[236:239], v[24:31], v55
 ds_read_b128 a[188:191], v47 offset:29696
 v_mfma_f32_16x16x32_bf16 v[160:163], a[192:195], v[28:31], v[160:163]
 v_exp_f32 v11, v11
 v_mfma_f32_16x16x32_bf16 v[164:167], a[196:199], v[28:31], v[164:167]
 ds_read_b128 a[184:187], v46 offset:29696
 v_cvt_pk_bf16_f32 v33, v10, v11
 v_mfma_f32_16x16x32_bf16 v[168:171], a[200:203], v[28:31], v[168:171]
 v_exp_f32 v12, v12
 v_mfma_f32_16x16x32_bf16 v[172:175], a[204:207], v[28:31], v[172:175]
 ds_read_b128 a[180:183], v47 offset:28672
 v_fma_f32 v14, v14, s24, v44
 v_mfma_f32_16x16x32_bf16 v[176:179], a[208:211], v[28:31], v[176:179]
 v_exp_f32 v13, v13
 v_mfma_f32_16x16x32_bf16 v[180:183], a[212:215], v[28:31], v[180:183]
 ds_read_b128 a[176:179], v46 offset:28672
 v_cvt_pk_bf16_f32 v34, v12, v13
 v_mfma_f32_16x16x32_bf16 v[184:187], a[216:219], v[28:31], v[184:187]
 v_fma_f32 v15, v15, s24, v44
 v_fma_f32 v16, v16, s24, v45
 v_mfma_f32_16x16x32_bf16 v[188:191], a[220:223], v[28:31], v[188:191]
 s_waitcnt lgkmcnt(3)
 v_exp_f32 v14, v14
 v_mfma_f32_16x16x32_bf16 v[0:3], a[160:163], a[96:99], 0
 v_exp_f32 v15, v15
 v_mfma_f32_16x16x32_bf16 v[0:3], a[164:167], a[100:103], v[0:3]
 v_cvt_pk_bf16_f32 v35, v14, v15
 v_fma_f32 v17, v17, s24, v45
 v_mfma_f32_16x16x32_bf16 v[0:3], a[168:171], a[104:107], v[0:3]
 v_exp_f32 v16, v16
 v_mfma_f32_16x16x32_bf16 v[0:3], a[172:175], a[108:111], v[0:3]
 v_exp_f32 v17, v17
 v_mfma_f32_16x16x32_bf16 v[4:7], a[188:191], a[108:111], 0
 s_waitcnt lgkmcnt(0)
 v_cvt_pk_bf16_f32 v36, v16, v17
 v_fma_f32 v18, v18, s24, v45
 v_mfma_f32_16x16x32_bf16 v[4:7], a[184:187], a[104:107], v[4:7]
 v_fma_f32 v19, v19, s24, v45
 v_fma_f32 v20, v20, s24, v45
 v_mfma_f32_16x16x32_bf16 v[4:7], a[180:183], a[100:103], v[4:7]
 v_exp_f32 v18, v18
 v_mfma_f32_16x16x32_bf16 v[4:7], a[176:179], a[96:99], v[4:7]
 v_exp_f32 v19, v19
 v_mfma_f32_16x16x32_bf16 v[192:195], a[192:195], v[32:35], v[192:195]
 v_cvt_pk_bf16_f32 v37, v18, v19
 v_fma_f32 v21, v21, s24, v45
 v_mfma_f32_16x16x32_bf16 v[196:199], a[196:199], v[32:35], v[196:199]
 v_exp_f32 v20, v20
 v_mfma_f32_16x16x32_bf16 v[200:203], a[200:203], v[32:35], v[200:203]
 v_exp_f32 v21, v21
 v_mfma_f32_16x16x32_bf16 v[204:207], a[204:207], v[32:35], v[204:207]
 v_cvt_pk_bf16_f32 v38, v20, v21
 v_fma_f32 v22, v22, s24, v45
 v_mfma_f32_16x16x32_bf16 v[208:211], a[208:211], v[32:35], v[208:211]
 v_fma_f32 v23, v23, s24, v45
 v_fma_f32 v0, v0, s24, v63
 v_mfma_f32_16x16x32_bf16 v[212:215], a[212:215], v[32:35], v[212:215]
 v_exp_f32 v22, v22
 v_mfma_f32_16x16x32_bf16 v[216:219], a[216:219], v[32:35], v[216:219]
 v_exp_f32 v23, v23
 v_mfma_f32_16x16x32_bf16 v[220:223], a[220:223], v[32:35], v[220:223]
 v_cvt_pk_bf16_f32 v39, v22, v23
 v_fma_f32 v1, v1, s24, v63
 v_mfma_f32_16x16x32_bf16 v[8:11], a[160:163], a[112:115], 0
 ds_read_b128 a[160:163], v46 offset:40960
 v_fma_f32 v2, v2, s24, v63
 v_mfma_f32_16x16x32_bf16 v[8:11], a[164:167], a[116:119], v[8:11]
 v_exp_f32 v0, v0
 v_mfma_f32_16x16x32_bf16 v[8:11], a[168:171], a[120:123], v[8:11]
 ds_read_b128 a[164:167], v47 offset:40960
 v_fma_f32 v3, v3, s24, v63
 v_mfma_f32_16x16x32_bf16 v[8:11], a[172:175], a[124:127], v[8:11]
 v_exp_f32 v1, v1
 v_mfma_f32_16x16x32_bf16 v[12:15], a[188:191], a[124:127], 0
 ds_read_b128 a[168:171], v46 offset:41984
 v_cvt_pk_bf16_f32 v24, v0, v1
 v_mfma_f32_16x16x32_bf16 v[12:15], a[184:187], a[120:123], v[12:15]
 v_exp_f32 v2, v2
 v_mfma_f32_16x16x32_bf16 v[12:15], a[180:183], a[116:119], v[12:15]
 ds_read_b128 a[172:175], v47 offset:41984
 v_fma_f32 v4, v4, s24, v63
 v_mfma_f32_16x16x32_bf16 v[12:15], a[176:179], a[112:115], v[12:15]
 v_exp_f32 v3, v3
 v_smfmac_f32_16x16x64_bf16 a[232:235], a[236:239], v[32:39], v55
 ds_read_b128 a[188:191], v47 offset:46080
 v_mfma_f32_16x16x32_bf16 v[224:227], a[192:195], v[36:39], v[224:227]
 v_cvt_pk_bf16_f32 v25, v2, v3
 v_fma_f32 v5, v5, s24, v63
 v_mfma_f32_16x16x32_bf16 v[228:231], a[196:199], v[36:39], v[228:231]
 ds_read_b128 a[184:187], v46 offset:46080
 v_fma_f32 v6, v6, s24, v63
 v_mfma_f32_16x16x32_bf16 v[232:235], a[200:203], v[36:39], v[232:235]
 v_exp_f32 v4, v4
 v_mfma_f32_16x16x32_bf16 v[236:239], a[204:207], v[36:39], v[236:239]
 ds_read_b128 a[180:183], v47 offset:45056
 v_fma_f32 v7, v7, s24, v63
 v_mfma_f32_16x16x32_bf16 v[240:243], a[208:211], v[36:39], v[240:243]
 v_exp_f32 v5, v5
 v_mfma_f32_16x16x32_bf16 v[244:247], a[212:215], v[36:39], v[244:247]
 ds_read_b128 a[176:179], v46 offset:45056
 v_cvt_pk_bf16_f32 v26, v4, v5
 v_mfma_f32_16x16x32_bf16 v[248:251], a[216:219], v[36:39], v[248:251]
 v_exp_f32 v6, v6
 v_mfma_f32_16x16x32_bf16 v[252:255], a[220:223], v[36:39], v[252:255]
 s_waitcnt lgkmcnt(3)
 ds_read_b64_tr_b16 a[192:193], v48 offset:24576
 ds_read_b64_tr_b16 a[194:195], v48 offset:28672
 v_mfma_f32_16x16x32_bf16 v[16:19], a[160:163], a[96:99], 0
 ds_read_b64_tr_b16 a[196:197], v49 offset:24576
 ds_read_b64_tr_b16 a[198:199], v49 offset:28672
 v_mfma_f32_16x16x32_bf16 v[16:19], a[164:167], a[100:103], v[16:19]
 ds_read_b64_tr_b16 a[200:201], v50 offset:24576
 ds_read_b64_tr_b16 a[202:203], v50 offset:28672
 v_mfma_f32_16x16x32_bf16 v[16:19], a[168:171], a[104:107], v[16:19]
 ds_read_b64_tr_b16 a[204:205], v51 offset:24576
 ds_read_b64_tr_b16 a[206:207], v51 offset:28672
 v_mfma_f32_16x16x32_bf16 v[16:19], a[172:175], a[108:111], v[16:19]
 ds_read_b64_tr_b16 a[208:209], v48 offset:25600
 ds_read_b64_tr_b16 a[210:211], v48 offset:29696
 v_mfma_f32_16x16x32_bf16 v[20:23], a[188:191], a[108:111], 0
 s_waitcnt lgkmcnt(10)
 ds_read_b64_tr_b16 a[212:213], v49 offset:25600
 ds_read_b64_tr_b16 a[214:215], v49 offset:29696
 v_mfma_f32_16x16x32_bf16 v[20:23], a[184:187], a[104:107], v[20:23]
 ds_read_b64_tr_b16 a[216:217], v50 offset:25600
 ds_read_b64_tr_b16 a[218:219], v50 offset:29696
 v_exp_f32 v7, v7
 v_mfma_f32_16x16x32_bf16 v[20:23], a[180:183], a[100:103], v[20:23]
 ds_read_b64_tr_b16 a[220:221], v51 offset:25600
 ds_read_b64_tr_b16 a[222:223], v51 offset:29696
 v_cvt_pk_bf16_f32 v27, v6, v7
 v_mfma_f32_16x16x32_bf16 v[20:23], a[176:179], a[96:99], v[20:23]
 s_waitcnt lgkmcnt(12)
 v_fma_f32 v8, v8, s24, v41
 v_fma_f32 v9, v9, s24, v41
 v_mfma_f32_16x16x32_bf16 v[64:67], a[192:195], v[24:27], v[64:67]
 v_exp_f32 v8, v8
 v_mfma_f32_16x16x32_bf16 v[68:71], a[196:199], v[24:27], v[68:71]
 s_waitcnt lgkmcnt(8)
 v_exp_f32 v9, v9
 v_mfma_f32_16x16x32_bf16 v[72:75], a[200:203], v[24:27], v[72:75]
 v_cvt_pk_bf16_f32 v28, v8, v9
 v_fma_f32 v10, v10, s24, v41
 v_mfma_f32_16x16x32_bf16 v[76:79], a[204:207], v[24:27], v[76:79]
 s_waitcnt lgkmcnt(4)
 v_fma_f32 v11, v11, s24, v41
 v_fma_f32 v12, v12, s24, v41
 v_mfma_f32_16x16x32_bf16 v[80:83], a[208:211], v[24:27], v[80:83]
 v_exp_f32 v10, v10
 v_mfma_f32_16x16x32_bf16 v[84:87], a[212:215], v[24:27], v[84:87]
 s_waitcnt lgkmcnt(0)
 v_exp_f32 v11, v11
 v_mfma_f32_16x16x32_bf16 v[88:91], a[216:219], v[24:27], v[88:91]
 s_waitcnt vmcnt(3)
 v_cvt_pk_bf16_f32 v29, v10, v11
 v_fma_f32 v13, v13, s24, v41
 v_mfma_f32_16x16x32_bf16 v[92:95], a[220:223], v[24:27], v[92:95]
 s_barrier
 v_exp_f32 v12, v12
 v_mfma_f32_16x16x32_bf16 v[0:3], a[160:163], a[112:115], 0
 ds_read_b128 a[160:163], v46 offset:49152
 v_fma_f32 v14, v14, s24, v41
 v_mfma_f32_16x16x32_bf16 v[0:3], a[164:167], a[116:119], v[0:3]
 v_exp_f32 v13, v13
 v_mfma_f32_16x16x32_bf16 v[0:3], a[168:171], a[120:123], v[0:3]
 ds_read_b128 a[164:167], v47 offset:49152
 v_cvt_pk_bf16_f32 v30, v12, v13
 v_mfma_f32_16x16x32_bf16 v[0:3], a[172:175], a[124:127], v[0:3]
 v_fma_f32 v15, v15, s24, v41
 v_fma_f32 v16, v16, s24, v63
 v_mfma_f32_16x16x32_bf16 v[4:7], a[188:191], a[124:127], 0
 ds_read_b128 a[168:171], v46 offset:50176
 v_exp_f32 v14, v14
 v_mfma_f32_16x16x32_bf16 v[4:7], a[184:187], a[120:123], v[4:7]
 v_exp_f32 v15, v15
 v_mfma_f32_16x16x32_bf16 v[4:7], a[180:183], a[116:119], v[4:7]
 ds_read_b128 a[172:175], v47 offset:50176
 v_cvt_pk_bf16_f32 v31, v14, v15
 v_mfma_f32_16x16x32_bf16 v[4:7], a[176:179], a[112:115], v[4:7]
 v_fma_f32 v17, v17, s24, v63
 v_fma_f32 v18, v18, s24, v63
 v_smfmac_f32_16x16x64_bf16 a[224:227], a[236:239], v[24:31], v55
 ds_read_b128 a[188:191], v47 offset:54272
 v_mfma_f32_16x16x32_bf16 v[96:99], a[192:195], v[28:31], v[96:99]
 v_exp_f32 v16, v16
 v_mfma_f32_16x16x32_bf16 v[100:103], a[196:199], v[28:31], v[100:103]
 ds_read_b128 a[184:187], v46 offset:54272
 v_fma_f32 v19, v19, s24, v63
 v_mfma_f32_16x16x32_bf16 v[104:107], a[200:203], v[28:31], v[104:107]
 v_exp_f32 v17, v17
 v_mfma_f32_16x16x32_bf16 v[108:111], a[204:207], v[28:31], v[108:111]
 ds_read_b128 a[180:183], v47 offset:53248
 v_cvt_pk_bf16_f32 v32, v16, v17
 v_mfma_f32_16x16x32_bf16 v[112:115], a[208:211], v[28:31], v[112:115]
 v_exp_f32 v18, v18
 v_mfma_f32_16x16x32_bf16 v[116:119], a[212:215], v[28:31], v[116:119]
 ds_read_b128 a[176:179], v46 offset:53248
 v_fma_f32 v20, v20, s24, v63
 v_mfma_f32_16x16x32_bf16 v[120:123], a[216:219], v[28:31], v[120:123]
 v_exp_f32_e64 v19, v19
 v_mfma_f32_16x16x32_bf16 v[124:127], a[220:223], v[28:31], v[124:127]
 s_waitcnt lgkmcnt(3)
 ds_read_b64_tr_b16 a[192:193], v48 offset:40960
 ds_read_b64_tr_b16 a[194:195], v48 offset:45056
 v_mfma_f32_16x16x32_bf16 v[8:11], a[160:163], a[96:99], 0
 ds_read_b64_tr_b16 a[196:197], v49 offset:40960
 ds_read_b64_tr_b16 a[198:199], v49 offset:45056
 v_cvt_pk_bf16_f32 v33, v18, v19
 v_mfma_f32_16x16x32_bf16 v[8:11], a[164:167], a[100:103], v[8:11]
 ds_read_b64_tr_b16 a[200:201], v50 offset:40960
 ds_read_b64_tr_b16 a[202:203], v50 offset:45056
 v_fma_f32 v21, v21, s24, v63
 v_exp_f32 v20, v20
 v_mfma_f32_16x16x32_bf16 v[8:11], a[168:171], a[104:107], v[8:11]
 ds_read_b64_tr_b16 a[204:205], v51 offset:40960
 ds_read_b64_tr_b16 a[206:207], v51 offset:45056
 v_exp_f32 v21, v21
 v_mfma_f32_16x16x32_bf16 v[8:11], a[172:175], a[108:111], v[8:11]
 ds_read_b64_tr_b16 a[208:209], v48 offset:41984
 ds_read_b64_tr_b16 a[210:211], v48 offset:46080
 v_cvt_pk_bf16_f32 v34, v20, v21
 v_fma_f32 v22, v22, s24, v63
 v_mfma_f32_16x16x32_bf16 v[12:15], a[188:191], a[108:111], 0
 s_waitcnt lgkmcnt(10)
 ds_read_b64_tr_b16 a[212:213], v49 offset:41984
 ds_read_b64_tr_b16 a[214:215], v49 offset:46080
 v_fma_f32 v23, v23, s24, v63
 v_exp_f32 v22, v22
 v_mfma_f32_16x16x32_bf16 v[12:15], a[184:187], a[104:107], v[12:15]
 ds_read_b64_tr_b16 a[216:217], v50 offset:41984
 ds_read_b64_tr_b16 a[218:219], v50 offset:46080
 v_exp_f32 v23, v23
 v_mfma_f32_16x16x32_bf16 v[12:15], a[180:183], a[100:103], v[12:15]
 ds_read_b64_tr_b16 a[220:221], v51 offset:41984
 ds_read_b64_tr_b16 a[222:223], v51 offset:46080
 v_cvt_pk_bf16_f32 v35, v22, v23
 v_mfma_f32_16x16x32_bf16 v[12:15], a[176:179], a[96:99], v[12:15]
 s_waitcnt lgkmcnt(12)
 v_fma_f32 v0, v0, s24, v41
 v_fma_f32 v1, v1, s24, v41
 v_mfma_f32_16x16x32_bf16 v[64:67], a[192:195], v[32:35], v[64:67]
 v_exp_f32 v0, v0
 v_mfma_f32_16x16x32_bf16 v[68:71], a[196:199], v[32:35], v[68:71]
 s_waitcnt lgkmcnt(8)
 v_exp_f32 v1, v1
 v_mfma_f32_16x16x32_bf16 v[72:75], a[200:203], v[32:35], v[72:75]
 v_cvt_pk_bf16_f32 v36, v0, v1
 v_fma_f32 v2, v2, s24, v41
 v_mfma_f32_16x16x32_bf16 v[76:79], a[204:207], v[32:35], v[76:79]
 s_waitcnt lgkmcnt(4)
 v_fma_f32 v3, v3, s24, v41
 v_fma_f32 v4, v4, s24, v41
 v_mfma_f32_16x16x32_bf16 v[80:83], a[208:211], v[32:35], v[80:83]
 v_exp_f32 v2, v2
 v_mfma_f32_16x16x32_bf16 v[84:87], a[212:215], v[32:35], v[84:87]
 s_waitcnt lgkmcnt(0)
 v_exp_f32 v3, v3
 v_mfma_f32_16x16x32_bf16 v[88:91], a[216:219], v[32:35], v[88:91]
 s_waitcnt vmcnt(1)
 v_cvt_pk_bf16_f32 v37, v2, v3
 v_fma_f32 v5, v5, s24, v41
 v_mfma_f32_16x16x32_bf16 v[92:95], a[220:223], v[32:35], v[92:95]
 s_barrier
 v_exp_f32 v4, v4
 v_mfma_f32_16x16x32_bf16 v[16:19], a[160:163], a[112:115], 0
 ds_read_b128 a[160:163], v46 offset:57344
 v_fma_f32 v6, v6, s24, v41
 v_mfma_f32_16x16x32_bf16 v[16:19], a[164:167], a[116:119], v[16:19]
 v_exp_f32 v5, v5
 v_mfma_f32_16x16x32_bf16 v[16:19], a[168:171], a[120:123], v[16:19]
 ds_read_b128 a[164:167], v47 offset:57344
 v_cvt_pk_bf16_f32 v38, v4, v5
 v_mfma_f32_16x16x32_bf16 v[16:19], a[172:175], a[124:127], v[16:19]
 v_fma_f32 v7, v7, s24, v41
 v_fma_f32 v8, v8, s24, v63
 v_mfma_f32_16x16x32_bf16 v[20:23], a[188:191], a[124:127], 0
 ds_read_b128 a[168:171], v46 offset:58368
 v_exp_f32 v6, v6
 v_mfma_f32_16x16x32_bf16 v[20:23], a[184:187], a[120:123], v[20:23]
 v_exp_f32 v7, v7
 v_mfma_f32_16x16x32_bf16 v[20:23], a[180:183], a[116:119], v[20:23]
 ds_read_b128 a[172:175], v47 offset:58368
 v_cvt_pk_bf16_f32 v39, v6, v7
 v_mfma_f32_16x16x32_bf16 v[20:23], a[176:179], a[112:115], v[20:23]
 v_fma_f32 v9, v9, s24, v63
 v_fma_f32 v10, v10, s24, v63
 v_smfmac_f32_16x16x64_bf16 a[224:227], a[236:239], v[32:39], v55
 ds_read_b128 a[188:191], v47 offset:62464
 v_mfma_f32_16x16x32_bf16 v[96:99], a[192:195], v[36:39], v[96:99]
 v_exp_f32 v8, v8
 v_mfma_f32_16x16x32_bf16 v[100:103], a[196:199], v[36:39], v[100:103]
 ds_read_b128 a[184:187], v46 offset:62464
 v_fma_f32 v11, v11, s24, v63
 v_mfma_f32_16x16x32_bf16 v[104:107], a[200:203], v[36:39], v[104:107]
 v_exp_f32 v9, v9
 v_mfma_f32_16x16x32_bf16 v[108:111], a[204:207], v[36:39], v[108:111]
 ds_read_b128 a[180:183], v47 offset:61440
 v_cvt_pk_bf16_f32 v24, v8, v9
 v_mfma_f32_16x16x32_bf16 v[112:115], a[208:211], v[36:39], v[112:115]
 v_exp_f32 v10, v10
 v_mfma_f32_16x16x32_bf16 v[116:119], a[212:215], v[36:39], v[116:119]
 ds_read_b128 a[176:179], v46 offset:61440
 v_fma_f32 v12, v12, s24, v63
 v_mfma_f32_16x16x32_bf16 v[120:123], a[216:219], v[36:39], v[120:123]
 v_exp_f32 v11, v11
 v_mfma_f32_16x16x32_bf16 v[124:127], a[220:223], v[36:39], v[124:127]
 s_waitcnt lgkmcnt(3)
 ds_read_b64_tr_b16 a[192:193], v48 offset:49152
 ds_read_b64_tr_b16 a[194:195], v48 offset:53248
 v_mfma_f32_16x16x32_bf16 v[0:3], a[160:163], a[96:99], 0
 ds_read_b64_tr_b16 a[196:197], v49 offset:49152
 ds_read_b64_tr_b16 a[198:199], v49 offset:53248
 v_cvt_pk_bf16_f32 v25, v10, v11
 v_mfma_f32_16x16x32_bf16 v[0:3], a[164:167], a[100:103], v[0:3]
 ds_read_b64_tr_b16 a[200:201], v50 offset:49152
 ds_read_b64_tr_b16 a[202:203], v50 offset:53248
 v_fma_f32 v13, v13, s24, v63
 v_exp_f32 v12, v12
 v_mfma_f32_16x16x32_bf16 v[0:3], a[168:171], a[104:107], v[0:3]
 ds_read_b64_tr_b16 a[204:205], v51 offset:49152
 ds_read_b64_tr_b16 a[206:207], v51 offset:53248
 v_exp_f32 v13, v13
 v_mfma_f32_16x16x32_bf16 v[0:3], a[172:175], a[108:111], v[0:3]
 ds_read_b64_tr_b16 a[208:209], v48 offset:50176
 ds_read_b64_tr_b16 a[210:211], v48 offset:54272
 v_cvt_pk_bf16_f32 v26, v12, v13
 v_fma_f32 v14, v14, s24, v63
 v_mfma_f32_16x16x32_bf16 v[4:7], a[188:191], a[108:111], 0
 s_waitcnt lgkmcnt(10)
 ds_read_b64_tr_b16 a[212:213], v49 offset:50176
 ds_read_b64_tr_b16 a[214:215], v49 offset:54272
 v_fma_f32 v15, v15, s24, v63
 v_exp_f32 v14, v14
 v_mfma_f32_16x16x32_bf16 v[4:7], a[184:187], a[104:107], v[4:7]
 ds_read_b64_tr_b16 a[216:217], v50 offset:50176
 ds_read_b64_tr_b16 a[218:219], v50 offset:54272
 v_exp_f32 v15, v15
 v_mfma_f32_16x16x32_bf16 v[4:7], a[180:183], a[100:103], v[4:7]
 ds_read_b64_tr_b16 a[220:221], v51 offset:50176
 ds_read_b64_tr_b16 a[222:223], v51 offset:54272
 v_cvt_pk_bf16_f32 v27, v14, v15
 v_mfma_f32_16x16x32_bf16 v[4:7], a[176:179], a[96:99], v[4:7]
 s_waitcnt lgkmcnt(12)
 v_fma_f32 v16, v16, s24, v41
 v_fma_f32 v17, v17, s24, v41
 v_mfma_f32_16x16x32_bf16 v[64:67], a[192:195], v[24:27], v[64:67]
 v_exp_f32 v16, v16
 v_mfma_f32_16x16x32_bf16 v[68:71], a[196:199], v[24:27], v[68:71]
 s_waitcnt lgkmcnt(8)
 v_exp_f32 v17, v17
 v_mfma_f32_16x16x32_bf16 v[72:75], a[200:203], v[24:27], v[72:75]
 v_cvt_pk_bf16_f32 v28, v16, v17
 v_fma_f32 v18, v18, s24, v41
 v_mfma_f32_16x16x32_bf16 v[76:79], a[204:207], v[24:27], v[76:79]
 s_waitcnt lgkmcnt(4)
 v_fma_f32 v19, v19, s24, v41
 v_fma_f32 v20, v20, s24, v41
 v_mfma_f32_16x16x32_bf16 v[80:83], a[208:211], v[24:27], v[80:83]
 v_exp_f32 v18, v18
 v_mfma_f32_16x16x32_bf16 v[84:87], a[212:215], v[24:27], v[84:87]
 s_waitcnt lgkmcnt(0)
 v_exp_f32 v19, v19
 v_mfma_f32_16x16x32_bf16 v[88:91], a[216:219], v[24:27], v[88:91]
 v_cvt_pk_bf16_f32 v29, v18, v19
 v_fma_f32 v21, v21, s24, v41
 v_mfma_f32_16x16x32_bf16 v[92:95], a[220:223], v[24:27], v[92:95]
 v_exp_f32 v20, v20
 v_mfma_f32_16x16x32_bf16 v[8:11], a[160:163], a[112:115], 0
 v_exp_f32 v21, v21
 v_mfma_f32_16x16x32_bf16 v[8:11], a[164:167], a[116:119], v[8:11]
 v_cvt_pk_bf16_f32 v30, v20, v21
 v_fma_f32 v22, v22, s24, v41
 v_mfma_f32_16x16x32_bf16 v[8:11], a[168:171], a[120:123], v[8:11]
 v_fma_f32 v23, v23, s24, v41
 v_fma_f32 v0, v0, s24, v63
 v_mfma_f32_16x16x32_bf16 v[8:11], a[172:175], a[124:127], v[8:11]
 v_exp_f32 v22, v22
 v_mfma_f32_16x16x32_bf16 v[12:15], a[188:191], a[124:127], 0
 v_exp_f32 v23, v23
 v_mfma_f32_16x16x32_bf16 v[12:15], a[184:187], a[120:123], v[12:15]
 v_cvt_pk_bf16_f32 v31, v22, v23
 v_fma_f32 v1, v1, s24, v63
 v_mfma_f32_16x16x32_bf16 v[12:15], a[180:183], a[116:119], v[12:15]
 v_exp_f32 v0, v0
 v_mfma_f32_16x16x32_bf16 v[12:15], a[176:179], a[112:115], v[12:15]
 v_exp_f32 v1, v1
 v_smfmac_f32_16x16x64_bf16 a[224:227], a[236:239], v[24:31], v55
 v_cvt_pk_bf16_f32 v32, v0, v1
 v_mfma_f32_16x16x32_bf16 v[96:99], a[192:195], v[28:31], v[96:99]
 ds_read_b64_tr_b16 a[192:193], v48 offset:57344
 ds_read_b64_tr_b16 a[194:195], v48 offset:61440
 v_mfma_f32_16x16x32_bf16 v[100:103], a[196:199], v[28:31], v[100:103]
 v_fma_f32 v2, v2, s24, v63
 v_fma_f32 v3, v3, s24, v63
 v_mfma_f32_16x16x32_bf16 v[104:107], a[200:203], v[28:31], v[104:107]
 ds_read_b64_tr_b16 a[196:197], v49 offset:57344
 ds_read_b64_tr_b16 a[198:199], v49 offset:61440
 v_mfma_f32_16x16x32_bf16 v[108:111], a[204:207], v[28:31], v[108:111]
 v_exp_f32 v2, v2
 v_mfma_f32_16x16x32_bf16 v[112:115], a[208:211], v[28:31], v[112:115]
 ds_read_b64_tr_b16 a[200:201], v50 offset:57344
 ds_read_b64_tr_b16 a[202:203], v50 offset:61440
 v_mfma_f32_16x16x32_bf16 v[116:119], a[212:215], v[28:31], v[116:119]
 v_exp_f32 v3, v3
 v_mfma_f32_16x16x32_bf16 v[120:123], a[216:219], v[28:31], v[120:123]
 ds_read_b64_tr_b16 a[204:205], v51 offset:57344
 ds_read_b64_tr_b16 a[206:207], v51 offset:61440
 v_mfma_f32_16x16x32_bf16 v[124:127], a[220:223], v[28:31], v[124:127]
 v_cvt_pk_bf16_f32 v33, v2, v3
 v_fma_f32 v4, v4, s24, v63
 v_mfma_f32_16x16x32_bf16 v[16:19], a[160:163], a[128:131], 0
 ds_read_b64_tr_b16 a[208:209], v48 offset:58368
 ds_read_b64_tr_b16 a[210:211], v48 offset:62464
 v_mfma_f32_16x16x32_bf16 v[16:19], a[164:167], a[132:135], v[16:19]
 v_fma_f32 v5, v5, s24, v63
 v_exp_f32 v4, v4
 v_mfma_f32_16x16x32_bf16 v[16:19], a[168:171], a[136:139], v[16:19]
 ds_read_b64_tr_b16 a[212:213], v49 offset:58368
 ds_read_b64_tr_b16 a[214:215], v49 offset:62464
 v_exp_f32 v5, v5
 v_mfma_f32_16x16x32_bf16 v[16:19], a[172:175], a[140:143], v[16:19]
 v_cvt_pk_bf16_f32 v34, v4, v5
 v_fma_f32 v6, v6, s24, v63
 v_mfma_f32_16x16x32_bf16 v[20:23], a[188:191], a[140:143], 0
 ds_read_b64_tr_b16 a[216:217], v50 offset:58368
 ds_read_b64_tr_b16 a[218:219], v50 offset:62464
 v_fma_f32 v7, v7, s24, v63
 v_exp_f32 v6, v6
 v_mfma_f32_16x16x32_bf16 v[20:23], a[184:187], a[136:139], v[20:23]
 v_exp_f32 v7, v7
 v_mfma_f32_16x16x32_bf16 v[20:23], a[180:183], a[132:135], v[20:23]
 ds_read_b64_tr_b16 a[220:221], v51 offset:58368
 ds_read_b64_tr_b16 a[222:223], v51 offset:62464
 v_cvt_pk_bf16_f32 v35, v6, v7
 v_mfma_f32_16x16x32_bf16 v[20:23], a[176:179], a[128:131], v[20:23]
 s_waitcnt lgkmcnt(6)
 v_fma_f32 v8, v8, s24, v41
 v_fma_f32 v9, v9, s24, v41
 v_mfma_f32_16x16x32_bf16 v[64:67], a[192:195], v[32:35], v[64:67]
 v_exp_f32 v8, v8
 v_mfma_f32_16x16x32_bf16 v[68:71], a[196:199], v[32:35], v[68:71]
 v_exp_f32 v9, v9
 v_mfma_f32_16x16x32_bf16 v[72:75], a[200:203], v[32:35], v[72:75]
 v_cvt_pk_bf16_f32 v36, v8, v9
 v_fma_f32 v10, v10, s24, v41
 v_mfma_f32_16x16x32_bf16 v[76:79], a[204:207], v[32:35], v[76:79]
 v_fma_f32 v11, v11, s24, v41
 v_fma_f32 v12, v12, s24, v41
 v_mfma_f32_16x16x32_bf16 v[80:83], a[208:211], v[32:35], v[80:83]
 s_waitcnt lgkmcnt(2)
 v_exp_f32 v10, v10
 v_mfma_f32_16x16x32_bf16 v[84:87], a[212:215], v[32:35], v[84:87]
 v_exp_f32 v11, v11
 v_mfma_f32_16x16x32_bf16 v[88:91], a[216:219], v[32:35], v[88:91]
 s_waitcnt lgkmcnt(0)
 v_cvt_pk_bf16_f32 v37, v10, v11
 v_fma_f32 v13, v13, s24, v41
 v_mfma_f32_16x16x32_bf16 v[92:95], a[220:223], v[32:35], v[92:95]
 v_exp_f32 v12, v12
 v_mfma_f32_16x16x32_bf16 v[0:3], a[160:163], a[144:147], 0
 ds_read_b128 a[160:163], v46 offset:49152
 v_fma_f32 v14, v14, s24, v41
 v_mfma_f32_16x16x32_bf16 v[0:3], a[164:167], a[148:151], v[0:3]
 v_exp_f32 v13, v13
 v_mfma_f32_16x16x32_bf16 v[0:3], a[168:171], a[152:155], v[0:3]
 ds_read_b128 a[164:167], v47 offset:49152
 v_cvt_pk_bf16_f32 v38, v12, v13
 v_mfma_f32_16x16x32_bf16 v[0:3], a[172:175], a[156:159], v[0:3]
 v_fma_f32 v15, v15, s24, v41
 v_fma_f32 v16, v16, s24, v42
 v_mfma_f32_16x16x32_bf16 v[4:7], a[188:191], a[156:159], 0
 ds_read_b128 a[168:171], v46 offset:50176
 v_exp_f32 v14, v14
 v_mfma_f32_16x16x32_bf16 v[4:7], a[184:187], a[152:155], v[4:7]
 v_exp_f32 v15, v15
 v_mfma_f32_16x16x32_bf16 v[4:7], a[180:183], a[148:151], v[4:7]
 ds_read_b128 a[172:175], v47 offset:50176
 v_cvt_pk_bf16_f32 v39, v14, v15
 v_mfma_f32_16x16x32_bf16 v[4:7], a[176:179], a[144:147], v[4:7]
 v_fma_f32 v17, v17, s24, v42
 v_fma_f32 v18, v18, s24, v42
 v_smfmac_f32_16x16x64_bf16 a[224:227], a[236:239], v[32:39], v55
 ds_read_b128 a[188:191], v47 offset:54272
 v_mfma_f32_16x16x32_bf16 v[96:99], a[192:195], v[36:39], v[96:99]
 v_exp_f32 v16, v16
 v_mfma_f32_16x16x32_bf16 v[100:103], a[196:199], v[36:39], v[100:103]
 ds_read_b128 a[184:187], v46 offset:54272
 v_fma_f32 v19, v19, s24, v42
 v_mfma_f32_16x16x32_bf16 v[104:107], a[200:203], v[36:39], v[104:107]
 v_exp_f32 v17, v17
 v_mfma_f32_16x16x32_bf16 v[108:111], a[204:207], v[36:39], v[108:111]
 ds_read_b128 a[180:183], v47 offset:53248
 v_cvt_pk_bf16_f32 v24, v16, v17
 v_mfma_f32_16x16x32_bf16 v[112:115], a[208:211], v[36:39], v[112:115]
 v_accvgpr_read_b32 v60, a224
 v_accvgpr_read_b32 v61, a225
 v_add_f32 v60, v60, v61
 v_cmp_ngt_f32_e64 s[52:53], s25, v60
 v_mfma_f32_16x16x32_bf16 v[116:119], a[212:215], v[36:39], v[116:119]
L_stub14:
 s_cbranch_vccnz L_back0
.if ((L_stub14-L_main)>>6) != 896
.error "stub misplaced"
.endif
 ds_read_b128 a[176:179], v46 offset:53248
 v_rcp_f32 v60, v60
 v_mfma_f32_16x16x32_bf16 v[120:123], a[216:219], v[36:39], v[120:123]
 v_exp_f32 v18, v18
 v_accvgpr_read_b32 v62, a226
 v_accvgpr_read_b32 v61, a227
 v_mfma_f32_16x16x32_bf16 v[124:127], a[220:223], v[36:39], v[124:127]
 s_waitcnt lgkmcnt(3)
 v_exp_f32 v19, v19
 v_add_f32_e64 v62, v62, v61
 v_cmp_ngt_f32_e64 s[54:55], s25, v62
 v_cvt_pk_bf16_f32 v25, v18, v19
 v_pk_mul_f32 v[64:65], v[64:65], v[60:61] op_sel_hi:[1,0]
 v_cvt_pk_bf16_f32 v64, v64, v65
 v_pk_mul_f32 v[66:67], v[66:67], v[60:61] op_sel_hi:[1,0]
 v_cvt_pk_bf16_f32 v65, v66, v67
 v_pk_mul_f32 v[68:69], v[68:69], v[60:61] op_sel_hi:[1,0]
 v_pk_mul_f32 v[70:71], v[70:71], v[60:61] op_sel_hi:[1,0]
 v_pk_mul_f32 v[72:73], v[72:73], v[60:61] op_sel_hi:[1,0]
 v_pk_mul_f32 v[74:75], v[74:75], v[60:61] op_sel_hi:[1,0]
 v_pk_mul_f32 v[76:77], v[76:77], v[60:61] op_sel_hi:[1,0]
 v_pk_mul_f32 v[78:79], v[78:79], v[60:61] op_sel_hi:[1,0]
 v_pk_mul_f32 v[80:81], v[80:81], v[60:61] op_sel_hi:[1,0]
 v_pk_mul_f32 v[82:83], v[82:83], v[60:61] op_sel_hi:[1,0]
 v_pk_mul_f32 v[84:85], v[84:85], v[60:61] op_sel_hi:[1,0]
 v_pk_mul_f32 v[86:87], v[86:87], v[60:61] op_sel_hi:[1,0]
 v_pk_mul_f32 v[88:89], v[88:89], v[60:61] op_sel_hi:[1,0]
 v_pk_mul_f32 v[90:91], v[90:91], v[60:61] op_sel_hi:[1,0]
 v_pk_mul_f32 v[92:93], v[92:93], v[60:61] op_sel_hi:[1,0]
 v_pk_mul_f32 v[94:95], v[94:95], v[60:61] op_sel_hi:[1,0]
 v_mfma_f32_16x16x32_bf16 v[8:11], a[160:163], a[128:131], 0
 v_fma_f32 v20, v20, s24, v42
 v_cvt_pk_bf16_f32 v80, v80, v81
 v_cvt_pk_bf16_f32 v81, v82, v83
 v_rcp_f32 v62, v62
 v_mfma_f32_16x16x32_bf16 v[8:11], a[164:167], a[132:135], v[8:11]
 ds_write2st64_b64 v56, v[64:65], v[80:81] offset0:0 offset1:2
 v_fma_f32 v21, v21, s24, v42
 v_exp_f32 v20, v20
 v_mfma_f32_16x16x32_bf16 v[8:11], a[168:171], a[136:139], v[8:11]
 v_exp_f32_e64 v21, v21
 v_cvt_pk_bf16_f32 v68, v68, v69
 v_cvt_pk_bf16_f32 v69, v70, v71
 v_cvt_pk_bf16_f32 v26, v20, v21
 v_pk_mul_f32 v[96:97], v[96:97], v[62:63] op_sel_hi:[1,0]
 v_cvt_pk_bf16_f32 v96, v96, v97
 v_pk_mul_f32 v[98:99], v[98:99], v[62:63] op_sel_hi:[1,0]
 v_cvt_pk_bf16_f32 v97, v98, v99
 v_pk_mul_f32 v[100:101], v[100:101], v[62:63] op_sel_hi:[1,0]
 v_pk_mul_f32 v[102:103], v[102:103], v[62:63] op_sel_hi:[1,0]
 v_pk_mul_f32 v[104:105], v[104:105], v[62:63] op_sel_hi:[1,0]
 v_pk_mul_f32 v[106:107], v[106:107], v[62:63] op_sel_hi:[1,0]
 v_pk_mul_f32 v[108:109], v[108:109], v[62:63] op_sel_hi:[1,0]
 v_pk_mul_f32 v[110:111], v[110:111], v[62:63] op_sel_hi:[1,0]
 v_pk_mul_f32 v[112:113], v[112:113], v[62:63] op_sel_hi:[1,0]
 v_pk_mul_f32 v[114:115], v[114:115], v[62:63] op_sel_hi:[1,0]
 v_pk_mul_f32 v[116:117], v[116:117], v[62:63] op_sel_hi:[1,0]
 v_pk_mul_f32 v[118:119], v[118:119], v[62:63] op_sel_hi:[1,0]
 v_pk_mul_f32 v[120:121], v[120:121], v[62:63] op_sel_hi:[1,0]
 v_pk_mul_f32 v[122:123], v[122:123], v[62:63] op_sel_hi:[1,0]
 v_pk_mul_f32 v[124:125], v[124:125], v[62:63] op_sel_hi:[1,0]
 v_pk_mul_f32 v[126:127], v[126:127], v[62:63] op_sel_hi:[1,0]
 v_mfma_f32_16x16x32_bf16 v[8:11], a[172:175], a[140:143], v[8:11]
 v_fma_f32 v22, v22, s24, v42
 v_cvt_pk_bf16_f32 v84, v84, v85
 v_cvt_pk_bf16_f32 v85, v86, v87
 v_cvt_pk_bf16_f32 v112, v112, v113
 v_cvt_pk_bf16_f32 v113, v114, v115
 v_mfma_f32_16x16x32_bf16 v[12:15], a[188:191], a[140:143], 0
 s_waitcnt lgkmcnt(1)
 ds_write2st64_b64 v57, v[68:69], v[84:85] offset0:0 offset1:2
 v_fma_f32 v23, v23, s24, v42
 v_exp_f32 v22, v22
 v_mfma_f32_16x16x32_bf16 v[12:15], a[184:187], a[136:139], v[12:15]
 v_exp_f32_e64 v23, v23
 v_cvt_pk_bf16_f32 v72, v72, v73
 v_cvt_pk_bf16_f32 v73, v74, v75
 v_cvt_pk_bf16_f32 v100, v100, v101
 v_cvt_pk_bf16_f32 v101, v102, v103
 v_mfma_f32_16x16x32_bf16 v[12:15], a[180:183], a[132:135], v[12:15]
 ds_write2st64_b64 v56, v[96:97], v[112:113] offset0:8 offset1:10
 v_cvt_pk_bf16_f32 v27, v22, v23
 v_cvt_pk_bf16_f32 v88, v88, v89
 v_cvt_pk_bf16_f32 v89, v90, v91
 v_cvt_pk_bf16_f32 v116, v116, v117
 v_cvt_pk_bf16_f32 v117, v118, v119
 v_mfma_f32_16x16x32_bf16 v[12:15], a[176:179], a[128:131], v[12:15]
 v_cvt_pk_bf16_f32 v76, v76, v77
 v_cvt_pk_bf16_f32 v77, v78, v79
 v_mfma_f32_16x16x32_bf16 v[128:131], a[192:195], v[24:27], v[128:131]
 ds_write2st64_b64 v52, v[72:73], v[88:89] offset0:0 offset1:2
 v_cvt_pk_bf16_f32 v104, v104, v105
 v_cvt_pk_bf16_f32 v105, v106, v107
 v_mfma_f32_16x16x32_bf16 v[132:135], a[196:199], v[24:27], v[132:135]
 v_cvt_pk_bf16_f32 v92, v92, v93
 v_cvt_pk_bf16_f32 v93, v94, v95
 v_cvt_pk_bf16_f32 v120, v120, v121
 v_cvt_pk_bf16_f32 v121, v122, v123
 v_mfma_f32_16x16x32_bf16 v[136:139], a[200:203], v[24:27], v[136:139]
 ds_write2st64_b64 v57, v[100:101], v[116:117] offset0:8 offset1:10
 v_fma_f32 v0, v0, s24, v43
 v_mfma_f32_16x16x32_bf16 v[140:143], a[204:207], v[24:27], v[140:143]
 v_cvt_pk_bf16_f32 v108, v108, v109
 v_cvt_pk_bf16_f32 v109, v110, v111
 v_fma_f32 v1, v1, s24, v43
 v_exp_f32 v0, v0
 v_mfma_f32_16x16x32_bf16 v[144:147], a[208:211], v[24:27], v[144:147]
 ds_write2st64_b64 v53, v[76:77], v[92:93] offset0:0 offset1:2
 v_cvt_pk_bf16_f32 v124, v124, v125
 v_cvt_pk_bf16_f32 v125, v126, v127
 v_exp_f32 v1, v1
 v_mfma_f32_16x16x32_bf16 v[148:151], a[212:215], v[24:27], v[148:151]
 v_cvt_pk_bf16_f32 v28, v0, v1
 v_fma_f32 v2, v2, s24, v43
 v_mfma_f32_16x16x32_bf16 v[152:155], a[216:219], v[24:27], v[152:155]
 ds_write2st64_b64 v52, v[104:105], v[120:121] offset0:8 offset1:10
 v_fma_f32 v3, v3, s24, v43
 v_exp_f32 v2, v2
 v_mfma_f32_16x16x32_bf16 v[156:159], a[220:223], v[24:27], v[156:159]
 v_exp_f32 v3, v3
 v_mfma_f32_16x16x32_bf16 v[16:19], a[160:163], a[144:147], 0
 ds_write2st64_b64 v53, v[108:109], v[124:125] offset0:8 offset1:10
 v_cvt_pk_bf16_f32 v29, v2, v3
 v_fma_f32 v4, v4, s24, v43
 v_mfma_f32_16x16x32_bf16 v[16:19], a[164:167], a[148:151], v[16:19]
 ds_read_b128 a[96:99], v59 offset:0
 v_fma_f32 v5, v5, s24, v43
 v_exp_f32 v4, v4
 v_mfma_f32_16x16x32_bf16 v[16:19], a[168:171], a[152:155], v[16:19]
 ds_read_b64 a[104:105], v59 offset:2056
 v_exp_f32 v5, v5
 v_mfma_f32_16x16x32_bf16 v[16:19], a[172:175], a[156:159], v[16:19]
 ds_read_b64 a[106:107], v59 offset:2048
 v_cvt_pk_bf16_f32 v30, v4, v5
 v_fma_f32 v6, v6, s24, v43
 v_mfma_f32_16x16x32_bf16 v[20:23], a[188:191], a[156:159], 0
 ds_read_b128 a[100:103], v59 offset:1024
 v_fma_f32 v7, v7, s24, v43
 v_exp_f32 v6, v6
 v_mfma_f32_16x16x32_bf16 v[20:23], a[184:187], a[152:155], v[20:23]
 ds_read_b64 a[108:109], v59 offset:3080
 v_exp_f32 v7, v7
 v_mfma_f32_16x16x32_bf16 v[20:23], a[180:183], a[148:151], v[20:23]
 ds_read_b64 a[110:111], v59 offset:3072
 v_cvt_pk_bf16_f32 v31, v6, v7
 v_mfma_f32_16x16x32_bf16 v[20:23], a[176:179], a[144:147], v[20:23]
 ds_read_b128 a[112:115], v59 offset:4096
 v_fma_f32 v8, v8, s24, v42
 v_smfmac_f32_16x16x64_bf16 a[228:231], a[236:239], v[24:31], v55
 ds_read_b64 a[120:121], v59 offset:6152
 ds_read_b128 a[160:163], v46 offset:40960
 v_mfma_f32_16x16x32_bf16 v[160:163], a[192:195], v[28:31], v[160:163]
 ds_read_b64 a[122:123], v59 offset:6144
 ds_read_b128 a[164:167], v47 offset:40960
 v_mfma_f32_16x16x32_bf16 v[164:167], a[196:199], v[28:31], v[164:167]
 ds_read_b128 a[116:119], v59 offset:5120
 ds_read_b128 a[168:171], v46 offset:41984
 v_mfma_f32_16x16x32_bf16 v[168:171], a[200:203], v[28:31], v[168:171]
 ds_read_b64 a[124:125], v59 offset:7176
 ds_read_b128 a[172:175], v47 offset:41984
 v_mfma_f32_16x16x32_bf16 v[172:175], a[204:207], v[28:31], v[172:175]
 ds_read_b64 a[126:127], v59 offset:7168
 ds_read_b128 a[188:191], v47 offset:46080
 v_fma_f32 v9, v9, s24, v42
 v_exp_f32 v8, v8
 v_mfma_f32_16x16x32_bf16 v[176:179], a[208:211], v[28:31], v[176:179]
 s_waitcnt lgkmcnt(12)
 buffer_store_dwordx4 a[96:99], v58, s[20:23], s31 offen offset:0 sc0 sc1 nt
 ds_read_b128 a[184:187], v46 offset:46080
 v_exp_f32 v9, v9
 v_mfma_f32_16x16x32_bf16 v[180:183], a[212:215], v[28:31], v[180:183]
 ds_read_b128 a[180:183], v47 offset:45056
 v_cvt_pk_bf16_f32 v32, v8, v9
 v_fma_f32 v10, v10, s24, v42
 v_mfma_f32_16x16x32_bf16 v[184:187], a[216:219], v[28:31], v[184:187]
 ds_read_b128 a[176:179], v46 offset:45056
 v_fma_f32 v11, v11, s24, v42
 v_exp_f32 v10, v10
 v_mfma_f32_16x16x32_bf16 v[188:191], a[220:223], v[28:31], v[188:191]
 s_waitcnt lgkmcnt(9)
 ds_read_b64_tr_b16 a[192:193], v48 offset:49152
 ds_read_b64_tr_b16 a[194:195], v48 offset:53248
 v_exp_f32 v11, v11
 v_mfma_f32_16x16x32_bf16 v[0:3], a[160:163], a[128:131], 0
 ds_read_b64_tr_b16 a[196:197], v49 offset:49152
 ds_read_b64_tr_b16 a[198:199], v49 offset:53248
 v_cvt_pk_bf16_f32 v33, v10, v11
 v_fma_f32 v12, v12, s24, v42
 v_mfma_f32_16x16x32_bf16 v[0:3], a[164:167], a[132:135], v[0:3]
 s_waitcnt lgkmcnt(9)
 ds_read_b64_tr_b16 a[200:201], v50 offset:49152
 ds_read_b64_tr_b16 a[202:203], v50 offset:53248
 v_fma_f32 v13, v13, s24, v42
 v_exp_f32 v12, v12
 v_mfma_f32_16x16x32_bf16 v[0:3], a[168:171], a[136:139], v[0:3]
 ds_read_b64_tr_b16 a[204:205], v51 offset:49152
 ds_read_b64_tr_b16 a[206:207], v51 offset:53248
 v_exp_f32 v13, v13
 v_mfma_f32_16x16x32_bf16 v[0:3], a[172:175], a[140:143], v[0:3]
 s_waitcnt lgkmcnt(10)
 buffer_store_dwordx4 a[104:107], v58, s[20:23], s31 offen offset:2048 sc0 sc1 nt
 ds_read_b64_tr_b16 a[208:209], v48 offset:50176
 ds_read_b64_tr_b16 a[210:211], v48 offset:54272
 v_cvt_pk_bf16_f32 v34, v12, v13
 v_fma_f32 v14, v14, s24, v42
 v_mfma_f32_16x16x32_bf16 v[4:7], a[188:191], a[140:143], 0
 ds_read_b64_tr_b16 a[212:213], v49 offset:50176
 ds_read_b64_tr_b16 a[214:215], v49 offset:54272
 v_fma_f32 v15, v15, s24, v42
 v_exp_f32 v14, v14
 v_mfma_f32_16x16x32_bf16 v[4:7], a[184:187], a[136:139], v[4:7]
 s_waitcnt lgkmcnt(12)
 ds_read_b64_tr_b16 a[216:217], v50 offset:50176
 ds_read_b64_tr_b16 a[218:219], v50 offset:54272
 v_exp_f32 v15, v15
 v_mfma_f32_16x16x32_bf16 v[4:7], a[180:183], a[132:135], v[4:7]
 ds_read_b64_tr_b16 a[220:221], v51 offset:50176
 ds_read_b64_tr_b16 a[222:223], v51 offset:54272
 v_cvt_pk_bf16_f32 v35, v14, v15
 v_mfma_f32_16x16x32_bf16 v[4:7], a[176:179], a[128:131], v[4:7]
 s_waitcnt lgkmcnt(12)
 v_fma_f32 v16, v16, s24, v43
 v_fma_f32 v17, v17, s24, v43
 v_mfma_f32_16x16x32_bf16 v[128:131], a[192:195], v[32:35], v[128:131]
 v_exp_f32 v16, v16
 v_mfma_f32_16x16x32_bf16 v[132:135], a[196:199], v[32:35], v[132:135]
 s_waitcnt lgkmcnt(8)
 v_exp_f32 v17, v17
 v_mfma_f32_16x16x32_bf16 v[136:139], a[200:203], v[32:35], v[136:139]
 v_cvt_pk_bf16_f32 v36, v16, v17
 v_fma_f32 v18, v18, s24, v43
 v_mfma_f32_16x16x32_bf16 v[140:143], a[204:207], v[32:35], v[140:143]
 s_waitcnt lgkmcnt(4)
 v_fma_f32 v19, v19, s24, v43
 v_fma_f32 v20, v20, s24, v43
 v_mfma_f32_16x16x32_bf16 v[144:147], a[208:211], v[32:35], v[144:147]
 v_exp_f32 v18, v18
 v_mfma_f32_16x16x32_bf16 v[148:151], a[212:215], v[32:35], v[148:151]
 s_waitcnt lgkmcnt(0)
 v_exp_f32 v19, v19
 v_mfma_f32_16x16x32_bf16 v[152:155], a[216:219], v[32:35], v[152:155]
 v_cvt_pk_bf16_f32 v37, v18, v19
 v_fma_f32 v21, v21, s24, v43
 v_mfma_f32_16x16x32_bf16 v[156:159], a[220:223], v[32:35], v[156:159]
 buffer_store_dwordx4 a[100:103], v58, s[20:23], s31 offen offset:128 sc0 sc1 nt
 v_exp_f32 v20, v20
 v_fma_f32 v22, v22, s24, v43
 v_mfma_f32_16x16x32_bf16 v[8:11], a[160:163], a[144:147], 0
 v_exp_f32 v21, v21
 v_mfma_f32_16x16x32_bf16 v[8:11], a[164:167], a[148:151], v[8:11]
 v_cvt_pk_bf16_f32 v38, v20, v21
 v_fma_f32 v23, v23, s24, v43
 v_mfma_f32_16x16x32_bf16 v[8:11], a[168:171], a[152:155], v[8:11]
 v_exp_f32 v22, v22
 v_mfma_f32_16x16x32_bf16 v[8:11], a[172:175], a[156:159], v[8:11]
 v_exp_f32 v23, v23
 v_mfma_f32_16x16x32_bf16 v[12:15], a[188:191], a[156:159], 0
 v_cvt_pk_bf16_f32 v39, v22, v23
 v_fma_f32 v0, v0, s24, v42
 v_mfma_f32_16x16x32_bf16 v[12:15], a[184:187], a[152:155], v[12:15]
 v_fma_f32 v1, v1, s24, v42
 v_fma_f32 v2, v2, s24, v42
 v_mfma_f32_16x16x32_bf16 v[12:15], a[180:183], a[148:151], v[12:15]
 v_exp_f32 v0, v0
 v_mfma_f32_16x16x32_bf16 v[12:15], a[176:179], a[144:147], v[12:15]
 v_exp_f32 v1, v1
 v_smfmac_f32_16x16x64_bf16 a[228:231], a[236:239], v[32:39], v55
 ds_read_b128 a[160:163], v46 offset:24576
 v_mfma_f32_16x16x32_bf16 v[160:163], a[192:195], v[36:39], v[160:163]
 ds_read_b128 a[164:167], v47 offset:24576
 v_cvt_pk_bf16_f32 v24, v0, v1
 v_mfma_f32_16x16x32_bf16 v[164:167], a[196:199], v[36:39], v[164:167]
 ds_read_b128 a[168:171], v46 offset:25600
 v_fma_f32 v3, v3, s24, v42
 v_mfma_f32_16x16x32_bf16 v[168:171], a[200:203], v[36:39], v[168:171]
 buffer_store_dwordx4 a[108:111], v58, s[20:23], s31 offen offset:2176 sc0 sc1 nt
 ds_read_b128 a[172:175], v47 offset:25600
 v_exp_f32 v2, v2
 v_mfma_f32_16x16x32_bf16 v[172:175], a[204:207], v[36:39], v[172:175]
 s_addk_i32 s31, 4096
 ds_read_b128 a[188:191], v47 offset:29696
 v_fma_f32 v4, v4, s24, v42
 v_mfma_f32_16x16x32_bf16 v[176:179], a[208:211], v[36:39], v[176:179]
 ds_read_b128 a[184:187], v46 offset:29696
 v_fma_f32 v5, v5, s24, v42
 v_mfma_f32_16x16x32_bf16 v[180:183], a[212:215], v[36:39], v[180:183]
 ds_read_b128 a[180:183], v47 offset:28672
 v_fma_f32 v6, v6, s24, v42
 v_mfma_f32_16x16x32_bf16 v[184:187], a[216:219], v[36:39], v[184:187]
 ds_read_b128 a[176:179], v46 offset:28672
 v_fma_f32 v7, v7, s24, v42
 v_mfma_f32_16x16x32_bf16 v[188:191], a[220:223], v[36:39], v[188:191]
 s_waitcnt lgkmcnt(6)
 ds_read_b64_tr_b16 a[192:193], v48 offset:40960
 ds_read_b64_tr_b16 a[194:195], v48 offset:45056
 v_exp_f32 v3, v3
 v_mfma_f32_16x16x32_bf16 v[16:19], a[160:163], a[128:131], 0
 ds_read_b64_tr_b16 a[196:197], v49 offset:40960
 ds_read_b64_tr_b16 a[198:199], v49 offset:45056
 v_cvt_pk_bf16_f32 v25, v2, v3
 v_mfma_f32_16x16x32_bf16 v[16:19], a[164:167], a[132:135], v[16:19]
 s_waitcnt lgkmcnt(8)
 ds_read_b64_tr_b16 a[200:201], v50 offset:40960
 ds_read_b64_tr_b16 a[202:203], v50 offset:45056
 v_exp_f32 v4, v4
 v_mfma_f32_16x16x32_bf16 v[16:19], a[168:171], a[136:139], v[16:19]
 ds_read_b64_tr_b16 a[204:205], v51 offset:40960
 ds_read_b64_tr_b16 a[206:207], v51 offset:45056
 v_exp_f32 v5, v5
 v_mfma_f32_16x16x32_bf16 v[16:19], a[172:175], a[140:143], v[16:19]
 s_waitcnt lgkmcnt(10)
 ds_read_b64_tr_b16 a[208:209], v48 offset:41984
 ds_read_b64_tr_b16 a[210:211], v48 offset:46080
 v_cvt_pk_bf16_f32 v26, v4, v5
 v_mfma_f32_16x16x32_bf16 v[20:23], a[188:191], a[140:143], 0
 ds_read_b64_tr_b16 a[212:213], v49 offset:41984
 ds_read_b64_tr_b16 a[214:215], v49 offset:46080
 v_exp_f32 v6, v6
 v_mfma_f32_16x16x32_bf16 v[20:23], a[184:187], a[136:139], v[20:23]
 s_waitcnt lgkmcnt(12)
 ds_read_b64_tr_b16 a[216:217], v50 offset:41984
 ds_read_b64_tr_b16 a[218:219], v50 offset:46080
 v_exp_f32 v7, v7
 v_mfma_f32_16x16x32_bf16 v[20:23], a[180:183], a[132:135], v[20:23]
 buffer_store_dwordx4 a[112:115], v58, s[20:23], s31 offen offset:0 sc0 sc1 nt
 ds_read_b64_tr_b16 a[220:221], v51 offset:41984
 ds_read_b64_tr_b16 a[222:223], v51 offset:46080
 v_cvt_pk_bf16_f32 v27, v6, v7
 v_mfma_f32_16x16x32_bf16 v[20:23], a[176:179], a[128:131], v[20:23]
 s_waitcnt lgkmcnt(12)
 v_fma_f32 v8, v8, s24, v43
 v_fma_f32 v9, v9, s24, v43
 v_mfma_f32_16x16x32_bf16 v[128:131], a[192:195], v[24:27], v[128:131]
 v_exp_f32 v8, v8
 v_mfma_f32_16x16x32_bf16 v[132:135], a[196:199], v[24:27], v[132:135]
 s_waitcnt lgkmcnt(8)
 v_exp_f32 v9, v9
 v_mfma_f32_16x16x32_bf16 v[136:139], a[200:203], v[24:27], v[136:139]
 v_cvt_pk_bf16_f32 v28, v8, v9
 v_fma_f32 v10, v10, s24, v43
 v_mfma_f32_16x16x32_bf16 v[140:143], a[204:207], v[24:27], v[140:143]
 s_waitcnt lgkmcnt(4)
 v_fma_f32 v11, v11, s24, v43
 v_fma_f32 v12, v12, s24, v43
 v_mfma_f32_16x16x32_bf16 v[144:147], a[208:211], v[24:27], v[144:147]
 v_exp_f32 v10, v10
 v_mfma_f32_16x16x32_bf16 v[148:151], a[212:215], v[24:27], v[148:151]
 s_waitcnt lgkmcnt(0)
 v_exp_f32 v11, v11
 v_mfma_f32_16x16x32_bf16 v[152:155], a[216:219], v[24:27], v[152:155]
 v_cvt_pk_bf16_f32 v29, v10, v11
 v_fma_f32 v13, v13, s24, v43
 v_mfma_f32_16x16x32_bf16 v[156:159], a[220:223], v[24:27], v[156:159]
 v_exp_f32 v12, v12
 v_mfma_f32_16x16x32_bf16 v[0:3], a[160:163], a[144:147], 0
 v_exp_f32 v13, v13
 v_mfma_f32_16x16x32_bf16 v[0:3], a[164:167], a[148:151], v[0:3]
 v_cvt_pk_bf16_f32 v30, v12, v13
 v_fma_f32 v14, v14, s24, v43
 v_mfma_f32_16x16x32_bf16 v[0:3], a[168:171], a[152:155], v[0:3]
 buffer_store_dwordx4 a[120:123], v58, s[20:23], s31 offen offset:2048 sc0 sc1 nt
 v_fma_f32 v15, v15, s24, v43
 v_exp_f32 v14, v14
 v_mfma_f32_16x16x32_bf16 v[0:3], a[172:175], a[156:159], v[0:3]
 v_exp_f32 v15, v15
 v_mfma_f32_16x16x32_bf16 v[4:7], a[188:191], a[156:159], 0
 v_cvt_pk_bf16_f32 v31, v14, v15
 v_fma_f32 v16, v16, s24, v42
 v_mfma_f32_16x16x32_bf16 v[4:7], a[184:187], a[152:155], v[4:7]
 v_fma_f32 v17, v17, s24, v42
 v_fma_f32 v18, v18, s24, v42
 v_mfma_f32_16x16x32_bf16 v[4:7], a[180:183], a[148:151], v[4:7]
 v_exp_f32 v16, v16
 v_mfma_f32_16x16x32_bf16 v[4:7], a[176:179], a[144:147], v[4:7]
 v_exp_f32 v17, v17
 v_smfmac_f32_16x16x64_bf16 a[228:231], a[236:239], v[24:31], v55
 v_cvt_pk_bf16_f32 v32, v16, v17
 v_mfma_f32_16x16x32_bf16 v[160:163], a[192:195], v[28:31], v[160:163]
 v_fma_f32 v19, v19, s24, v42
 v_fma_f32 v20, v20, s24, v42
 v_mfma_f32_16x16x32_bf16 v[164:167], a[196:199], v[28:31], v[164:167]
 v_exp_f32 v18, v18
 v_mfma_f32_16x16x32_bf16 v[168:171], a[200:203], v[28:31], v[168:171]
 v_exp_f32 v19, v19
 v_mfma_f32_16x16x32_bf16 v[172:175], a[204:207], v[28:31], v[172:175]
 v_cvt_pk_bf16_f32 v33, v18, v19
 v_fma_f32 v21, v21, s24, v42
 v_mfma_f32_16x16x32_bf16 v[176:179], a[208:211], v[28:31], v[176:179]
 v_exp_f32 v20, v20
 v_mfma_f32_16x16x32_bf16 v[180:183], a[212:215], v[28:31], v[180:183]
 buffer_store_dwordx4 a[116:119], v58, s[20:23], s31 offen offset:128 sc0 sc1 nt
 ds_read_b64_tr_b16 a[192:193], v48 offset:24576
 v_exp_f32 v21, v21
 v_mfma_f32_16x16x32_bf16 v[184:187], a[216:219], v[28:31], v[184:187]
 v_cvt_pk_bf16_f32 v34, v20, v21
 v_fma_f32 v22, v22, s24, v42
 v_mfma_f32_16x16x32_bf16 v[188:191], a[220:223], v[28:31], v[188:191]
 ds_read_b64_tr_b16 a[194:195], v48 offset:28672
 ds_read_b64_tr_b16 a[196:197], v49 offset:24576
 v_mfma_f32_16x16x32_bf16 v[8:11], a[160:163], a[0:3], 0
 ds_read_b64_tr_b16 a[198:199], v49 offset:28672
 v_fma_f32 v23, v23, s24, v42
 v_mfma_f32_16x16x32_bf16 v[8:11], a[164:167], a[4:7], v[8:11]
 ds_read_b64_tr_b16 a[200:201], v50 offset:24576
 ds_read_b64_tr_b16 a[202:203], v50 offset:28672
 v_mfma_f32_16x16x32_bf16 v[8:11], a[168:171], a[8:11], v[8:11]
 ds_read_b64_tr_b16 a[204:205], v51 offset:24576
 ds_read_b64_tr_b16 a[206:207], v51 offset:28672
 v_mfma_f32_16x16x32_bf16 v[8:11], a[172:175], a[12:15], v[8:11]
 ds_read_b64_tr_b16 a[208:209], v48 offset:25600
 ds_read_b64_tr_b16 a[210:211], v48 offset:29696
 v_mfma_f32_16x16x32_bf16 v[12:15], a[188:191], a[12:15], 0
 ds_read_b64_tr_b16 a[212:213], v49 offset:25600
 ds_read_b64_tr_b16 a[214:215], v49 offset:29696
 v_exp_f32 v22, v22
 v_mfma_f32_16x16x32_bf16 v[12:15], a[184:187], a[8:11], v[12:15]
 ds_read_b64_tr_b16 a[216:217], v50 offset:25600
 ds_read_b64_tr_b16 a[218:219], v50 offset:29696
 v_exp_f32 v23, v23
 v_mfma_f32_16x16x32_bf16 v[12:15], a[180:183], a[4:7], v[12:15]
 ds_read_b64_tr_b16 a[220:221], v51 offset:25600
 ds_read_b64_tr_b16 a[222:223], v51 offset:29696
 v_cvt_pk_bf16_f32 v35, v22, v23
 v_mfma_f32_16x16x32_bf16 v[12:15], a[176:179], a[0:3], v[12:15]
 s_waitcnt lgkmcnt(12)
 v_fma_f32 v0, v0, s24, v43
 v_fma_f32 v1, v1, s24, v43
 v_mfma_f32_16x16x32_bf16 v[128:131], a[192:195], v[32:35], v[128:131]
 v_exp_f32 v0, v0
 v_mfma_f32_16x16x32_bf16 v[132:135], a[196:199], v[32:35], v[132:135]
 s_waitcnt lgkmcnt(8)
 buffer_store_dwordx4 a[124:127], v58, s[20:23], s31 offen offset:2176 sc0 sc1 nt
 v_exp_f32 v1, v1
 v_fma_f32 v2, v2, s24, v43
 v_mfma_f32_16x16x32_bf16 v[136:139], a[200:203], v[32:35], v[136:139]
 s_addk_i32 s31, 4096
 v_cvt_pk_bf16_f32 v36, v0, v1
 v_fma_f32 v3, v3, s24, v43
 v_mfma_f32_16x16x32_bf16 v[140:143], a[204:207], v[32:35], v[140:143]
 s_waitcnt lgkmcnt(4)
 v_exp_f32 v2, v2
 v_mfma_f32_16x16x32_bf16 v[144:147], a[208:211], v[32:35], v[144:147]
 v_exp_f32 v3, v3
 v_mfma_f32_16x16x32_bf16 v[148:151], a[212:215], v[32:35], v[148:151]
 s_waitcnt lgkmcnt(0)
 v_cvt_pk_bf16_f32 v37, v2, v3
 v_fma_f32 v4, v4, s24, v43
 v_mfma_f32_16x16x32_bf16 v[152:155], a[216:219], v[32:35], v[152:155]
 v_fma_f32 v5, v5, s24, v43
 v_fma_f32 v6, v6, s24, v43
 v_mfma_f32_16x16x32_bf16 v[156:159], a[220:223], v[32:35], v[156:159]
 v_exp_f32 v4, v4
 v_mfma_f32_16x16x32_bf16 v[16:19], a[160:163], a[16:19], 0
 ds_read_b128 a[160:163], v46 offset:40960
 v_fma_f32 v7, v7, s24, v43
 v_mfma_f32_16x16x32_bf16 v[16:19], a[164:167], a[20:23], v[16:19]
 v_exp_f32 v5, v5
 v_mfma_f32_16x16x32_bf16 v[16:19], a[168:171], a[24:27], v[16:19]
 ds_read_b128 a[164:167], v47 offset:40960
 v_cvt_pk_bf16_f32 v38, v4, v5
 v_mfma_f32_16x16x32_bf16 v[16:19], a[172:175], a[28:31], v[16:19]
 v_exp_f32 v6, v6
 v_mfma_f32_16x16x32_bf16 v[20:23], a[188:191], a[28:31], 0
 ds_read_b128 a[168:171], v46 offset:41984
 v_fma_f32 v8, v8, s24, v44
 v_mfma_f32_16x16x32_bf16 v[20:23], a[184:187], a[24:27], v[20:23]
 v_exp_f32 v7, v7
 v_mfma_f32_16x16x32_bf16 v[20:23], a[180:183], a[20:23], v[20:23]
 ds_read_b128 a[172:175], v47 offset:41984
 v_cvt_pk_bf16_f32 v39, v6, v7
 v_mfma_f32_16x16x32_bf16 v[20:23], a[176:179], a[16:19], v[20:23]
 v_fma_f32 v9, v9, s24, v44
 v_fma_f32 v10, v10, s24, v44
 v_smfmac_f32_16x16x64_bf16 a[228:231], a[236:239], v[32:39], v55
 ds_read_b128 a[188:191], v47 offset:46080
 v_mfma_f32_16x16x32_bf16 v[160:163], a[192:195], v[36:39], v[160:163]
 v_exp_f32 v8, v8
 v_mfma_f32_16x16x32_bf16 v[164:167], a[196:199], v[36:39], v[164:167]
 ds_read_b128 a[184:187], v46 offset:46080
 v_fma_f32 v11, v11, s24, v44
 v_mfma_f32_16x16x32_bf16 v[168:171], a[200:203], v[36:39], v[168:171]
 v_exp_f32 v9, v9
 v_mfma_f32_16x16x32_bf16 v[172:175], a[204:207], v[36:39], v[172:175]
 ds_read_b128 a[180:183], v47 offset:45056
 v_cvt_pk_bf16_f32 v24, v8, v9
 v_mfma_f32_16x16x32_bf16 v[176:179], a[208:211], v[36:39], v[176:179]
 v_accvgpr_read_b32 v60, a228
 v_accvgpr_read_b32 v61, a229
 v_add_f32 v60, v60, v61
 v_cmp_ngt_f32_e64 s[56:57], s25, v60
 v_mfma_f32_16x16x32_bf16 v[180:183], a[212:215], v[36:39], v[180:183]
 ds_read_b128 a[176:179], v46 offset:45056
 v_rcp_f32 v60, v60
 v_mfma_f32_16x16x32_bf16 v[184:187], a[216:219], v[36:39], v[184:187]
 v_exp_f32 v10, v10
 v_accvgpr_read_b32 v62, a230
 v_accvgpr_read_b32 v61, a231
 v_mfma_f32_16x16x32_bf16 v[188:191], a[220:223], v[36:39], v[188:191]
 s_waitcnt lgkmcnt(3)
 v_exp_f32 v11, v11
 v_add_f32_e64 v62, v62, v61
 v_cmp_ngt_f32_e64 s[58:59], s25, v62
 v_cvt_pk_bf16_f32 v25, v10, v11
 v_pk_mul_f32 v[128:129], v[128:129], v[60:61] op_sel_hi:[1,0]
 v_cvt_pk_bf16_f32 v128, v128, v129
 v_pk_mul_f32 v[130:131], v[130:131], v[60:61] op_sel_hi:[1,0]
 v_cvt_pk_bf16_f32 v129, v130, v131
 v_pk_mul_f32 v[132:133], v[132:133], v[60:61] op_sel_hi:[1,0]
 v_pk_mul_f32 v[134:135], v[134:135], v[60:61] op_sel_hi:[1,0]
 v_pk_mul_f32 v[136:137], v[136:137], v[60:61] op_sel_hi:[1,0]
 v_pk_mul_f32 v[138:139], v[138:139], v[60:61] op_sel_hi:[1,0]
 v_pk_mul_f32 v[140:141], v[140:141], v[60:61] op_sel_hi:[1,0]
 v_pk_mul_f32 v[142:143], v[142:143], v[60:61] op_sel_hi:[1,0]
 v_pk_mul_f32 v[144:145], v[144:145], v[60:61] op_sel_hi:[1,0]
 v_pk_mul_f32 v[146:147], v[146:147], v[60:61] op_sel_hi:[1,0]
 v_pk_mul_f32 v[148:149], v[148:149], v[60:61] op_sel_hi:[1,0]
 v_pk_mul_f32 v[150:151], v[150:151], v[60:61] op_sel_hi:[1,0]
 v_pk_mul_f32 v[152:153], v[152:153], v[60:61] op_sel_hi:[1,0]
 v_pk_mul_f32 v[154:155], v[154:155], v[60:61] op_sel_hi:[1,0]
 v_pk_mul_f32 v[156:157], v[156:157], v[60:61] op_sel_hi:[1,0]
 v_pk_mul_f32 v[158:159], v[158:159], v[60:61] op_sel_hi:[1,0]
 v_mfma_f32_16x16x32_bf16 v[0:3], a[160:163], a[0:3], 0
 v_fma_f32 v12, v12, s24, v44
 v_cvt_pk_bf16_f32 v144, v144, v145
 v_cvt_pk_bf16_f32 v145, v146, v147
 v_rcp_f32 v62, v62
 v_mfma_f32_16x16x32_bf16 v[0:3], a[164:167], a[4:7], v[0:3]
 ds_write2st64_b64 v56, v[128:129], v[144:145] offset0:0 offset1:2
 v_fma_f32 v13, v13, s24, v44
 v_exp_f32 v12, v12
 v_mfma_f32_16x16x32_bf16 v[0:3], a[168:171], a[8:11], v[0:3]
 v_exp_f32_e64 v13, v13
 v_cvt_pk_bf16_f32 v132, v132, v133
 v_cvt_pk_bf16_f32 v133, v134, v135
 v_cvt_pk_bf16_f32 v26, v12, v13
 v_pk_mul_f32 v[160:161], v[160:161], v[62:63] op_sel_hi:[1,0]
 v_cvt_pk_bf16_f32 v160, v160, v161
 v_pk_mul_f32 v[162:163], v[162:163], v[62:63] op_sel_hi:[1,0]
 v_cvt_pk_bf16_f32 v161, v162, v163
 v_pk_mul_f32 v[164:165], v[164:165], v[62:63] op_sel_hi:[1,0]
 v_pk_mul_f32 v[166:167], v[166:167], v[62:63] op_sel_hi:[1,0]
 v_pk_mul_f32 v[168:169], v[168:169], v[62:63] op_sel_hi:[1,0]
 v_pk_mul_f32 v[170:171], v[170:171], v[62:63] op_sel_hi:[1,0]
 v_pk_mul_f32 v[172:173], v[172:173], v[62:63] op_sel_hi:[1,0]
 v_pk_mul_f32 v[174:175], v[174:175], v[62:63] op_sel_hi:[1,0]
 v_pk_mul_f32 v[176:177], v[176:177], v[62:63] op_sel_hi:[1,0]
 v_pk_mul_f32 v[178:179], v[178:179], v[62:63] op_sel_hi:[1,0]
 v_pk_mul_f32 v[180:181], v[180:181], v[62:63] op_sel_hi:[1,0]
 v_pk_mul_f32 v[182:183], v[182:183], v[62:63] op_sel_hi:[1,0]
 v_pk_mul_f32 v[184:185], v[184:185], v[62:63] op_sel_hi:[1,0]
 v_pk_mul_f32 v[186:187], v[186:187], v[62:63] op_sel_hi:[1,0]
 v_pk_mul_f32 v[188:189], v[188:189], v[62:63] op_sel_hi:[1,0]
 v_pk_mul_f32 v[190:191], v[190:191], v[62:63] op_sel_hi:[1,0]
 v_mfma_f32_16x16x32_bf16 v[0:3], a[172:175], a[12:15], v[0:3]
 v_fma_f32 v14, v14, s24, v44
 v_cvt_pk_bf16_f32 v148, v148, v149
 v_cvt_pk_bf16_f32 v149, v150, v151
 v_cvt_pk_bf16_f32 v176, v176, v177
 v_cvt_pk_bf16_f32 v177, v178, v179
 v_mfma_f32_16x16x32_bf16 v[4:7], a[188:191], a[12:15], 0
 s_waitcnt lgkmcnt(1)
 ds_write2st64_b64 v57, v[132:133], v[148:149] offset0:0 offset1:2
 v_fma_f32 v15, v15, s24, v44
 v_exp_f32 v14, v14
 v_mfma_f32_16x16x32_bf16 v[4:7], a[184:187], a[8:11], v[4:7]
L_stub15:
 s_cbranch_vccnz L_back0
.if ((L_stub15-L_main)>>6) != 960
.error "stub misplaced"
.endif
 v_exp_f32 v15, v15
 v_cvt_pk_bf16_f32 v136, v136, v137
 v_cvt_pk_bf16_f32 v137, v138, v139
 v_cvt_pk_bf16_f32 v164, v164, v165
 v_cvt_pk_bf16_f32 v165, v166, v167
 v_mfma_f32_16x16x32_bf16 v[4:7], a[180:183], a[4:7], v[4:7]
 ds_write2st64_b64 v56, v[160:161], v[176:177] offset0:8 offset1:10
 v_cvt_pk_bf16_f32 v27, v14, v15
 v_cvt_pk_bf16_f32 v152, v152, v153
 v_cvt_pk_bf16_f32 v153, v154, v155
 v_cvt_pk_bf16_f32 v180, v180, v181
 v_cvt_pk_bf16_f32 v181, v182, v183
 v_mfma_f32_16x16x32_bf16 v[4:7], a[176:179], a[0:3], v[4:7]
 v_cvt_pk_bf16_f32 v140, v140, v141
 v_cvt_pk_bf16_f32 v141, v142, v143
 v_mfma_f32_16x16x32_bf16 v[192:195], a[192:195], v[24:27], v[192:195]
 ds_write2st64_b64 v52, v[136:137], v[152:153] offset0:0 offset1:2
 v_cvt_pk_bf16_f32 v168, v168, v169
 v_cvt_pk_bf16_f32 v169, v170, v171
 v_mfma_f32_16x16x32_bf16 v[196:199], a[196:199], v[24:27], v[196:199]
 v_cvt_pk_bf16_f32 v156, v156, v157
 v_cvt_pk_bf16_f32 v157, v158, v159
 v_cvt_pk_bf16_f32 v184, v184, v185
 v_cvt_pk_bf16_f32 v185, v186, v187
 v_mfma_f32_16x16x32_bf16 v[200:203], a[200:203], v[24:27], v[200:203]
 ds_write2st64_b64 v57, v[164:165], v[180:181] offset0:8 offset1:10
 v_fma_f32 v16, v16, s24, v45
 v_mfma_f32_16x16x32_bf16 v[204:207], a[204:207], v[24:27], v[204:207]
 v_cvt_pk_bf16_f32 v172, v172, v173
 v_cvt_pk_bf16_f32 v173, v174, v175
 v_fma_f32 v17, v17, s24, v45
 v_exp_f32 v16, v16
 v_mfma_f32_16x16x32_bf16 v[208:211], a[208:211], v[24:27], v[208:211]
 ds_write2st64_b64 v53, v[140:141], v[156:157] offset0:0 offset1:2
 v_cvt_pk_bf16_f32 v188, v188, v189
 v_cvt_pk_bf16_f32 v189, v190, v191
 v_exp_f32 v17, v17
 v_mfma_f32_16x16x32_bf16 v[212:215], a[212:215], v[24:27], v[212:215]
 v_cvt_pk_bf16_f32 v28, v16, v17
 v_fma_f32 v18, v18, s24, v45
 v_mfma_f32_16x16x32_bf16 v[216:219], a[216:219], v[24:27], v[216:219]
 ds_write2st64_b64 v52, v[168:169], v[184:185] offset0:8 offset1:10
 v_fma_f32 v19, v19, s24, v45
 v_exp_f32 v18, v18
 v_mfma_f32_16x16x32_bf16 v[220:223], a[220:223], v[24:27], v[220:223]
 v_exp_f32 v19, v19
 v_mfma_f32_16x16x32_bf16 v[8:11], a[160:163], a[16:19], 0
 ds_write2st64_b64 v53, v[172:173], v[188:189] offset0:8 offset1:10
 v_cvt_pk_bf16_f32 v29, v18, v19
 v_fma_f32 v20, v20, s24, v45
 v_mfma_f32_16x16x32_bf16 v[8:11], a[164:167], a[20:23], v[8:11]
 ds_read_b128 a[128:131], v59 offset:0
 v_fma_f32 v21, v21, s24, v45
 v_exp_f32 v20, v20
 v_mfma_f32_16x16x32_bf16 v[8:11], a[168:171], a[24:27], v[8:11]
 ds_read_b64 a[136:137], v59 offset:2056
 v_exp_f32 v21, v21
 v_mfma_f32_16x16x32_bf16 v[8:11], a[172:175], a[28:31], v[8:11]
 ds_read_b64 a[138:139], v59 offset:2048
 v_cvt_pk_bf16_f32 v30, v20, v21
 v_fma_f32 v22, v22, s24, v45
 v_mfma_f32_16x16x32_bf16 v[12:15], a[188:191], a[28:31], 0
 ds_read_b128 a[132:135], v59 offset:1024
 v_fma_f32 v23, v23, s24, v45
 v_exp_f32 v22, v22
 v_mfma_f32_16x16x32_bf16 v[12:15], a[184:187], a[24:27], v[12:15]
 ds_read_b64 a[140:141], v59 offset:3080
 v_exp_f32 v23, v23
 v_mfma_f32_16x16x32_bf16 v[12:15], a[180:183], a[20:23], v[12:15]
 ds_read_b64 a[142:143], v59 offset:3072
 v_cvt_pk_bf16_f32 v31, v22, v23
 v_mfma_f32_16x16x32_bf16 v[12:15], a[176:179], a[16:19], v[12:15]
 ds_read_b128 a[144:147], v59 offset:4096
 v_fma_f32 v0, v0, s24, v44
 v_smfmac_f32_16x16x64_bf16 a[232:235], a[236:239], v[24:31], v55
 ds_read_b64 a[152:153], v59 offset:6152
 ds_read_b128 a[160:163], v46 offset:49152
 v_mfma_f32_16x16x32_bf16 v[224:227], a[192:195], v[28:31], v[224:227]
 ds_read_b64 a[154:155], v59 offset:6144
 ds_read_b128 a[164:167], v47 offset:49152
 v_mfma_f32_16x16x32_bf16 v[228:231], a[196:199], v[28:31], v[228:231]
 ds_read_b128 a[148:151], v59 offset:5120
 ds_read_b128 a[168:171], v46 offset:50176
 v_mfma_f32_16x16x32_bf16 v[232:235], a[200:203], v[28:31], v[232:235]
 ds_read_b64 a[156:157], v59 offset:7176
 ds_read_b128 a[172:175], v47 offset:50176
 v_mfma_f32_16x16x32_bf16 v[236:239], a[204:207], v[28:31], v[236:239]
 ds_read_b64 a[158:159], v59 offset:7168
 ds_read_b128 a[188:191], v47 offset:54272
 v_fma_f32 v1, v1, s24, v44
 v_exp_f32 v0, v0
 v_mfma_f32_16x16x32_bf16 v[240:243], a[208:211], v[28:31], v[240:243]
 s_waitcnt lgkmcnt(12)
 buffer_store_dwordx4 a[128:131], v58, s[20:23], s31 offen offset:0 sc0 sc1 nt
 ds_read_b128 a[184:187], v46 offset:54272
 v_exp_f32 v1, v1
 v_mfma_f32_16x16x32_bf16 v[244:247], a[212:215], v[28:31], v[244:247]
 ds_read_b128 a[180:183], v47 offset:53248
 v_cvt_pk_bf16_f32 v32, v0, v1
 v_fma_f32 v2, v2, s24, v44
 v_mfma_f32_16x16x32_bf16 v[248:251], a[216:219], v[28:31], v[248:251]
 ds_read_b128 a[176:179], v46 offset:53248
 v_fma_f32 v3, v3, s24, v44
 v_exp_f32 v2, v2
 v_mfma_f32_16x16x32_bf16 v[252:255], a[220:223], v[28:31], v[252:255]
 s_waitcnt lgkmcnt(9)
 ds_read_b64_tr_b16 a[192:193], v48 offset:40960
 ds_read_b64_tr_b16 a[194:195], v48 offset:45056
 v_exp_f32 v3, v3
 v_mfma_f32_16x16x32_bf16 v[16:19], a[160:163], a[0:3], 0
 ds_read_b64_tr_b16 a[196:197], v49 offset:40960
 ds_read_b64_tr_b16 a[198:199], v49 offset:45056
 v_cvt_pk_bf16_f32 v33, v2, v3
 v_fma_f32 v4, v4, s24, v44
 v_mfma_f32_16x16x32_bf16 v[16:19], a[164:167], a[4:7], v[16:19]
 s_waitcnt lgkmcnt(9)
 ds_read_b64_tr_b16 a[200:201], v50 offset:40960
 ds_read_b64_tr_b16 a[202:203], v50 offset:45056
 v_fma_f32 v5, v5, s24, v44
 v_exp_f32 v4, v4
 v_mfma_f32_16x16x32_bf16 v[16:19], a[168:171], a[8:11], v[16:19]
 ds_read_b64_tr_b16 a[204:205], v51 offset:40960
 ds_read_b64_tr_b16 a[206:207], v51 offset:45056
 v_exp_f32 v5, v5
 v_mfma_f32_16x16x32_bf16 v[16:19], a[172:175], a[12:15], v[16:19]
 s_waitcnt lgkmcnt(10)
 buffer_store_dwordx4 a[136:139], v58, s[20:23], s31 offen offset:2048 sc0 sc1 nt
 ds_read_b64_tr_b16 a[208:209], v48 offset:41984
 ds_read_b64_tr_b16 a[210:211], v48 offset:46080
 v_cvt_pk_bf16_f32 v34, v4, v5
 v_fma_f32 v6, v6, s24, v44
 v_mfma_f32_16x16x32_bf16 v[20:23], a[188:191], a[12:15], 0
 ds_read_b64_tr_b16 a[212:213], v49 offset:41984
 ds_read_b64_tr_b16 a[214:215], v49 offset:46080
 v_fma_f32 v7, v7, s24, v44
 v_exp_f32 v6, v6
 v_mfma_f32_16x16x32_bf16 v[20:23], a[184:187], a[8:11], v[20:23]
 s_waitcnt lgkmcnt(12)
 ds_read_b64_tr_b16 a[216:217], v50 offset:41984
 ds_read_b64_tr_b16 a[218:219], v50 offset:46080
 v_exp_f32 v7, v7
 v_mfma_f32_16x16x32_bf16 v[20:23], a[180:183], a[4:7], v[20:23]
 ds_read_b64_tr_b16 a[220:221], v51 offset:41984
 ds_read_b64_tr_b16 a[222:223], v51 offset:46080
 v_cvt_pk_bf16_f32 v35, v6, v7
 v_mfma_f32_16x16x32_bf16 v[20:23], a[176:179], a[0:3], v[20:23]
 s_waitcnt lgkmcnt(12)
 v_fma_f32 v8, v8, s24, v45
 v_fma_f32 v9, v9, s24, v45
 v_mfma_f32_16x16x32_bf16 v[192:195], a[192:195], v[32:35], v[192:195]
 v_exp_f32 v8, v8
 v_mfma_f32_16x16x32_bf16 v[196:199], a[196:199], v[32:35], v[196:199]
 s_waitcnt lgkmcnt(8)
 v_exp_f32 v9, v9
 v_mfma_f32_16x16x32_bf16 v[200:203], a[200:203], v[32:35], v[200:203]
 v_cvt_pk_bf16_f32 v36, v8, v9
 v_fma_f32 v10, v10, s24, v45
 v_mfma_f32_16x16x32_bf16 v[204:207], a[204:207], v[32:35], v[204:207]
 s_waitcnt lgkmcnt(4)
 v_fma_f32 v11, v11, s24, v45
 v_fma_f32 v12, v12, s24, v45
 v_mfma_f32_16x16x32_bf16 v[208:211], a[208:211], v[32:35], v[208:211]
 v_exp_f32 v10, v10
 v_mfma_f32_16x16x32_bf16 v[212:215], a[212:215], v[32:35], v[212:215]
 s_waitcnt lgkmcnt(0)
 v_exp_f32 v11, v11
 v_mfma_f32_16x16x32_bf16 v[216:219], a[216:219], v[32:35], v[216:219]
 v_cvt_pk_bf16_f32 v37, v10, v11
 v_fma_f32 v13, v13, s24, v45
 v_mfma_f32_16x16x32_bf16 v[220:223], a[220:223], v[32:35], v[220:223]
 buffer_store_dwordx4 a[132:135], v58, s[20:23], s31 offen offset:128 sc0 sc1 nt
 v_exp_f32 v12, v12
 v_fma_f32 v14, v14, s24, v45
 v_mfma_f32_16x16x32_bf16 v[0:3], a[160:163], a[16:19], 0
 v_exp_f32 v13, v13
 v_mfma_f32_16x16x32_bf16 v[0:3], a[164:167], a[20:23], v[0:3]
 v_cvt_pk_bf16_f32 v38, v12, v13
 v_fma_f32 v15, v15, s24, v45
 v_mfma_f32_16x16x32_bf16 v[0:3], a[168:171], a[24:27], v[0:3]
 v_exp_f32 v14, v14
 v_mfma_f32_16x16x32_bf16 v[0:3], a[172:175], a[28:31], v[0:3]
 v_exp_f32 v15, v15
 v_mfma_f32_16x16x32_bf16 v[4:7], a[188:191], a[28:31], 0
 v_cvt_pk_bf16_f32 v39, v14, v15
 v_fma_f32 v16, v16, s24, v44
 v_mfma_f32_16x16x32_bf16 v[4:7], a[184:187], a[24:27], v[4:7]
 v_fma_f32 v17, v17, s24, v44
 v_fma_f32 v18, v18, s24, v44
 v_mfma_f32_16x16x32_bf16 v[4:7], a[180:183], a[20:23], v[4:7]
 v_exp_f32 v16, v16
 v_mfma_f32_16x16x32_bf16 v[4:7], a[176:179], a[16:19], v[4:7]
 v_exp_f32 v17, v17
 v_smfmac_f32_16x16x64_bf16 a[232:235], a[236:239], v[32:39], v55
 ds_read_b128 a[160:163], v46 offset:57344
 v_mfma_f32_16x16x32_bf16 v[224:227], a[192:195], v[36:39], v[224:227]
 ds_read_b128 a[164:167], v47 offset:57344
 v_cvt_pk_bf16_f32 v24, v16, v17
 v_mfma_f32_16x16x32_bf16 v[228:231], a[196:199], v[36:39], v[228:231]
 ds_read_b128 a[168:171], v46 offset:58368
 v_fma_f32 v19, v19, s24, v44
 v_mfma_f32_16x16x32_bf16 v[232:235], a[200:203], v[36:39], v[232:235]
 buffer_store_dwordx4 a[140:143], v58, s[20:23], s31 offen offset:2176 sc0 sc1 nt
 ds_read_b128 a[172:175], v47 offset:58368
 v_exp_f32 v18, v18
 v_mfma_f32_16x16x32_bf16 v[236:239], a[204:207], v[36:39], v[236:239]
 s_addk_i32 s31, 4096
 ds_read_b128 a[188:191], v47 offset:62464
 v_fma_f32 v20, v20, s24, v44
 v_mfma_f32_16x16x32_bf16 v[240:243], a[208:211], v[36:39], v[240:243]
 ds_read_b128 a[184:187], v46 offset:62464
 v_fma_f32 v21, v21, s24, v44
 v_mfma_f32_16x16x32_bf16 v[244:247], a[212:215], v[36:39], v[244:247]
 ds_read_b128 a[180:183], v47 offset:61440
 v_fma_f32 v22, v22, s24, v44
 v_mfma_f32_16x16x32_bf16 v[248:251], a[216:219], v[36:39], v[248:251]
 ds_read_b128 a[176:179], v46 offset:61440
 v_fma_f32 v23, v23, s24, v44
 v_mfma_f32_16x16x32_bf16 v[252:255], a[220:223], v[36:39], v[252:255]
 s_waitcnt lgkmcnt(6)
 ds_read_b64_tr_b16 a[192:193], v48 offset:49152
 ds_read_b64_tr_b16 a[194:195], v48 offset:53248
 v_exp_f32 v19, v19
 v_mfma_f32_16x16x32_bf16 v[8:11], a[160:163], a[0:3], 0
 ds_read_b64_tr_b16 a[196:197], v49 offset:49152
 ds_read_b64_tr_b16 a[198:199], v49 offset:53248
 v_cvt_pk_bf16_f32 v25, v18, v19
 v_mfma_f32_16x16x32_bf16 v[8:11], a[164:167], a[4:7], v[8:11]
 s_waitcnt lgkmcnt(8)
 ds_read_b64_tr_b16 a[200:201], v50 offset:49152
 ds_read_b64_tr_b16 a[202:203], v50 offset:53248
 v_exp_f32 v20, v20
 v_mfma_f32_16x16x32_bf16 v[8:11], a[168:171], a[8:11], v[8:11]
 ds_read_b64_tr_b16 a[204:205], v51 offset:49152
 ds_read_b64_tr_b16 a[206:207], v51 offset:53248
 v_exp_f32 v21, v21
 v_mfma_f32_16x16x32_bf16 v[8:11], a[172:175], a[12:15], v[8:11]
 s_waitcnt lgkmcnt(10)
 ds_read_b64_tr_b16 a[208:209], v48 offset:50176
 ds_read_b64_tr_b16 a[210:211], v48 offset:54272
 v_cvt_pk_bf16_f32 v26, v20, v21
 v_mfma_f32_16x16x32_bf16 v[12:15], a[188:191], a[12:15], 0
 ds_read_b64_tr_b16 a[212:213], v49 offset:50176
 ds_read_b64_tr_b16 a[214:215], v49 offset:54272
 v_exp_f32 v22, v22
 v_mfma_f32_16x16x32_bf16 v[12:15], a[184:187], a[8:11], v[12:15]
 s_waitcnt lgkmcnt(12)
 ds_read_b64_tr_b16 a[216:217], v50 offset:50176
 ds_read_b64_tr_b16 a[218:219], v50 offset:54272
 v_exp_f32 v23, v23
 v_mfma_f32_16x16x32_bf16 v[12:15], a[180:183], a[4:7], v[12:15]
 buffer_store_dwordx4 a[144:147], v58, s[20:23], s31 offen offset:0 sc0 sc1 nt
 ds_read_b64_tr_b16 a[220:221], v51 offset:50176
 ds_read_b64_tr_b16 a[222:223], v51 offset:54272
 v_cvt_pk_bf16_f32 v27, v22, v23
 v_mfma_f32_16x16x32_bf16 v[12:15], a[176:179], a[0:3], v[12:15]
 s_waitcnt lgkmcnt(12)
 v_fma_f32 v0, v0, s24, v45
 v_fma_f32 v1, v1, s24, v45
 v_mfma_f32_16x16x32_bf16 v[192:195], a[192:195], v[24:27], v[192:195]
 v_exp_f32 v0, v0
 v_mfma_f32_16x16x32_bf16 v[196:199], a[196:199], v[24:27], v[196:199]
 s_waitcnt lgkmcnt(8)
 v_exp_f32 v1, v1
 v_mfma_f32_16x16x32_bf16 v[200:203], a[200:203], v[24:27], v[200:203]
 v_cvt_pk_bf16_f32 v28, v0, v1
 v_fma_f32 v2, v2, s24, v45
 v_mfma_f32_16x16x32_bf16 v[204:207], a[204:207], v[24:27], v[204:207]
 s_waitcnt lgkmcnt(4)
 v_fma_f32 v3, v3, s24, v45
 v_fma_f32 v4, v4, s24, v45
 v_mfma_f32_16x16x32_bf16 v[208:211], a[208:211], v[24:27], v[208:211]
 v_exp_f32 v2, v2
 v_mfma_f32_16x16x32_bf16 v[212:215], a[212:215], v[24:27], v[212:215]
 s_waitcnt lgkmcnt(0)
 v_exp_f32 v3, v3
 v_mfma_f32_16x16x32_bf16 v[216:219], a[216:219], v[24:27], v[216:219]
 v_cvt_pk_bf16_f32 v29, v2, v3
 v_fma_f32 v5, v5, s24, v45
 v_mfma_f32_16x16x32_bf16 v[220:223], a[220:223], v[24:27], v[220:223]
 v_exp_f32 v4, v4
 v_mfma_f32_16x16x32_bf16 v[16:19], a[160:163], a[16:19], 0
 v_exp_f32 v5, v5
 v_mfma_f32_16x16x32_bf16 v[16:19], a[164:167], a[20:23], v[16:19]
 v_cvt_pk_bf16_f32 v30, v4, v5
 v_fma_f32 v6, v6, s24, v45
 v_mfma_f32_16x16x32_bf16 v[16:19], a[168:171], a[24:27], v[16:19]
 buffer_store_dwordx4 a[152:155], v58, s[20:23], s31 offen offset:2048 sc0 sc1 nt
 v_fma_f32 v8, v8, s24, v44
 v_fma_f32 v7, v7, s24, v45
 v_fma_f32 v9, v9, s24, v44
 v_mfma_f32_16x16x32_bf16 v[16:19], a[172:175], a[28:31], v[16:19]
 v_exp_f32 v6, v6
 v_mfma_f32_16x16x32_bf16 v[20:23], a[188:191], a[28:31], 0
 v_exp_f32 v8, v8
 v_mfma_f32_16x16x32_bf16 v[20:23], a[184:187], a[24:27], v[20:23]
 v_exp_f32 v7, v7
 v_exp_f32 v9, v9
 v_mfma_f32_16x16x32_bf16 v[20:23], a[180:183], a[20:23], v[20:23]
 v_cvt_pk_bf16_f32 v31, v6, v7
 v_cvt_pk_bf16_f32 v32, v8, v9
 v_fma_f32 v10, v10, s24, v44
 v_mfma_f32_16x16x32_bf16 v[20:23], a[176:179], a[16:19], v[20:23]
 v_fma_f32 v11, v11, s24, v44
 v_exp_f32 v10, v10
 v_smfmac_f32_16x16x64_bf16 a[232:235], a[236:239], v[24:31], v55
 v_exp_f32 v11, v11
 v_mfma_f32_16x16x32_bf16 v[224:227], a[192:195], v[28:31], v[224:227]
 ds_read_b64_tr_b16 a[192:193], v48 offset:57344
 ds_read_b64_tr_b16 a[194:195], v48 offset:61440
 v_cvt_pk_bf16_f32 v33, v10, v11
 v_fma_f32 v12, v12, s24, v44
 v_mfma_f32_16x16x32_bf16 v[228:231], a[196:199], v[28:31], v[228:231]
 ds_read_b64_tr_b16 a[196:197], v49 offset:57344
 ds_read_b64_tr_b16 a[198:199], v49 offset:61440
 v_fma_f32 v13, v13, s24, v44
 v_exp_f32 v12, v12
 v_mfma_f32_16x16x32_bf16 v[232:235], a[200:203], v[28:31], v[232:235]
 ds_read_b64_tr_b16 a[200:201], v50 offset:57344
 ds_read_b64_tr_b16 a[202:203], v50 offset:61440
 v_exp_f32 v13, v13
 v_mfma_f32_16x16x32_bf16 v[236:239], a[204:207], v[28:31], v[236:239]
 ds_read_b64_tr_b16 a[204:205], v51 offset:57344
 ds_read_b64_tr_b16 a[206:207], v51 offset:61440
 v_cvt_pk_bf16_f32 v34, v12, v13
 v_fma_f32 v14, v14, s24, v44
 v_fma_f32 v16, v16, s24, v45
 v_mfma_f32_16x16x32_bf16 v[240:243], a[208:211], v[28:31], v[240:243]
 ds_read_b64_tr_b16 a[208:209], v48 offset:58368
 ds_read_b64_tr_b16 a[210:211], v48 offset:62464
 v_fma_f32 v15, v15, s24, v44
 v_exp_f32 v14, v14
 v_fma_f32 v17, v17, s24, v45
 v_exp_f32 v16, v16
 v_mfma_f32_16x16x32_bf16 v[244:247], a[212:215], v[28:31], v[244:247]
 buffer_store_dwordx4 a[148:151], v58, s[20:23], s31 offen offset:128 sc0 sc1 nt
 ds_read_b64_tr_b16 a[212:213], v49 offset:58368
 ds_read_b64_tr_b16 a[214:215], v49 offset:62464
 v_exp_f32 v15, v15
 v_exp_f32 v17, v17
 v_mfma_f32_16x16x32_bf16 v[248:251], a[216:219], v[28:31], v[248:251]
 ds_read_b64_tr_b16 a[216:217], v50 offset:58368
 ds_read_b64_tr_b16 a[218:219], v50 offset:62464
 v_cvt_pk_bf16_f32 v35, v14, v15
 v_cvt_pk_bf16_f32 v36, v16, v17
 v_fma_f32 v18, v18, s24, v45
 v_mfma_f32_16x16x32_bf16 v[252:255], a[220:223], v[28:31], v[252:255]
 ds_read_b64_tr_b16 a[220:221], v51 offset:58368
 ds_read_b64_tr_b16 a[222:223], v51 offset:62464
 v_fma_f32 v19, v19, s24, v45
 v_exp_f32 v18, v18
 v_mfma_f32_16x16x32_bf16 a[232:235], a[240:243], v[32:35], a[232:235]
 s_waitcnt lgkmcnt(12)
 v_exp_f32 v19, v19
 v_mfma_f32_16x16x32_bf16 v[192:195], a[192:195], v[32:35], v[192:195]
 v_cvt_pk_bf16_f32 v37, v18, v19
 v_fma_f32 v20, v20, s24, v45
 v_mfma_f32_16x16x32_bf16 v[196:199], a[196:199], v[32:35], v[196:199]
 s_waitcnt lgkmcnt(8)
 v_fma_f32 v21, v21, s24, v45
 v_exp_f32 v20, v20
 v_mfma_f32_16x16x32_bf16 v[200:203], a[200:203], v[32:35], v[200:203]
 v_exp_f32 v21, v21
 v_mfma_f32_16x16x32_bf16 v[204:207], a[204:207], v[32:35], v[204:207]
 s_waitcnt lgkmcnt(4)
 v_cvt_pk_bf16_f32 v38, v20, v21
 v_fma_f32 v22, v22, s24, v45
 v_mfma_f32_16x16x32_bf16 v[208:211], a[208:211], v[32:35], v[208:211]
 v_fma_f32 v23, v23, s24, v45
 v_exp_f32 v22, v22
 v_mfma_f32_16x16x32_bf16 v[212:215], a[212:215], v[32:35], v[212:215]
 s_waitcnt lgkmcnt(0)
 v_exp_f32 v23, v23
 v_mfma_f32_16x16x32_bf16 v[216:219], a[216:219], v[32:35], v[216:219]
 v_cvt_pk_bf16_f32 v39, v22, v23
 v_accvgpr_read_b32 v60, a232
 v_accvgpr_read_b32 v61, a233
 v_mfma_f32_16x16x32_bf16 v[220:223], a[220:223], v[32:35], v[220:223]
 v_add_f32 v60, v60, v61
 v_cmp_ngt_f32_e64 s[60:61], s25, v60
 v_mfma_f32_16x16x32_bf16 a[232:235], a[244:247], v[36:39], a[232:235]
 buffer_store_dwordx4 a[156:159], v58, s[20:23], s31 offen offset:2176 sc0 sc1 nt
 v_rcp_f32_e64 v60, v60
 v_mfma_f32_16x16x32_bf16 v[224:227], a[192:195], v[36:39], v[224:227]
 s_addk_i32 s31, 4096
 v_mfma_f32_16x16x32_bf16 v[228:231], a[196:199], v[36:39], v[228:231]
 v_pk_mul_f32 v[192:193], v[192:193], v[60:61] op_sel_hi:[1,0]
 v_cvt_pk_bf16_f32 v192, v192, v193
 v_pk_mul_f32 v[194:195], v[194:195], v[60:61] op_sel_hi:[1,0]
 v_cvt_pk_bf16_f32 v193, v194, v195
 v_pk_mul_f32 v[196:197], v[196:197], v[60:61] op_sel_hi:[1,0]
 v_pk_mul_f32 v[198:199], v[198:199], v[60:61] op_sel_hi:[1,0]
 v_pk_mul_f32 v[200:201], v[200:201], v[60:61] op_sel_hi:[1,0]
 v_pk_mul_f32 v[202:203], v[202:203], v[60:61] op_sel_hi:[1,0]
 v_pk_mul_f32 v[204:205], v[204:205], v[60:61] op_sel_hi:[1,0]
 v_pk_mul_f32 v[206:207], v[206:207], v[60:61] op_sel_hi:[1,0]
 v_pk_mul_f32 v[208:209], v[208:209], v[60:61] op_sel_hi:[1,0]
 v_pk_mul_f32 v[210:211], v[210:211], v[60:61] op_sel_hi:[1,0]
 v_pk_mul_f32 v[212:213], v[212:213], v[60:61] op_sel_hi:[1,0]
 v_pk_mul_f32 v[214:215], v[214:215], v[60:61] op_sel_hi:[1,0]
 v_pk_mul_f32 v[216:217], v[216:217], v[60:61] op_sel_hi:[1,0]
 v_pk_mul_f32 v[218:219], v[218:219], v[60:61] op_sel_hi:[1,0]
 v_pk_mul_f32 v[220:221], v[220:221], v[60:61] op_sel_hi:[1,0]
 v_pk_mul_f32 v[222:223], v[222:223], v[60:61] op_sel_hi:[1,0]
 v_mfma_f32_16x16x32_bf16 v[232:235], a[200:203], v[36:39], v[232:235]
 v_cvt_pk_bf16_f32 v208, v208, v209
 v_cvt_pk_bf16_f32 v209, v210, v211
 v_mfma_f32_16x16x32_bf16 v[236:239], a[204:207], v[36:39], v[236:239]
 ds_write2st64_b64 v56, v[192:193], v[208:209] offset0:0 offset1:2
 v_mfma_f32_16x16x32_bf16 v[240:243], a[208:211], v[36:39], v[240:243]
 v_cvt_pk_bf16_f32 v196, v196, v197
 v_cvt_pk_bf16_f32 v197, v198, v199
 v_mfma_f32_16x16x32_bf16 v[244:247], a[212:215], v[36:39], v[244:247]
 v_cvt_pk_bf16_f32 v212, v212, v213
 v_cvt_pk_bf16_f32 v213, v214, v215
 v_mfma_f32_16x16x32_bf16 v[248:251], a[216:219], v[36:39], v[248:251]
 ds_write2st64_b64 v57, v[196:197], v[212:213] offset0:0 offset1:2
 v_cvt_pk_bf16_f32 v200, v200, v201
 v_cvt_pk_bf16_f32 v201, v202, v203
 v_cvt_pk_bf16_f32 v216, v216, v217
 v_cvt_pk_bf16_f32 v217, v218, v219
 v_cvt_pk_bf16_f32 v204, v204, v205
 v_cvt_pk_bf16_f32 v205, v206, v207
 v_cvt_pk_bf16_f32 v220, v220, v221
 v_cvt_pk_bf16_f32 v221, v222, v223
 v_accvgpr_read_b32 v62, a234
 v_accvgpr_read_b32 v61, a235
 v_mfma_f32_16x16x32_bf16 v[252:255], a[220:223], v[36:39], v[252:255]
 ds_write2st64_b64 v52, v[200:201], v[216:217] offset0:0 offset1:2
 ds_write2st64_b64 v53, v[204:205], v[220:221] offset0:0 offset1:2
 ds_read_b128 a[0:3], v59 offset:0
 ds_read_b64 a[8:9], v59 offset:2056
 ds_read_b64 a[10:11], v59 offset:2048
 ds_read_b128 a[4:7], v59 offset:1024
 ds_read_b64 a[12:13], v59 offset:3080
 ds_read_b64 a[14:15], v59 offset:3072
 v_add_f32 v62, v62, v61
 v_cmp_ngt_f32_e64 s[62:63], s25, v62
 v_rcp_f32_e64 v62, v62
 s_waitcnt lgkmcnt(5)
 buffer_store_dwordx4 a[0:3], v58, s[20:23], s31 offen offset:0 sc0 sc1 nt
 v_pk_mul_f32 v[224:225], v[224:225], v[62:63] op_sel_hi:[1,0]
 v_pk_mul_f32 v[226:227], v[226:227], v[62:63] op_sel_hi:[1,0]
 v_pk_mul_f32 v[228:229], v[228:229], v[62:63] op_sel_hi:[1,0]
 v_pk_mul_f32 v[230:231], v[230:231], v[62:63] op_sel_hi:[1,0]
 v_pk_mul_f32 v[232:233], v[232:233], v[62:63] op_sel_hi:[1,0]
 v_pk_mul_f32 v[234:235], v[234:235], v[62:63] op_sel_hi:[1,0]
 v_pk_mul_f32 v[236:237], v[236:237], v[62:63] op_sel_hi:[1,0]
 v_pk_mul_f32 v[238:239], v[238:239], v[62:63] op_sel_hi:[1,0]
 v_cvt_pk_bf16_f32 v224, v224, v225
 v_cvt_pk_bf16_f32 v225, v226, v227
 v_cvt_pk_bf16_f32 v228, v228, v229
 v_cvt_pk_bf16_f32 v229, v230, v231
 v_cvt_pk_bf16_f32 v232, v232, v233
 v_cvt_pk_bf16_f32 v233, v234, v235
 v_cvt_pk_bf16_f32 v236, v236, v237
 v_cvt_pk_bf16_f32 v237, v238, v239
 ds_write_b64 v56, v[224:225] offset:4096
 ds_write_b64 v57, v[228:229] offset:4096
 ds_write_b64 v52, v[232:233] offset:4096
 ds_write_b64 v53, v[236:237] offset:4096
 ds_read_b128 a[16:19], v59 offset:4096
 ds_read_b64 a[24:25], v59 offset:6152
 ds_read_b64 a[26:27], v59 offset:6144
 s_waitcnt lgkmcnt(10)
 buffer_store_dwordx4 a[8:11], v58, s[20:23], s31 offen offset:2048 sc0 sc1 nt
 s_waitcnt lgkmcnt(9)
 buffer_store_dwordx4 a[4:7], v58, s[20:23], s31 offen offset:128 sc0 sc1 nt
 s_waitcnt lgkmcnt(7)
 buffer_store_dwordx4 a[12:15], v58, s[20:23], s31 offen offset:2176 sc0 sc1 nt
 s_addk_i32 s31, 4096
 v_pk_mul_f32 v[240:241], v[240:241], v[62:63] op_sel_hi:[1,0]
 v_pk_mul_f32 v[242:243], v[242:243], v[62:63] op_sel_hi:[1,0]
 v_pk_mul_f32 v[244:245], v[244:245], v[62:63] op_sel_hi:[1,0]
 v_pk_mul_f32 v[246:247], v[246:247], v[62:63] op_sel_hi:[1,0]
 v_pk_mul_f32 v[248:249], v[248:249], v[62:63] op_sel_hi:[1,0]
 v_pk_mul_f32 v[250:251], v[250:251], v[62:63] op_sel_hi:[1,0]
 v_pk_mul_f32 v[252:253], v[252:253], v[62:63] op_sel_hi:[1,0]
 v_pk_mul_f32 v[254:255], v[254:255], v[62:63] op_sel_hi:[1,0]
 v_cvt_pk_bf16_f32 v240, v240, v241
 v_cvt_pk_bf16_f32 v241, v242, v243
 v_cvt_pk_bf16_f32 v244, v244, v245
 v_cvt_pk_bf16_f32 v245, v246, v247
 v_cvt_pk_bf16_f32 v248, v248, v249
 v_cvt_pk_bf16_f32 v249, v250, v251
 v_cvt_pk_bf16_f32 v252, v252, v253
 v_cvt_pk_bf16_f32 v253, v254, v255
 ds_write_b64 v56, v[240:241] offset:5120
 ds_write_b64 v57, v[244:245] offset:5120
 ds_write_b64 v52, v[248:249] offset:5120
 ds_write_b64 v53, v[252:253] offset:5120
 ds_read_b128 a[20:23], v59 offset:5120
 ds_read_b64 a[28:29], v59 offset:7176
 ds_read_b64 a[30:31], v59 offset:7168
 s_waitcnt lgkmcnt(9)
 buffer_store_dwordx4 a[16:19], v58, s[20:23], s31 offen offset:0 sc0 sc1 nt
 s_waitcnt lgkmcnt(7)
 buffer_store_dwordx4 a[24:27], v58, s[20:23], s31 offen offset:2048 sc0 sc1 nt
 s_waitcnt lgkmcnt(2)
 buffer_store_dwordx4 a[20:23], v58, s[20:23], s31 offen offset:128 sc0 sc1 nt
 s_waitcnt lgkmcnt(0)
 buffer_store_dwordx4 a[28:31], v58, s[20:23], s31 offen offset:2176 sc0 sc1 nt
 s_nop 1
    s_or_b64 s[64:65], s[40:41], s[42:43]
    s_or_b64 s[64:65], s[64:65], s[44:45]
    s_or_b64 s[64:65], s[64:65], s[46:47]
    s_or_b64 s[64:65], s[64:65], s[48:49]
    s_or_b64 s[64:65], s[64:65], s[50:51]
    s_or_b64 s[64:65], s[64:65], s[52:53]
    s_or_b64 s[64:65], s[64:65], s[54:55]
    s_or_b64 s[64:65], s[64:65], s[56:57]
    s_or_b64 s[64:65], s[64:65], s[58:59]
    s_or_b64 s[64:65], s[64:65], s[60:61]
    s_or_b64 s[64:65], s[64:65], s[62:63]
    s_cbranch_scc1 L_slow
    s_endpgm
L_slow:
    s_mov_b32 s66, 0
    s_cmp_lg_u64 s[40:41], 0
    s_cselect_b32 s67, 1, 0
    s_or_b32 s66, s66, s67
    s_cmp_lg_u64 s[42:43], 0
    s_cselect_b32 s67, 2, 0
    s_or_b32 s66, s66, s67
    s_cmp_lg_u64 s[44:45], 0
    s_cselect_b32 s67, 4, 0
    s_or_b32 s66, s66, s67
    s_cmp_lg_u64 s[46:47], 0
    s_cselect_b32 s67, 8, 0
    s_or_b32 s66, s66, s67
    s_cmp_lg_u64 s[48:49], 0
    s_cselect_b32 s67, 16, 0
    s_or_b32 s66, s66, s67
    s_cmp_lg_u64 s[50:51], 0
    s_cselect_b32 s67, 32, 0
    s_or_b32 s66, s66, s67
    s_cmp_lg_u64 s[52:53], 0
    s_cselect_b32 s67, 64, 0
    s_or_b32 s66, s66, s67
    s_cmp_lg_u64 s[54:55], 0
    s_cselect_b32 s67, 128, 0
    s_or_b32 s66, s66, s67
    s_cmp_lg_u64 s[56:57], 0
    s_cselect_b32 s67, 256, 0
    s_or_b32 s66, s66, s67
    s_cmp_lg_u64 s[58:59], 0
    s_cselect_b32 s67, 512, 0
    s_or_b32 s66, s66, s67
    s_cmp_lg_u64 s[60:61], 0
    s_cselect_b32 s67, 1024, 0
    s_or_b32 s66, s66, s67
    s_cmp_lg_u64 s[62:63], 0
    s_cselect_b32 s67, 2048, 0
    s_or_b32 s66, s66, s67
    s_waitcnt vmcnt(0) lgkmcnt(0)
    v_mbcnt_lo_u32_b32 v8, -1, 0
    v_mbcnt_hi_u32_b32 v8, -1, v8
    v_and_b32 v9, 15, v8
    v_lshrrev_b32 v10, 4, v8
    v_lshlrev_b32 v11, 4, v10
    v_lshl_add_u32 v14, v9, 8, v11
    v_add_u32 v15, s83, v14
    v_and_b32 v11, 1, v10
    v_lshlrev_b32 v11, 1, v11
    v_lshrrev_b32 v12, 1, v10
    v_or_b32 v11, v11, v12
    v_lshlrev_b32 v11, 4, v11
    v_lshl_add_u32 v11, v9, 8, v11
    v_add_u32 v13, s83, v11
    v_subrev_u32 v16, s81, v54
    s_add_u32 s68, s28, 65536
    v_add_u32 v20, s68, v48
    v_add_u32 v21, s68, v49
    v_add_u32 v22, s68, v50
    v_add_u32 v23, s68, v51
    v_mov_b32 v196, 0x3f803f80
    v_mov_b32 v197, 0x3f803f80
    v_mov_b32 v198, 0x3f803f80
    v_mov_b32 v199, 0x3f803f80
    s_mov_b32 s69, 0
L_slow_tile:
    s_bitcmp1_b32 s66, s69
    s_cbranch_scc0 L_slow_next
    s_cmp_ge_u32 s69, 6
    s_cselect_b32 s70, 0x20000, 0
    s_cselect_b32 s71, 172032, 0
    s_lshl_b32 s72, s69, 12
    s_add_u32 s71, s71, s72
    buffer_load_dwordx4 v[64:67], v15, s[8:11], s71 offen offset:0
    buffer_load_dwordx4 v[68:71], v15, s[8:11], s71 offen offset:64
    buffer_load_dwordx4 v[72:75], v15, s[8:11], s71 offen offset:128
    buffer_load_dwordx4 v[76:79], v15, s[8:11], s71 offen offset:192
    v_mov_b32 v17, 0xff800000
    s_mov_b32 s72, s70
    s_add_u32 s73, s70, 0x20000
L_slow_max:
    buffer_load_dwordx4 v[80:83], v14, s[12:15], s72 offen offset:0
    buffer_load_dwordx4 v[84:87], v14, s[12:15], s72 offen offset:64
    buffer_load_dwordx4 v[88:91], v14, s[12:15], s72 offen offset:128
    buffer_load_dwordx4 v[92:95], v14, s[12:15], s72 offen offset:192
    s_waitcnt vmcnt(0)
    v_mfma_f32_16x16x32_bf16 v[0:3], v[80:83], v[64:67], 0
    v_mfma_f32_16x16x32_bf16 v[0:3], v[84:87], v[68:71], v[0:3]
    v_mfma_f32_16x16x32_bf16 v[0:3], v[88:91], v[72:75], v[0:3]
    v_mfma_f32_16x16x32_bf16 v[0:3], v[92:95], v[76:79], v[0:3]
    s_nop 15
    v_max3_f32 v17, v17, v0, v1
    v_max3_f32 v17, v17, v2, v3
    s_add_u32 s72, s72, 4096
    s_cmp_lt_u32 s72, s73
    s_cbranch_scc1 L_slow_max
    v_mov_b32 v18, v17
    s_nop 1
    v_permlane16_swap_b32 v17, v18
    s_nop 1
    v_max_f32 v17, v17, v18
    v_mov_b32 v18, v17
    s_nop 1
    v_permlane32_swap_b32 v17, v18
    s_nop 1
    v_max_f32 v17, v17, v18
    v_mul_f32 v17, 0xbe0293ee, v17
    v_mov_b32 v160, 0
    v_mov_b32 v161, 0
    v_mov_b32 v162, 0
    v_mov_b32 v163, 0
    v_mov_b32 v164, 0
    v_mov_b32 v165, 0
    v_mov_b32 v166, 0
    v_mov_b32 v167, 0
    v_mov_b32 v168, 0
    v_mov_b32 v169, 0
    v_mov_b32 v170, 0
    v_mov_b32 v171, 0
    v_mov_b32 v172, 0
    v_mov_b32 v173, 0
    v_mov_b32 v174, 0
    v_mov_b32 v175, 0
    v_mov_b32 v176, 0
    v_mov_b32 v177, 0
    v_mov_b32 v178, 0
    v_mov_b32 v179, 0
    v_mov_b32 v180, 0
    v_mov_b32 v181, 0
    v_mov_b32 v182, 0
    v_mov_b32 v183, 0
    v_mov_b32 v184, 0
    v_mov_b32 v185, 0
    v_mov_b32 v186, 0
    v_mov_b32 v187, 0
    v_mov_b32 v188, 0
    v_mov_b32 v189, 0
    v_mov_b32 v190, 0
    v_mov_b32 v191, 0
    v_mov_b32 v192, 0
    v_mov_b32 v193, 0
    v_mov_b32 v194, 0
    v_mov_b32 v195, 0
    s_mov_b32 s72, s70
L_slow_blk:
    s_add_u32 s74, s72, 4096
    buffer_load_dwordx4 v[80:83], v14, s[12:15], s72 offen offset:0
    buffer_load_dwordx4 v[84:87], v14, s[12:15], s72 offen offset:64
    buffer_load_dwordx4 v[88:91], v14, s[12:15], s72 offen offset:128
    buffer_load_dwordx4 v[92:95], v14, s[12:15], s72 offen offset:192
    buffer_load_dwordx4 v[96:99], v14, s[12:15], s74 offen offset:0
    buffer_load_dwordx4 v[100:103], v14, s[12:15], s74 offen offset:64
    buffer_load_dwordx4 v[104:107], v14, s[12:15], s74 offen offset:128
    buffer_load_dwordx4 v[108:111], v14, s[12:15], s74 offen offset:192
    s_add_u32 m0, s28, 131072
    s_nop 0
    buffer_load_dwordx4 v16, s[16:19], s72 offen offset:0 lds
    buffer_load_dwordx4 v16, s[16:19], s72 offen offset:2048 lds
    s_add_u32 m0, s28, 131968
    s_nop 0
    buffer_load_dwordx4 v16, s[16:19], s72 offen offset:128 lds
    buffer_load_dwordx4 v16, s[16:19], s72 offen offset:2176 lds
    s_add_u32 m0, s28, 135168
    s_nop 0
    buffer_load_dwordx4 v16, s[16:19], s74 offen offset:0 lds
    buffer_load_dwordx4 v16, s[16:19], s74 offen offset:2048 lds
    s_add_u32 m0, s28, 136064
    s_nop 0
    buffer_load_dwordx4 v16, s[16:19], s74 offen offset:128 lds
    buffer_load_dwordx4 v16, s[16:19], s74 offen offset:2176 lds
    s_waitcnt vmcnt(0)
    ds_read_b64_tr_b16 v[112:113], v20 offset:0
    ds_read_b64_tr_b16 v[114:115], v20 offset:4096
    ds_read_b64_tr_b16 v[116:117], v21 offset:0
    ds_read_b64_tr_b16 v[118:119], v21 offset:4096
    ds_read_b64_tr_b16 v[120:121], v22 offset:0
    ds_read_b64_tr_b16 v[122:123], v22 offset:4096
    ds_read_b64_tr_b16 v[124:125], v23 offset:0
    ds_read_b64_tr_b16 v[126:127], v23 offset:4096
    ds_read_b64_tr_b16 v[128:129], v20 offset:1024
    ds_read_b64_tr_b16 v[130:131], v20 offset:5120
    ds_read_b64_tr_b16 v[132:133], v21 offset:1024
    ds_read_b64_tr_b16 v[134:135], v21 offset:5120
    ds_read_b64_tr_b16 v[136:137], v22 offset:1024
    ds_read_b64_tr_b16 v[138:139], v22 offset:5120
    ds_read_b64_tr_b16 v[140:141], v23 offset:1024
    ds_read_b64_tr_b16 v[142:143], v23 offset:5120
    v_mfma_f32_16x16x32_bf16 v[0:3], v[80:83], v[64:67], 0
    v_mfma_f32_16x16x32_bf16 v[0:3], v[84:87], v[68:71], v[0:3]
    v_mfma_f32_16x16x32_bf16 v[0:3], v[88:91], v[72:75], v[0:3]
    v_mfma_f32_16x16x32_bf16 v[0:3], v[92:95], v[76:79], v[0:3]
    v_mfma_f32_16x16x32_bf16 v[4:7], v[96:99], v[64:67], 0
    v_mfma_f32_16x16x32_bf16 v[4:7], v[100:103], v[68:71], v[4:7]
    v_mfma_f32_16x16x32_bf16 v[4:7], v[104:107], v[72:75], v[4:7]
    v_mfma_f32_16x16x32_bf16 v[4:7], v[108:111], v[76:79], v[4:7]
    s_nop 15
    v_fma_f32 v0, v0, s24, v17
    v_fma_f32 v1, v1, s24, v17
    v_fma_f32 v2, v2, s24, v17
    v_fma_f32 v3, v3, s24, v17
    v_fma_f32 v4, v4, s24, v17
    v_fma_f32 v5, v5, s24, v17
    v_fma_f32 v6, v6, s24, v17
    v_fma_f32 v7, v7, s24, v17
    v_exp_f32 v0, v0
    v_exp_f32 v1, v1
    v_exp_f32 v2, v2
    v_exp_f32 v3, v3
    v_exp_f32 v4, v4
    v_exp_f32 v5, v5
    v_exp_f32 v6, v6
    v_exp_f32 v7, v7
    s_nop 1
    v_cvt_pk_bf16_f32 v24, v0, v1
    v_cvt_pk_bf16_f32 v25, v2, v3
    v_cvt_pk_bf16_f32 v26, v4, v5
    v_cvt_pk_bf16_f32 v27, v6, v7
    s_waitcnt lgkmcnt(0)
    s_nop 1
    v_mfma_f32_16x16x32_bf16 v[160:163], v[112:115], v[24:27], v[160:163]
    v_mfma_f32_16x16x32_bf16 v[164:167], v[116:119], v[24:27], v[164:167]
    v_mfma_f32_16x16x32_bf16 v[168:171], v[120:123], v[24:27], v[168:171]
    v_mfma_f32_16x16x32_bf16 v[172:175], v[124:127], v[24:27], v[172:175]
    v_mfma_f32_16x16x32_bf16 v[176:179], v[128:131], v[24:27], v[176:179]
    v_mfma_f32_16x16x32_bf16 v[180:183], v[132:135], v[24:27], v[180:183]
    v_mfma_f32_16x16x32_bf16 v[184:187], v[136:139], v[24:27], v[184:187]
    v_mfma_f32_16x16x32_bf16 v[188:191], v[140:143], v[24:27], v[188:191]
    v_mfma_f32_16x16x32_bf16 v[192:195], v[196:199], v[24:27], v[192:195]
    s_add_u32 s72, s72, 8192
    s_cmp_lt_u32 s72, s73
    s_cbranch_scc1 L_slow_blk
    s_nop 15
    v_rcp_f32 v18, v192
    s_nop 1
    v_mul_f32 v160, v160, v18
    v_mul_f32 v161, v161, v18
    v_mul_f32 v162, v162, v18
    v_mul_f32 v163, v163, v18
    v_mul_f32 v164, v164, v18
    v_mul_f32 v165, v165, v18
    v_mul_f32 v166, v166, v18
    v_mul_f32 v167, v167, v18
    v_mul_f32 v168, v168, v18
    v_mul_f32 v169, v169, v18
    v_mul_f32 v170, v170, v18
    v_mul_f32 v171, v171, v18
    v_mul_f32 v172, v172, v18
    v_mul_f32 v173, v173, v18
    v_mul_f32 v174, v174, v18
    v_mul_f32 v175, v175, v18
    v_mul_f32 v176, v176, v18
    v_mul_f32 v177, v177, v18
    v_mul_f32 v178, v178, v18
    v_mul_f32 v179, v179, v18
    v_mul_f32 v180, v180, v18
    v_mul_f32 v181, v181, v18
    v_mul_f32 v182, v182, v18
    v_mul_f32 v183, v183, v18
    v_mul_f32 v184, v184, v18
    v_mul_f32 v185, v185, v18
    v_mul_f32 v186, v186, v18
    v_mul_f32 v187, v187, v18
    v_mul_f32 v188, v188, v18
    v_mul_f32 v189, v189, v18
    v_mul_f32 v190, v190, v18
    v_mul_f32 v191, v191, v18
    v_cvt_pk_bf16_f32 v160, v160, v161
    v_cvt_pk_bf16_f32 v161, v162, v163
    v_cvt_pk_bf16_f32 v162, v164, v165
    v_cvt_pk_bf16_f32 v163, v166, v167
    s_nop 1
    v_permlane16_swap_b32 v160, v162
    v_permlane16_swap_b32 v161, v163
    buffer_store_dwordx4 v[160:163], v13, s[20:23], s71 offen offset:0
    v_cvt_pk_bf16_f32 v168, v168, v169
    v_cvt_pk_bf16_f32 v169, v170, v171
    v_cvt_pk_bf16_f32 v170, v172, v173
    v_cvt_pk_bf16_f32 v171, v174, v175
    s_nop 1
    v_permlane16_swap_b32 v168, v170
    v_permlane16_swap_b32 v169, v171
    buffer_store_dwordx4 v[168:171], v13, s[20:23], s71 offen offset:64
    v_cvt_pk_bf16_f32 v176, v176, v177
    v_cvt_pk_bf16_f32 v177, v178, v179
    v_cvt_pk_bf16_f32 v178, v180, v181
    v_cvt_pk_bf16_f32 v179, v182, v183
    s_nop 1
    v_permlane16_swap_b32 v176, v178
    v_permlane16_swap_b32 v177, v179
    buffer_store_dwordx4 v[176:179], v13, s[20:23], s71 offen offset:128
    v_cvt_pk_bf16_f32 v184, v184, v185
    v_cvt_pk_bf16_f32 v185, v186, v187
    v_cvt_pk_bf16_f32 v186, v188, v189
    v_cvt_pk_bf16_f32 v187, v190, v191
    s_nop 1
    v_permlane16_swap_b32 v184, v186
    v_permlane16_swap_b32 v185, v187
    buffer_store_dwordx4 v[184:187], v13, s[20:23], s71 offen offset:192
    s_waitcnt vmcnt(0)
L_slow_next:
    s_add_u32 s69, s69, 1
    s_cmp_lt_u32 s69, 12
    s_cbranch_scc1 L_slow_tile
L_end:
    s_endpgm
.section .rodata,"a"
.p2align 6
.amdhsa_kernel standalone__gqa_softmax__near_ridge_kernel
  .amdhsa_next_free_vgpr 512
  .amdhsa_next_free_sgpr 102
  .amdhsa_accum_offset 256
  .amdhsa_group_segment_fixed_size 0
  .amdhsa_kernarg_size 48
  .amdhsa_user_sgpr_count 2
  .amdhsa_user_sgpr_kernarg_segment_ptr 1
  .amdhsa_system_sgpr_workgroup_id_x 1
.end_amdhsa_kernel
```
